```python
import torch

def _softmax(x, axis=-1):
    return torch.softmax(x, dim=axis)
def _gelu(x):
    return torch.nn.functional.gelu(x, approximate="tanh")
def _silu(x):
    return torch.nn.functional.silu(x)
def _sigmoid(x):
    return torch.sigmoid(x)
def _layernorm(x, axis=-1, eps=1e-5):
    m = x.mean(dim=axis, keepdim=True)
    v = x.var(dim=axis, keepdim=True, unbiased=False)
    return (x - m) / torch.sqrt(v + eps)
def _scatter_add(tgt, idx, src, axis=0):
    return tgt.clone().index_add_(axis, idx, src)
def _segment_sum(src, seg, n):
    out = torch.zeros((n,) + src.shape[1:], dtype=src.dtype)
    return out.index_add_(0, seg, src)
def _pad(x, pw):
    flat = tuple(v for pair in reversed(pw) for v in pair)
    return torch.nn.functional.pad(x, flat)

kernel_name = 'recurrent_scan__mha_block_cached__dense_activation_silu__prompt'

def setup_inputs():

    _w = (lambda a: (lambda t: t.to(torch.bfloat16) if t.is_floating_point() else t)(torch.as_tensor(a)))
    def _A_setup():
        B, Sq, D = 1, 2048, 1024
        H, Sk, Dh = 32, 2048, 128
        return {
            "x": _w((lambda *s: torch.randn(*s, dtype=torch.bfloat16) * 0.05)(B, Sq, D)),
            "k_cache": _w((lambda *s: torch.randn(*s, dtype=torch.bfloat16) * 3.2)(B, H, Sk, Dh)),
            "v_cache": _w((lambda *s: torch.randn(*s, dtype=torch.bfloat16) * 3.2)(B, H, Sk, Dh)),
            "wq": _w((lambda *s: torch.randn(*s, dtype=torch.bfloat16) * 3.2)(D, H * Dh) * (D ** -0.5)),
            "wo": _w((lambda *s: torch.randn(*s, dtype=torch.bfloat16) * 3.2)(H * Dh, D) * ((H * Dh) ** -0.5)),
        }
    _A_in = _A_setup()

    def _B_setup():
        B, S, D, F = 1, 2048, 1024, 3584
        return {
            "x": _w((lambda *s: torch.randn(*s, dtype=torch.bfloat16) * 0.05)(B, S, D)),
            "w1": _w((lambda *s: torch.randn(*s, dtype=torch.bfloat16) * 3.2)(D, F) * (D ** -0.5)),
            "w2": _w((lambda *s: torch.randn(*s, dtype=torch.bfloat16) * 0.4)(F, D) * (F ** -0.5)),
        }
    _B_in = _B_setup()

    return {
        "A_x": _A_in["x"],
        "A_k_cache": _A_in["k_cache"],
        "A_v_cache": _A_in["v_cache"],
        "A_wq": _A_in["wq"],
        "A_wo": _A_in["wo"],
        "B_x": _B_in["x"],
        "B_w1": _B_in["w1"],
        "B_w2": _B_in["w2"],
    }

def reference(A_x, A_k_cache, A_v_cache, A_wq, A_wo, B_x, B_w1, B_w2):
    def _A_ref(x, k_cache, v_cache, wq, wo):
        B, Sq, D = x.shape
        H, Dh = 32, 128
        q = (lambda x, *d: x.permute(*d))((x @ wq).reshape(B, Sq, H, Dh), 0, 2, 1, 3)
        scores = torch.einsum("bhqd,bhkd->bhqk", q, k_cache) * (Dh ** -0.5)
        p = _softmax(scores, axis=-1)
        o = torch.einsum("bhqk,bhkd->bhqd", p, v_cache)
        return (lambda x, *d: x.permute(*d))(o, 0, 2, 1, 3).reshape(B, Sq, H * Dh) @ wo

    def _B_ref(x, w1, w2):
        h = torch.einsum("bsd,df->bsf", x, w1)
        h = _silu(h)
        out = torch.einsum("bsf,fd->bsd", h, w2)
        return out

    x = A_x
    xn = _layernorm(x, axis=-1)
    s = _A_ref(xn, A_k_cache, A_v_cache, A_wq, A_wo)
    g = _silu(_B_ref(xn, B_w1, B_w2))
    return x + s * g
```

```asm
; @launch grid=(256,1,1) block=(256,1,1) lds=135424
.amdgcn_target "amdgcn-amd-amdhsa--gfx950"
.text
.globl recurrent_scan__mha_block_cached__dense_activation_silu__prompt_kernel
.p2align 8
.type recurrent_scan__mha_block_cached__dense_activation_silu__prompt_kernel,@function
recurrent_scan__mha_block_cached__dense_activation_silu__prompt_kernel:
    s_cmp_ge_u32 s2, 256
    s_cbranch_scc1 L_end
    s_load_dwordx16 s[72:87], s[0:1], 0
    s_load_dwordx4 s[88:91], s[0:1], 64
    s_load_dwordx2 s[92:93], s[0:1], 80
    v_and_b32 v242, 63, v0
    v_lshrrev_b32 v216, 6, v0
    s_nop 0
    v_readfirstlane_b32 s54, v216
    s_and_b32 s58, s2, 7
    s_lshr_b32 s59, s2, 3
    s_lshr_b32 s57, s59, 2
    s_and_b32 s59, s59, 3
    s_lshl_b32 s55, s58, 2
    s_add_u32 s55, s55, s59
    s_lshl_b32 s62, s57, 5
    s_add_u32 s62, s62, s55
    s_lshl_b32 s62, s62, 3
    v_and_b32 v48, 7, v242
    v_add_u32 v49, s62, v48
    v_lshrrev_b32 v50, 3, v242
    s_lshl_b32 s63, s54, 3
    v_add_u32 v50, s63, v50
    v_lshlrev_b32 v51, 11, v49
    v_lshl_add_u32 v52, v50, 6, v51
    s_mov_b32 s34, 4194304
    s_mov_b32 s35, 0x20000
    s_waitcnt lgkmcnt(0)
    s_mov_b32 s32, s72
    s_mov_b32 s33, s73
    buffer_load_dwordx4 v[0:3], v52, s[32:35], 0 offen
    buffer_load_dwordx4 v[4:7], v52, s[32:35], 0 offen offset:16
    buffer_load_dwordx4 v[8:11], v52, s[32:35], 0 offen offset:32
    buffer_load_dwordx4 v[12:15], v52, s[32:35], 0 offen offset:48
    buffer_load_dword v53, v51, s[32:35], 0 offen
    s_mul_i32 s56, s58, 3
    s_add_u32 s56, s56, 4
    s_add_u32 s56, s56, s59
    s_mov_b32 s14, 7340032
    s_mov_b32 s26, 14680064
    s_cmp_eq_u32 s59, 3
    s_cmov_b32 s14, 0
    s_cmov_b32 s26, 0
    s_cmp_lt_u32 s58, 4
    s_cmov_b32 s56, s55
    s_cmov_b32 s14, 7340032
    s_cmov_b32 s26, 14680064
    s_mul_i32 s53, s54, 4224
    v_lshrrev_b32 v252, 4, v242
    v_and_b32 v217, 15, v242
    v_lshlrev_b32 v218, 4, v217
    v_lshl_add_u32 v160, v252, 17, v218
    s_lshl_b32 s62, s54, 15
    s_lshl_b32 s63, s55, 8
    s_add_u32 s62, s62, s63
    v_add_u32 v160, s62, v160
    v_add_u32 v161, 7136, v160
    v_add_u32 v162, 14272, v160
    v_add_u32 v163, 21408, v160
    v_mul_u32_u24 v164, 114688, v252
    v_add_u32 v164, v164, v218
    s_mul_i32 s62, s54, 28672
    s_lshl_b32 s63, s56, 8
    s_add_u32 s62, s62, s63
    v_add_u32 v164, s62, v164
    v_add_u32 v165, 6112, v164
    v_add_u32 v166, 12224, v164
    v_add_u32 v167, 18336, v164
    s_mov_b32 s48, 0
    s_mov_b32 s49, 0
    s_mov_b32 s50, 0
    s_mov_b32 s8, s78
    s_mov_b32 s9, s79
    s_mov_b32 s10, 8388608
    s_mov_b32 s11, 0x20000
    s_mov_b32 s12, s84
    s_mov_b32 s13, s85
    s_mov_b32 s15, 0x20000
    s_add_u32 s40, s92, 41943040
    s_addc_u32 s41, s93, 0
    s_mov_b32 s42, 4096
    s_mov_b32 s43, 0x20000
    s_and_b32 s62, s2, 4
    s_add_u32 s62, s62, s59
    s_lshl_b32 s62, s62, 2
    s_and_b32 s63, s2, 3
    s_add_u32 s62, s62, s63
    s_mov_b32 s3, s62
    s_lshl_b32 s98, s57, 9
    v_mov_b32 v57, s55
    v_mov_b32 v58, s62
    v_cmp_le_u32 vcc, 2, v242
    v_lshlrev_b32 v59, 7, v242
    v_mov_b32 v60, 0
    v_cndmask_b32 v57, v57, v58, vcc
    v_lshl_add_u32 v57, v57, 2, v59
    s_cmp_lg_u32 s54, 0
    s_cbranch_scc1 L_sgz
    s_mov_b64 exec, 15
    buffer_store_dword v60, v57, s[40:43], s98 offen sc1
    s_mov_b64 exec, -1
L_sgz:
    s_mov_b32 s4, s92
    s_mov_b32 s5, s93
    s_mov_b32 s6, 94371840
    s_mov_b32 s7, 0x20000
    s_mov_b32 s36, s90
    s_mov_b32 s37, s91
    s_mov_b32 s38, 256
    s_mov_b32 s39, 0x20000
    s_mov_b32 s16, s74
    s_mov_b32 s17, s75
    s_mov_b32 s18, 16777216
    s_mov_b32 s19, 0x20000
    s_mov_b32 s20, s76
    s_mov_b32 s21, s77
    s_mov_b32 s22, 16777216
    s_mov_b32 s23, 0x20000
    s_add_u32 s24, s92, 5242880
    s_addc_u32 s25, s93, 0
    s_mov_b32 s27, 0x20000
    s_add_u32 s28, s92, 20971520
    s_addc_u32 s29, s93, 0
    s_mov_b32 s30, 16777216
    s_mov_b32 s31, 0x20000
    s_mov_b32 s40, s80
    s_mov_b32 s41, s81
    s_mov_b32 s42, 8388608
    s_mov_b32 s43, 0x20000
    s_mov_b32 s44, s86
    s_mov_b32 s45, s87
    s_mov_b32 s46, 7340032
    s_mov_b32 s47, 0x20000
    s_mov_b32 s100, s88
    s_mov_b32 s101, s89
    v_lshrrev_b32 v54, 4, v49
    v_mul_u32_u24 v54, 32768, v54
    v_lshl_add_u32 v54, v50, 10, v54
    v_and_b32 v55, 15, v49
    v_lshl_add_u32 v54, v55, 4, v54
    v_lshlrev_b32 v55, 3, v48
    v_add_u32 v55, 135168, v55
    s_lshl_b32 s62, s54, 6
    v_add_u32 v56, s62, v55
    s_lshl_b32 s99, s57, 2
    s_add_u32 s99, s99, s54
    s_mul_i32 s62, s99, 131072
    v_lshlrev_b32 v243, 4, v242
    v_add_u32 v168, s62, v243
    v_add_u32 v169, 32768, v168
    v_add_u32 v170, 65536, v168
    v_add_u32 v171, 98304, v168
    v_lshl_add_u32 v240, v252, 12, v218
    s_lshl_b32 s62, s54, 10
    v_add_u32 v240, s62, v240
    s_lshl_b32 s51, s55, 19
    s_mov_b32 s52, s51
    s_lshl_b32 s62, s2, 2
    s_add_u32 s62, s62, s54
    s_lshl_b32 s65, s62, 13
    v_lshlrev_b32 v254, 7, v242
    v_mov_b32 v255, 0x40000000
    v_cmp_gt_u32 vcc, 10, v242
    s_mov_b32 s61, 746586112
    s_mov_b32 s66, 1040356334
    v_cndmask_b32 v254, v255, v254, vcc
    s_mov_b32 s67, 1040356334
    s_mov_b32 s70, 0xbfb8aa3b
    s_mov_b32 s71, 0xbfb8aa3b
    v_lshrrev_b32 v218, 2, v242
    v_mul_u32_u24 v218, 1056, v218
    v_and_b32 v219, 3, v242
    v_lshl_add_u32 v238, v219, 3, v218
    v_add_u32 v239, 67584, v238
    v_lshl_add_u32 v172, v219, 4, v218
    v_add_u32 v173, 67584, v172
    v_mul_u32_u24 v236, 1056, v217
    v_lshl_add_u32 v236, v252, 4, v236
    v_add_u32 v237, 67584, v236
    s_mov_b32 s62, 0xffff0000
    s_mov_b32 s63, 0x3a800000
    v_mov_b32 v244, 0x3f803f80
    v_cmp_eq_u32 vcc, 0, v217
    s_nop 1
    v_cndmask_b32 v244, 0, v244, vcc
    v_mov_b32 v224, 0
    v_mov_b32 v248, -1
    v_mov_b32 v245, v244
    v_mov_b32 v225, 0
    v_mov_b32 v249, -1
    v_mov_b32 v246, v244
    v_mov_b32 v226, 0
    v_mov_b32 v250, -1
    v_mov_b32 v247, v244
    v_mov_b32 v227, 0
    v_mov_b32 v251, -1
    s_waitcnt vmcnt(0)
    s_add_u32 m0, s53, 0
    s_mov_b32 s49, 0
    s_nop 0
    buffer_load_dwordx4 v160, s[8:11], s49 offen offset:0 lds
    buffer_load_dwordx4 v161, s[8:11], s49 offen offset:1056 lds
    buffer_load_dwordx4 v162, s[8:11], s49 offen offset:2112 lds
    buffer_load_dwordx4 v163, s[8:11], s49 offen offset:3168 lds
    s_add_u32 m0, s53, 16896
    s_mov_b32 s49, 0
    s_nop 0
    buffer_load_dwordx4 v164, s[12:15], s49 offen offset:0 lds
    buffer_load_dwordx4 v165, s[12:15], s49 offen offset:1056 lds
    buffer_load_dwordx4 v166, s[12:15], s49 offen offset:2112 lds
    buffer_load_dwordx4 v167, s[12:15], s49 offen offset:3168 lds
    v_lshlrev_b32 v16, 16, v0
    v_and_b32 v17, s62, v0
    v_lshlrev_b32 v18, 16, v1
    v_and_b32 v19, s62, v1
    v_lshlrev_b32 v20, 16, v2
    v_and_b32 v21, s62, v2
    v_lshlrev_b32 v22, 16, v3
    v_and_b32 v23, s62, v3
    v_lshlrev_b32 v24, 16, v4
    v_and_b32 v25, s62, v4
    v_lshlrev_b32 v26, 16, v5
    v_and_b32 v27, s62, v5
    v_lshlrev_b32 v28, 16, v6
    v_and_b32 v29, s62, v6
    v_lshlrev_b32 v30, 16, v7
    v_and_b32 v31, s62, v7
    v_lshlrev_b32 v32, 16, v8
    v_and_b32 v33, s62, v8
    v_lshlrev_b32 v34, 16, v9
    v_and_b32 v35, s62, v9
    v_lshlrev_b32 v36, 16, v10
    v_and_b32 v37, s62, v10
    v_lshlrev_b32 v38, 16, v11
    v_and_b32 v39, s62, v11
    v_lshlrev_b32 v40, 16, v12
    v_and_b32 v41, s62, v12
    v_lshlrev_b32 v42, 16, v13
    v_and_b32 v43, s62, v13
    v_lshlrev_b32 v44, 16, v14
    v_and_b32 v45, s62, v14
    v_lshlrev_b32 v46, 16, v15
    v_and_b32 v47, s62, v15
    v_lshlrev_b32 v58, 16, v53
    v_lshlrev_b32 v59, 16, v53
    v_pk_add_f32 v[60:61], v[16:17], v[58:59] neg_lo:[0,1] neg_hi:[0,1]
    v_pk_mul_f32 v[62:63], v[60:61], v[60:61]
    v_pk_add_f32 v[66:67], v[18:19], v[58:59] neg_lo:[0,1] neg_hi:[0,1]
    v_pk_add_f32 v[60:61], v[60:61], v[66:67]
    v_pk_fma_f32 v[62:63], v[66:67], v[66:67], v[62:63]
    v_pk_add_f32 v[64:65], v[20:21], v[58:59] neg_lo:[0,1] neg_hi:[0,1]
    v_pk_add_f32 v[60:61], v[60:61], v[64:65]
    v_pk_fma_f32 v[62:63], v[64:65], v[64:65], v[62:63]
    v_pk_add_f32 v[66:67], v[22:23], v[58:59] neg_lo:[0,1] neg_hi:[0,1]
    v_pk_add_f32 v[60:61], v[60:61], v[66:67]
    v_pk_fma_f32 v[62:63], v[66:67], v[66:67], v[62:63]
    v_pk_add_f32 v[64:65], v[24:25], v[58:59] neg_lo:[0,1] neg_hi:[0,1]
    v_pk_add_f32 v[60:61], v[60:61], v[64:65]
    v_pk_fma_f32 v[62:63], v[64:65], v[64:65], v[62:63]
    v_pk_add_f32 v[66:67], v[26:27], v[58:59] neg_lo:[0,1] neg_hi:[0,1]
    v_pk_add_f32 v[60:61], v[60:61], v[66:67]
    v_pk_fma_f32 v[62:63], v[66:67], v[66:67], v[62:63]
    v_pk_add_f32 v[64:65], v[28:29], v[58:59] neg_lo:[0,1] neg_hi:[0,1]
    v_pk_add_f32 v[60:61], v[60:61], v[64:65]
    v_pk_fma_f32 v[62:63], v[64:65], v[64:65], v[62:63]
    v_pk_add_f32 v[66:67], v[30:31], v[58:59] neg_lo:[0,1] neg_hi:[0,1]
    v_pk_add_f32 v[60:61], v[60:61], v[66:67]
    v_pk_fma_f32 v[62:63], v[66:67], v[66:67], v[62:63]
    v_pk_add_f32 v[64:65], v[32:33], v[58:59] neg_lo:[0,1] neg_hi:[0,1]
    v_pk_add_f32 v[60:61], v[60:61], v[64:65]
    v_pk_fma_f32 v[62:63], v[64:65], v[64:65], v[62:63]
    v_pk_add_f32 v[66:67], v[34:35], v[58:59] neg_lo:[0,1] neg_hi:[0,1]
    v_pk_add_f32 v[60:61], v[60:61], v[66:67]
    v_pk_fma_f32 v[62:63], v[66:67], v[66:67], v[62:63]
    v_pk_add_f32 v[64:65], v[36:37], v[58:59] neg_lo:[0,1] neg_hi:[0,1]
    v_pk_add_f32 v[60:61], v[60:61], v[64:65]
    v_pk_fma_f32 v[62:63], v[64:65], v[64:65], v[62:63]
    v_pk_add_f32 v[66:67], v[38:39], v[58:59] neg_lo:[0,1] neg_hi:[0,1]
    v_pk_add_f32 v[60:61], v[60:61], v[66:67]
    v_pk_fma_f32 v[62:63], v[66:67], v[66:67], v[62:63]
    v_pk_add_f32 v[64:65], v[40:41], v[58:59] neg_lo:[0,1] neg_hi:[0,1]
    v_pk_add_f32 v[60:61], v[60:61], v[64:65]
    v_pk_fma_f32 v[62:63], v[64:65], v[64:65], v[62:63]
    v_pk_add_f32 v[66:67], v[42:43], v[58:59] neg_lo:[0,1] neg_hi:[0,1]
    v_pk_add_f32 v[60:61], v[60:61], v[66:67]
    v_pk_fma_f32 v[62:63], v[66:67], v[66:67], v[62:63]
    v_pk_add_f32 v[64:65], v[44:45], v[58:59] neg_lo:[0,1] neg_hi:[0,1]
    v_pk_add_f32 v[60:61], v[60:61], v[64:65]
    v_pk_fma_f32 v[62:63], v[64:65], v[64:65], v[62:63]
    v_pk_add_f32 v[66:67], v[46:47], v[58:59] neg_lo:[0,1] neg_hi:[0,1]
    v_pk_add_f32 v[60:61], v[60:61], v[66:67]
    v_pk_fma_f32 v[62:63], v[66:67], v[66:67], v[62:63]
    v_add_f32 v60, v60, v61
    v_add_f32 v61, v62, v63
    s_nop 1
    v_add_f32_dpp v60, v60, v60 row_ror:8 row_mask:0xf bank_mask:0xf
    v_add_f32_dpp v61, v61, v61 row_ror:8 row_mask:0xf bank_mask:0xf
    v_mov_b32 v62, v60
    v_mov_b32 v63, v61
    s_nop 0
    v_permlane16_swap_b32 v60, v62
    v_permlane16_swap_b32 v61, v63
    v_pk_add_f32 v[60:61], v[60:61], v[62:63]
    v_mov_b32 v62, v60
    v_mov_b32 v63, v61
    s_nop 0
    v_permlane32_swap_b32 v60, v62
    v_permlane32_swap_b32 v61, v63
    v_pk_add_f32 v[60:61], v[60:61], v[62:63]
    ds_write_b64 v56, v[60:61]
    s_waitcnt lgkmcnt(0)
    s_barrier
    ds_read_b64 v[60:61], v55
    ds_read_b64 v[62:63], v55 offset:64
    ds_read_b64 v[64:65], v55 offset:128
    ds_read_b64 v[66:67], v55 offset:192
    s_waitcnt lgkmcnt(0)
    v_pk_add_f32 v[60:61], v[60:61], v[62:63]
    v_pk_add_f32 v[64:65], v[64:65], v[66:67]
    v_pk_add_f32 v[60:61], v[60:61], v[64:65]
    v_mul_f32 v60, s63, v60
    v_mul_f32 v61, s63, v61
    v_fma_f32 v61, -v60, v60, v61
    v_max_f32 v61, 0, v61
    v_add_f32 v60, v60, v58
    v_cvt_pk_bf16_f32 v62, v60, v61
    v_lshlrev_b32 v60, 16, v62
    v_and_b32 v61, s62, v62
    v_add_f32 v61, 0x3727c5ac, v61
    v_cvt_pk_bf16_f32 v61, v61, v61
    v_and_b32 v61, s62, v61
    v_sqrt_f32 v61, v61
    s_nop 0
    v_cvt_pk_bf16_f32 v61, v61, v61
    v_and_b32 v61, s62, v61
    v_rcp_f32 v62, v61
    v_mov_b32 v61, v60
    v_mov_b32 v63, v62
    v_pk_add_f32 v[16:17], v[16:17], v[60:61] neg_lo:[0,1] neg_hi:[0,1]
    v_cvt_pk_bf16_f32 v64, v16, v17
    v_lshlrev_b32 v16, 16, v64
    v_and_b32 v17, s62, v64
    v_pk_mul_f32 v[16:17], v[16:17], v[62:63]
    v_cvt_pk_bf16_f32 v0, v16, v17
    v_pk_add_f32 v[18:19], v[18:19], v[60:61] neg_lo:[0,1] neg_hi:[0,1]
    v_cvt_pk_bf16_f32 v64, v18, v19
    v_lshlrev_b32 v18, 16, v64
    v_and_b32 v19, s62, v64
    v_pk_mul_f32 v[18:19], v[18:19], v[62:63]
    v_cvt_pk_bf16_f32 v1, v18, v19
    v_pk_add_f32 v[32:33], v[32:33], v[60:61] neg_lo:[0,1] neg_hi:[0,1]
    v_cvt_pk_bf16_f32 v64, v32, v33
    v_lshlrev_b32 v32, 16, v64
    v_and_b32 v33, s62, v64
    v_pk_mul_f32 v[32:33], v[32:33], v[62:63]
    v_cvt_pk_bf16_f32 v2, v32, v33
    v_pk_add_f32 v[34:35], v[34:35], v[60:61] neg_lo:[0,1] neg_hi:[0,1]
    v_cvt_pk_bf16_f32 v64, v34, v35
    v_lshlrev_b32 v34, 16, v64
    v_and_b32 v35, s62, v64
    v_pk_mul_f32 v[34:35], v[34:35], v[62:63]
    v_cvt_pk_bf16_f32 v3, v34, v35
    buffer_store_dwordx4 v[0:3], v54, s[4:7], 0 offen offset:0 sc1
    v_pk_add_f32 v[20:21], v[20:21], v[60:61] neg_lo:[0,1] neg_hi:[0,1]
    v_cvt_pk_bf16_f32 v64, v20, v21
    v_lshlrev_b32 v20, 16, v64
    v_and_b32 v21, s62, v64
    v_pk_mul_f32 v[20:21], v[20:21], v[62:63]
    v_cvt_pk_bf16_f32 v4, v20, v21
    v_pk_add_f32 v[22:23], v[22:23], v[60:61] neg_lo:[0,1] neg_hi:[0,1]
    v_cvt_pk_bf16_f32 v64, v22, v23
    v_lshlrev_b32 v22, 16, v64
    v_and_b32 v23, s62, v64
    v_pk_mul_f32 v[22:23], v[22:23], v[62:63]
    v_cvt_pk_bf16_f32 v5, v22, v23
    v_pk_add_f32 v[36:37], v[36:37], v[60:61] neg_lo:[0,1] neg_hi:[0,1]
    v_cvt_pk_bf16_f32 v64, v36, v37
    v_lshlrev_b32 v36, 16, v64
    v_and_b32 v37, s62, v64
    v_pk_mul_f32 v[36:37], v[36:37], v[62:63]
    v_cvt_pk_bf16_f32 v6, v36, v37
    v_pk_add_f32 v[38:39], v[38:39], v[60:61] neg_lo:[0,1] neg_hi:[0,1]
    v_cvt_pk_bf16_f32 v64, v38, v39
    v_lshlrev_b32 v38, 16, v64
    v_and_b32 v39, s62, v64
    v_pk_mul_f32 v[38:39], v[38:39], v[62:63]
    v_cvt_pk_bf16_f32 v7, v38, v39
    buffer_store_dwordx4 v[4:7], v54, s[4:7], 0 offen offset:256 sc1
    v_pk_add_f32 v[24:25], v[24:25], v[60:61] neg_lo:[0,1] neg_hi:[0,1]
    v_cvt_pk_bf16_f32 v64, v24, v25
    v_lshlrev_b32 v24, 16, v64
    v_and_b32 v25, s62, v64
    v_pk_mul_f32 v[24:25], v[24:25], v[62:63]
    v_cvt_pk_bf16_f32 v8, v24, v25
    v_pk_add_f32 v[26:27], v[26:27], v[60:61] neg_lo:[0,1] neg_hi:[0,1]
    v_cvt_pk_bf16_f32 v64, v26, v27
    v_lshlrev_b32 v26, 16, v64
    v_and_b32 v27, s62, v64
    v_pk_mul_f32 v[26:27], v[26:27], v[62:63]
    v_cvt_pk_bf16_f32 v9, v26, v27
    v_pk_add_f32 v[40:41], v[40:41], v[60:61] neg_lo:[0,1] neg_hi:[0,1]
    v_cvt_pk_bf16_f32 v64, v40, v41
    v_lshlrev_b32 v40, 16, v64
    v_and_b32 v41, s62, v64
    v_pk_mul_f32 v[40:41], v[40:41], v[62:63]
    v_cvt_pk_bf16_f32 v10, v40, v41
    v_pk_add_f32 v[42:43], v[42:43], v[60:61] neg_lo:[0,1] neg_hi:[0,1]
    v_cvt_pk_bf16_f32 v64, v42, v43
    v_lshlrev_b32 v42, 16, v64
    v_and_b32 v43, s62, v64
    v_pk_mul_f32 v[42:43], v[42:43], v[62:63]
    v_cvt_pk_bf16_f32 v11, v42, v43
    buffer_store_dwordx4 v[8:11], v54, s[4:7], 0 offen offset:512 sc1
    v_pk_add_f32 v[28:29], v[28:29], v[60:61] neg_lo:[0,1] neg_hi:[0,1]
    v_cvt_pk_bf16_f32 v64, v28, v29
    v_lshlrev_b32 v28, 16, v64
    v_and_b32 v29, s62, v64
    v_pk_mul_f32 v[28:29], v[28:29], v[62:63]
    v_cvt_pk_bf16_f32 v12, v28, v29
    v_pk_add_f32 v[30:31], v[30:31], v[60:61] neg_lo:[0,1] neg_hi:[0,1]
    v_cvt_pk_bf16_f32 v64, v30, v31
    v_lshlrev_b32 v30, 16, v64
    v_and_b32 v31, s62, v64
    v_pk_mul_f32 v[30:31], v[30:31], v[62:63]
    v_cvt_pk_bf16_f32 v13, v30, v31
    v_pk_add_f32 v[44:45], v[44:45], v[60:61] neg_lo:[0,1] neg_hi:[0,1]
    v_cvt_pk_bf16_f32 v64, v44, v45
    v_lshlrev_b32 v44, 16, v64
    v_and_b32 v45, s62, v64
    v_pk_mul_f32 v[44:45], v[44:45], v[62:63]
    v_cvt_pk_bf16_f32 v14, v44, v45
    v_pk_add_f32 v[46:47], v[46:47], v[60:61] neg_lo:[0,1] neg_hi:[0,1]
    v_cvt_pk_bf16_f32 v64, v46, v47
    v_lshlrev_b32 v46, 16, v64
    v_and_b32 v47, s62, v64
    v_pk_mul_f32 v[46:47], v[46:47], v[62:63]
    v_cvt_pk_bf16_f32 v15, v46, v47
    buffer_store_dwordx4 v[12:15], v54, s[4:7], 0 offen offset:768 sc1
    s_waitcnt vmcnt(0)
    s_barrier
    s_cmp_lg_u32 s54, 0
    s_cbranch_scc1 L_lno
    s_lshl_b32 s63, s57, 5
    v_mov_b32 v216, 1
    s_mov_b64 exec, 1
    buffer_atomic_add v216, off, s[36:39], s63
    s_mov_b32 s64, 0x40000
L_lnp:
    s_sleep 16
    buffer_load_dword v216, off, s[36:39], s63 sc1
    s_waitcnt vmcnt(0)
    v_readfirstlane_b32 s62, v216
    s_cmp_ge_u32 s62, 32
    s_cbranch_scc1 L_lnq
    s_sub_u32 s64, s64, 1
    s_cmp_lg_u32 s64, 0
    s_cbranch_scc1 L_lnp
L_lnq:
    s_mov_b64 exec, -1
    s_barrier
    s_mov_b32 s48, 0
    buffer_load_dwordx4 a[128:131], v168, s[4:7], s48 offen offset:0 sc1
    buffer_load_dwordx4 a[132:135], v168, s[4:7], s48 offen offset:1024 sc1
    buffer_load_dwordx4 a[136:139], v169, s[4:7], s48 offen offset:0 sc1
    buffer_load_dwordx4 a[140:143], v169, s[4:7], s48 offen offset:1024 sc1
    buffer_load_dwordx4 a[144:147], v170, s[4:7], s48 offen offset:0 sc1
    buffer_load_dwordx4 a[148:151], v170, s[4:7], s48 offen offset:1024 sc1
    buffer_load_dwordx4 a[152:155], v171, s[4:7], s48 offen offset:0 sc1
    buffer_load_dwordx4 a[156:159], v171, s[4:7], s48 offen offset:1024 sc1
    s_mov_b32 s48, 2048
    buffer_load_dwordx4 a[160:163], v168, s[4:7], s48 offen offset:0 sc1
    buffer_load_dwordx4 a[164:167], v168, s[4:7], s48 offen offset:1024 sc1
    buffer_load_dwordx4 a[168:171], v169, s[4:7], s48 offen offset:0 sc1
    buffer_load_dwordx4 a[172:175], v169, s[4:7], s48 offen offset:1024 sc1
    buffer_load_dwordx4 a[176:179], v170, s[4:7], s48 offen offset:0 sc1
    buffer_load_dwordx4 a[180:183], v170, s[4:7], s48 offen offset:1024 sc1
    buffer_load_dwordx4 a[184:187], v171, s[4:7], s48 offen offset:0 sc1
    buffer_load_dwordx4 a[188:191], v171, s[4:7], s48 offen offset:1024 sc1
    s_add_u32 m0, s53, 33792
    s_mov_b32 s49, 524288
    s_nop 0
    buffer_load_dwordx4 v160, s[8:11], s49 offen offset:0 lds
    buffer_load_dwordx4 v161, s[8:11], s49 offen offset:1056 lds
    buffer_load_dwordx4 v162, s[8:11], s49 offen offset:2112 lds
    buffer_load_dwordx4 v163, s[8:11], s49 offen offset:3168 lds
    s_add_u32 m0, s53, 50688
    s_mov_b32 s49, 458752
    s_nop 0
    buffer_load_dwordx4 v164, s[12:15], s49 offen offset:0 lds
    buffer_load_dwordx4 v165, s[12:15], s49 offen offset:1056 lds
    buffer_load_dwordx4 v166, s[12:15], s49 offen offset:2112 lds
    buffer_load_dwordx4 v167, s[12:15], s49 offen offset:3168 lds
    s_add_u32 m0, s53, 67584
    s_mov_b32 s49, 1048576
    s_nop 0
    buffer_load_dwordx4 v160, s[8:11], s49 offen offset:0 lds
    buffer_load_dwordx4 v161, s[8:11], s49 offen offset:1056 lds
    buffer_load_dwordx4 v162, s[8:11], s49 offen offset:2112 lds
    buffer_load_dwordx4 v163, s[8:11], s49 offen offset:3168 lds
    s_add_u32 m0, s53, 84480
    s_mov_b32 s49, 917504
    s_nop 0
    buffer_load_dwordx4 v164, s[12:15], s49 offen offset:0 lds
    buffer_load_dwordx4 v165, s[12:15], s49 offen offset:1056 lds
    buffer_load_dwordx4 v166, s[12:15], s49 offen offset:2112 lds
    buffer_load_dwordx4 v167, s[12:15], s49 offen offset:3168 lds
    s_waitcnt vmcnt(24)
    s_branch L_lnd
L_lno:
    s_add_u32 m0, s53, 33792
    s_mov_b32 s49, 524288
    s_nop 0
    buffer_load_dwordx4 v160, s[8:11], s49 offen offset:0 lds
    buffer_load_dwordx4 v161, s[8:11], s49 offen offset:1056 lds
    buffer_load_dwordx4 v162, s[8:11], s49 offen offset:2112 lds
    buffer_load_dwordx4 v163, s[8:11], s49 offen offset:3168 lds
    s_add_u32 m0, s53, 50688
    s_mov_b32 s49, 458752
    s_nop 0
    buffer_load_dwordx4 v164, s[12:15], s49 offen offset:0 lds
    buffer_load_dwordx4 v165, s[12:15], s49 offen offset:1056 lds
    buffer_load_dwordx4 v166, s[12:15], s49 offen offset:2112 lds
    buffer_load_dwordx4 v167, s[12:15], s49 offen offset:3168 lds
    s_add_u32 m0, s53, 67584
    s_mov_b32 s49, 1048576
    s_nop 0
    buffer_load_dwordx4 v160, s[8:11], s49 offen offset:0 lds
    buffer_load_dwordx4 v161, s[8:11], s49 offen offset:1056 lds
    buffer_load_dwordx4 v162, s[8:11], s49 offen offset:2112 lds
    buffer_load_dwordx4 v163, s[8:11], s49 offen offset:3168 lds
    s_add_u32 m0, s53, 84480
    s_mov_b32 s49, 917504
    s_nop 0
    buffer_load_dwordx4 v164, s[12:15], s49 offen offset:0 lds
    buffer_load_dwordx4 v165, s[12:15], s49 offen offset:1056 lds
    buffer_load_dwordx4 v166, s[12:15], s49 offen offset:2112 lds
    buffer_load_dwordx4 v167, s[12:15], s49 offen offset:3168 lds
    s_getpc_b64 s[62:63]
L_pcb:
    s_mul_i32 s64, s54, 32768
    s_sub_u32 s64, s64, 32768
    v_lshlrev_b32 v64, 7, v242
    v_add_u32 v64, s64, v64
    v_mov_b32 v67, s63
    v_add_u32 v65, 0, v64
    v_min_u32 v65, L_last - L_pcb, v65
    v_add_co_u32 v68, vcc, s62, v65
    s_nop 1
    v_addc_co_u32 v69, vcc, 0, v67, vcc
    global_load_dword v255, v[68:69], off
    v_add_u32 v65, 8192, v64
    v_min_u32 v65, L_last - L_pcb, v65
    v_add_co_u32 v68, vcc, s62, v65
    s_nop 1
    v_addc_co_u32 v69, vcc, 0, v67, vcc
    global_load_dword v255, v[68:69], off
    v_add_u32 v65, 16384, v64
    v_min_u32 v65, L_last - L_pcb, v65
    v_add_co_u32 v68, vcc, s62, v65
    s_nop 1
    v_addc_co_u32 v69, vcc, 0, v67, vcc
    global_load_dword v255, v[68:69], off
    v_add_u32 v65, 24576, v64
    v_min_u32 v65, L_last - L_pcb, v65
    v_add_co_u32 v68, vcc, s62, v65
    s_nop 1
    v_addc_co_u32 v69, vcc, 0, v67, vcc
    global_load_dword v255, v[68:69], off
    s_barrier
    s_mov_b32 s48, 0
    buffer_load_dwordx4 a[128:131], v168, s[4:7], s48 offen offset:0 sc1
    buffer_load_dwordx4 a[132:135], v168, s[4:7], s48 offen offset:1024 sc1
    buffer_load_dwordx4 a[136:139], v169, s[4:7], s48 offen offset:0 sc1
    buffer_load_dwordx4 a[140:143], v169, s[4:7], s48 offen offset:1024 sc1
    buffer_load_dwordx4 a[144:147], v170, s[4:7], s48 offen offset:0 sc1
    buffer_load_dwordx4 a[148:151], v170, s[4:7], s48 offen offset:1024 sc1
    buffer_load_dwordx4 a[152:155], v171, s[4:7], s48 offen offset:0 sc1
    buffer_load_dwordx4 a[156:159], v171, s[4:7], s48 offen offset:1024 sc1
    s_mov_b32 s48, 2048
    buffer_load_dwordx4 a[160:163], v168, s[4:7], s48 offen offset:0 sc1
    buffer_load_dwordx4 a[164:167], v168, s[4:7], s48 offen offset:1024 sc1
    buffer_load_dwordx4 a[168:171], v169, s[4:7], s48 offen offset:0 sc1
    buffer_load_dwordx4 a[172:175], v169, s[4:7], s48 offen offset:1024 sc1
    buffer_load_dwordx4 a[176:179], v170, s[4:7], s48 offen offset:0 sc1
    buffer_load_dwordx4 a[180:183], v170, s[4:7], s48 offen offset:1024 sc1
    buffer_load_dwordx4 a[184:187], v171, s[4:7], s48 offen offset:0 sc1
    buffer_load_dwordx4 a[188:191], v171, s[4:7], s48 offen offset:1024 sc1
    s_waitcnt vmcnt(8)
L_lnd:
    s_add_u32 s36, s4, 41943040
    s_addc_u32 s37, s5, 0
    s_mov_b32 s38, 4096
    s_mov_b32 s39, 0x20000
    ds_read_b64_tr_b16 v[128:129], v172 offset:0
    ds_read_b64_tr_b16 v[130:131], v172 offset:256
    ds_read_b64_tr_b16 v[132:133], v172 offset:512
    ds_read_b64_tr_b16 v[134:135], v172 offset:768
    ds_read_b64_tr_b16 v[136:137], v172 offset:8
    ds_read_b64_tr_b16 v[138:139], v172 offset:264
    ds_read_b64_tr_b16 v[140:141], v172 offset:520
    ds_read_b64_tr_b16 v[142:143], v172 offset:776
    ds_read_b64_tr_b16 v[144:145], v172 offset:64
    ds_read_b64_tr_b16 v[146:147], v172 offset:320
    ds_read_b64_tr_b16 v[148:149], v172 offset:576
    ds_read_b64_tr_b16 v[150:151], v172 offset:832
    s_mul_i32 s59, s99, 458752
    s_lshl_b32 s62, s56, 12
    s_add_u32 s59, s59, s62
    v_add_u32 v253, s59, v243
    s_mov_b32 s62, 114688
    s_mov_b32 s63, 229376
    s_mov_b32 s64, 344064
    s_waitcnt lgkmcnt(0)
    s_waitcnt vmcnt(63)
    v_mfma_f32_16x16x32_bf16 v[0:3], v[128:131], a[128:131], 0
    ds_read_b64_tr_b16 v[152:153], v172 offset:72
    ds_read_b64_tr_b16 v[154:155], v172 offset:328
    v_mfma_f32_16x16x32_bf16 v[0:3], v[132:135], a[132:135], v[0:3]
    ds_read_b64_tr_b16 v[156:157], v172 offset:584
    s_mov_b32 s48, 4096
    v_mfma_f32_16x16x32_bf16 v[4:7], v[128:131], a[136:139], 0
    ds_read_b64_tr_b16 v[158:159], v172 offset:840
    v_mfma_f32_16x16x32_bf16 v[4:7], v[132:135], a[140:143], v[4:7]
    buffer_load_dwordx4 a[192:195], v168, s[4:7], s48 offen offset:0 sc1
    v_mfma_f32_16x16x32_bf16 v[8:11], v[128:131], a[144:147], 0
    v_mfma_f32_16x16x32_bf16 v[8:11], v[132:135], a[148:151], v[8:11]
    v_mfma_f32_16x16x32_bf16 v[12:15], v[128:131], a[152:155], 0
    v_mfma_f32_16x16x32_bf16 v[12:15], v[132:135], a[156:159], v[12:15]
    v_mfma_f32_16x16x32_bf16 v[16:19], v[136:139], a[128:131], 0
    buffer_load_dwordx4 a[196:199], v168, s[4:7], s48 offen offset:1024 sc1
    v_mfma_f32_16x16x32_bf16 v[16:19], v[140:143], a[132:135], v[16:19]
    ds_read_b64_tr_b16 v[128:129], v172 offset:128
    ds_read_b64_tr_b16 v[130:131], v172 offset:384
    v_mfma_f32_16x16x32_bf16 v[20:23], v[136:139], a[136:139], 0
    ds_read_b64_tr_b16 v[132:133], v172 offset:640
    ds_read_b64_tr_b16 v[134:135], v172 offset:896
    v_mfma_f32_16x16x32_bf16 v[20:23], v[140:143], a[140:143], v[20:23]
    v_mfma_f32_16x16x32_bf16 v[24:27], v[136:139], a[144:147], 0
    v_mfma_f32_16x16x32_bf16 v[24:27], v[140:143], a[148:151], v[24:27]
    v_mfma_f32_16x16x32_bf16 v[28:31], v[136:139], a[152:155], 0
    v_mfma_f32_16x16x32_bf16 v[28:31], v[140:143], a[156:159], v[28:31]
    buffer_load_dwordx4 a[200:203], v169, s[4:7], s48 offen offset:0 sc1
    v_mfma_f32_16x16x32_bf16 v[32:35], v[144:147], a[128:131], 0
    ds_read_b64_tr_b16 v[136:137], v172 offset:136
    ds_read_b64_tr_b16 v[138:139], v172 offset:392
    v_mfma_f32_16x16x32_bf16 v[32:35], v[148:151], a[132:135], v[32:35]
    ds_read_b64_tr_b16 v[140:141], v172 offset:648
    ds_read_b64_tr_b16 v[142:143], v172 offset:904
    v_mfma_f32_16x16x32_bf16 v[36:39], v[144:147], a[136:139], 0
    v_mfma_f32_16x16x32_bf16 v[36:39], v[148:151], a[140:143], v[36:39]
    v_mfma_f32_16x16x32_bf16 v[40:43], v[144:147], a[144:147], 0
    v_mfma_f32_16x16x32_bf16 v[40:43], v[148:151], a[148:151], v[40:43]
    v_mfma_f32_16x16x32_bf16 v[44:47], v[144:147], a[152:155], 0
    v_mfma_f32_16x16x32_bf16 v[44:47], v[148:151], a[156:159], v[44:47]
    buffer_load_dwordx4 a[204:207], v169, s[4:7], s48 offen offset:1024 sc1
    s_waitcnt lgkmcnt(0)
    v_mfma_f32_16x16x32_bf16 v[48:51], v[152:155], a[128:131], 0
    ds_read_b64_tr_b16 v[144:145], v172 offset:192
    ds_read_b64_tr_b16 v[146:147], v172 offset:448
    v_mfma_f32_16x16x32_bf16 v[48:51], v[156:159], a[132:135], v[48:51]
    ds_read_b64_tr_b16 v[148:149], v172 offset:704
    ds_read_b64_tr_b16 v[150:151], v172 offset:960
    v_mfma_f32_16x16x32_bf16 v[52:55], v[152:155], a[136:139], 0
    v_mfma_f32_16x16x32_bf16 v[52:55], v[156:159], a[140:143], v[52:55]
    v_mfma_f32_16x16x32_bf16 v[56:59], v[152:155], a[144:147], 0
    v_mfma_f32_16x16x32_bf16 v[56:59], v[156:159], a[148:151], v[56:59]
    v_mfma_f32_16x16x32_bf16 v[60:63], v[152:155], a[152:155], 0
    buffer_load_dwordx4 a[208:211], v170, s[4:7], s48 offen offset:0 sc1
    v_mfma_f32_16x16x32_bf16 v[60:63], v[156:159], a[156:159], v[60:63]
    v_mfma_f32_16x16x32_bf16 v[64:67], v[128:131], a[128:131], 0
    ds_read_b64_tr_b16 v[152:153], v172 offset:200
    ds_read_b64_tr_b16 v[154:155], v172 offset:456
    v_mfma_f32_16x16x32_bf16 v[64:67], v[132:135], a[132:135], v[64:67]
    ds_read_b64_tr_b16 v[156:157], v172 offset:712
    ds_read_b64_tr_b16 v[158:159], v172 offset:968
    v_mfma_f32_16x16x32_bf16 v[68:71], v[128:131], a[136:139], 0
    v_mfma_f32_16x16x32_bf16 v[68:71], v[132:135], a[140:143], v[68:71]
    v_mfma_f32_16x16x32_bf16 v[72:75], v[128:131], a[144:147], 0
    v_mfma_f32_16x16x32_bf16 v[72:75], v[132:135], a[148:151], v[72:75]
    v_mfma_f32_16x16x32_bf16 v[76:79], v[128:131], a[152:155], 0
    buffer_load_dwordx4 a[212:215], v170, s[4:7], s48 offen offset:1024 sc1
    v_mfma_f32_16x16x32_bf16 v[76:79], v[132:135], a[156:159], v[76:79]
    v_mfma_f32_16x16x32_bf16 v[80:83], v[136:139], a[128:131], 0
    ds_read_b64_tr_b16 v[128:129], v238 offset:16896
    ds_read_b64_tr_b16 v[130:131], v238 offset:17152
    v_mfma_f32_16x16x32_bf16 v[80:83], v[140:143], a[132:135], v[80:83]
    ds_read_b64_tr_b16 v[132:133], v238 offset:17408
    ds_read_b64_tr_b16 v[134:135], v238 offset:17664
    v_mfma_f32_16x16x32_bf16 v[84:87], v[136:139], a[136:139], 0
    v_mfma_f32_16x16x32_bf16 v[84:87], v[140:143], a[140:143], v[84:87]
    v_mfma_f32_16x16x32_bf16 v[88:91], v[136:139], a[144:147], 0
    v_mfma_f32_16x16x32_bf16 v[88:91], v[140:143], a[148:151], v[88:91]
    buffer_load_dwordx4 a[216:219], v171, s[4:7], s48 offen offset:0 sc1
    v_mfma_f32_16x16x32_bf16 v[92:95], v[136:139], a[152:155], 0
    v_mfma_f32_16x16x32_bf16 v[92:95], v[140:143], a[156:159], v[92:95]
    s_waitcnt lgkmcnt(0)
    v_mfma_f32_16x16x32_bf16 v[96:99], v[144:147], a[128:131], 0
    ds_read_b64_tr_b16 v[136:137], v238 offset:16928
    ds_read_b64_tr_b16 v[138:139], v238 offset:17184
    v_mfma_f32_16x16x32_bf16 v[96:99], v[148:151], a[132:135], v[96:99]
    ds_read_b64_tr_b16 v[140:141], v238 offset:17440
    ds_read_b64_tr_b16 v[142:143], v238 offset:17696
    v_mfma_f32_16x16x32_bf16 v[100:103], v[144:147], a[136:139], 0
    v_mfma_f32_16x16x32_bf16 v[100:103], v[148:151], a[140:143], v[100:103]
    v_mfma_f32_16x16x32_bf16 v[104:107], v[144:147], a[144:147], 0
    v_mfma_f32_16x16x32_bf16 v[104:107], v[148:151], a[148:151], v[104:107]
    buffer_load_dwordx4 a[220:223], v171, s[4:7], s48 offen offset:1024 sc1
    v_mfma_f32_16x16x32_bf16 v[108:111], v[144:147], a[152:155], 0
    v_mfma_f32_16x16x32_bf16 v[108:111], v[148:151], a[156:159], v[108:111]
    v_mfma_f32_16x16x32_bf16 v[112:115], v[152:155], a[128:131], 0
    ds_read_b64_tr_b16 v[144:145], v238 offset:16960
    ds_read_b64_tr_b16 v[146:147], v238 offset:17216
    v_mfma_f32_16x16x32_bf16 v[112:115], v[156:159], a[132:135], v[112:115]
    ds_read_b64_tr_b16 v[148:149], v238 offset:17472
    ds_read_b64_tr_b16 v[150:151], v238 offset:17728
    v_mfma_f32_16x16x32_bf16 v[116:119], v[152:155], a[136:139], 0
    v_mfma_f32_16x16x32_bf16 v[116:119], v[156:159], a[140:143], v[116:119]
    s_add_u32 m0, s53, 101376
    s_mov_b32 s49, 1572864
    v_mfma_f32_16x16x32_bf16 v[120:123], v[152:155], a[144:147], 0
    buffer_load_dwordx4 v160, s[8:11], s49 offen offset:0 lds
    v_mfma_f32_16x16x32_bf16 v[120:123], v[156:159], a[148:151], v[120:123]
    v_mfma_f32_16x16x32_bf16 v[124:127], v[152:155], a[152:155], 0
    v_mfma_f32_16x16x32_bf16 v[124:127], v[156:159], a[156:159], v[124:127]
    v_mfma_f32_16x16x32_bf16 a[0:3], v[128:131], a[128:131], 0
    ds_read_b64_tr_b16 v[152:153], v238 offset:16992
    ds_read_b64_tr_b16 v[154:155], v238 offset:17248
    v_mfma_f32_16x16x32_bf16 a[0:3], v[132:135], a[132:135], a[0:3]
    ds_read_b64_tr_b16 v[156:157], v238 offset:17504
    ds_read_b64_tr_b16 v[158:159], v238 offset:17760
    v_mfma_f32_16x16x32_bf16 a[4:7], v[128:131], a[136:139], 0
    v_mfma_f32_16x16x32_bf16 a[4:7], v[132:135], a[140:143], a[4:7]
    buffer_load_dwordx4 v161, s[8:11], s49 offen offset:1056 lds
    v_mfma_f32_16x16x32_bf16 a[8:11], v[128:131], a[144:147], 0
    v_mfma_f32_16x16x32_bf16 a[8:11], v[132:135], a[148:151], a[8:11]
    v_mfma_f32_16x16x32_bf16 a[12:15], v[128:131], a[152:155], 0
    v_mfma_f32_16x16x32_bf16 a[12:15], v[132:135], a[156:159], a[12:15]
    s_waitcnt lgkmcnt(0)
    v_mfma_f32_16x16x32_bf16 a[16:19], v[136:139], a[128:131], 0
    ds_read_b64_tr_b16 v[128:129], v238 offset:17024
    ds_read_b64_tr_b16 v[130:131], v238 offset:17280
    v_mfma_f32_16x16x32_bf16 a[16:19], v[140:143], a[132:135], a[16:19]
    ds_read_b64_tr_b16 v[132:133], v238 offset:17536
    ds_read_b64_tr_b16 v[134:135], v238 offset:17792
    v_mfma_f32_16x16x32_bf16 a[20:23], v[136:139], a[136:139], 0
    v_mfma_f32_16x16x32_bf16 a[20:23], v[140:143], a[140:143], a[20:23]
    buffer_load_dwordx4 v162, s[8:11], s49 offen offset:2112 lds
    v_mfma_f32_16x16x32_bf16 a[24:27], v[136:139], a[144:147], 0
    v_mfma_f32_16x16x32_bf16 a[24:27], v[140:143], a[148:151], a[24:27]
    v_mfma_f32_16x16x32_bf16 a[28:31], v[136:139], a[152:155], 0
    v_mfma_f32_16x16x32_bf16 a[28:31], v[140:143], a[156:159], a[28:31]
    v_mfma_f32_16x16x32_bf16 a[32:35], v[144:147], a[128:131], 0
    ds_read_b64_tr_b16 v[136:137], v238 offset:17056
    ds_read_b64_tr_b16 v[138:139], v238 offset:17312
    v_mfma_f32_16x16x32_bf16 a[32:35], v[148:151], a[132:135], a[32:35]
    ds_read_b64_tr_b16 v[140:141], v238 offset:17568
    ds_read_b64_tr_b16 v[142:143], v238 offset:17824
    v_mfma_f32_16x16x32_bf16 a[36:39], v[144:147], a[136:139], 0
    buffer_load_dwordx4 v163, s[8:11], s49 offen offset:3168 lds
    v_mfma_f32_16x16x32_bf16 a[36:39], v[148:151], a[140:143], a[36:39]
    v_mfma_f32_16x16x32_bf16 a[40:43], v[144:147], a[144:147], 0
    v_mfma_f32_16x16x32_bf16 a[40:43], v[148:151], a[148:151], a[40:43]
    v_mfma_f32_16x16x32_bf16 a[44:47], v[144:147], a[152:155], 0
    v_mfma_f32_16x16x32_bf16 a[44:47], v[148:151], a[156:159], a[44:47]
    v_mfma_f32_16x16x32_bf16 a[48:51], v[152:155], a[128:131], 0
    ds_read_b64_tr_b16 v[144:145], v238 offset:17088
    ds_read_b64_tr_b16 v[146:147], v238 offset:17344
    v_mfma_f32_16x16x32_bf16 a[48:51], v[156:159], a[132:135], a[48:51]
    s_add_u32 m0, s53, 118272
    s_mov_b32 s49, 1376256
    v_mfma_f32_16x16x32_bf16 a[52:55], v[152:155], a[136:139], 0
    ds_read_b64_tr_b16 v[148:149], v238 offset:17600
    ds_read_b64_tr_b16 v[150:151], v238 offset:17856
    v_mfma_f32_16x16x32_bf16 a[52:55], v[156:159], a[140:143], a[52:55]
    buffer_load_dwordx4 v164, s[12:15], s49 offen offset:0 lds
    v_mfma_f32_16x16x32_bf16 a[56:59], v[152:155], a[144:147], 0
    v_mfma_f32_16x16x32_bf16 a[56:59], v[156:159], a[148:151], a[56:59]
    v_mfma_f32_16x16x32_bf16 a[60:63], v[152:155], a[152:155], 0
    v_mfma_f32_16x16x32_bf16 a[60:63], v[156:159], a[156:159], a[60:63]
    s_waitcnt lgkmcnt(2)
    v_mfma_f32_16x16x32_bf16 a[64:67], v[128:131], a[128:131], 0
    ds_read_b64_tr_b16 v[152:153], v238 offset:17120
    ds_read_b64_tr_b16 v[154:155], v238 offset:17376
    v_mfma_f32_16x16x32_bf16 a[64:67], v[132:135], a[132:135], a[64:67]
    ds_read_b64_tr_b16 v[156:157], v238 offset:17632
    ds_read_b64_tr_b16 v[158:159], v238 offset:17888
    v_mfma_f32_16x16x32_bf16 a[68:71], v[128:131], a[136:139], 0
    buffer_load_dwordx4 v165, s[12:15], s49 offen offset:1056 lds
    v_mfma_f32_16x16x32_bf16 a[68:71], v[132:135], a[140:143], a[68:71]
    v_mfma_f32_16x16x32_bf16 a[72:75], v[128:131], a[144:147], 0
    v_mfma_f32_16x16x32_bf16 a[72:75], v[132:135], a[148:151], a[72:75]
    v_mfma_f32_16x16x32_bf16 a[76:79], v[128:131], a[152:155], 0
    v_mfma_f32_16x16x32_bf16 a[76:79], v[132:135], a[156:159], a[76:79]
    v_mfma_f32_16x16x32_bf16 a[80:83], v[136:139], a[128:131], 0
    v_mfma_f32_16x16x32_bf16 a[80:83], v[140:143], a[132:135], a[80:83]
    buffer_load_dwordx4 v166, s[12:15], s49 offen offset:2112 lds
    v_mfma_f32_16x16x32_bf16 a[84:87], v[136:139], a[136:139], 0
    s_waitcnt vmcnt(23) lgkmcnt(0)
    s_barrier
    v_mfma_f32_16x16x32_bf16 a[84:87], v[140:143], a[140:143], a[84:87]
    ds_read_b64_tr_b16 v[128:129], v172 offset:33792
    ds_read_b64_tr_b16 v[130:131], v172 offset:34048
    v_mfma_f32_16x16x32_bf16 a[88:91], v[136:139], a[144:147], 0
    ds_read_b64_tr_b16 v[132:133], v172 offset:34304
    ds_read_b64_tr_b16 v[134:135], v172 offset:34560
    v_mfma_f32_16x16x32_bf16 a[88:91], v[140:143], a[148:151], a[88:91]
    v_mfma_f32_16x16x32_bf16 a[92:95], v[136:139], a[152:155], 0
    v_mfma_f32_16x16x32_bf16 a[92:95], v[140:143], a[156:159], a[92:95]
    v_mfma_f32_16x16x32_bf16 a[96:99], v[144:147], a[128:131], 0
    buffer_load_dwordx4 v167, s[12:15], s49 offen offset:3168 lds
    v_mfma_f32_16x16x32_bf16 a[96:99], v[148:151], a[132:135], a[96:99]
    ds_read_b64_tr_b16 v[136:137], v172 offset:33800
    ds_read_b64_tr_b16 v[138:139], v172 offset:34056
    v_mfma_f32_16x16x32_bf16 a[100:103], v[144:147], a[136:139], 0
    ds_read_b64_tr_b16 v[140:141], v172 offset:34312
    ds_read_b64_tr_b16 v[142:143], v172 offset:34568
    v_mfma_f32_16x16x32_bf16 a[100:103], v[148:151], a[140:143], a[100:103]
    v_mfma_f32_16x16x32_bf16 a[104:107], v[144:147], a[144:147], 0
    v_mfma_f32_16x16x32_bf16 a[104:107], v[148:151], a[148:151], a[104:107]
    v_mfma_f32_16x16x32_bf16 a[108:111], v[144:147], a[152:155], 0
    v_mfma_f32_16x16x32_bf16 a[108:111], v[148:151], a[156:159], a[108:111]
    v_mfma_f32_16x16x32_bf16 a[112:115], v[152:155], a[128:131], 0
    ds_read_b64_tr_b16 v[144:145], v172 offset:33856
    ds_read_b64_tr_b16 v[146:147], v172 offset:34112
    v_mfma_f32_16x16x32_bf16 a[112:115], v[156:159], a[132:135], a[112:115]
    ds_read_b64_tr_b16 v[148:149], v172 offset:34368
    ds_read_b64_tr_b16 v[150:151], v172 offset:34624
    v_mfma_f32_16x16x32_bf16 a[116:119], v[152:155], a[136:139], 0
    v_mfma_f32_16x16x32_bf16 a[116:119], v[156:159], a[140:143], a[116:119]
    v_mfma_f32_16x16x32_bf16 a[120:123], v[152:155], a[144:147], 0
    v_mfma_f32_16x16x32_bf16 a[120:123], v[156:159], a[148:151], a[120:123]
    v_mfma_f32_16x16x32_bf16 a[124:127], v[152:155], a[152:155], 0
    v_mfma_f32_16x16x32_bf16 a[124:127], v[156:159], a[156:159], a[124:127]
    s_waitcnt vmcnt(16)
    s_waitcnt lgkmcnt(0)
    v_mfma_f32_16x16x32_bf16 v[0:3], v[128:131], a[160:163], v[0:3]
    ds_read_b64_tr_b16 v[152:153], v172 offset:33864
    ds_read_b64_tr_b16 v[154:155], v172 offset:34120
    v_mfma_f32_16x16x32_bf16 v[0:3], v[132:135], a[164:167], v[0:3]
    ds_read_b64_tr_b16 v[156:157], v172 offset:34376
    s_mov_b32 s48, 6144
    v_mfma_f32_16x16x32_bf16 v[4:7], v[128:131], a[168:171], v[4:7]
    ds_read_b64_tr_b16 v[158:159], v172 offset:34632
    v_mfma_f32_16x16x32_bf16 v[4:7], v[132:135], a[172:175], v[4:7]
    buffer_load_dwordx4 a[224:227], v168, s[4:7], s48 offen offset:0 sc1
    v_mfma_f32_16x16x32_bf16 v[8:11], v[128:131], a[176:179], v[8:11]
    v_mfma_f32_16x16x32_bf16 v[8:11], v[132:135], a[180:183], v[8:11]
    v_mfma_f32_16x16x32_bf16 v[12:15], v[128:131], a[184:187], v[12:15]
    v_mfma_f32_16x16x32_bf16 v[12:15], v[132:135], a[188:191], v[12:15]
    v_mfma_f32_16x16x32_bf16 v[16:19], v[136:139], a[160:163], v[16:19]
    buffer_load_dwordx4 a[228:231], v168, s[4:7], s48 offen offset:1024 sc1
    v_mfma_f32_16x16x32_bf16 v[16:19], v[140:143], a[164:167], v[16:19]
    ds_read_b64_tr_b16 v[128:129], v172 offset:33920
    ds_read_b64_tr_b16 v[130:131], v172 offset:34176
    v_mfma_f32_16x16x32_bf16 v[20:23], v[136:139], a[168:171], v[20:23]
    ds_read_b64_tr_b16 v[132:133], v172 offset:34432
    ds_read_b64_tr_b16 v[134:135], v172 offset:34688
    v_mfma_f32_16x16x32_bf16 v[20:23], v[140:143], a[172:175], v[20:23]
    v_mfma_f32_16x16x32_bf16 v[24:27], v[136:139], a[176:179], v[24:27]
    v_mfma_f32_16x16x32_bf16 v[24:27], v[140:143], a[180:183], v[24:27]
    v_mfma_f32_16x16x32_bf16 v[28:31], v[136:139], a[184:187], v[28:31]
    v_mfma_f32_16x16x32_bf16 v[28:31], v[140:143], a[188:191], v[28:31]
    buffer_load_dwordx4 a[232:235], v169, s[4:7], s48 offen offset:0 sc1
    v_mfma_f32_16x16x32_bf16 v[32:35], v[144:147], a[160:163], v[32:35]
    ds_read_b64_tr_b16 v[136:137], v172 offset:33928
    ds_read_b64_tr_b16 v[138:139], v172 offset:34184
    v_mfma_f32_16x16x32_bf16 v[32:35], v[148:151], a[164:167], v[32:35]
    ds_read_b64_tr_b16 v[140:141], v172 offset:34440
    ds_read_b64_tr_b16 v[142:143], v172 offset:34696
    v_mfma_f32_16x16x32_bf16 v[36:39], v[144:147], a[168:171], v[36:39]
    v_mfma_f32_16x16x32_bf16 v[36:39], v[148:151], a[172:175], v[36:39]
    v_mfma_f32_16x16x32_bf16 v[40:43], v[144:147], a[176:179], v[40:43]
    v_mfma_f32_16x16x32_bf16 v[40:43], v[148:151], a[180:183], v[40:43]
    v_mfma_f32_16x16x32_bf16 v[44:47], v[144:147], a[184:187], v[44:47]
    v_mfma_f32_16x16x32_bf16 v[44:47], v[148:151], a[188:191], v[44:47]
    buffer_load_dwordx4 a[236:239], v169, s[4:7], s48 offen offset:1024 sc1
    s_waitcnt lgkmcnt(0)
    v_mfma_f32_16x16x32_bf16 v[48:51], v[152:155], a[160:163], v[48:51]
    ds_read_b64_tr_b16 v[144:145], v172 offset:33984
    ds_read_b64_tr_b16 v[146:147], v172 offset:34240
    v_mfma_f32_16x16x32_bf16 v[48:51], v[156:159], a[164:167], v[48:51]
    ds_read_b64_tr_b16 v[148:149], v172 offset:34496
    ds_read_b64_tr_b16 v[150:151], v172 offset:34752
    v_mfma_f32_16x16x32_bf16 v[52:55], v[152:155], a[168:171], v[52:55]
    v_mfma_f32_16x16x32_bf16 v[52:55], v[156:159], a[172:175], v[52:55]
    v_mfma_f32_16x16x32_bf16 v[56:59], v[152:155], a[176:179], v[56:59]
    v_mfma_f32_16x16x32_bf16 v[56:59], v[156:159], a[180:183], v[56:59]
    v_mfma_f32_16x16x32_bf16 v[60:63], v[152:155], a[184:187], v[60:63]
    buffer_load_dwordx4 a[240:243], v170, s[4:7], s48 offen offset:0 sc1
    v_mfma_f32_16x16x32_bf16 v[60:63], v[156:159], a[188:191], v[60:63]
    v_mfma_f32_16x16x32_bf16 v[64:67], v[128:131], a[160:163], v[64:67]
    ds_read_b64_tr_b16 v[152:153], v172 offset:33992
    ds_read_b64_tr_b16 v[154:155], v172 offset:34248
    v_mfma_f32_16x16x32_bf16 v[64:67], v[132:135], a[164:167], v[64:67]
    ds_read_b64_tr_b16 v[156:157], v172 offset:34504
    ds_read_b64_tr_b16 v[158:159], v172 offset:34760
    v_mfma_f32_16x16x32_bf16 v[68:71], v[128:131], a[168:171], v[68:71]
    v_mfma_f32_16x16x32_bf16 v[68:71], v[132:135], a[172:175], v[68:71]
    v_mfma_f32_16x16x32_bf16 v[72:75], v[128:131], a[176:179], v[72:75]
    v_mfma_f32_16x16x32_bf16 v[72:75], v[132:135], a[180:183], v[72:75]
    v_mfma_f32_16x16x32_bf16 v[76:79], v[128:131], a[184:187], v[76:79]
    buffer_load_dwordx4 a[244:247], v170, s[4:7], s48 offen offset:1024 sc1
    v_mfma_f32_16x16x32_bf16 v[76:79], v[132:135], a[188:191], v[76:79]
    v_mfma_f32_16x16x32_bf16 v[80:83], v[136:139], a[160:163], v[80:83]
    ds_read_b64_tr_b16 v[128:129], v238 offset:50688
    ds_read_b64_tr_b16 v[130:131], v238 offset:50944
    v_mfma_f32_16x16x32_bf16 v[80:83], v[140:143], a[164:167], v[80:83]
    ds_read_b64_tr_b16 v[132:133], v238 offset:51200
    ds_read_b64_tr_b16 v[134:135], v238 offset:51456
    v_mfma_f32_16x16x32_bf16 v[84:87], v[136:139], a[168:171], v[84:87]
    v_mfma_f32_16x16x32_bf16 v[84:87], v[140:143], a[172:175], v[84:87]
    v_mfma_f32_16x16x32_bf16 v[88:91], v[136:139], a[176:179], v[88:91]
    v_mfma_f32_16x16x32_bf16 v[88:91], v[140:143], a[180:183], v[88:91]
    buffer_load_dwordx4 a[248:251], v171, s[4:7], s48 offen offset:0 sc1
    v_mfma_f32_16x16x32_bf16 v[92:95], v[136:139], a[184:187], v[92:95]
    v_mfma_f32_16x16x32_bf16 v[92:95], v[140:143], a[188:191], v[92:95]
    s_waitcnt lgkmcnt(0)
    v_mfma_f32_16x16x32_bf16 v[96:99], v[144:147], a[160:163], v[96:99]
    ds_read_b64_tr_b16 v[136:137], v238 offset:50720
    ds_read_b64_tr_b16 v[138:139], v238 offset:50976
    v_mfma_f32_16x16x32_bf16 v[96:99], v[148:151], a[164:167], v[96:99]
    ds_read_b64_tr_b16 v[140:141], v238 offset:51232
    ds_read_b64_tr_b16 v[142:143], v238 offset:51488
    v_mfma_f32_16x16x32_bf16 v[100:103], v[144:147], a[168:171], v[100:103]
    v_mfma_f32_16x16x32_bf16 v[100:103], v[148:151], a[172:175], v[100:103]
    v_mfma_f32_16x16x32_bf16 v[104:107], v[144:147], a[176:179], v[104:107]
    v_mfma_f32_16x16x32_bf16 v[104:107], v[148:151], a[180:183], v[104:107]
    buffer_load_dwordx4 a[252:255], v171, s[4:7], s48 offen offset:1024 sc1
    v_mfma_f32_16x16x32_bf16 v[108:111], v[144:147], a[184:187], v[108:111]
    v_mfma_f32_16x16x32_bf16 v[108:111], v[148:151], a[188:191], v[108:111]
    v_mfma_f32_16x16x32_bf16 v[112:115], v[152:155], a[160:163], v[112:115]
    ds_read_b64_tr_b16 v[144:145], v238 offset:50752
    ds_read_b64_tr_b16 v[146:147], v238 offset:51008
    v_mfma_f32_16x16x32_bf16 v[112:115], v[156:159], a[164:167], v[112:115]
    ds_read_b64_tr_b16 v[148:149], v238 offset:51264
    ds_read_b64_tr_b16 v[150:151], v238 offset:51520
    v_mfma_f32_16x16x32_bf16 v[116:119], v[152:155], a[168:171], v[116:119]
    v_mfma_f32_16x16x32_bf16 v[116:119], v[156:159], a[172:175], v[116:119]
    s_add_u32 m0, s53, 0
    s_mov_b32 s49, 2097152
    v_mfma_f32_16x16x32_bf16 v[120:123], v[152:155], a[176:179], v[120:123]
    buffer_load_dwordx4 v160, s[8:11], s49 offen offset:0 lds
    v_mfma_f32_16x16x32_bf16 v[120:123], v[156:159], a[180:183], v[120:123]
    v_mfma_f32_16x16x32_bf16 v[124:127], v[152:155], a[184:187], v[124:127]
    v_mfma_f32_16x16x32_bf16 v[124:127], v[156:159], a[188:191], v[124:127]
    v_mfma_f32_16x16x32_bf16 a[0:3], v[128:131], a[160:163], a[0:3]
    ds_read_b64_tr_b16 v[152:153], v238 offset:50784
    ds_read_b64_tr_b16 v[154:155], v238 offset:51040
    v_mfma_f32_16x16x32_bf16 a[0:3], v[132:135], a[164:167], a[0:3]
    ds_read_b64_tr_b16 v[156:157], v238 offset:51296
    ds_read_b64_tr_b16 v[158:159], v238 offset:51552
    v_mfma_f32_16x16x32_bf16 a[4:7], v[128:131], a[168:171], a[4:7]
    v_mfma_f32_16x16x32_bf16 a[4:7], v[132:135], a[172:175], a[4:7]
    buffer_load_dwordx4 v161, s[8:11], s49 offen offset:1056 lds
    v_mfma_f32_16x16x32_bf16 a[8:11], v[128:131], a[176:179], a[8:11]
    v_mfma_f32_16x16x32_bf16 a[8:11], v[132:135], a[180:183], a[8:11]
    v_mfma_f32_16x16x32_bf16 a[12:15], v[128:131], a[184:187], a[12:15]
    v_mfma_f32_16x16x32_bf16 a[12:15], v[132:135], a[188:191], a[12:15]
    s_waitcnt lgkmcnt(0)
    v_mfma_f32_16x16x32_bf16 a[16:19], v[136:139], a[160:163], a[16:19]
    ds_read_b64_tr_b16 v[128:129], v238 offset:50816
    ds_read_b64_tr_b16 v[130:131], v238 offset:51072
    v_mfma_f32_16x16x32_bf16 a[16:19], v[140:143], a[164:167], a[16:19]
    ds_read_b64_tr_b16 v[132:133], v238 offset:51328
    ds_read_b64_tr_b16 v[134:135], v238 offset:51584
    v_mfma_f32_16x16x32_bf16 a[20:23], v[136:139], a[168:171], a[20:23]
    v_mfma_f32_16x16x32_bf16 a[20:23], v[140:143], a[172:175], a[20:23]
    buffer_load_dwordx4 v162, s[8:11], s49 offen offset:2112 lds
    v_mfma_f32_16x16x32_bf16 a[24:27], v[136:139], a[176:179], a[24:27]
    v_mfma_f32_16x16x32_bf16 a[24:27], v[140:143], a[180:183], a[24:27]
    v_mfma_f32_16x16x32_bf16 a[28:31], v[136:139], a[184:187], a[28:31]
    v_mfma_f32_16x16x32_bf16 a[28:31], v[140:143], a[188:191], a[28:31]
    v_mfma_f32_16x16x32_bf16 a[32:35], v[144:147], a[160:163], a[32:35]
    ds_read_b64_tr_b16 v[136:137], v238 offset:50848
    ds_read_b64_tr_b16 v[138:139], v238 offset:51104
    v_mfma_f32_16x16x32_bf16 a[32:35], v[148:151], a[164:167], a[32:35]
    ds_read_b64_tr_b16 v[140:141], v238 offset:51360
    ds_read_b64_tr_b16 v[142:143], v238 offset:51616
    v_mfma_f32_16x16x32_bf16 a[36:39], v[144:147], a[168:171], a[36:39]
    buffer_load_dwordx4 v163, s[8:11], s49 offen offset:3168 lds
    v_mfma_f32_16x16x32_bf16 a[36:39], v[148:151], a[172:175], a[36:39]
    v_mfma_f32_16x16x32_bf16 a[40:43], v[144:147], a[176:179], a[40:43]
    v_mfma_f32_16x16x32_bf16 a[40:43], v[148:151], a[180:183], a[40:43]
    v_mfma_f32_16x16x32_bf16 a[44:47], v[144:147], a[184:187], a[44:47]
    v_mfma_f32_16x16x32_bf16 a[44:47], v[148:151], a[188:191], a[44:47]
    v_mfma_f32_16x16x32_bf16 a[48:51], v[152:155], a[160:163], a[48:51]
    ds_read_b64_tr_b16 v[144:145], v238 offset:50880
    ds_read_b64_tr_b16 v[146:147], v238 offset:51136
    v_mfma_f32_16x16x32_bf16 a[48:51], v[156:159], a[164:167], a[48:51]
    s_add_u32 m0, s53, 16896
    s_mov_b32 s49, 1835008
    v_mfma_f32_16x16x32_bf16 a[52:55], v[152:155], a[168:171], a[52:55]
    ds_read_b64_tr_b16 v[148:149], v238 offset:51392
    ds_read_b64_tr_b16 v[150:151], v238 offset:51648
    v_mfma_f32_16x16x32_bf16 a[52:55], v[156:159], a[172:175], a[52:55]
    buffer_load_dwordx4 v164, s[12:15], s49 offen offset:0 lds
    v_mfma_f32_16x16x32_bf16 a[56:59], v[152:155], a[176:179], a[56:59]
    v_mfma_f32_16x16x32_bf16 a[56:59], v[156:159], a[180:183], a[56:59]
    v_mfma_f32_16x16x32_bf16 a[60:63], v[152:155], a[184:187], a[60:63]
    v_mfma_f32_16x16x32_bf16 a[60:63], v[156:159], a[188:191], a[60:63]
    s_waitcnt lgkmcnt(2)
    v_mfma_f32_16x16x32_bf16 a[64:67], v[128:131], a[160:163], a[64:67]
    ds_read_b64_tr_b16 v[152:153], v238 offset:50912
    ds_read_b64_tr_b16 v[154:155], v238 offset:51168
    v_mfma_f32_16x16x32_bf16 a[64:67], v[132:135], a[164:167], a[64:67]
    ds_read_b64_tr_b16 v[156:157], v238 offset:51424
    ds_read_b64_tr_b16 v[158:159], v238 offset:51680
    v_mfma_f32_16x16x32_bf16 a[68:71], v[128:131], a[168:171], a[68:71]
    buffer_load_dwordx4 v165, s[12:15], s49 offen offset:1056 lds
    v_mfma_f32_16x16x32_bf16 a[68:71], v[132:135], a[172:175], a[68:71]
    v_mfma_f32_16x16x32_bf16 a[72:75], v[128:131], a[176:179], a[72:75]
    v_mfma_f32_16x16x32_bf16 a[72:75], v[132:135], a[180:183], a[72:75]
    v_mfma_f32_16x16x32_bf16 a[76:79], v[128:131], a[184:187], a[76:79]
    v_mfma_f32_16x16x32_bf16 a[76:79], v[132:135], a[188:191], a[76:79]
    v_mfma_f32_16x16x32_bf16 a[80:83], v[136:139], a[160:163], a[80:83]
    v_mfma_f32_16x16x32_bf16 a[80:83], v[140:143], a[164:167], a[80:83]
    buffer_load_dwordx4 v166, s[12:15], s49 offen offset:2112 lds
    v_mfma_f32_16x16x32_bf16 a[84:87], v[136:139], a[168:171], a[84:87]
    s_waitcnt vmcnt(31) lgkmcnt(0)
    s_barrier
    v_mfma_f32_16x16x32_bf16 a[84:87], v[140:143], a[172:175], a[84:87]
    ds_read_b64_tr_b16 v[128:129], v173 offset:0
    ds_read_b64_tr_b16 v[130:131], v173 offset:256
    v_mfma_f32_16x16x32_bf16 a[88:91], v[136:139], a[176:179], a[88:91]
    ds_read_b64_tr_b16 v[132:133], v173 offset:512
    ds_read_b64_tr_b16 v[134:135], v173 offset:768
    v_mfma_f32_16x16x32_bf16 a[88:91], v[140:143], a[180:183], a[88:91]
    v_mfma_f32_16x16x32_bf16 a[92:95], v[136:139], a[184:187], a[92:95]
    v_mfma_f32_16x16x32_bf16 a[92:95], v[140:143], a[188:191], a[92:95]
    v_mfma_f32_16x16x32_bf16 a[96:99], v[144:147], a[160:163], a[96:99]
    buffer_load_dwordx4 v167, s[12:15], s49 offen offset:3168 lds
    v_mfma_f32_16x16x32_bf16 a[96:99], v[148:151], a[164:167], a[96:99]
    ds_read_b64_tr_b16 v[136:137], v173 offset:8
    ds_read_b64_tr_b16 v[138:139], v173 offset:264
    v_mfma_f32_16x16x32_bf16 a[100:103], v[144:147], a[168:171], a[100:103]
    ds_read_b64_tr_b16 v[140:141], v173 offset:520
    ds_read_b64_tr_b16 v[142:143], v173 offset:776
    v_mfma_f32_16x16x32_bf16 a[100:103], v[148:151], a[172:175], a[100:103]
    v_mfma_f32_16x16x32_bf16 a[104:107], v[144:147], a[176:179], a[104:107]
    v_mfma_f32_16x16x32_bf16 a[104:107], v[148:151], a[180:183], a[104:107]
    v_mfma_f32_16x16x32_bf16 a[108:111], v[144:147], a[184:187], a[108:111]
    v_mfma_f32_16x16x32_bf16 a[108:111], v[148:151], a[188:191], a[108:111]
    v_mfma_f32_16x16x32_bf16 a[112:115], v[152:155], a[160:163], a[112:115]
    ds_read_b64_tr_b16 v[144:145], v173 offset:64
    ds_read_b64_tr_b16 v[146:147], v173 offset:320
    v_mfma_f32_16x16x32_bf16 a[112:115], v[156:159], a[164:167], a[112:115]
    ds_read_b64_tr_b16 v[148:149], v173 offset:576
    ds_read_b64_tr_b16 v[150:151], v173 offset:832
    v_mfma_f32_16x16x32_bf16 a[116:119], v[152:155], a[168:171], a[116:119]
    v_mfma_f32_16x16x32_bf16 a[116:119], v[156:159], a[172:175], a[116:119]
    v_mfma_f32_16x16x32_bf16 a[120:123], v[152:155], a[176:179], a[120:123]
    v_mfma_f32_16x16x32_bf16 a[120:123], v[156:159], a[180:183], a[120:123]
    v_mfma_f32_16x16x32_bf16 a[124:127], v[152:155], a[184:187], a[124:127]
    v_mfma_f32_16x16x32_bf16 a[124:127], v[156:159], a[188:191], a[124:127]
    s_waitcnt vmcnt(24)
    s_waitcnt lgkmcnt(0)
    v_mfma_f32_16x16x32_bf16 v[0:3], v[128:131], a[192:195], v[0:3]
    ds_read_b64_tr_b16 v[152:153], v173 offset:72
    ds_read_b64_tr_b16 v[154:155], v173 offset:328
    v_mfma_f32_16x16x32_bf16 v[0:3], v[132:135], a[196:199], v[0:3]
    ds_read_b64_tr_b16 v[156:157], v173 offset:584
    s_mov_b32 s48, 8192
    v_mfma_f32_16x16x32_bf16 v[4:7], v[128:131], a[200:203], v[4:7]
    ds_read_b64_tr_b16 v[158:159], v173 offset:840
    v_mfma_f32_16x16x32_bf16 v[4:7], v[132:135], a[204:207], v[4:7]
    buffer_load_dwordx4 a[128:131], v168, s[4:7], s48 offen offset:0 sc1
    v_mfma_f32_16x16x32_bf16 v[8:11], v[128:131], a[208:211], v[8:11]
    v_mfma_f32_16x16x32_bf16 v[8:11], v[132:135], a[212:215], v[8:11]
    v_mfma_f32_16x16x32_bf16 v[12:15], v[128:131], a[216:219], v[12:15]
    v_mfma_f32_16x16x32_bf16 v[12:15], v[132:135], a[220:223], v[12:15]
    v_mfma_f32_16x16x32_bf16 v[16:19], v[136:139], a[192:195], v[16:19]
    buffer_load_dwordx4 a[132:135], v168, s[4:7], s48 offen offset:1024 sc1
    v_mfma_f32_16x16x32_bf16 v[16:19], v[140:143], a[196:199], v[16:19]
    ds_read_b64_tr_b16 v[128:129], v173 offset:128
    ds_read_b64_tr_b16 v[130:131], v173 offset:384
    v_mfma_f32_16x16x32_bf16 v[20:23], v[136:139], a[200:203], v[20:23]
    ds_read_b64_tr_b16 v[132:133], v173 offset:640
    ds_read_b64_tr_b16 v[134:135], v173 offset:896
    v_mfma_f32_16x16x32_bf16 v[20:23], v[140:143], a[204:207], v[20:23]
    v_mfma_f32_16x16x32_bf16 v[24:27], v[136:139], a[208:211], v[24:27]
    v_mfma_f32_16x16x32_bf16 v[24:27], v[140:143], a[212:215], v[24:27]
    v_mfma_f32_16x16x32_bf16 v[28:31], v[136:139], a[216:219], v[28:31]
    v_mfma_f32_16x16x32_bf16 v[28:31], v[140:143], a[220:223], v[28:31]
    buffer_load_dwordx4 a[136:139], v169, s[4:7], s48 offen offset:0 sc1
    v_mfma_f32_16x16x32_bf16 v[32:35], v[144:147], a[192:195], v[32:35]
    ds_read_b64_tr_b16 v[136:137], v173 offset:136
    ds_read_b64_tr_b16 v[138:139], v173 offset:392
    v_mfma_f32_16x16x32_bf16 v[32:35], v[148:151], a[196:199], v[32:35]
    ds_read_b64_tr_b16 v[140:141], v173 offset:648
    ds_read_b64_tr_b16 v[142:143], v173 offset:904
    v_mfma_f32_16x16x32_bf16 v[36:39], v[144:147], a[200:203], v[36:39]
    v_mfma_f32_16x16x32_bf16 v[36:39], v[148:151], a[204:207], v[36:39]
    v_mfma_f32_16x16x32_bf16 v[40:43], v[144:147], a[208:211], v[40:43]
    v_mfma_f32_16x16x32_bf16 v[40:43], v[148:151], a[212:215], v[40:43]
    v_mfma_f32_16x16x32_bf16 v[44:47], v[144:147], a[216:219], v[44:47]
    v_mfma_f32_16x16x32_bf16 v[44:47], v[148:151], a[220:223], v[44:47]
    buffer_load_dwordx4 a[140:143], v169, s[4:7], s48 offen offset:1024 sc1
    s_waitcnt lgkmcnt(0)
    v_mfma_f32_16x16x32_bf16 v[48:51], v[152:155], a[192:195], v[48:51]
    ds_read_b64_tr_b16 v[144:145], v173 offset:192
    ds_read_b64_tr_b16 v[146:147], v173 offset:448
    v_mfma_f32_16x16x32_bf16 v[48:51], v[156:159], a[196:199], v[48:51]
    ds_read_b64_tr_b16 v[148:149], v173 offset:704
    ds_read_b64_tr_b16 v[150:151], v173 offset:960
    v_mfma_f32_16x16x32_bf16 v[52:55], v[152:155], a[200:203], v[52:55]
    v_mfma_f32_16x16x32_bf16 v[52:55], v[156:159], a[204:207], v[52:55]
    v_mfma_f32_16x16x32_bf16 v[56:59], v[152:155], a[208:211], v[56:59]
    v_mfma_f32_16x16x32_bf16 v[56:59], v[156:159], a[212:215], v[56:59]
    v_mfma_f32_16x16x32_bf16 v[60:63], v[152:155], a[216:219], v[60:63]
    buffer_load_dwordx4 a[144:147], v170, s[4:7], s48 offen offset:0 sc1
    v_mfma_f32_16x16x32_bf16 v[60:63], v[156:159], a[220:223], v[60:63]
    v_mfma_f32_16x16x32_bf16 v[64:67], v[128:131], a[192:195], v[64:67]
    ds_read_b64_tr_b16 v[152:153], v173 offset:200
    ds_read_b64_tr_b16 v[154:155], v173 offset:456
    v_mfma_f32_16x16x32_bf16 v[64:67], v[132:135], a[196:199], v[64:67]
    ds_read_b64_tr_b16 v[156:157], v173 offset:712
    ds_read_b64_tr_b16 v[158:159], v173 offset:968
    v_mfma_f32_16x16x32_bf16 v[68:71], v[128:131], a[200:203], v[68:71]
    v_mfma_f32_16x16x32_bf16 v[68:71], v[132:135], a[204:207], v[68:71]
    v_mfma_f32_16x16x32_bf16 v[72:75], v[128:131], a[208:211], v[72:75]
    v_mfma_f32_16x16x32_bf16 v[72:75], v[132:135], a[212:215], v[72:75]
    v_mfma_f32_16x16x32_bf16 v[76:79], v[128:131], a[216:219], v[76:79]
    buffer_load_dwordx4 a[148:151], v170, s[4:7], s48 offen offset:1024 sc1
    v_mfma_f32_16x16x32_bf16 v[76:79], v[132:135], a[220:223], v[76:79]
    v_mfma_f32_16x16x32_bf16 v[80:83], v[136:139], a[192:195], v[80:83]
    ds_read_b64_tr_b16 v[128:129], v239 offset:16896
    ds_read_b64_tr_b16 v[130:131], v239 offset:17152
    v_mfma_f32_16x16x32_bf16 v[80:83], v[140:143], a[196:199], v[80:83]
    ds_read_b64_tr_b16 v[132:133], v239 offset:17408
    ds_read_b64_tr_b16 v[134:135], v239 offset:17664
    v_mfma_f32_16x16x32_bf16 v[84:87], v[136:139], a[200:203], v[84:87]
    v_mfma_f32_16x16x32_bf16 v[84:87], v[140:143], a[204:207], v[84:87]
    v_mfma_f32_16x16x32_bf16 v[88:91], v[136:139], a[208:211], v[88:91]
    v_mfma_f32_16x16x32_bf16 v[88:91], v[140:143], a[212:215], v[88:91]
    buffer_load_dwordx4 a[152:155], v171, s[4:7], s48 offen offset:0 sc1
    v_mfma_f32_16x16x32_bf16 v[92:95], v[136:139], a[216:219], v[92:95]
    v_mfma_f32_16x16x32_bf16 v[92:95], v[140:143], a[220:223], v[92:95]
    s_waitcnt lgkmcnt(0)
    v_mfma_f32_16x16x32_bf16 v[96:99], v[144:147], a[192:195], v[96:99]
    ds_read_b64_tr_b16 v[136:137], v239 offset:16928
    ds_read_b64_tr_b16 v[138:139], v239 offset:17184
    v_mfma_f32_16x16x32_bf16 v[96:99], v[148:151], a[196:199], v[96:99]
    ds_read_b64_tr_b16 v[140:141], v239 offset:17440
    ds_read_b64_tr_b16 v[142:143], v239 offset:17696
    v_mfma_f32_16x16x32_bf16 v[100:103], v[144:147], a[200:203], v[100:103]
    v_mfma_f32_16x16x32_bf16 v[100:103], v[148:151], a[204:207], v[100:103]
    v_mfma_f32_16x16x32_bf16 v[104:107], v[144:147], a[208:211], v[104:107]
    v_mfma_f32_16x16x32_bf16 v[104:107], v[148:151], a[212:215], v[104:107]
    buffer_load_dwordx4 a[156:159], v171, s[4:7], s48 offen offset:1024 sc1
    v_mfma_f32_16x16x32_bf16 v[108:111], v[144:147], a[216:219], v[108:111]
    v_mfma_f32_16x16x32_bf16 v[108:111], v[148:151], a[220:223], v[108:111]
    v_mfma_f32_16x16x32_bf16 v[112:115], v[152:155], a[192:195], v[112:115]
    ds_read_b64_tr_b16 v[144:145], v239 offset:16960
    ds_read_b64_tr_b16 v[146:147], v239 offset:17216
    v_mfma_f32_16x16x32_bf16 v[112:115], v[156:159], a[196:199], v[112:115]
    ds_read_b64_tr_b16 v[148:149], v239 offset:17472
    ds_read_b64_tr_b16 v[150:151], v239 offset:17728
    v_mfma_f32_16x16x32_bf16 v[116:119], v[152:155], a[200:203], v[116:119]
    v_mfma_f32_16x16x32_bf16 v[116:119], v[156:159], a[204:207], v[116:119]
    s_add_u32 m0, s53, 33792
    s_mov_b32 s49, 2621440
    v_mfma_f32_16x16x32_bf16 v[120:123], v[152:155], a[208:211], v[120:123]
    buffer_load_dwordx4 v160, s[8:11], s49 offen offset:0 lds
    v_mfma_f32_16x16x32_bf16 v[120:123], v[156:159], a[212:215], v[120:123]
    v_mfma_f32_16x16x32_bf16 v[124:127], v[152:155], a[216:219], v[124:127]
    v_mfma_f32_16x16x32_bf16 v[124:127], v[156:159], a[220:223], v[124:127]
    v_mfma_f32_16x16x32_bf16 a[0:3], v[128:131], a[192:195], a[0:3]
    ds_read_b64_tr_b16 v[152:153], v239 offset:16992
    ds_read_b64_tr_b16 v[154:155], v239 offset:17248
    v_mfma_f32_16x16x32_bf16 a[0:3], v[132:135], a[196:199], a[0:3]
    ds_read_b64_tr_b16 v[156:157], v239 offset:17504
    ds_read_b64_tr_b16 v[158:159], v239 offset:17760
    v_mfma_f32_16x16x32_bf16 a[4:7], v[128:131], a[200:203], a[4:7]
    v_mfma_f32_16x16x32_bf16 a[4:7], v[132:135], a[204:207], a[4:7]
    buffer_load_dwordx4 v161, s[8:11], s49 offen offset:1056 lds
    v_mfma_f32_16x16x32_bf16 a[8:11], v[128:131], a[208:211], a[8:11]
    v_mfma_f32_16x16x32_bf16 a[8:11], v[132:135], a[212:215], a[8:11]
    v_mfma_f32_16x16x32_bf16 a[12:15], v[128:131], a[216:219], a[12:15]
    v_mfma_f32_16x16x32_bf16 a[12:15], v[132:135], a[220:223], a[12:15]
    s_waitcnt lgkmcnt(0)
    v_mfma_f32_16x16x32_bf16 a[16:19], v[136:139], a[192:195], a[16:19]
    ds_read_b64_tr_b16 v[128:129], v239 offset:17024
    ds_read_b64_tr_b16 v[130:131], v239 offset:17280
    v_mfma_f32_16x16x32_bf16 a[16:19], v[140:143], a[196:199], a[16:19]
    ds_read_b64_tr_b16 v[132:133], v239 offset:17536
    ds_read_b64_tr_b16 v[134:135], v239 offset:17792
    v_mfma_f32_16x16x32_bf16 a[20:23], v[136:139], a[200:203], a[20:23]
    v_mfma_f32_16x16x32_bf16 a[20:23], v[140:143], a[204:207], a[20:23]
    buffer_load_dwordx4 v162, s[8:11], s49 offen offset:2112 lds
    v_mfma_f32_16x16x32_bf16 a[24:27], v[136:139], a[208:211], a[24:27]
    v_mfma_f32_16x16x32_bf16 a[24:27], v[140:143], a[212:215], a[24:27]
    v_mfma_f32_16x16x32_bf16 a[28:31], v[136:139], a[216:219], a[28:31]
    v_mfma_f32_16x16x32_bf16 a[28:31], v[140:143], a[220:223], a[28:31]
    v_mfma_f32_16x16x32_bf16 a[32:35], v[144:147], a[192:195], a[32:35]
    ds_read_b64_tr_b16 v[136:137], v239 offset:17056
    ds_read_b64_tr_b16 v[138:139], v239 offset:17312
    v_mfma_f32_16x16x32_bf16 a[32:35], v[148:151], a[196:199], a[32:35]
    ds_read_b64_tr_b16 v[140:141], v239 offset:17568
    ds_read_b64_tr_b16 v[142:143], v239 offset:17824
    v_mfma_f32_16x16x32_bf16 a[36:39], v[144:147], a[200:203], a[36:39]
    buffer_load_dwordx4 v163, s[8:11], s49 offen offset:3168 lds
    v_mfma_f32_16x16x32_bf16 a[36:39], v[148:151], a[204:207], a[36:39]
    v_mfma_f32_16x16x32_bf16 a[40:43], v[144:147], a[208:211], a[40:43]
    v_mfma_f32_16x16x32_bf16 a[40:43], v[148:151], a[212:215], a[40:43]
    v_mfma_f32_16x16x32_bf16 a[44:47], v[144:147], a[216:219], a[44:47]
    v_mfma_f32_16x16x32_bf16 a[44:47], v[148:151], a[220:223], a[44:47]
    v_mfma_f32_16x16x32_bf16 a[48:51], v[152:155], a[192:195], a[48:51]
    ds_read_b64_tr_b16 v[144:145], v239 offset:17088
    ds_read_b64_tr_b16 v[146:147], v239 offset:17344
    v_mfma_f32_16x16x32_bf16 a[48:51], v[156:159], a[196:199], a[48:51]
    s_add_u32 m0, s53, 50688
    s_mov_b32 s49, 2293760
    v_mfma_f32_16x16x32_bf16 a[52:55], v[152:155], a[200:203], a[52:55]
    ds_read_b64_tr_b16 v[148:149], v239 offset:17600
    ds_read_b64_tr_b16 v[150:151], v239 offset:17856
    v_mfma_f32_16x16x32_bf16 a[52:55], v[156:159], a[204:207], a[52:55]
    buffer_load_dwordx4 v164, s[12:15], s49 offen offset:0 lds
    v_mfma_f32_16x16x32_bf16 a[56:59], v[152:155], a[208:211], a[56:59]
    v_mfma_f32_16x16x32_bf16 a[56:59], v[156:159], a[212:215], a[56:59]
    v_mfma_f32_16x16x32_bf16 a[60:63], v[152:155], a[216:219], a[60:63]
    v_mfma_f32_16x16x32_bf16 a[60:63], v[156:159], a[220:223], a[60:63]
    s_waitcnt lgkmcnt(2)
    v_mfma_f32_16x16x32_bf16 a[64:67], v[128:131], a[192:195], a[64:67]
    ds_read_b64_tr_b16 v[152:153], v239 offset:17120
    ds_read_b64_tr_b16 v[154:155], v239 offset:17376
    v_mfma_f32_16x16x32_bf16 a[64:67], v[132:135], a[196:199], a[64:67]
    ds_read_b64_tr_b16 v[156:157], v239 offset:17632
    ds_read_b64_tr_b16 v[158:159], v239 offset:17888
    v_mfma_f32_16x16x32_bf16 a[68:71], v[128:131], a[200:203], a[68:71]
    buffer_load_dwordx4 v165, s[12:15], s49 offen offset:1056 lds
    v_mfma_f32_16x16x32_bf16 a[68:71], v[132:135], a[204:207], a[68:71]
    v_mfma_f32_16x16x32_bf16 a[72:75], v[128:131], a[208:211], a[72:75]
    v_mfma_f32_16x16x32_bf16 a[72:75], v[132:135], a[212:215], a[72:75]
    v_mfma_f32_16x16x32_bf16 a[76:79], v[128:131], a[216:219], a[76:79]
    v_mfma_f32_16x16x32_bf16 a[76:79], v[132:135], a[220:223], a[76:79]
    v_mfma_f32_16x16x32_bf16 a[80:83], v[136:139], a[192:195], a[80:83]
    v_mfma_f32_16x16x32_bf16 a[80:83], v[140:143], a[196:199], a[80:83]
    buffer_load_dwordx4 v166, s[12:15], s49 offen offset:2112 lds
    v_mfma_f32_16x16x32_bf16 a[84:87], v[136:139], a[200:203], a[84:87]
    s_waitcnt vmcnt(31) lgkmcnt(0)
    s_barrier
    v_mfma_f32_16x16x32_bf16 a[84:87], v[140:143], a[204:207], a[84:87]
    ds_read_b64_tr_b16 v[128:129], v173 offset:33792
    ds_read_b64_tr_b16 v[130:131], v173 offset:34048
    v_mfma_f32_16x16x32_bf16 a[88:91], v[136:139], a[208:211], a[88:91]
    ds_read_b64_tr_b16 v[132:133], v173 offset:34304
    ds_read_b64_tr_b16 v[134:135], v173 offset:34560
    v_mfma_f32_16x16x32_bf16 a[88:91], v[140:143], a[212:215], a[88:91]
    v_mfma_f32_16x16x32_bf16 a[92:95], v[136:139], a[216:219], a[92:95]
    v_mfma_f32_16x16x32_bf16 a[92:95], v[140:143], a[220:223], a[92:95]
    v_mfma_f32_16x16x32_bf16 a[96:99], v[144:147], a[192:195], a[96:99]
    buffer_load_dwordx4 v167, s[12:15], s49 offen offset:3168 lds
    v_mfma_f32_16x16x32_bf16 a[96:99], v[148:151], a[196:199], a[96:99]
    ds_read_b64_tr_b16 v[136:137], v173 offset:33800
    ds_read_b64_tr_b16 v[138:139], v173 offset:34056
    v_mfma_f32_16x16x32_bf16 a[100:103], v[144:147], a[200:203], a[100:103]
    ds_read_b64_tr_b16 v[140:141], v173 offset:34312
    ds_read_b64_tr_b16 v[142:143], v173 offset:34568
    v_mfma_f32_16x16x32_bf16 a[100:103], v[148:151], a[204:207], a[100:103]
    v_mfma_f32_16x16x32_bf16 a[104:107], v[144:147], a[208:211], a[104:107]
    v_mfma_f32_16x16x32_bf16 a[104:107], v[148:151], a[212:215], a[104:107]
    v_mfma_f32_16x16x32_bf16 a[108:111], v[144:147], a[216:219], a[108:111]
    v_mfma_f32_16x16x32_bf16 a[108:111], v[148:151], a[220:223], a[108:111]
    v_mfma_f32_16x16x32_bf16 a[112:115], v[152:155], a[192:195], a[112:115]
    ds_read_b64_tr_b16 v[144:145], v173 offset:33856
    ds_read_b64_tr_b16 v[146:147], v173 offset:34112
    v_mfma_f32_16x16x32_bf16 a[112:115], v[156:159], a[196:199], a[112:115]
    ds_read_b64_tr_b16 v[148:149], v173 offset:34368
    ds_read_b64_tr_b16 v[150:151], v173 offset:34624
    v_mfma_f32_16x16x32_bf16 a[116:119], v[152:155], a[200:203], a[116:119]
    v_mfma_f32_16x16x32_bf16 a[116:119], v[156:159], a[204:207], a[116:119]
    v_mfma_f32_16x16x32_bf16 a[120:123], v[152:155], a[208:211], a[120:123]
    v_mfma_f32_16x16x32_bf16 a[120:123], v[156:159], a[212:215], a[120:123]
    v_mfma_f32_16x16x32_bf16 a[124:127], v[152:155], a[216:219], a[124:127]
    v_mfma_f32_16x16x32_bf16 a[124:127], v[156:159], a[220:223], a[124:127]
    s_waitcnt vmcnt(24)
    s_waitcnt lgkmcnt(0)
    v_mfma_f32_16x16x32_bf16 v[0:3], v[128:131], a[224:227], v[0:3]
    ds_read_b64_tr_b16 v[152:153], v173 offset:33864
    ds_read_b64_tr_b16 v[154:155], v173 offset:34120
    v_mfma_f32_16x16x32_bf16 v[0:3], v[132:135], a[228:231], v[0:3]
    ds_read_b64_tr_b16 v[156:157], v173 offset:34376
    s_mov_b32 s48, 10240
    v_mfma_f32_16x16x32_bf16 v[4:7], v[128:131], a[232:235], v[4:7]
    ds_read_b64_tr_b16 v[158:159], v173 offset:34632
    v_mfma_f32_16x16x32_bf16 v[4:7], v[132:135], a[236:239], v[4:7]
    buffer_load_dwordx4 a[160:163], v168, s[4:7], s48 offen offset:0 sc1
    v_mfma_f32_16x16x32_bf16 v[8:11], v[128:131], a[240:243], v[8:11]
    v_mfma_f32_16x16x32_bf16 v[8:11], v[132:135], a[244:247], v[8:11]
    v_mfma_f32_16x16x32_bf16 v[12:15], v[128:131], a[248:251], v[12:15]
    v_mfma_f32_16x16x32_bf16 v[12:15], v[132:135], a[252:255], v[12:15]
    v_mfma_f32_16x16x32_bf16 v[16:19], v[136:139], a[224:227], v[16:19]
    buffer_load_dwordx4 a[164:167], v168, s[4:7], s48 offen offset:1024 sc1
    v_mfma_f32_16x16x32_bf16 v[16:19], v[140:143], a[228:231], v[16:19]
    ds_read_b64_tr_b16 v[128:129], v173 offset:33920
    ds_read_b64_tr_b16 v[130:131], v173 offset:34176
    v_mfma_f32_16x16x32_bf16 v[20:23], v[136:139], a[232:235], v[20:23]
    ds_read_b64_tr_b16 v[132:133], v173 offset:34432
    ds_read_b64_tr_b16 v[134:135], v173 offset:34688
    v_mfma_f32_16x16x32_bf16 v[20:23], v[140:143], a[236:239], v[20:23]
    v_mfma_f32_16x16x32_bf16 v[24:27], v[136:139], a[240:243], v[24:27]
    v_mfma_f32_16x16x32_bf16 v[24:27], v[140:143], a[244:247], v[24:27]
    v_mfma_f32_16x16x32_bf16 v[28:31], v[136:139], a[248:251], v[28:31]
    v_mfma_f32_16x16x32_bf16 v[28:31], v[140:143], a[252:255], v[28:31]
    buffer_load_dwordx4 a[168:171], v169, s[4:7], s48 offen offset:0 sc1
    v_mfma_f32_16x16x32_bf16 v[32:35], v[144:147], a[224:227], v[32:35]
    ds_read_b64_tr_b16 v[136:137], v173 offset:33928
    ds_read_b64_tr_b16 v[138:139], v173 offset:34184
    v_mfma_f32_16x16x32_bf16 v[32:35], v[148:151], a[228:231], v[32:35]
    ds_read_b64_tr_b16 v[140:141], v173 offset:34440
    ds_read_b64_tr_b16 v[142:143], v173 offset:34696
    v_mfma_f32_16x16x32_bf16 v[36:39], v[144:147], a[232:235], v[36:39]
    v_mfma_f32_16x16x32_bf16 v[36:39], v[148:151], a[236:239], v[36:39]
    v_mfma_f32_16x16x32_bf16 v[40:43], v[144:147], a[240:243], v[40:43]
    v_mfma_f32_16x16x32_bf16 v[40:43], v[148:151], a[244:247], v[40:43]
    v_mfma_f32_16x16x32_bf16 v[44:47], v[144:147], a[248:251], v[44:47]
    v_mfma_f32_16x16x32_bf16 v[44:47], v[148:151], a[252:255], v[44:47]
    buffer_load_dwordx4 a[172:175], v169, s[4:7], s48 offen offset:1024 sc1
    s_waitcnt lgkmcnt(0)
    v_mfma_f32_16x16x32_bf16 v[48:51], v[152:155], a[224:227], v[48:51]
    ds_read_b64_tr_b16 v[144:145], v173 offset:33984
    ds_read_b64_tr_b16 v[146:147], v173 offset:34240
    v_mfma_f32_16x16x32_bf16 v[48:51], v[156:159], a[228:231], v[48:51]
    ds_read_b64_tr_b16 v[148:149], v173 offset:34496
    ds_read_b64_tr_b16 v[150:151], v173 offset:34752
    v_mfma_f32_16x16x32_bf16 v[52:55], v[152:155], a[232:235], v[52:55]
    v_mfma_f32_16x16x32_bf16 v[52:55], v[156:159], a[236:239], v[52:55]
    v_mfma_f32_16x16x32_bf16 v[56:59], v[152:155], a[240:243], v[56:59]
    v_mfma_f32_16x16x32_bf16 v[56:59], v[156:159], a[244:247], v[56:59]
    v_mfma_f32_16x16x32_bf16 v[60:63], v[152:155], a[248:251], v[60:63]
    buffer_load_dwordx4 a[176:179], v170, s[4:7], s48 offen offset:0 sc1
    v_mfma_f32_16x16x32_bf16 v[60:63], v[156:159], a[252:255], v[60:63]
    v_mfma_f32_16x16x32_bf16 v[64:67], v[128:131], a[224:227], v[64:67]
    ds_read_b64_tr_b16 v[152:153], v173 offset:33992
    ds_read_b64_tr_b16 v[154:155], v173 offset:34248
    v_mfma_f32_16x16x32_bf16 v[64:67], v[132:135], a[228:231], v[64:67]
    ds_read_b64_tr_b16 v[156:157], v173 offset:34504
    ds_read_b64_tr_b16 v[158:159], v173 offset:34760
    v_mfma_f32_16x16x32_bf16 v[68:71], v[128:131], a[232:235], v[68:71]
    v_mfma_f32_16x16x32_bf16 v[68:71], v[132:135], a[236:239], v[68:71]
    v_mfma_f32_16x16x32_bf16 v[72:75], v[128:131], a[240:243], v[72:75]
    v_mfma_f32_16x16x32_bf16 v[72:75], v[132:135], a[244:247], v[72:75]
    v_mfma_f32_16x16x32_bf16 v[76:79], v[128:131], a[248:251], v[76:79]
    buffer_load_dwordx4 a[180:183], v170, s[4:7], s48 offen offset:1024 sc1
    v_mfma_f32_16x16x32_bf16 v[76:79], v[132:135], a[252:255], v[76:79]
    v_mfma_f32_16x16x32_bf16 v[80:83], v[136:139], a[224:227], v[80:83]
    ds_read_b64_tr_b16 v[128:129], v239 offset:50688
    ds_read_b64_tr_b16 v[130:131], v239 offset:50944
    v_mfma_f32_16x16x32_bf16 v[80:83], v[140:143], a[228:231], v[80:83]
    ds_read_b64_tr_b16 v[132:133], v239 offset:51200
    ds_read_b64_tr_b16 v[134:135], v239 offset:51456
    v_mfma_f32_16x16x32_bf16 v[84:87], v[136:139], a[232:235], v[84:87]
    v_mfma_f32_16x16x32_bf16 v[84:87], v[140:143], a[236:239], v[84:87]
    v_mfma_f32_16x16x32_bf16 v[88:91], v[136:139], a[240:243], v[88:91]
    v_mfma_f32_16x16x32_bf16 v[88:91], v[140:143], a[244:247], v[88:91]
    buffer_load_dwordx4 a[184:187], v171, s[4:7], s48 offen offset:0 sc1
    v_mfma_f32_16x16x32_bf16 v[92:95], v[136:139], a[248:251], v[92:95]
    v_mfma_f32_16x16x32_bf16 v[92:95], v[140:143], a[252:255], v[92:95]
    s_waitcnt lgkmcnt(0)
    v_mfma_f32_16x16x32_bf16 v[96:99], v[144:147], a[224:227], v[96:99]
    ds_read_b64_tr_b16 v[136:137], v239 offset:50720
    ds_read_b64_tr_b16 v[138:139], v239 offset:50976
    v_mfma_f32_16x16x32_bf16 v[96:99], v[148:151], a[228:231], v[96:99]
    ds_read_b64_tr_b16 v[140:141], v239 offset:51232
    ds_read_b64_tr_b16 v[142:143], v239 offset:51488
    v_mfma_f32_16x16x32_bf16 v[100:103], v[144:147], a[232:235], v[100:103]
    v_mfma_f32_16x16x32_bf16 v[100:103], v[148:151], a[236:239], v[100:103]
    v_mfma_f32_16x16x32_bf16 v[104:107], v[144:147], a[240:243], v[104:107]
    v_mfma_f32_16x16x32_bf16 v[104:107], v[148:151], a[244:247], v[104:107]
    buffer_load_dwordx4 a[188:191], v171, s[4:7], s48 offen offset:1024 sc1
    v_mfma_f32_16x16x32_bf16 v[108:111], v[144:147], a[248:251], v[108:111]
    v_mfma_f32_16x16x32_bf16 v[108:111], v[148:151], a[252:255], v[108:111]
    v_mfma_f32_16x16x32_bf16 v[112:115], v[152:155], a[224:227], v[112:115]
    ds_read_b64_tr_b16 v[144:145], v239 offset:50752
    ds_read_b64_tr_b16 v[146:147], v239 offset:51008
    v_mfma_f32_16x16x32_bf16 v[112:115], v[156:159], a[228:231], v[112:115]
    ds_read_b64_tr_b16 v[148:149], v239 offset:51264
    ds_read_b64_tr_b16 v[150:151], v239 offset:51520
    v_mfma_f32_16x16x32_bf16 v[116:119], v[152:155], a[232:235], v[116:119]
    v_mfma_f32_16x16x32_bf16 v[116:119], v[156:159], a[236:239], v[116:119]
    s_add_u32 m0, s53, 67584
    s_mov_b32 s49, 3145728
    v_mfma_f32_16x16x32_bf16 v[120:123], v[152:155], a[240:243], v[120:123]
    buffer_load_dwordx4 v160, s[8:11], s49 offen offset:0 lds
    v_mfma_f32_16x16x32_bf16 v[120:123], v[156:159], a[244:247], v[120:123]
    v_mfma_f32_16x16x32_bf16 v[124:127], v[152:155], a[248:251], v[124:127]
    v_mfma_f32_16x16x32_bf16 v[124:127], v[156:159], a[252:255], v[124:127]
    v_mfma_f32_16x16x32_bf16 a[0:3], v[128:131], a[224:227], a[0:3]
    ds_read_b64_tr_b16 v[152:153], v239 offset:50784
    ds_read_b64_tr_b16 v[154:155], v239 offset:51040
    v_mfma_f32_16x16x32_bf16 a[0:3], v[132:135], a[228:231], a[0:3]
    ds_read_b64_tr_b16 v[156:157], v239 offset:51296
    ds_read_b64_tr_b16 v[158:159], v239 offset:51552
    v_mfma_f32_16x16x32_bf16 a[4:7], v[128:131], a[232:235], a[4:7]
    v_mfma_f32_16x16x32_bf16 a[4:7], v[132:135], a[236:239], a[4:7]
    buffer_load_dwordx4 v161, s[8:11], s49 offen offset:1056 lds
    v_mfma_f32_16x16x32_bf16 a[8:11], v[128:131], a[240:243], a[8:11]
    v_mfma_f32_16x16x32_bf16 a[8:11], v[132:135], a[244:247], a[8:11]
    v_mfma_f32_16x16x32_bf16 a[12:15], v[128:131], a[248:251], a[12:15]
    v_mfma_f32_16x16x32_bf16 a[12:15], v[132:135], a[252:255], a[12:15]
    s_waitcnt lgkmcnt(0)
    v_mfma_f32_16x16x32_bf16 a[16:19], v[136:139], a[224:227], a[16:19]
    ds_read_b64_tr_b16 v[128:129], v239 offset:50816
    ds_read_b64_tr_b16 v[130:131], v239 offset:51072
    v_mfma_f32_16x16x32_bf16 a[16:19], v[140:143], a[228:231], a[16:19]
    ds_read_b64_tr_b16 v[132:133], v239 offset:51328
    ds_read_b64_tr_b16 v[134:135], v239 offset:51584
    v_mfma_f32_16x16x32_bf16 a[20:23], v[136:139], a[232:235], a[20:23]
    v_mfma_f32_16x16x32_bf16 a[20:23], v[140:143], a[236:239], a[20:23]
    buffer_load_dwordx4 v162, s[8:11], s49 offen offset:2112 lds
    v_mfma_f32_16x16x32_bf16 a[24:27], v[136:139], a[240:243], a[24:27]
    v_mfma_f32_16x16x32_bf16 a[24:27], v[140:143], a[244:247], a[24:27]
    v_mfma_f32_16x16x32_bf16 a[28:31], v[136:139], a[248:251], a[28:31]
    v_mfma_f32_16x16x32_bf16 a[28:31], v[140:143], a[252:255], a[28:31]
    v_mfma_f32_16x16x32_bf16 a[32:35], v[144:147], a[224:227], a[32:35]
    ds_read_b64_tr_b16 v[136:137], v239 offset:50848
    ds_read_b64_tr_b16 v[138:139], v239 offset:51104
    v_mfma_f32_16x16x32_bf16 a[32:35], v[148:151], a[228:231], a[32:35]
    ds_read_b64_tr_b16 v[140:141], v239 offset:51360
    ds_read_b64_tr_b16 v[142:143], v239 offset:51616
    v_mfma_f32_16x16x32_bf16 a[36:39], v[144:147], a[232:235], a[36:39]
    buffer_load_dwordx4 v163, s[8:11], s49 offen offset:3168 lds
    v_mfma_f32_16x16x32_bf16 a[36:39], v[148:151], a[236:239], a[36:39]
    v_mfma_f32_16x16x32_bf16 a[40:43], v[144:147], a[240:243], a[40:43]
    v_mfma_f32_16x16x32_bf16 a[40:43], v[148:151], a[244:247], a[40:43]
    v_mfma_f32_16x16x32_bf16 a[44:47], v[144:147], a[248:251], a[44:47]
    v_mfma_f32_16x16x32_bf16 a[44:47], v[148:151], a[252:255], a[44:47]
    v_mfma_f32_16x16x32_bf16 a[48:51], v[152:155], a[224:227], a[48:51]
    ds_read_b64_tr_b16 v[144:145], v239 offset:50880
    ds_read_b64_tr_b16 v[146:147], v239 offset:51136
    v_mfma_f32_16x16x32_bf16 a[48:51], v[156:159], a[228:231], a[48:51]
    s_add_u32 m0, s53, 84480
    s_mov_b32 s49, 2752512
    v_mfma_f32_16x16x32_bf16 a[52:55], v[152:155], a[232:235], a[52:55]
    ds_read_b64_tr_b16 v[148:149], v239 offset:51392
    ds_read_b64_tr_b16 v[150:151], v239 offset:51648
    v_mfma_f32_16x16x32_bf16 a[52:55], v[156:159], a[236:239], a[52:55]
    buffer_load_dwordx4 v164, s[12:15], s49 offen offset:0 lds
    v_mfma_f32_16x16x32_bf16 a[56:59], v[152:155], a[240:243], a[56:59]
    v_mfma_f32_16x16x32_bf16 a[56:59], v[156:159], a[244:247], a[56:59]
    v_mfma_f32_16x16x32_bf16 a[60:63], v[152:155], a[248:251], a[60:63]
    v_mfma_f32_16x16x32_bf16 a[60:63], v[156:159], a[252:255], a[60:63]
    s_waitcnt lgkmcnt(2)
    v_mfma_f32_16x16x32_bf16 a[64:67], v[128:131], a[224:227], a[64:67]
    ds_read_b64_tr_b16 v[152:153], v239 offset:50912
    ds_read_b64_tr_b16 v[154:155], v239 offset:51168
    v_mfma_f32_16x16x32_bf16 a[64:67], v[132:135], a[228:231], a[64:67]
    ds_read_b64_tr_b16 v[156:157], v239 offset:51424
    ds_read_b64_tr_b16 v[158:159], v239 offset:51680
    v_mfma_f32_16x16x32_bf16 a[68:71], v[128:131], a[232:235], a[68:71]
    buffer_load_dwordx4 v165, s[12:15], s49 offen offset:1056 lds
    v_mfma_f32_16x16x32_bf16 a[68:71], v[132:135], a[236:239], a[68:71]
    v_mfma_f32_16x16x32_bf16 a[72:75], v[128:131], a[240:243], a[72:75]
    v_mfma_f32_16x16x32_bf16 a[72:75], v[132:135], a[244:247], a[72:75]
    v_mfma_f32_16x16x32_bf16 a[76:79], v[128:131], a[248:251], a[76:79]
    v_mfma_f32_16x16x32_bf16 a[76:79], v[132:135], a[252:255], a[76:79]
    v_mfma_f32_16x16x32_bf16 a[80:83], v[136:139], a[224:227], a[80:83]
    v_mfma_f32_16x16x32_bf16 a[80:83], v[140:143], a[228:231], a[80:83]
    buffer_load_dwordx4 v166, s[12:15], s49 offen offset:2112 lds
    v_mfma_f32_16x16x32_bf16 a[84:87], v[136:139], a[232:235], a[84:87]
    s_waitcnt vmcnt(31) lgkmcnt(0)
    s_barrier
    v_mfma_f32_16x16x32_bf16 a[84:87], v[140:143], a[236:239], a[84:87]
    ds_read_b64_tr_b16 v[128:129], v172 offset:0
    ds_read_b64_tr_b16 v[130:131], v172 offset:256
    v_mfma_f32_16x16x32_bf16 a[88:91], v[136:139], a[240:243], a[88:91]
    ds_read_b64_tr_b16 v[132:133], v172 offset:512
    ds_read_b64_tr_b16 v[134:135], v172 offset:768
    v_mfma_f32_16x16x32_bf16 a[88:91], v[140:143], a[244:247], a[88:91]
    v_mfma_f32_16x16x32_bf16 a[92:95], v[136:139], a[248:251], a[92:95]
    v_mfma_f32_16x16x32_bf16 a[92:95], v[140:143], a[252:255], a[92:95]
    v_mfma_f32_16x16x32_bf16 a[96:99], v[144:147], a[224:227], a[96:99]
    buffer_load_dwordx4 v167, s[12:15], s49 offen offset:3168 lds
    v_mfma_f32_16x16x32_bf16 a[96:99], v[148:151], a[228:231], a[96:99]
    ds_read_b64_tr_b16 v[136:137], v172 offset:8
    ds_read_b64_tr_b16 v[138:139], v172 offset:264
    v_mfma_f32_16x16x32_bf16 a[100:103], v[144:147], a[232:235], a[100:103]
    ds_read_b64_tr_b16 v[140:141], v172 offset:520
    ds_read_b64_tr_b16 v[142:143], v172 offset:776
    v_mfma_f32_16x16x32_bf16 a[100:103], v[148:151], a[236:239], a[100:103]
    v_mfma_f32_16x16x32_bf16 a[104:107], v[144:147], a[240:243], a[104:107]
    v_mfma_f32_16x16x32_bf16 a[104:107], v[148:151], a[244:247], a[104:107]
    v_mfma_f32_16x16x32_bf16 a[108:111], v[144:147], a[248:251], a[108:111]
    v_mfma_f32_16x16x32_bf16 a[108:111], v[148:151], a[252:255], a[108:111]
    v_mfma_f32_16x16x32_bf16 a[112:115], v[152:155], a[224:227], a[112:115]
    ds_read_b64_tr_b16 v[144:145], v172 offset:64
    ds_read_b64_tr_b16 v[146:147], v172 offset:320
    v_mfma_f32_16x16x32_bf16 a[112:115], v[156:159], a[228:231], a[112:115]
    ds_read_b64_tr_b16 v[148:149], v172 offset:576
    ds_read_b64_tr_b16 v[150:151], v172 offset:832
    v_mfma_f32_16x16x32_bf16 a[116:119], v[152:155], a[232:235], a[116:119]
    v_mfma_f32_16x16x32_bf16 a[116:119], v[156:159], a[236:239], a[116:119]
    v_mfma_f32_16x16x32_bf16 a[120:123], v[152:155], a[240:243], a[120:123]
    v_mfma_f32_16x16x32_bf16 a[120:123], v[156:159], a[244:247], a[120:123]
    v_mfma_f32_16x16x32_bf16 a[124:127], v[152:155], a[248:251], a[124:127]
    v_mfma_f32_16x16x32_bf16 a[124:127], v[156:159], a[252:255], a[124:127]
    s_waitcnt vmcnt(24)
    s_waitcnt lgkmcnt(0)
    v_mfma_f32_16x16x32_bf16 v[0:3], v[128:131], a[128:131], v[0:3]
    ds_read_b64_tr_b16 v[152:153], v172 offset:72
    ds_read_b64_tr_b16 v[154:155], v172 offset:328
    v_mfma_f32_16x16x32_bf16 v[0:3], v[132:135], a[132:135], v[0:3]
    ds_read_b64_tr_b16 v[156:157], v172 offset:584
    s_mov_b32 s48, 12288
    v_mfma_f32_16x16x32_bf16 v[4:7], v[128:131], a[136:139], v[4:7]
    ds_read_b64_tr_b16 v[158:159], v172 offset:840
    v_mfma_f32_16x16x32_bf16 v[4:7], v[132:135], a[140:143], v[4:7]
    buffer_load_dwordx4 a[192:195], v168, s[4:7], s48 offen offset:0 sc1
    v_mfma_f32_16x16x32_bf16 v[8:11], v[128:131], a[144:147], v[8:11]
    v_mfma_f32_16x16x32_bf16 v[8:11], v[132:135], a[148:151], v[8:11]
    v_mfma_f32_16x16x32_bf16 v[12:15], v[128:131], a[152:155], v[12:15]
    v_mfma_f32_16x16x32_bf16 v[12:15], v[132:135], a[156:159], v[12:15]
    v_mfma_f32_16x16x32_bf16 v[16:19], v[136:139], a[128:131], v[16:19]
    buffer_load_dwordx4 a[196:199], v168, s[4:7], s48 offen offset:1024 sc1
    v_mfma_f32_16x16x32_bf16 v[16:19], v[140:143], a[132:135], v[16:19]
    ds_read_b64_tr_b16 v[128:129], v172 offset:128
    ds_read_b64_tr_b16 v[130:131], v172 offset:384
    v_mfma_f32_16x16x32_bf16 v[20:23], v[136:139], a[136:139], v[20:23]
    ds_read_b64_tr_b16 v[132:133], v172 offset:640
    ds_read_b64_tr_b16 v[134:135], v172 offset:896
    v_mfma_f32_16x16x32_bf16 v[20:23], v[140:143], a[140:143], v[20:23]
    v_mfma_f32_16x16x32_bf16 v[24:27], v[136:139], a[144:147], v[24:27]
    v_mfma_f32_16x16x32_bf16 v[24:27], v[140:143], a[148:151], v[24:27]
    v_mfma_f32_16x16x32_bf16 v[28:31], v[136:139], a[152:155], v[28:31]
    v_mfma_f32_16x16x32_bf16 v[28:31], v[140:143], a[156:159], v[28:31]
    buffer_load_dwordx4 a[200:203], v169, s[4:7], s48 offen offset:0 sc1
    v_mfma_f32_16x16x32_bf16 v[32:35], v[144:147], a[128:131], v[32:35]
    ds_read_b64_tr_b16 v[136:137], v172 offset:136
    ds_read_b64_tr_b16 v[138:139], v172 offset:392
    v_mfma_f32_16x16x32_bf16 v[32:35], v[148:151], a[132:135], v[32:35]
    ds_read_b64_tr_b16 v[140:141], v172 offset:648
    ds_read_b64_tr_b16 v[142:143], v172 offset:904
    v_mfma_f32_16x16x32_bf16 v[36:39], v[144:147], a[136:139], v[36:39]
    v_mfma_f32_16x16x32_bf16 v[36:39], v[148:151], a[140:143], v[36:39]
    v_mfma_f32_16x16x32_bf16 v[40:43], v[144:147], a[144:147], v[40:43]
    v_mfma_f32_16x16x32_bf16 v[40:43], v[148:151], a[148:151], v[40:43]
    v_mfma_f32_16x16x32_bf16 v[44:47], v[144:147], a[152:155], v[44:47]
    v_mfma_f32_16x16x32_bf16 v[44:47], v[148:151], a[156:159], v[44:47]
    buffer_load_dwordx4 a[204:207], v169, s[4:7], s48 offen offset:1024 sc1
    s_waitcnt lgkmcnt(0)
    v_mfma_f32_16x16x32_bf16 v[48:51], v[152:155], a[128:131], v[48:51]
    ds_read_b64_tr_b16 v[144:145], v172 offset:192
    ds_read_b64_tr_b16 v[146:147], v172 offset:448
    v_mfma_f32_16x16x32_bf16 v[48:51], v[156:159], a[132:135], v[48:51]
    ds_read_b64_tr_b16 v[148:149], v172 offset:704
    ds_read_b64_tr_b16 v[150:151], v172 offset:960
    v_mfma_f32_16x16x32_bf16 v[52:55], v[152:155], a[136:139], v[52:55]
    v_mfma_f32_16x16x32_bf16 v[52:55], v[156:159], a[140:143], v[52:55]
    v_mfma_f32_16x16x32_bf16 v[56:59], v[152:155], a[144:147], v[56:59]
    v_mfma_f32_16x16x32_bf16 v[56:59], v[156:159], a[148:151], v[56:59]
    v_mfma_f32_16x16x32_bf16 v[60:63], v[152:155], a[152:155], v[60:63]
    buffer_load_dwordx4 a[208:211], v170, s[4:7], s48 offen offset:0 sc1
    v_mfma_f32_16x16x32_bf16 v[60:63], v[156:159], a[156:159], v[60:63]
    v_mfma_f32_16x16x32_bf16 v[64:67], v[128:131], a[128:131], v[64:67]
    ds_read_b64_tr_b16 v[152:153], v172 offset:200
    ds_read_b64_tr_b16 v[154:155], v172 offset:456
    v_mfma_f32_16x16x32_bf16 v[64:67], v[132:135], a[132:135], v[64:67]
    ds_read_b64_tr_b16 v[156:157], v172 offset:712
    ds_read_b64_tr_b16 v[158:159], v172 offset:968
    v_mfma_f32_16x16x32_bf16 v[68:71], v[128:131], a[136:139], v[68:71]
    v_mfma_f32_16x16x32_bf16 v[68:71], v[132:135], a[140:143], v[68:71]
    v_mfma_f32_16x16x32_bf16 v[72:75], v[128:131], a[144:147], v[72:75]
    v_mfma_f32_16x16x32_bf16 v[72:75], v[132:135], a[148:151], v[72:75]
    v_mfma_f32_16x16x32_bf16 v[76:79], v[128:131], a[152:155], v[76:79]
    buffer_load_dwordx4 a[212:215], v170, s[4:7], s48 offen offset:1024 sc1
    v_mfma_f32_16x16x32_bf16 v[76:79], v[132:135], a[156:159], v[76:79]
    v_mfma_f32_16x16x32_bf16 v[80:83], v[136:139], a[128:131], v[80:83]
    ds_read_b64_tr_b16 v[128:129], v238 offset:16896
    ds_read_b64_tr_b16 v[130:131], v238 offset:17152
    v_mfma_f32_16x16x32_bf16 v[80:83], v[140:143], a[132:135], v[80:83]
    ds_read_b64_tr_b16 v[132:133], v238 offset:17408
    ds_read_b64_tr_b16 v[134:135], v238 offset:17664
    v_mfma_f32_16x16x32_bf16 v[84:87], v[136:139], a[136:139], v[84:87]
    v_mfma_f32_16x16x32_bf16 v[84:87], v[140:143], a[140:143], v[84:87]
    v_mfma_f32_16x16x32_bf16 v[88:91], v[136:139], a[144:147], v[88:91]
    v_mfma_f32_16x16x32_bf16 v[88:91], v[140:143], a[148:151], v[88:91]
    buffer_load_dwordx4 a[216:219], v171, s[4:7], s48 offen offset:0 sc1
    v_mfma_f32_16x16x32_bf16 v[92:95], v[136:139], a[152:155], v[92:95]
    v_mfma_f32_16x16x32_bf16 v[92:95], v[140:143], a[156:159], v[92:95]
    s_waitcnt lgkmcnt(0)
    v_mfma_f32_16x16x32_bf16 v[96:99], v[144:147], a[128:131], v[96:99]
    ds_read_b64_tr_b16 v[136:137], v238 offset:16928
    ds_read_b64_tr_b16 v[138:139], v238 offset:17184
    v_mfma_f32_16x16x32_bf16 v[96:99], v[148:151], a[132:135], v[96:99]
    ds_read_b64_tr_b16 v[140:141], v238 offset:17440
    ds_read_b64_tr_b16 v[142:143], v238 offset:17696
    v_mfma_f32_16x16x32_bf16 v[100:103], v[144:147], a[136:139], v[100:103]
    v_mfma_f32_16x16x32_bf16 v[100:103], v[148:151], a[140:143], v[100:103]
    v_mfma_f32_16x16x32_bf16 v[104:107], v[144:147], a[144:147], v[104:107]
    v_mfma_f32_16x16x32_bf16 v[104:107], v[148:151], a[148:151], v[104:107]
    buffer_load_dwordx4 a[220:223], v171, s[4:7], s48 offen offset:1024 sc1
    v_mfma_f32_16x16x32_bf16 v[108:111], v[144:147], a[152:155], v[108:111]
    v_mfma_f32_16x16x32_bf16 v[108:111], v[148:151], a[156:159], v[108:111]
    v_mfma_f32_16x16x32_bf16 v[112:115], v[152:155], a[128:131], v[112:115]
    ds_read_b64_tr_b16 v[144:145], v238 offset:16960
    ds_read_b64_tr_b16 v[146:147], v238 offset:17216
    v_mfma_f32_16x16x32_bf16 v[112:115], v[156:159], a[132:135], v[112:115]
    ds_read_b64_tr_b16 v[148:149], v238 offset:17472
    ds_read_b64_tr_b16 v[150:151], v238 offset:17728
    v_mfma_f32_16x16x32_bf16 v[116:119], v[152:155], a[136:139], v[116:119]
    v_mfma_f32_16x16x32_bf16 v[116:119], v[156:159], a[140:143], v[116:119]
    s_add_u32 m0, s53, 101376
    s_mov_b32 s49, 3670016
    v_mfma_f32_16x16x32_bf16 v[120:123], v[152:155], a[144:147], v[120:123]
    buffer_load_dwordx4 v160, s[8:11], s49 offen offset:0 lds
    v_mfma_f32_16x16x32_bf16 v[120:123], v[156:159], a[148:151], v[120:123]
    v_mfma_f32_16x16x32_bf16 v[124:127], v[152:155], a[152:155], v[124:127]
    v_mfma_f32_16x16x32_bf16 v[124:127], v[156:159], a[156:159], v[124:127]
    v_mfma_f32_16x16x32_bf16 a[0:3], v[128:131], a[128:131], a[0:3]
    ds_read_b64_tr_b16 v[152:153], v238 offset:16992
    ds_read_b64_tr_b16 v[154:155], v238 offset:17248
    v_mfma_f32_16x16x32_bf16 a[0:3], v[132:135], a[132:135], a[0:3]
    ds_read_b64_tr_b16 v[156:157], v238 offset:17504
    ds_read_b64_tr_b16 v[158:159], v238 offset:17760
    v_mfma_f32_16x16x32_bf16 a[4:7], v[128:131], a[136:139], a[4:7]
    v_mfma_f32_16x16x32_bf16 a[4:7], v[132:135], a[140:143], a[4:7]
    buffer_load_dwordx4 v161, s[8:11], s49 offen offset:1056 lds
    v_mfma_f32_16x16x32_bf16 a[8:11], v[128:131], a[144:147], a[8:11]
    v_mfma_f32_16x16x32_bf16 a[8:11], v[132:135], a[148:151], a[8:11]
    v_mfma_f32_16x16x32_bf16 a[12:15], v[128:131], a[152:155], a[12:15]
    v_mfma_f32_16x16x32_bf16 a[12:15], v[132:135], a[156:159], a[12:15]
    s_waitcnt lgkmcnt(0)
    v_mfma_f32_16x16x32_bf16 a[16:19], v[136:139], a[128:131], a[16:19]
    ds_read_b64_tr_b16 v[128:129], v238 offset:17024
    ds_read_b64_tr_b16 v[130:131], v238 offset:17280
    v_mfma_f32_16x16x32_bf16 a[16:19], v[140:143], a[132:135], a[16:19]
    ds_read_b64_tr_b16 v[132:133], v238 offset:17536
    ds_read_b64_tr_b16 v[134:135], v238 offset:17792
    v_mfma_f32_16x16x32_bf16 a[20:23], v[136:139], a[136:139], a[20:23]
    v_mfma_f32_16x16x32_bf16 a[20:23], v[140:143], a[140:143], a[20:23]
    buffer_load_dwordx4 v162, s[8:11], s49 offen offset:2112 lds
    v_mfma_f32_16x16x32_bf16 a[24:27], v[136:139], a[144:147], a[24:27]
    v_mfma_f32_16x16x32_bf16 a[24:27], v[140:143], a[148:151], a[24:27]
    v_mfma_f32_16x16x32_bf16 a[28:31], v[136:139], a[152:155], a[28:31]
    v_mfma_f32_16x16x32_bf16 a[28:31], v[140:143], a[156:159], a[28:31]
    v_mfma_f32_16x16x32_bf16 a[32:35], v[144:147], a[128:131], a[32:35]
    ds_read_b64_tr_b16 v[136:137], v238 offset:17056
    ds_read_b64_tr_b16 v[138:139], v238 offset:17312
    v_mfma_f32_16x16x32_bf16 a[32:35], v[148:151], a[132:135], a[32:35]
    ds_read_b64_tr_b16 v[140:141], v238 offset:17568
    ds_read_b64_tr_b16 v[142:143], v238 offset:17824
    v_mfma_f32_16x16x32_bf16 a[36:39], v[144:147], a[136:139], a[36:39]
    buffer_load_dwordx4 v163, s[8:11], s49 offen offset:3168 lds
    v_mfma_f32_16x16x32_bf16 a[36:39], v[148:151], a[140:143], a[36:39]
    v_mfma_f32_16x16x32_bf16 a[40:43], v[144:147], a[144:147], a[40:43]
    v_mfma_f32_16x16x32_bf16 a[40:43], v[148:151], a[148:151], a[40:43]
    v_mfma_f32_16x16x32_bf16 a[44:47], v[144:147], a[152:155], a[44:47]
    v_mfma_f32_16x16x32_bf16 a[44:47], v[148:151], a[156:159], a[44:47]
    v_mfma_f32_16x16x32_bf16 a[48:51], v[152:155], a[128:131], a[48:51]
    ds_read_b64_tr_b16 v[144:145], v238 offset:17088
    ds_read_b64_tr_b16 v[146:147], v238 offset:17344
    v_mfma_f32_16x16x32_bf16 a[48:51], v[156:159], a[132:135], a[48:51]
    s_add_u32 m0, s53, 118272
    s_mov_b32 s49, 3211264
    v_mfma_f32_16x16x32_bf16 a[52:55], v[152:155], a[136:139], a[52:55]
    ds_read_b64_tr_b16 v[148:149], v238 offset:17600
    ds_read_b64_tr_b16 v[150:151], v238 offset:17856
    v_mfma_f32_16x16x32_bf16 a[52:55], v[156:159], a[140:143], a[52:55]
    buffer_load_dwordx4 v164, s[12:15], s49 offen offset:0 lds
    v_mfma_f32_16x16x32_bf16 a[56:59], v[152:155], a[144:147], a[56:59]
    v_mfma_f32_16x16x32_bf16 a[56:59], v[156:159], a[148:151], a[56:59]
    v_mfma_f32_16x16x32_bf16 a[60:63], v[152:155], a[152:155], a[60:63]
    v_mfma_f32_16x16x32_bf16 a[60:63], v[156:159], a[156:159], a[60:63]
    s_waitcnt lgkmcnt(2)
    v_mfma_f32_16x16x32_bf16 a[64:67], v[128:131], a[128:131], a[64:67]
    ds_read_b64_tr_b16 v[152:153], v238 offset:17120
    ds_read_b64_tr_b16 v[154:155], v238 offset:17376
    v_mfma_f32_16x16x32_bf16 a[64:67], v[132:135], a[132:135], a[64:67]
    ds_read_b64_tr_b16 v[156:157], v238 offset:17632
    ds_read_b64_tr_b16 v[158:159], v238 offset:17888
    v_mfma_f32_16x16x32_bf16 a[68:71], v[128:131], a[136:139], a[68:71]
    buffer_load_dwordx4 v165, s[12:15], s49 offen offset:1056 lds
    v_mfma_f32_16x16x32_bf16 a[68:71], v[132:135], a[140:143], a[68:71]
    v_mfma_f32_16x16x32_bf16 a[72:75], v[128:131], a[144:147], a[72:75]
    v_mfma_f32_16x16x32_bf16 a[72:75], v[132:135], a[148:151], a[72:75]
    v_mfma_f32_16x16x32_bf16 a[76:79], v[128:131], a[152:155], a[76:79]
    v_mfma_f32_16x16x32_bf16 a[76:79], v[132:135], a[156:159], a[76:79]
    v_mfma_f32_16x16x32_bf16 a[80:83], v[136:139], a[128:131], a[80:83]
    v_mfma_f32_16x16x32_bf16 a[80:83], v[140:143], a[132:135], a[80:83]
    buffer_load_dwordx4 v166, s[12:15], s49 offen offset:2112 lds
    v_mfma_f32_16x16x32_bf16 a[84:87], v[136:139], a[136:139], a[84:87]
    s_waitcnt vmcnt(31) lgkmcnt(0)
    s_barrier
    v_mfma_f32_16x16x32_bf16 a[84:87], v[140:143], a[140:143], a[84:87]
    ds_read_b64_tr_b16 v[128:129], v172 offset:33792
    ds_read_b64_tr_b16 v[130:131], v172 offset:34048
    v_mfma_f32_16x16x32_bf16 a[88:91], v[136:139], a[144:147], a[88:91]
    ds_read_b64_tr_b16 v[132:133], v172 offset:34304
    ds_read_b64_tr_b16 v[134:135], v172 offset:34560
    v_mfma_f32_16x16x32_bf16 a[88:91], v[140:143], a[148:151], a[88:91]
    v_mfma_f32_16x16x32_bf16 a[92:95], v[136:139], a[152:155], a[92:95]
    v_mfma_f32_16x16x32_bf16 a[92:95], v[140:143], a[156:159], a[92:95]
    v_mfma_f32_16x16x32_bf16 a[96:99], v[144:147], a[128:131], a[96:99]
    buffer_load_dwordx4 v167, s[12:15], s49 offen offset:3168 lds
    v_mfma_f32_16x16x32_bf16 a[96:99], v[148:151], a[132:135], a[96:99]
    ds_read_b64_tr_b16 v[136:137], v172 offset:33800
    ds_read_b64_tr_b16 v[138:139], v172 offset:34056
    v_mfma_f32_16x16x32_bf16 a[100:103], v[144:147], a[136:139], a[100:103]
    ds_read_b64_tr_b16 v[140:141], v172 offset:34312
    ds_read_b64_tr_b16 v[142:143], v172 offset:34568
    v_mfma_f32_16x16x32_bf16 a[100:103], v[148:151], a[140:143], a[100:103]
    v_mfma_f32_16x16x32_bf16 a[104:107], v[144:147], a[144:147], a[104:107]
    v_mfma_f32_16x16x32_bf16 a[104:107], v[148:151], a[148:151], a[104:107]
    v_mfma_f32_16x16x32_bf16 a[108:111], v[144:147], a[152:155], a[108:111]
    v_mfma_f32_16x16x32_bf16 a[108:111], v[148:151], a[156:159], a[108:111]
    v_mfma_f32_16x16x32_bf16 a[112:115], v[152:155], a[128:131], a[112:115]
    ds_read_b64_tr_b16 v[144:145], v172 offset:33856
    ds_read_b64_tr_b16 v[146:147], v172 offset:34112
    v_mfma_f32_16x16x32_bf16 a[112:115], v[156:159], a[132:135], a[112:115]
    ds_read_b64_tr_b16 v[148:149], v172 offset:34368
    ds_read_b64_tr_b16 v[150:151], v172 offset:34624
    v_mfma_f32_16x16x32_bf16 a[116:119], v[152:155], a[136:139], a[116:119]
    v_mfma_f32_16x16x32_bf16 a[116:119], v[156:159], a[140:143], a[116:119]
    v_mfma_f32_16x16x32_bf16 a[120:123], v[152:155], a[144:147], a[120:123]
    v_mfma_f32_16x16x32_bf16 a[120:123], v[156:159], a[148:151], a[120:123]
    v_mfma_f32_16x16x32_bf16 a[124:127], v[152:155], a[152:155], a[124:127]
    v_mfma_f32_16x16x32_bf16 a[124:127], v[156:159], a[156:159], a[124:127]
    s_waitcnt vmcnt(24)
    s_waitcnt lgkmcnt(0)
    v_mfma_f32_16x16x32_bf16 v[0:3], v[128:131], a[160:163], v[0:3]
    ds_read_b64_tr_b16 v[152:153], v172 offset:33864
    ds_read_b64_tr_b16 v[154:155], v172 offset:34120
    v_mfma_f32_16x16x32_bf16 v[0:3], v[132:135], a[164:167], v[0:3]
    ds_read_b64_tr_b16 v[156:157], v172 offset:34376
    s_mov_b32 s48, 14336
    v_mfma_f32_16x16x32_bf16 v[4:7], v[128:131], a[168:171], v[4:7]
    ds_read_b64_tr_b16 v[158:159], v172 offset:34632
    v_mfma_f32_16x16x32_bf16 v[4:7], v[132:135], a[172:175], v[4:7]
    buffer_load_dwordx4 a[224:227], v168, s[4:7], s48 offen offset:0 sc1
    v_mfma_f32_16x16x32_bf16 v[8:11], v[128:131], a[176:179], v[8:11]
    v_mfma_f32_16x16x32_bf16 v[8:11], v[132:135], a[180:183], v[8:11]
    v_mfma_f32_16x16x32_bf16 v[12:15], v[128:131], a[184:187], v[12:15]
    v_mfma_f32_16x16x32_bf16 v[12:15], v[132:135], a[188:191], v[12:15]
    v_mfma_f32_16x16x32_bf16 v[16:19], v[136:139], a[160:163], v[16:19]
    buffer_load_dwordx4 a[228:231], v168, s[4:7], s48 offen offset:1024 sc1
    v_mfma_f32_16x16x32_bf16 v[16:19], v[140:143], a[164:167], v[16:19]
    ds_read_b64_tr_b16 v[128:129], v172 offset:33920
    ds_read_b64_tr_b16 v[130:131], v172 offset:34176
    v_mfma_f32_16x16x32_bf16 v[20:23], v[136:139], a[168:171], v[20:23]
    ds_read_b64_tr_b16 v[132:133], v172 offset:34432
    ds_read_b64_tr_b16 v[134:135], v172 offset:34688
    v_mfma_f32_16x16x32_bf16 v[20:23], v[140:143], a[172:175], v[20:23]
    v_mfma_f32_16x16x32_bf16 v[24:27], v[136:139], a[176:179], v[24:27]
    v_mfma_f32_16x16x32_bf16 v[24:27], v[140:143], a[180:183], v[24:27]
    v_mfma_f32_16x16x32_bf16 v[28:31], v[136:139], a[184:187], v[28:31]
    v_mfma_f32_16x16x32_bf16 v[28:31], v[140:143], a[188:191], v[28:31]
    buffer_load_dwordx4 a[232:235], v169, s[4:7], s48 offen offset:0 sc1
    v_mfma_f32_16x16x32_bf16 v[32:35], v[144:147], a[160:163], v[32:35]
    ds_read_b64_tr_b16 v[136:137], v172 offset:33928
    ds_read_b64_tr_b16 v[138:139], v172 offset:34184
    v_mfma_f32_16x16x32_bf16 v[32:35], v[148:151], a[164:167], v[32:35]
    ds_read_b64_tr_b16 v[140:141], v172 offset:34440
    ds_read_b64_tr_b16 v[142:143], v172 offset:34696
    v_mfma_f32_16x16x32_bf16 v[36:39], v[144:147], a[168:171], v[36:39]
    v_mfma_f32_16x16x32_bf16 v[36:39], v[148:151], a[172:175], v[36:39]
    v_mfma_f32_16x16x32_bf16 v[40:43], v[144:147], a[176:179], v[40:43]
    v_mfma_f32_16x16x32_bf16 v[40:43], v[148:151], a[180:183], v[40:43]
    v_mfma_f32_16x16x32_bf16 v[44:47], v[144:147], a[184:187], v[44:47]
    v_mfma_f32_16x16x32_bf16 v[44:47], v[148:151], a[188:191], v[44:47]
    buffer_load_dwordx4 a[236:239], v169, s[4:7], s48 offen offset:1024 sc1
    s_waitcnt lgkmcnt(0)
    v_mfma_f32_16x16x32_bf16 v[48:51], v[152:155], a[160:163], v[48:51]
    ds_read_b64_tr_b16 v[144:145], v172 offset:33984
    ds_read_b64_tr_b16 v[146:147], v172 offset:34240
    v_mfma_f32_16x16x32_bf16 v[48:51], v[156:159], a[164:167], v[48:51]
    ds_read_b64_tr_b16 v[148:149], v172 offset:34496
    ds_read_b64_tr_b16 v[150:151], v172 offset:34752
    v_mfma_f32_16x16x32_bf16 v[52:55], v[152:155], a[168:171], v[52:55]
    v_mfma_f32_16x16x32_bf16 v[52:55], v[156:159], a[172:175], v[52:55]
    v_mfma_f32_16x16x32_bf16 v[56:59], v[152:155], a[176:179], v[56:59]
    v_mfma_f32_16x16x32_bf16 v[56:59], v[156:159], a[180:183], v[56:59]
    v_mfma_f32_16x16x32_bf16 v[60:63], v[152:155], a[184:187], v[60:63]
    buffer_load_dwordx4 a[240:243], v170, s[4:7], s48 offen offset:0 sc1
    v_mfma_f32_16x16x32_bf16 v[60:63], v[156:159], a[188:191], v[60:63]
    v_mfma_f32_16x16x32_bf16 v[64:67], v[128:131], a[160:163], v[64:67]
    ds_read_b64_tr_b16 v[152:153], v172 offset:33992
    ds_read_b64_tr_b16 v[154:155], v172 offset:34248
    v_mfma_f32_16x16x32_bf16 v[64:67], v[132:135], a[164:167], v[64:67]
    ds_read_b64_tr_b16 v[156:157], v172 offset:34504
    ds_read_b64_tr_b16 v[158:159], v172 offset:34760
    v_mfma_f32_16x16x32_bf16 v[68:71], v[128:131], a[168:171], v[68:71]
    v_mfma_f32_16x16x32_bf16 v[68:71], v[132:135], a[172:175], v[68:71]
    v_mfma_f32_16x16x32_bf16 v[72:75], v[128:131], a[176:179], v[72:75]
    v_mfma_f32_16x16x32_bf16 v[72:75], v[132:135], a[180:183], v[72:75]
    v_mfma_f32_16x16x32_bf16 v[76:79], v[128:131], a[184:187], v[76:79]
    buffer_load_dwordx4 a[244:247], v170, s[4:7], s48 offen offset:1024 sc1
    v_mfma_f32_16x16x32_bf16 v[76:79], v[132:135], a[188:191], v[76:79]
    v_mfma_f32_16x16x32_bf16 v[80:83], v[136:139], a[160:163], v[80:83]
    ds_read_b64_tr_b16 v[128:129], v238 offset:50688
    ds_read_b64_tr_b16 v[130:131], v238 offset:50944
    v_mfma_f32_16x16x32_bf16 v[80:83], v[140:143], a[164:167], v[80:83]
    ds_read_b64_tr_b16 v[132:133], v238 offset:51200
    ds_read_b64_tr_b16 v[134:135], v238 offset:51456
    v_mfma_f32_16x16x32_bf16 v[84:87], v[136:139], a[168:171], v[84:87]
    v_mfma_f32_16x16x32_bf16 v[84:87], v[140:143], a[172:175], v[84:87]
    v_mfma_f32_16x16x32_bf16 v[88:91], v[136:139], a[176:179], v[88:91]
    v_mfma_f32_16x16x32_bf16 v[88:91], v[140:143], a[180:183], v[88:91]
    buffer_load_dwordx4 a[248:251], v171, s[4:7], s48 offen offset:0 sc1
    v_mfma_f32_16x16x32_bf16 v[92:95], v[136:139], a[184:187], v[92:95]
    v_mfma_f32_16x16x32_bf16 v[92:95], v[140:143], a[188:191], v[92:95]
    s_waitcnt lgkmcnt(0)
    v_mfma_f32_16x16x32_bf16 v[96:99], v[144:147], a[160:163], v[96:99]
    ds_read_b64_tr_b16 v[136:137], v238 offset:50720
    ds_read_b64_tr_b16 v[138:139], v238 offset:50976
    v_mfma_f32_16x16x32_bf16 v[96:99], v[148:151], a[164:167], v[96:99]
    ds_read_b64_tr_b16 v[140:141], v238 offset:51232
    ds_read_b64_tr_b16 v[142:143], v238 offset:51488
    v_mfma_f32_16x16x32_bf16 v[100:103], v[144:147], a[168:171], v[100:103]
    v_mfma_f32_16x16x32_bf16 v[100:103], v[148:151], a[172:175], v[100:103]
    v_mfma_f32_16x16x32_bf16 v[104:107], v[144:147], a[176:179], v[104:107]
    v_mfma_f32_16x16x32_bf16 v[104:107], v[148:151], a[180:183], v[104:107]
    buffer_load_dwordx4 a[252:255], v171, s[4:7], s48 offen offset:1024 sc1
    v_mfma_f32_16x16x32_bf16 v[108:111], v[144:147], a[184:187], v[108:111]
    v_mfma_f32_16x16x32_bf16 v[108:111], v[148:151], a[188:191], v[108:111]
    v_mfma_f32_16x16x32_bf16 v[112:115], v[152:155], a[160:163], v[112:115]
    ds_read_b64_tr_b16 v[144:145], v238 offset:50752
    ds_read_b64_tr_b16 v[146:147], v238 offset:51008
    v_mfma_f32_16x16x32_bf16 v[112:115], v[156:159], a[164:167], v[112:115]
    ds_read_b64_tr_b16 v[148:149], v238 offset:51264
    ds_read_b64_tr_b16 v[150:151], v238 offset:51520
    v_mfma_f32_16x16x32_bf16 v[116:119], v[152:155], a[168:171], v[116:119]
    v_mfma_f32_16x16x32_bf16 v[116:119], v[156:159], a[172:175], v[116:119]
    s_add_u32 m0, s53, 0
    s_mov_b32 s49, 3670016
    v_mfma_f32_16x16x32_bf16 v[120:123], v[152:155], a[176:179], v[120:123]
    buffer_load_dwordx4 v164, s[12:15], s49 offen offset:0 lds
    v_mfma_f32_16x16x32_bf16 v[120:123], v[156:159], a[180:183], v[120:123]
    v_mfma_f32_16x16x32_bf16 v[124:127], v[152:155], a[184:187], v[124:127]
    v_mfma_f32_16x16x32_bf16 v[124:127], v[156:159], a[188:191], v[124:127]
    v_mfma_f32_16x16x32_bf16 a[0:3], v[128:131], a[160:163], a[0:3]
    ds_read_b64_tr_b16 v[152:153], v238 offset:50784
    ds_read_b64_tr_b16 v[154:155], v238 offset:51040
    v_mfma_f32_16x16x32_bf16 a[0:3], v[132:135], a[164:167], a[0:3]
    ds_read_b64_tr_b16 v[156:157], v238 offset:51296
    ds_read_b64_tr_b16 v[158:159], v238 offset:51552
    v_mfma_f32_16x16x32_bf16 a[4:7], v[128:131], a[168:171], a[4:7]
    v_mfma_f32_16x16x32_bf16 a[4:7], v[132:135], a[172:175], a[4:7]
    buffer_load_dwordx4 v165, s[12:15], s49 offen offset:1056 lds
    v_mfma_f32_16x16x32_bf16 a[8:11], v[128:131], a[176:179], a[8:11]
    v_mfma_f32_16x16x32_bf16 a[8:11], v[132:135], a[180:183], a[8:11]
    v_mfma_f32_16x16x32_bf16 a[12:15], v[128:131], a[184:187], a[12:15]
    v_mfma_f32_16x16x32_bf16 a[12:15], v[132:135], a[188:191], a[12:15]
    s_waitcnt lgkmcnt(0)
    v_mfma_f32_16x16x32_bf16 a[16:19], v[136:139], a[160:163], a[16:19]
    ds_read_b64_tr_b16 v[128:129], v238 offset:50816
    ds_read_b64_tr_b16 v[130:131], v238 offset:51072
    v_mfma_f32_16x16x32_bf16 a[16:19], v[140:143], a[164:167], a[16:19]
    ds_read_b64_tr_b16 v[132:133], v238 offset:51328
    ds_read_b64_tr_b16 v[134:135], v238 offset:51584
    v_mfma_f32_16x16x32_bf16 a[20:23], v[136:139], a[168:171], a[20:23]
    v_mfma_f32_16x16x32_bf16 a[20:23], v[140:143], a[172:175], a[20:23]
    buffer_load_dwordx4 v166, s[12:15], s49 offen offset:2112 lds
    v_mfma_f32_16x16x32_bf16 a[24:27], v[136:139], a[176:179], a[24:27]
    v_mfma_f32_16x16x32_bf16 a[24:27], v[140:143], a[180:183], a[24:27]
    v_mfma_f32_16x16x32_bf16 a[28:31], v[136:139], a[184:187], a[28:31]
    v_mfma_f32_16x16x32_bf16 a[28:31], v[140:143], a[188:191], a[28:31]
    v_mfma_f32_16x16x32_bf16 a[32:35], v[144:147], a[160:163], a[32:35]
    ds_read_b64_tr_b16 v[136:137], v238 offset:50848
    ds_read_b64_tr_b16 v[138:139], v238 offset:51104
    v_mfma_f32_16x16x32_bf16 a[32:35], v[148:151], a[164:167], a[32:35]
    ds_read_b64_tr_b16 v[140:141], v238 offset:51360
    ds_read_b64_tr_b16 v[142:143], v238 offset:51616
    v_mfma_f32_16x16x32_bf16 a[36:39], v[144:147], a[168:171], a[36:39]
    buffer_load_dwordx4 v167, s[12:15], s49 offen offset:3168 lds
    v_mfma_f32_16x16x32_bf16 a[36:39], v[148:151], a[172:175], a[36:39]
    v_mfma_f32_16x16x32_bf16 a[40:43], v[144:147], a[176:179], a[40:43]
    v_mfma_f32_16x16x32_bf16 a[40:43], v[148:151], a[180:183], a[40:43]
    v_mfma_f32_16x16x32_bf16 a[44:47], v[144:147], a[184:187], a[44:47]
    v_mfma_f32_16x16x32_bf16 a[44:47], v[148:151], a[188:191], a[44:47]
    v_mfma_f32_16x16x32_bf16 a[48:51], v[152:155], a[160:163], a[48:51]
    ds_read_b64_tr_b16 v[144:145], v238 offset:50880
    ds_read_b64_tr_b16 v[146:147], v238 offset:51136
    v_mfma_f32_16x16x32_bf16 a[48:51], v[156:159], a[164:167], a[48:51]
    s_add_u32 m0, s53, 16896
    s_mov_b32 s49, 4128768
    v_mfma_f32_16x16x32_bf16 a[52:55], v[152:155], a[168:171], a[52:55]
    ds_read_b64_tr_b16 v[148:149], v238 offset:51392
    ds_read_b64_tr_b16 v[150:151], v238 offset:51648
    v_mfma_f32_16x16x32_bf16 a[52:55], v[156:159], a[172:175], a[52:55]
    buffer_load_dwordx4 v164, s[12:15], s49 offen offset:0 lds
    v_mfma_f32_16x16x32_bf16 a[56:59], v[152:155], a[176:179], a[56:59]
    v_mfma_f32_16x16x32_bf16 a[56:59], v[156:159], a[180:183], a[56:59]
    v_mfma_f32_16x16x32_bf16 a[60:63], v[152:155], a[184:187], a[60:63]
    v_mfma_f32_16x16x32_bf16 a[60:63], v[156:159], a[188:191], a[60:63]
    s_waitcnt lgkmcnt(2)
    v_mfma_f32_16x16x32_bf16 a[64:67], v[128:131], a[160:163], a[64:67]
    ds_read_b64_tr_b16 v[152:153], v238 offset:50912
    ds_read_b64_tr_b16 v[154:155], v238 offset:51168
    v_mfma_f32_16x16x32_bf16 a[64:67], v[132:135], a[164:167], a[64:67]
    ds_read_b64_tr_b16 v[156:157], v238 offset:51424
    ds_read_b64_tr_b16 v[158:159], v238 offset:51680
    v_mfma_f32_16x16x32_bf16 a[68:71], v[128:131], a[168:171], a[68:71]
    buffer_load_dwordx4 v165, s[12:15], s49 offen offset:1056 lds
    v_mfma_f32_16x16x32_bf16 a[68:71], v[132:135], a[172:175], a[68:71]
    v_mfma_f32_16x16x32_bf16 a[72:75], v[128:131], a[176:179], a[72:75]
    v_mfma_f32_16x16x32_bf16 a[72:75], v[132:135], a[180:183], a[72:75]
    v_mfma_f32_16x16x32_bf16 a[76:79], v[128:131], a[184:187], a[76:79]
    v_mfma_f32_16x16x32_bf16 a[76:79], v[132:135], a[188:191], a[76:79]
    v_mfma_f32_16x16x32_bf16 a[80:83], v[136:139], a[160:163], a[80:83]
    v_mfma_f32_16x16x32_bf16 a[80:83], v[140:143], a[164:167], a[80:83]
    buffer_load_dwordx4 v166, s[12:15], s49 offen offset:2112 lds
    v_mfma_f32_16x16x32_bf16 a[84:87], v[136:139], a[168:171], a[84:87]
    s_waitcnt vmcnt(31) lgkmcnt(0)
    s_barrier
    v_mfma_f32_16x16x32_bf16 a[84:87], v[140:143], a[172:175], a[84:87]
    ds_read_b64_tr_b16 v[128:129], v173 offset:0
    ds_read_b64_tr_b16 v[130:131], v173 offset:256
    v_mfma_f32_16x16x32_bf16 a[88:91], v[136:139], a[176:179], a[88:91]
    ds_read_b64_tr_b16 v[132:133], v173 offset:512
    ds_read_b64_tr_b16 v[134:135], v173 offset:768
    v_mfma_f32_16x16x32_bf16 a[88:91], v[140:143], a[180:183], a[88:91]
    v_mfma_f32_16x16x32_bf16 a[92:95], v[136:139], a[184:187], a[92:95]
    v_mfma_f32_16x16x32_bf16 a[92:95], v[140:143], a[188:191], a[92:95]
    v_mfma_f32_16x16x32_bf16 a[96:99], v[144:147], a[160:163], a[96:99]
    buffer_load_dwordx4 v167, s[12:15], s49 offen offset:3168 lds
    v_mfma_f32_16x16x32_bf16 a[96:99], v[148:151], a[164:167], a[96:99]
    ds_read_b64_tr_b16 v[136:137], v173 offset:8
    ds_read_b64_tr_b16 v[138:139], v173 offset:264
    v_mfma_f32_16x16x32_bf16 a[100:103], v[144:147], a[168:171], a[100:103]
    ds_read_b64_tr_b16 v[140:141], v173 offset:520
    ds_read_b64_tr_b16 v[142:143], v173 offset:776
    v_mfma_f32_16x16x32_bf16 a[100:103], v[148:151], a[172:175], a[100:103]
    v_mfma_f32_16x16x32_bf16 a[104:107], v[144:147], a[176:179], a[104:107]
    v_mfma_f32_16x16x32_bf16 a[104:107], v[148:151], a[180:183], a[104:107]
    v_mfma_f32_16x16x32_bf16 a[108:111], v[144:147], a[184:187], a[108:111]
    v_mfma_f32_16x16x32_bf16 a[108:111], v[148:151], a[188:191], a[108:111]
    v_mfma_f32_16x16x32_bf16 a[112:115], v[152:155], a[160:163], a[112:115]
    ds_read_b64_tr_b16 v[144:145], v173 offset:64
    ds_read_b64_tr_b16 v[146:147], v173 offset:320
    v_mfma_f32_16x16x32_bf16 a[112:115], v[156:159], a[164:167], a[112:115]
    ds_read_b64_tr_b16 v[148:149], v173 offset:576
    ds_read_b64_tr_b16 v[150:151], v173 offset:832
    v_mfma_f32_16x16x32_bf16 a[116:119], v[152:155], a[168:171], a[116:119]
    v_mfma_f32_16x16x32_bf16 a[116:119], v[156:159], a[172:175], a[116:119]
    v_mfma_f32_16x16x32_bf16 a[120:123], v[152:155], a[176:179], a[120:123]
    v_mfma_f32_16x16x32_bf16 a[120:123], v[156:159], a[180:183], a[120:123]
    v_mfma_f32_16x16x32_bf16 a[124:127], v[152:155], a[184:187], a[124:127]
    v_mfma_f32_16x16x32_bf16 a[124:127], v[156:159], a[188:191], a[124:127]
    s_waitcnt vmcnt(24)
    s_waitcnt lgkmcnt(0)
    v_mfma_f32_16x16x32_bf16 v[0:3], v[128:131], a[192:195], v[0:3]
    ds_read_b64_tr_b16 v[152:153], v173 offset:72
    ds_read_b64_tr_b16 v[154:155], v173 offset:328
    v_mfma_f32_16x16x32_bf16 v[0:3], v[132:135], a[196:199], v[0:3]
    ds_read_b64_tr_b16 v[156:157], v173 offset:584
    s_mov_b32 s48, 16384
    v_mfma_f32_16x16x32_bf16 v[4:7], v[128:131], a[200:203], v[4:7]
    ds_read_b64_tr_b16 v[158:159], v173 offset:840
    v_mfma_f32_16x16x32_bf16 v[4:7], v[132:135], a[204:207], v[4:7]
    buffer_load_dwordx4 a[128:131], v168, s[4:7], s48 offen offset:0 sc1
    v_mfma_f32_16x16x32_bf16 v[8:11], v[128:131], a[208:211], v[8:11]
    v_mfma_f32_16x16x32_bf16 v[8:11], v[132:135], a[212:215], v[8:11]
    v_mfma_f32_16x16x32_bf16 v[12:15], v[128:131], a[216:219], v[12:15]
    v_mfma_f32_16x16x32_bf16 v[12:15], v[132:135], a[220:223], v[12:15]
    v_mfma_f32_16x16x32_bf16 v[16:19], v[136:139], a[192:195], v[16:19]
    buffer_load_dwordx4 a[132:135], v168, s[4:7], s48 offen offset:1024 sc1
    v_mfma_f32_16x16x32_bf16 v[16:19], v[140:143], a[196:199], v[16:19]
    ds_read_b64_tr_b16 v[128:129], v173 offset:128
    ds_read_b64_tr_b16 v[130:131], v173 offset:384
    v_mfma_f32_16x16x32_bf16 v[20:23], v[136:139], a[200:203], v[20:23]
    ds_read_b64_tr_b16 v[132:133], v173 offset:640
    ds_read_b64_tr_b16 v[134:135], v173 offset:896
    v_mfma_f32_16x16x32_bf16 v[20:23], v[140:143], a[204:207], v[20:23]
    v_mfma_f32_16x16x32_bf16 v[24:27], v[136:139], a[208:211], v[24:27]
    v_mfma_f32_16x16x32_bf16 v[24:27], v[140:143], a[212:215], v[24:27]
    v_mfma_f32_16x16x32_bf16 v[28:31], v[136:139], a[216:219], v[28:31]
    v_mfma_f32_16x16x32_bf16 v[28:31], v[140:143], a[220:223], v[28:31]
    buffer_load_dwordx4 a[136:139], v169, s[4:7], s48 offen offset:0 sc1
    v_mfma_f32_16x16x32_bf16 v[32:35], v[144:147], a[192:195], v[32:35]
    ds_read_b64_tr_b16 v[136:137], v173 offset:136
    ds_read_b64_tr_b16 v[138:139], v173 offset:392
    v_mfma_f32_16x16x32_bf16 v[32:35], v[148:151], a[196:199], v[32:35]
    ds_read_b64_tr_b16 v[140:141], v173 offset:648
    ds_read_b64_tr_b16 v[142:143], v173 offset:904
    v_mfma_f32_16x16x32_bf16 v[36:39], v[144:147], a[200:203], v[36:39]
    v_mfma_f32_16x16x32_bf16 v[36:39], v[148:151], a[204:207], v[36:39]
    v_mfma_f32_16x16x32_bf16 v[40:43], v[144:147], a[208:211], v[40:43]
    v_mfma_f32_16x16x32_bf16 v[40:43], v[148:151], a[212:215], v[40:43]
    v_mfma_f32_16x16x32_bf16 v[44:47], v[144:147], a[216:219], v[44:47]
    v_mfma_f32_16x16x32_bf16 v[44:47], v[148:151], a[220:223], v[44:47]
    buffer_load_dwordx4 a[140:143], v169, s[4:7], s48 offen offset:1024 sc1
    s_waitcnt lgkmcnt(0)
    v_mfma_f32_16x16x32_bf16 v[48:51], v[152:155], a[192:195], v[48:51]
    ds_read_b64_tr_b16 v[144:145], v173 offset:192
    ds_read_b64_tr_b16 v[146:147], v173 offset:448
    v_mfma_f32_16x16x32_bf16 v[48:51], v[156:159], a[196:199], v[48:51]
    ds_read_b64_tr_b16 v[148:149], v173 offset:704
    ds_read_b64_tr_b16 v[150:151], v173 offset:960
    v_mfma_f32_16x16x32_bf16 v[52:55], v[152:155], a[200:203], v[52:55]
    v_mfma_f32_16x16x32_bf16 v[52:55], v[156:159], a[204:207], v[52:55]
    v_mfma_f32_16x16x32_bf16 v[56:59], v[152:155], a[208:211], v[56:59]
    v_mfma_f32_16x16x32_bf16 v[56:59], v[156:159], a[212:215], v[56:59]
    v_mfma_f32_16x16x32_bf16 v[60:63], v[152:155], a[216:219], v[60:63]
    buffer_load_dwordx4 a[144:147], v170, s[4:7], s48 offen offset:0 sc1
    v_mfma_f32_16x16x32_bf16 v[60:63], v[156:159], a[220:223], v[60:63]
    v_mfma_f32_16x16x32_bf16 v[64:67], v[128:131], a[192:195], v[64:67]
    ds_read_b64_tr_b16 v[152:153], v173 offset:200
    ds_read_b64_tr_b16 v[154:155], v173 offset:456
    v_mfma_f32_16x16x32_bf16 v[64:67], v[132:135], a[196:199], v[64:67]
    ds_read_b64_tr_b16 v[156:157], v173 offset:712
    ds_read_b64_tr_b16 v[158:159], v173 offset:968
    v_mfma_f32_16x16x32_bf16 v[68:71], v[128:131], a[200:203], v[68:71]
    v_mfma_f32_16x16x32_bf16 v[68:71], v[132:135], a[204:207], v[68:71]
    v_mfma_f32_16x16x32_bf16 v[72:75], v[128:131], a[208:211], v[72:75]
    v_mfma_f32_16x16x32_bf16 v[72:75], v[132:135], a[212:215], v[72:75]
    v_mfma_f32_16x16x32_bf16 v[76:79], v[128:131], a[216:219], v[76:79]
    buffer_load_dwordx4 a[148:151], v170, s[4:7], s48 offen offset:1024 sc1
    v_mfma_f32_16x16x32_bf16 v[76:79], v[132:135], a[220:223], v[76:79]
    v_mfma_f32_16x16x32_bf16 v[80:83], v[136:139], a[192:195], v[80:83]
    ds_read_b64_tr_b16 v[128:129], v239 offset:16896
    ds_read_b64_tr_b16 v[130:131], v239 offset:17152
    v_mfma_f32_16x16x32_bf16 v[80:83], v[140:143], a[196:199], v[80:83]
    ds_read_b64_tr_b16 v[132:133], v239 offset:17408
    ds_read_b64_tr_b16 v[134:135], v239 offset:17664
    v_mfma_f32_16x16x32_bf16 v[84:87], v[136:139], a[200:203], v[84:87]
    v_mfma_f32_16x16x32_bf16 v[84:87], v[140:143], a[204:207], v[84:87]
    v_mfma_f32_16x16x32_bf16 v[88:91], v[136:139], a[208:211], v[88:91]
    v_mfma_f32_16x16x32_bf16 v[88:91], v[140:143], a[212:215], v[88:91]
    buffer_load_dwordx4 a[152:155], v171, s[4:7], s48 offen offset:0 sc1
    v_mfma_f32_16x16x32_bf16 v[92:95], v[136:139], a[216:219], v[92:95]
    v_mfma_f32_16x16x32_bf16 v[92:95], v[140:143], a[220:223], v[92:95]
    s_waitcnt lgkmcnt(0)
    v_mfma_f32_16x16x32_bf16 v[96:99], v[144:147], a[192:195], v[96:99]
    ds_read_b64_tr_b16 v[136:137], v239 offset:16928
    ds_read_b64_tr_b16 v[138:139], v239 offset:17184
    v_mfma_f32_16x16x32_bf16 v[96:99], v[148:151], a[196:199], v[96:99]
    ds_read_b64_tr_b16 v[140:141], v239 offset:17440
    ds_read_b64_tr_b16 v[142:143], v239 offset:17696
    v_mfma_f32_16x16x32_bf16 v[100:103], v[144:147], a[200:203], v[100:103]
    v_mfma_f32_16x16x32_bf16 v[100:103], v[148:151], a[204:207], v[100:103]
    v_mfma_f32_16x16x32_bf16 v[104:107], v[144:147], a[208:211], v[104:107]
    v_mfma_f32_16x16x32_bf16 v[104:107], v[148:151], a[212:215], v[104:107]
    buffer_load_dwordx4 a[156:159], v171, s[4:7], s48 offen offset:1024 sc1
    v_mfma_f32_16x16x32_bf16 v[108:111], v[144:147], a[216:219], v[108:111]
    v_mfma_f32_16x16x32_bf16 v[108:111], v[148:151], a[220:223], v[108:111]
    v_mfma_f32_16x16x32_bf16 v[112:115], v[152:155], a[192:195], v[112:115]
    ds_read_b64_tr_b16 v[144:145], v239 offset:16960
    ds_read_b64_tr_b16 v[146:147], v239 offset:17216
    v_mfma_f32_16x16x32_bf16 v[112:115], v[156:159], a[196:199], v[112:115]
    ds_read_b64_tr_b16 v[148:149], v239 offset:17472
    ds_read_b64_tr_b16 v[150:151], v239 offset:17728
    v_mfma_f32_16x16x32_bf16 v[116:119], v[152:155], a[200:203], v[116:119]
    v_mfma_f32_16x16x32_bf16 v[116:119], v[156:159], a[204:207], v[116:119]
    s_add_u32 m0, s53, 33792
    s_mov_b32 s49, 4587520
    v_mfma_f32_16x16x32_bf16 v[120:123], v[152:155], a[208:211], v[120:123]
    buffer_load_dwordx4 v164, s[12:15], s49 offen offset:0 lds
    v_mfma_f32_16x16x32_bf16 v[120:123], v[156:159], a[212:215], v[120:123]
    v_mfma_f32_16x16x32_bf16 v[124:127], v[152:155], a[216:219], v[124:127]
    v_mfma_f32_16x16x32_bf16 v[124:127], v[156:159], a[220:223], v[124:127]
    v_mfma_f32_16x16x32_bf16 a[0:3], v[128:131], a[192:195], a[0:3]
    ds_read_b64_tr_b16 v[152:153], v239 offset:16992
    ds_read_b64_tr_b16 v[154:155], v239 offset:17248
    v_mfma_f32_16x16x32_bf16 a[0:3], v[132:135], a[196:199], a[0:3]
    ds_read_b64_tr_b16 v[156:157], v239 offset:17504
    ds_read_b64_tr_b16 v[158:159], v239 offset:17760
    v_mfma_f32_16x16x32_bf16 a[4:7], v[128:131], a[200:203], a[4:7]
    v_mfma_f32_16x16x32_bf16 a[4:7], v[132:135], a[204:207], a[4:7]
    buffer_load_dwordx4 v165, s[12:15], s49 offen offset:1056 lds
    v_mfma_f32_16x16x32_bf16 a[8:11], v[128:131], a[208:211], a[8:11]
    v_mfma_f32_16x16x32_bf16 a[8:11], v[132:135], a[212:215], a[8:11]
    v_mfma_f32_16x16x32_bf16 a[12:15], v[128:131], a[216:219], a[12:15]
    v_mfma_f32_16x16x32_bf16 a[12:15], v[132:135], a[220:223], a[12:15]
    s_waitcnt lgkmcnt(0)
    v_mfma_f32_16x16x32_bf16 a[16:19], v[136:139], a[192:195], a[16:19]
    ds_read_b64_tr_b16 v[128:129], v239 offset:17024
    ds_read_b64_tr_b16 v[130:131], v239 offset:17280
    v_mfma_f32_16x16x32_bf16 a[16:19], v[140:143], a[196:199], a[16:19]
    ds_read_b64_tr_b16 v[132:133], v239 offset:17536
    ds_read_b64_tr_b16 v[134:135], v239 offset:17792
    v_mfma_f32_16x16x32_bf16 a[20:23], v[136:139], a[200:203], a[20:23]
    v_mfma_f32_16x16x32_bf16 a[20:23], v[140:143], a[204:207], a[20:23]
    buffer_load_dwordx4 v166, s[12:15], s49 offen offset:2112 lds
    v_mfma_f32_16x16x32_bf16 a[24:27], v[136:139], a[208:211], a[24:27]
    v_mfma_f32_16x16x32_bf16 a[24:27], v[140:143], a[212:215], a[24:27]
    v_mfma_f32_16x16x32_bf16 a[28:31], v[136:139], a[216:219], a[28:31]
    v_mfma_f32_16x16x32_bf16 a[28:31], v[140:143], a[220:223], a[28:31]
    v_mfma_f32_16x16x32_bf16 a[32:35], v[144:147], a[192:195], a[32:35]
    ds_read_b64_tr_b16 v[136:137], v239 offset:17056
    ds_read_b64_tr_b16 v[138:139], v239 offset:17312
    v_mfma_f32_16x16x32_bf16 a[32:35], v[148:151], a[196:199], a[32:35]
    ds_read_b64_tr_b16 v[140:141], v239 offset:17568
    ds_read_b64_tr_b16 v[142:143], v239 offset:17824
    v_mfma_f32_16x16x32_bf16 a[36:39], v[144:147], a[200:203], a[36:39]
    buffer_load_dwordx4 v167, s[12:15], s49 offen offset:3168 lds
    v_mfma_f32_16x16x32_bf16 a[36:39], v[148:151], a[204:207], a[36:39]
    v_mfma_f32_16x16x32_bf16 a[40:43], v[144:147], a[208:211], a[40:43]
    v_mfma_f32_16x16x32_bf16 a[40:43], v[148:151], a[212:215], a[40:43]
    v_mfma_f32_16x16x32_bf16 a[44:47], v[144:147], a[216:219], a[44:47]
    v_mfma_f32_16x16x32_bf16 a[44:47], v[148:151], a[220:223], a[44:47]
    v_mfma_f32_16x16x32_bf16 a[48:51], v[152:155], a[192:195], a[48:51]
    ds_read_b64_tr_b16 v[144:145], v239 offset:17088
    ds_read_b64_tr_b16 v[146:147], v239 offset:17344
    v_mfma_f32_16x16x32_bf16 a[48:51], v[156:159], a[196:199], a[48:51]
    s_add_u32 m0, s53, 50688
    s_mov_b32 s49, 5046272
    v_mfma_f32_16x16x32_bf16 a[52:55], v[152:155], a[200:203], a[52:55]
    ds_read_b64_tr_b16 v[148:149], v239 offset:17600
    ds_read_b64_tr_b16 v[150:151], v239 offset:17856
    v_mfma_f32_16x16x32_bf16 a[52:55], v[156:159], a[204:207], a[52:55]
    buffer_load_dwordx4 v164, s[12:15], s49 offen offset:0 lds
    v_mfma_f32_16x16x32_bf16 a[56:59], v[152:155], a[208:211], a[56:59]
    v_mfma_f32_16x16x32_bf16 a[56:59], v[156:159], a[212:215], a[56:59]
    v_mfma_f32_16x16x32_bf16 a[60:63], v[152:155], a[216:219], a[60:63]
    v_mfma_f32_16x16x32_bf16 a[60:63], v[156:159], a[220:223], a[60:63]
    s_waitcnt lgkmcnt(2)
    v_mfma_f32_16x16x32_bf16 a[64:67], v[128:131], a[192:195], a[64:67]
    ds_read_b64_tr_b16 v[152:153], v239 offset:17120
    ds_read_b64_tr_b16 v[154:155], v239 offset:17376
    v_mfma_f32_16x16x32_bf16 a[64:67], v[132:135], a[196:199], a[64:67]
    ds_read_b64_tr_b16 v[156:157], v239 offset:17632
    ds_read_b64_tr_b16 v[158:159], v239 offset:17888
    v_mfma_f32_16x16x32_bf16 a[68:71], v[128:131], a[200:203], a[68:71]
    buffer_load_dwordx4 v165, s[12:15], s49 offen offset:1056 lds
    v_mfma_f32_16x16x32_bf16 a[68:71], v[132:135], a[204:207], a[68:71]
    v_mfma_f32_16x16x32_bf16 a[72:75], v[128:131], a[208:211], a[72:75]
    v_mfma_f32_16x16x32_bf16 a[72:75], v[132:135], a[212:215], a[72:75]
    v_mfma_f32_16x16x32_bf16 a[76:79], v[128:131], a[216:219], a[76:79]
    v_mfma_f32_16x16x32_bf16 a[76:79], v[132:135], a[220:223], a[76:79]
    v_mfma_f32_16x16x32_bf16 a[80:83], v[136:139], a[192:195], a[80:83]
    v_mfma_f32_16x16x32_bf16 a[80:83], v[140:143], a[196:199], a[80:83]
    buffer_load_dwordx4 v166, s[12:15], s49 offen offset:2112 lds
    v_mfma_f32_16x16x32_bf16 a[84:87], v[136:139], a[200:203], a[84:87]
    s_waitcnt vmcnt(31) lgkmcnt(0)
    s_barrier
    v_mfma_f32_16x16x32_bf16 a[84:87], v[140:143], a[204:207], a[84:87]
    ds_read_b64_tr_b16 v[128:129], v173 offset:33792
    ds_read_b64_tr_b16 v[130:131], v173 offset:34048
    v_mfma_f32_16x16x32_bf16 a[88:91], v[136:139], a[208:211], a[88:91]
    ds_read_b64_tr_b16 v[132:133], v173 offset:34304
    ds_read_b64_tr_b16 v[134:135], v173 offset:34560
    v_mfma_f32_16x16x32_bf16 a[88:91], v[140:143], a[212:215], a[88:91]
    v_mfma_f32_16x16x32_bf16 a[92:95], v[136:139], a[216:219], a[92:95]
    v_mfma_f32_16x16x32_bf16 a[92:95], v[140:143], a[220:223], a[92:95]
    v_mfma_f32_16x16x32_bf16 a[96:99], v[144:147], a[192:195], a[96:99]
    buffer_load_dwordx4 v167, s[12:15], s49 offen offset:3168 lds
    v_mfma_f32_16x16x32_bf16 a[96:99], v[148:151], a[196:199], a[96:99]
    ds_read_b64_tr_b16 v[136:137], v173 offset:33800
    ds_read_b64_tr_b16 v[138:139], v173 offset:34056
    v_mfma_f32_16x16x32_bf16 a[100:103], v[144:147], a[200:203], a[100:103]
    ds_read_b64_tr_b16 v[140:141], v173 offset:34312
    ds_read_b64_tr_b16 v[142:143], v173 offset:34568
    v_mfma_f32_16x16x32_bf16 a[100:103], v[148:151], a[204:207], a[100:103]
    v_mfma_f32_16x16x32_bf16 a[104:107], v[144:147], a[208:211], a[104:107]
    v_mfma_f32_16x16x32_bf16 a[104:107], v[148:151], a[212:215], a[104:107]
    v_mfma_f32_16x16x32_bf16 a[108:111], v[144:147], a[216:219], a[108:111]
    v_mfma_f32_16x16x32_bf16 a[108:111], v[148:151], a[220:223], a[108:111]
    v_mfma_f32_16x16x32_bf16 a[112:115], v[152:155], a[192:195], a[112:115]
    ds_read_b64_tr_b16 v[144:145], v173 offset:33856
    ds_read_b64_tr_b16 v[146:147], v173 offset:34112
    v_mfma_f32_16x16x32_bf16 a[112:115], v[156:159], a[196:199], a[112:115]
    ds_read_b64_tr_b16 v[148:149], v173 offset:34368
    ds_read_b64_tr_b16 v[150:151], v173 offset:34624
    v_mfma_f32_16x16x32_bf16 a[116:119], v[152:155], a[200:203], a[116:119]
    v_mfma_f32_16x16x32_bf16 a[116:119], v[156:159], a[204:207], a[116:119]
    v_mfma_f32_16x16x32_bf16 a[120:123], v[152:155], a[208:211], a[120:123]
    v_mfma_f32_16x16x32_bf16 a[120:123], v[156:159], a[212:215], a[120:123]
    v_mfma_f32_16x16x32_bf16 a[124:127], v[152:155], a[216:219], a[124:127]
    v_mfma_f32_16x16x32_bf16 a[124:127], v[156:159], a[220:223], a[124:127]
    s_waitcnt vmcnt(24)
    s_waitcnt lgkmcnt(0)
    v_mfma_f32_16x16x32_bf16 v[0:3], v[128:131], a[224:227], v[0:3]
    ds_read_b64_tr_b16 v[152:153], v173 offset:33864
    ds_read_b64_tr_b16 v[154:155], v173 offset:34120
    v_mfma_f32_16x16x32_bf16 v[0:3], v[132:135], a[228:231], v[0:3]
    ds_read_b64_tr_b16 v[156:157], v173 offset:34376
    s_mov_b32 s48, 18432
    v_mfma_f32_16x16x32_bf16 v[4:7], v[128:131], a[232:235], v[4:7]
    ds_read_b64_tr_b16 v[158:159], v173 offset:34632
    v_mfma_f32_16x16x32_bf16 v[4:7], v[132:135], a[236:239], v[4:7]
    buffer_load_dwordx4 a[160:163], v168, s[4:7], s48 offen offset:0 sc1
    v_mfma_f32_16x16x32_bf16 v[8:11], v[128:131], a[240:243], v[8:11]
    v_mfma_f32_16x16x32_bf16 v[8:11], v[132:135], a[244:247], v[8:11]
    v_mfma_f32_16x16x32_bf16 v[12:15], v[128:131], a[248:251], v[12:15]
    v_mfma_f32_16x16x32_bf16 v[12:15], v[132:135], a[252:255], v[12:15]
    v_mfma_f32_16x16x32_bf16 v[16:19], v[136:139], a[224:227], v[16:19]
    buffer_load_dwordx4 a[164:167], v168, s[4:7], s48 offen offset:1024 sc1
    v_mfma_f32_16x16x32_bf16 v[16:19], v[140:143], a[228:231], v[16:19]
    ds_read_b64_tr_b16 v[128:129], v173 offset:33920
    ds_read_b64_tr_b16 v[130:131], v173 offset:34176
    v_mfma_f32_16x16x32_bf16 v[20:23], v[136:139], a[232:235], v[20:23]
    ds_read_b64_tr_b16 v[132:133], v173 offset:34432
    ds_read_b64_tr_b16 v[134:135], v173 offset:34688
    v_mfma_f32_16x16x32_bf16 v[20:23], v[140:143], a[236:239], v[20:23]
    v_mfma_f32_16x16x32_bf16 v[24:27], v[136:139], a[240:243], v[24:27]
    v_mfma_f32_16x16x32_bf16 v[24:27], v[140:143], a[244:247], v[24:27]
    v_mfma_f32_16x16x32_bf16 v[28:31], v[136:139], a[248:251], v[28:31]
    v_mfma_f32_16x16x32_bf16 v[28:31], v[140:143], a[252:255], v[28:31]
    buffer_load_dwordx4 a[168:171], v169, s[4:7], s48 offen offset:0 sc1
    v_mfma_f32_16x16x32_bf16 v[32:35], v[144:147], a[224:227], v[32:35]
    ds_read_b64_tr_b16 v[136:137], v173 offset:33928
    ds_read_b64_tr_b16 v[138:139], v173 offset:34184
    v_mfma_f32_16x16x32_bf16 v[32:35], v[148:151], a[228:231], v[32:35]
    ds_read_b64_tr_b16 v[140:141], v173 offset:34440
    ds_read_b64_tr_b16 v[142:143], v173 offset:34696
    v_mfma_f32_16x16x32_bf16 v[36:39], v[144:147], a[232:235], v[36:39]
    v_mfma_f32_16x16x32_bf16 v[36:39], v[148:151], a[236:239], v[36:39]
    v_mfma_f32_16x16x32_bf16 v[40:43], v[144:147], a[240:243], v[40:43]
    v_mfma_f32_16x16x32_bf16 v[40:43], v[148:151], a[244:247], v[40:43]
    v_mfma_f32_16x16x32_bf16 v[44:47], v[144:147], a[248:251], v[44:47]
    v_mfma_f32_16x16x32_bf16 v[44:47], v[148:151], a[252:255], v[44:47]
    buffer_load_dwordx4 a[172:175], v169, s[4:7], s48 offen offset:1024 sc1
    s_waitcnt lgkmcnt(0)
    v_mfma_f32_16x16x32_bf16 v[48:51], v[152:155], a[224:227], v[48:51]
    ds_read_b64_tr_b16 v[144:145], v173 offset:33984
    ds_read_b64_tr_b16 v[146:147], v173 offset:34240
    v_mfma_f32_16x16x32_bf16 v[48:51], v[156:159], a[228:231], v[48:51]
    ds_read_b64_tr_b16 v[148:149], v173 offset:34496
    ds_read_b64_tr_b16 v[150:151], v173 offset:34752
    v_mfma_f32_16x16x32_bf16 v[52:55], v[152:155], a[232:235], v[52:55]
    v_mfma_f32_16x16x32_bf16 v[52:55], v[156:159], a[236:239], v[52:55]
    v_mfma_f32_16x16x32_bf16 v[56:59], v[152:155], a[240:243], v[56:59]
    v_mfma_f32_16x16x32_bf16 v[56:59], v[156:159], a[244:247], v[56:59]
    v_mfma_f32_16x16x32_bf16 v[60:63], v[152:155], a[248:251], v[60:63]
    buffer_load_dwordx4 a[176:179], v170, s[4:7], s48 offen offset:0 sc1
    v_mfma_f32_16x16x32_bf16 v[60:63], v[156:159], a[252:255], v[60:63]
    v_mfma_f32_16x16x32_bf16 v[64:67], v[128:131], a[224:227], v[64:67]
    ds_read_b64_tr_b16 v[152:153], v173 offset:33992
    ds_read_b64_tr_b16 v[154:155], v173 offset:34248
    v_mfma_f32_16x16x32_bf16 v[64:67], v[132:135], a[228:231], v[64:67]
    ds_read_b64_tr_b16 v[156:157], v173 offset:34504
    ds_read_b64_tr_b16 v[158:159], v173 offset:34760
    v_mfma_f32_16x16x32_bf16 v[68:71], v[128:131], a[232:235], v[68:71]
    v_mfma_f32_16x16x32_bf16 v[68:71], v[132:135], a[236:239], v[68:71]
    v_mfma_f32_16x16x32_bf16 v[72:75], v[128:131], a[240:243], v[72:75]
    v_mfma_f32_16x16x32_bf16 v[72:75], v[132:135], a[244:247], v[72:75]
    v_mfma_f32_16x16x32_bf16 v[76:79], v[128:131], a[248:251], v[76:79]
    buffer_load_dwordx4 a[180:183], v170, s[4:7], s48 offen offset:1024 sc1
    v_mfma_f32_16x16x32_bf16 v[76:79], v[132:135], a[252:255], v[76:79]
    v_mfma_f32_16x16x32_bf16 v[80:83], v[136:139], a[224:227], v[80:83]
    ds_read_b64_tr_b16 v[128:129], v239 offset:50688
    ds_read_b64_tr_b16 v[130:131], v239 offset:50944
    v_mfma_f32_16x16x32_bf16 v[80:83], v[140:143], a[228:231], v[80:83]
    ds_read_b64_tr_b16 v[132:133], v239 offset:51200
    ds_read_b64_tr_b16 v[134:135], v239 offset:51456
    v_mfma_f32_16x16x32_bf16 v[84:87], v[136:139], a[232:235], v[84:87]
    v_mfma_f32_16x16x32_bf16 v[84:87], v[140:143], a[236:239], v[84:87]
    v_mfma_f32_16x16x32_bf16 v[88:91], v[136:139], a[240:243], v[88:91]
    v_mfma_f32_16x16x32_bf16 v[88:91], v[140:143], a[244:247], v[88:91]
    buffer_load_dwordx4 a[184:187], v171, s[4:7], s48 offen offset:0 sc1
    v_mfma_f32_16x16x32_bf16 v[92:95], v[136:139], a[248:251], v[92:95]
    v_mfma_f32_16x16x32_bf16 v[92:95], v[140:143], a[252:255], v[92:95]
    s_waitcnt lgkmcnt(0)
    v_mfma_f32_16x16x32_bf16 v[96:99], v[144:147], a[224:227], v[96:99]
    ds_read_b64_tr_b16 v[136:137], v239 offset:50720
    ds_read_b64_tr_b16 v[138:139], v239 offset:50976
    v_mfma_f32_16x16x32_bf16 v[96:99], v[148:151], a[228:231], v[96:99]
    ds_read_b64_tr_b16 v[140:141], v239 offset:51232
    ds_read_b64_tr_b16 v[142:143], v239 offset:51488
    v_mfma_f32_16x16x32_bf16 v[100:103], v[144:147], a[232:235], v[100:103]
    v_mfma_f32_16x16x32_bf16 v[100:103], v[148:151], a[236:239], v[100:103]
    v_mfma_f32_16x16x32_bf16 v[104:107], v[144:147], a[240:243], v[104:107]
    v_mfma_f32_16x16x32_bf16 v[104:107], v[148:151], a[244:247], v[104:107]
    buffer_load_dwordx4 a[188:191], v171, s[4:7], s48 offen offset:1024 sc1
    v_mfma_f32_16x16x32_bf16 v[108:111], v[144:147], a[248:251], v[108:111]
    v_mfma_f32_16x16x32_bf16 v[108:111], v[148:151], a[252:255], v[108:111]
    v_mfma_f32_16x16x32_bf16 v[112:115], v[152:155], a[224:227], v[112:115]
    ds_read_b64_tr_b16 v[144:145], v239 offset:50752
    ds_read_b64_tr_b16 v[146:147], v239 offset:51008
    v_mfma_f32_16x16x32_bf16 v[112:115], v[156:159], a[228:231], v[112:115]
    ds_read_b64_tr_b16 v[148:149], v239 offset:51264
    ds_read_b64_tr_b16 v[150:151], v239 offset:51520
    v_mfma_f32_16x16x32_bf16 v[116:119], v[152:155], a[232:235], v[116:119]
    v_mfma_f32_16x16x32_bf16 v[116:119], v[156:159], a[236:239], v[116:119]
    s_add_u32 m0, s53, 67584
    s_mov_b32 s49, 5505024
    v_mfma_f32_16x16x32_bf16 v[120:123], v[152:155], a[240:243], v[120:123]
    buffer_load_dwordx4 v164, s[12:15], s49 offen offset:0 lds
    v_mfma_f32_16x16x32_bf16 v[120:123], v[156:159], a[244:247], v[120:123]
    v_mfma_f32_16x16x32_bf16 v[124:127], v[152:155], a[248:251], v[124:127]
    v_mfma_f32_16x16x32_bf16 v[124:127], v[156:159], a[252:255], v[124:127]
    v_mfma_f32_16x16x32_bf16 a[0:3], v[128:131], a[224:227], a[0:3]
    ds_read_b64_tr_b16 v[152:153], v239 offset:50784
    ds_read_b64_tr_b16 v[154:155], v239 offset:51040
    v_mfma_f32_16x16x32_bf16 a[0:3], v[132:135], a[228:231], a[0:3]
    ds_read_b64_tr_b16 v[156:157], v239 offset:51296
    ds_read_b64_tr_b16 v[158:159], v239 offset:51552
    v_mfma_f32_16x16x32_bf16 a[4:7], v[128:131], a[232:235], a[4:7]
    v_mfma_f32_16x16x32_bf16 a[4:7], v[132:135], a[236:239], a[4:7]
    buffer_load_dwordx4 v165, s[12:15], s49 offen offset:1056 lds
    v_mfma_f32_16x16x32_bf16 a[8:11], v[128:131], a[240:243], a[8:11]
    v_mfma_f32_16x16x32_bf16 a[8:11], v[132:135], a[244:247], a[8:11]
    v_mfma_f32_16x16x32_bf16 a[12:15], v[128:131], a[248:251], a[12:15]
    v_mfma_f32_16x16x32_bf16 a[12:15], v[132:135], a[252:255], a[12:15]
    s_waitcnt lgkmcnt(0)
    v_mfma_f32_16x16x32_bf16 a[16:19], v[136:139], a[224:227], a[16:19]
    ds_read_b64_tr_b16 v[128:129], v239 offset:50816
    ds_read_b64_tr_b16 v[130:131], v239 offset:51072
    v_mfma_f32_16x16x32_bf16 a[16:19], v[140:143], a[228:231], a[16:19]
    ds_read_b64_tr_b16 v[132:133], v239 offset:51328
    ds_read_b64_tr_b16 v[134:135], v239 offset:51584
    v_mfma_f32_16x16x32_bf16 a[20:23], v[136:139], a[232:235], a[20:23]
    v_mfma_f32_16x16x32_bf16 a[20:23], v[140:143], a[236:239], a[20:23]
    buffer_load_dwordx4 v166, s[12:15], s49 offen offset:2112 lds
    v_mfma_f32_16x16x32_bf16 a[24:27], v[136:139], a[240:243], a[24:27]
    v_mfma_f32_16x16x32_bf16 a[24:27], v[140:143], a[244:247], a[24:27]
    v_mfma_f32_16x16x32_bf16 a[28:31], v[136:139], a[248:251], a[28:31]
    v_mfma_f32_16x16x32_bf16 a[28:31], v[140:143], a[252:255], a[28:31]
    v_mfma_f32_16x16x32_bf16 a[32:35], v[144:147], a[224:227], a[32:35]
    ds_read_b64_tr_b16 v[136:137], v239 offset:50848
    ds_read_b64_tr_b16 v[138:139], v239 offset:51104
    v_mfma_f32_16x16x32_bf16 a[32:35], v[148:151], a[228:231], a[32:35]
    ds_read_b64_tr_b16 v[140:141], v239 offset:51360
    ds_read_b64_tr_b16 v[142:143], v239 offset:51616
    v_mfma_f32_16x16x32_bf16 a[36:39], v[144:147], a[232:235], a[36:39]
    buffer_load_dwordx4 v167, s[12:15], s49 offen offset:3168 lds
    v_mfma_f32_16x16x32_bf16 a[36:39], v[148:151], a[236:239], a[36:39]
    v_mfma_f32_16x16x32_bf16 a[40:43], v[144:147], a[240:243], a[40:43]
    v_mfma_f32_16x16x32_bf16 a[40:43], v[148:151], a[244:247], a[40:43]
    v_mfma_f32_16x16x32_bf16 a[44:47], v[144:147], a[248:251], a[44:47]
    v_mfma_f32_16x16x32_bf16 a[44:47], v[148:151], a[252:255], a[44:47]
    v_mfma_f32_16x16x32_bf16 a[48:51], v[152:155], a[224:227], a[48:51]
    ds_read_b64_tr_b16 v[144:145], v239 offset:50880
    ds_read_b64_tr_b16 v[146:147], v239 offset:51136
    v_mfma_f32_16x16x32_bf16 a[48:51], v[156:159], a[228:231], a[48:51]
    s_add_u32 m0, s53, 84480
    s_mov_b32 s49, 5963776
    v_mfma_f32_16x16x32_bf16 a[52:55], v[152:155], a[232:235], a[52:55]
    ds_read_b64_tr_b16 v[148:149], v239 offset:51392
    ds_read_b64_tr_b16 v[150:151], v239 offset:51648
    v_mfma_f32_16x16x32_bf16 a[52:55], v[156:159], a[236:239], a[52:55]
    buffer_load_dwordx4 v164, s[12:15], s49 offen offset:0 lds
    v_mfma_f32_16x16x32_bf16 a[56:59], v[152:155], a[240:243], a[56:59]
    v_mfma_f32_16x16x32_bf16 a[56:59], v[156:159], a[244:247], a[56:59]
    v_mfma_f32_16x16x32_bf16 a[60:63], v[152:155], a[248:251], a[60:63]
    v_mfma_f32_16x16x32_bf16 a[60:63], v[156:159], a[252:255], a[60:63]
    s_waitcnt lgkmcnt(2)
    v_mfma_f32_16x16x32_bf16 a[64:67], v[128:131], a[224:227], a[64:67]
    ds_read_b64_tr_b16 v[152:153], v239 offset:50912
    ds_read_b64_tr_b16 v[154:155], v239 offset:51168
    v_mfma_f32_16x16x32_bf16 a[64:67], v[132:135], a[228:231], a[64:67]
    ds_read_b64_tr_b16 v[156:157], v239 offset:51424
    ds_read_b64_tr_b16 v[158:159], v239 offset:51680
    v_mfma_f32_16x16x32_bf16 a[68:71], v[128:131], a[232:235], a[68:71]
    buffer_load_dwordx4 v165, s[12:15], s49 offen offset:1056 lds
    v_mfma_f32_16x16x32_bf16 a[68:71], v[132:135], a[236:239], a[68:71]
    v_mfma_f32_16x16x32_bf16 a[72:75], v[128:131], a[240:243], a[72:75]
    v_mfma_f32_16x16x32_bf16 a[72:75], v[132:135], a[244:247], a[72:75]
    v_mfma_f32_16x16x32_bf16 a[76:79], v[128:131], a[248:251], a[76:79]
    v_mfma_f32_16x16x32_bf16 a[76:79], v[132:135], a[252:255], a[76:79]
    v_mfma_f32_16x16x32_bf16 a[80:83], v[136:139], a[224:227], a[80:83]
    v_mfma_f32_16x16x32_bf16 a[80:83], v[140:143], a[228:231], a[80:83]
    buffer_load_dwordx4 v166, s[12:15], s49 offen offset:2112 lds
    v_mfma_f32_16x16x32_bf16 a[84:87], v[136:139], a[232:235], a[84:87]
    s_waitcnt vmcnt(31) lgkmcnt(0)
    s_barrier
    v_mfma_f32_16x16x32_bf16 a[84:87], v[140:143], a[236:239], a[84:87]
    v_mfma_f32_16x16x32_bf16 a[88:91], v[136:139], a[240:243], a[88:91]
    v_mfma_f32_16x16x32_bf16 a[88:91], v[140:143], a[244:247], a[88:91]
    v_mfma_f32_16x16x32_bf16 a[92:95], v[136:139], a[248:251], a[92:95]
    v_mfma_f32_16x16x32_bf16 a[92:95], v[140:143], a[252:255], a[92:95]
    v_mfma_f32_16x16x32_bf16 a[96:99], v[144:147], a[224:227], a[96:99]
    buffer_load_dwordx4 v167, s[12:15], s49 offen offset:3168 lds
    v_mfma_f32_16x16x32_bf16 a[96:99], v[148:151], a[228:231], a[96:99]
    ds_read_b64_tr_b16 v[128:129], v238 offset:0
    ds_read_b64_tr_b16 v[130:131], v238 offset:256
    v_mfma_f32_16x16x32_bf16 a[100:103], v[144:147], a[232:235], a[100:103]
    ds_read_b64_tr_b16 v[132:133], v238 offset:512
    ds_read_b64_tr_b16 v[134:135], v238 offset:768
    v_mfma_f32_16x16x32_bf16 a[100:103], v[148:151], a[236:239], a[100:103]
    ds_read_b64_tr_b16 v[136:137], v238 offset:16896
    ds_read_b64_tr_b16 v[138:139], v238 offset:17152
    v_mfma_f32_16x16x32_bf16 a[104:107], v[144:147], a[240:243], a[104:107]
    ds_read_b64_tr_b16 v[140:141], v238 offset:17408
    ds_read_b64_tr_b16 v[142:143], v238 offset:17664
    v_mfma_f32_16x16x32_bf16 a[104:107], v[148:151], a[244:247], a[104:107]
    v_mfma_f32_16x16x32_bf16 a[108:111], v[144:147], a[248:251], a[108:111]
    v_mfma_f32_16x16x32_bf16 a[108:111], v[148:151], a[252:255], a[108:111]
    v_mfma_f32_16x16x32_bf16 a[112:115], v[152:155], a[224:227], a[112:115]
    v_mfma_f32_16x16x32_bf16 a[112:115], v[156:159], a[228:231], a[112:115]
    v_mfma_f32_16x16x32_bf16 a[116:119], v[152:155], a[232:235], a[116:119]
    v_mfma_f32_16x16x32_bf16 a[116:119], v[156:159], a[236:239], a[116:119]
    v_mfma_f32_16x16x32_bf16 a[120:123], v[152:155], a[240:243], a[120:123]
    v_mfma_f32_16x16x32_bf16 a[120:123], v[156:159], a[244:247], a[120:123]
    v_mfma_f32_16x16x32_bf16 a[124:127], v[152:155], a[248:251], a[124:127]
    v_mfma_f32_16x16x32_bf16 a[124:127], v[156:159], a[252:255], a[124:127]
    s_waitcnt vmcnt(8)
    s_waitcnt lgkmcnt(0)
    v_mfma_f32_16x16x32_bf16 a[0:3], v[128:131], a[128:131], a[0:3]
    ds_read_b64_tr_b16 v[144:145], v238 offset:32
    v_mfma_f32_16x16x32_bf16 a[0:3], v[132:135], a[132:135], a[0:3]
    ds_read_b64_tr_b16 v[146:147], v238 offset:288
    s_mov_b32 s48, 20480
    v_mfma_f32_16x16x32_bf16 a[0:3], v[136:139], a[160:163], a[0:3]
    buffer_load_dwordx4 a[192:195], v168, s[4:7], s48 offen offset:0 sc1
    v_mfma_f32_16x16x32_bf16 a[0:3], v[140:143], a[164:167], a[0:3]
    ds_read_b64_tr_b16 v[148:149], v238 offset:544
    ds_read_b64_tr_b16 v[150:151], v238 offset:800
    v_mfma_f32_16x16x32_bf16 a[4:7], v[128:131], a[136:139], a[4:7]
    ds_read_b64_tr_b16 v[152:153], v238 offset:16928
    v_mfma_f32_16x16x32_bf16 a[4:7], v[132:135], a[140:143], a[4:7]
    ds_read_b64_tr_b16 v[154:155], v238 offset:17184
    v_mfma_f32_16x16x32_bf16 a[4:7], v[136:139], a[168:171], a[4:7]
    ds_read_b64_tr_b16 v[156:157], v238 offset:17440
    v_mfma_f32_16x16x32_bf16 a[4:7], v[140:143], a[172:175], a[4:7]
    ds_read_b64_tr_b16 v[158:159], v238 offset:17696
    v_mfma_f32_16x16x32_bf16 a[8:11], v[128:131], a[144:147], a[8:11]
    buffer_load_dwordx4 a[196:199], v168, s[4:7], s48 offen offset:1024 sc1
    v_mfma_f32_16x16x32_bf16 a[8:11], v[132:135], a[148:151], a[8:11]
    v_mfma_f32_16x16x32_bf16 a[8:11], v[136:139], a[176:179], a[8:11]
    buffer_load_dwordx4 a[200:203], v169, s[4:7], s48 offen offset:0 sc1
    v_mfma_f32_16x16x32_bf16 a[8:11], v[140:143], a[180:183], a[8:11]
    v_mfma_f32_16x16x32_bf16 a[12:15], v[128:131], a[152:155], a[12:15]
    v_mfma_f32_16x16x32_bf16 a[12:15], v[132:135], a[156:159], a[12:15]
    v_mfma_f32_16x16x32_bf16 a[12:15], v[136:139], a[184:187], a[12:15]
    v_mfma_f32_16x16x32_bf16 a[12:15], v[140:143], a[188:191], a[12:15]
    buffer_load_dwordx4 a[204:207], v169, s[4:7], s48 offen offset:1024 sc1
    s_waitcnt lgkmcnt(0)
    v_mfma_f32_16x16x32_bf16 a[16:19], v[144:147], a[128:131], a[16:19]
    ds_read_b64_tr_b16 v[128:129], v238 offset:64
    v_mfma_f32_16x16x32_bf16 a[16:19], v[148:151], a[132:135], a[16:19]
    ds_read_b64_tr_b16 v[130:131], v238 offset:320
    v_mfma_f32_16x16x32_bf16 a[16:19], v[152:155], a[160:163], a[16:19]
    ds_read_b64_tr_b16 v[132:133], v238 offset:576
    v_mfma_f32_16x16x32_bf16 a[16:19], v[156:159], a[164:167], a[16:19]
    ds_read_b64_tr_b16 v[134:135], v238 offset:832
    v_mfma_f32_16x16x32_bf16 a[20:23], v[144:147], a[136:139], a[20:23]
    ds_read_b64_tr_b16 v[136:137], v238 offset:16960
    v_mfma_f32_16x16x32_bf16 a[20:23], v[148:151], a[140:143], a[20:23]
    buffer_load_dwordx4 a[208:211], v170, s[4:7], s48 offen offset:0 sc1
    v_mfma_f32_16x16x32_bf16 a[20:23], v[152:155], a[168:171], a[20:23]
    ds_read_b64_tr_b16 v[138:139], v238 offset:17216
    ds_read_b64_tr_b16 v[140:141], v238 offset:17472
    v_mfma_f32_16x16x32_bf16 a[20:23], v[156:159], a[172:175], a[20:23]
    ds_read_b64_tr_b16 v[142:143], v238 offset:17728
    v_mfma_f32_16x16x32_bf16 a[24:27], v[144:147], a[144:147], a[24:27]
    v_mfma_f32_16x16x32_bf16 a[24:27], v[148:151], a[148:151], a[24:27]
    buffer_load_dwordx4 a[212:215], v170, s[4:7], s48 offen offset:1024 sc1
    v_mfma_f32_16x16x32_bf16 a[24:27], v[152:155], a[176:179], a[24:27]
    v_mfma_f32_16x16x32_bf16 a[24:27], v[156:159], a[180:183], a[24:27]
    v_mfma_f32_16x16x32_bf16 a[28:31], v[144:147], a[152:155], a[28:31]
    v_mfma_f32_16x16x32_bf16 a[28:31], v[148:151], a[156:159], a[28:31]
    v_mfma_f32_16x16x32_bf16 a[28:31], v[152:155], a[184:187], a[28:31]
    buffer_load_dwordx4 a[216:219], v171, s[4:7], s48 offen offset:0 sc1
    v_mfma_f32_16x16x32_bf16 a[28:31], v[156:159], a[188:191], a[28:31]
    s_waitcnt lgkmcnt(0)
    v_mfma_f32_16x16x32_bf16 a[32:35], v[128:131], a[128:131], a[32:35]
    ds_read_b64_tr_b16 v[144:145], v238 offset:96
    v_mfma_f32_16x16x32_bf16 a[32:35], v[132:135], a[132:135], a[32:35]
    ds_read_b64_tr_b16 v[146:147], v238 offset:352
    v_mfma_f32_16x16x32_bf16 a[32:35], v[136:139], a[160:163], a[32:35]
    ds_read_b64_tr_b16 v[148:149], v238 offset:608
    v_mfma_f32_16x16x32_bf16 a[32:35], v[140:143], a[164:167], a[32:35]
    buffer_load_dwordx4 a[220:223], v171, s[4:7], s48 offen offset:1024 sc1
    v_mfma_f32_16x16x32_bf16 a[36:39], v[128:131], a[136:139], a[36:39]
    ds_read_b64_tr_b16 v[150:151], v238 offset:864
    ds_read_b64_tr_b16 v[152:153], v238 offset:16992
    v_mfma_f32_16x16x32_bf16 a[36:39], v[132:135], a[140:143], a[36:39]
    ds_read_b64_tr_b16 v[154:155], v238 offset:17248
    v_mfma_f32_16x16x32_bf16 a[36:39], v[136:139], a[168:171], a[36:39]
    ds_read_b64_tr_b16 v[156:157], v238 offset:17504
    v_mfma_f32_16x16x32_bf16 a[36:39], v[140:143], a[172:175], a[36:39]
    ds_read_b64_tr_b16 v[158:159], v238 offset:17760
    s_mov_b32 s48, 22528
    v_mfma_f32_16x16x32_bf16 a[40:43], v[128:131], a[144:147], a[40:43]
    buffer_load_dwordx4 a[224:227], v168, s[4:7], s48 offen offset:0 sc1
    v_mfma_f32_16x16x32_bf16 a[40:43], v[132:135], a[148:151], a[40:43]
    v_mfma_f32_16x16x32_bf16 a[40:43], v[136:139], a[176:179], a[40:43]
    v_mfma_f32_16x16x32_bf16 a[40:43], v[140:143], a[180:183], a[40:43]
    v_mfma_f32_16x16x32_bf16 a[44:47], v[128:131], a[152:155], a[44:47]
    v_mfma_f32_16x16x32_bf16 a[44:47], v[132:135], a[156:159], a[44:47]
    buffer_load_dwordx4 a[228:231], v168, s[4:7], s48 offen offset:1024 sc1
    v_mfma_f32_16x16x32_bf16 a[44:47], v[136:139], a[184:187], a[44:47]
    v_mfma_f32_16x16x32_bf16 a[44:47], v[140:143], a[188:191], a[44:47]
    s_waitcnt lgkmcnt(0)
    v_mfma_f32_16x16x32_bf16 a[48:51], v[144:147], a[128:131], a[48:51]
    ds_read_b64_tr_b16 v[128:129], v238 offset:128
    v_mfma_f32_16x16x32_bf16 a[48:51], v[148:151], a[132:135], a[48:51]
    ds_read_b64_tr_b16 v[130:131], v238 offset:384
    v_mfma_f32_16x16x32_bf16 a[48:51], v[152:155], a[160:163], a[48:51]
    buffer_load_dwordx4 a[232:235], v169, s[4:7], s48 offen offset:0 sc1
    v_mfma_f32_16x16x32_bf16 a[48:51], v[156:159], a[164:167], a[48:51]
    ds_read_b64_tr_b16 v[132:133], v238 offset:640
    ds_read_b64_tr_b16 v[134:135], v238 offset:896
    v_mfma_f32_16x16x32_bf16 a[52:55], v[144:147], a[136:139], a[52:55]
    ds_read_b64_tr_b16 v[136:137], v238 offset:17024
    v_mfma_f32_16x16x32_bf16 a[52:55], v[148:151], a[140:143], a[52:55]
    ds_read_b64_tr_b16 v[138:139], v238 offset:17280
    v_mfma_f32_16x16x32_bf16 a[52:55], v[152:155], a[168:171], a[52:55]
    ds_read_b64_tr_b16 v[140:141], v238 offset:17536
    v_mfma_f32_16x16x32_bf16 a[52:55], v[156:159], a[172:175], a[52:55]
    ds_read_b64_tr_b16 v[142:143], v238 offset:17792
    v_mfma_f32_16x16x32_bf16 a[56:59], v[144:147], a[144:147], a[56:59]
    buffer_load_dwordx4 a[236:239], v169, s[4:7], s48 offen offset:1024 sc1
    v_mfma_f32_16x16x32_bf16 a[56:59], v[148:151], a[148:151], a[56:59]
    v_mfma_f32_16x16x32_bf16 a[56:59], v[152:155], a[176:179], a[56:59]
    v_mfma_f32_16x16x32_bf16 a[56:59], v[156:159], a[180:183], a[56:59]
    v_mfma_f32_16x16x32_bf16 a[60:63], v[144:147], a[152:155], a[60:63]
    buffer_load_dwordx4 a[240:243], v170, s[4:7], s48 offen offset:0 sc1
    v_mfma_f32_16x16x32_bf16 a[60:63], v[148:151], a[156:159], a[60:63]
    v_mfma_f32_16x16x32_bf16 a[60:63], v[152:155], a[184:187], a[60:63]
    v_mfma_f32_16x16x32_bf16 a[60:63], v[156:159], a[188:191], a[60:63]
    s_waitcnt lgkmcnt(0)
    v_mfma_f32_16x16x32_bf16 a[64:67], v[128:131], a[128:131], a[64:67]
    ds_read_b64_tr_b16 v[144:145], v238 offset:160
    v_mfma_f32_16x16x32_bf16 a[64:67], v[132:135], a[132:135], a[64:67]
    buffer_load_dwordx4 a[244:247], v170, s[4:7], s48 offen offset:1024 sc1
    v_mfma_f32_16x16x32_bf16 a[64:67], v[136:139], a[160:163], a[64:67]
    ds_read_b64_tr_b16 v[146:147], v238 offset:416
    ds_read_b64_tr_b16 v[148:149], v238 offset:672
    v_mfma_f32_16x16x32_bf16 a[64:67], v[140:143], a[164:167], a[64:67]
    ds_read_b64_tr_b16 v[150:151], v238 offset:928
    v_mfma_f32_16x16x32_bf16 a[68:71], v[128:131], a[136:139], a[68:71]
    ds_read_b64_tr_b16 v[152:153], v238 offset:17056
    v_mfma_f32_16x16x32_bf16 a[68:71], v[132:135], a[140:143], a[68:71]
    ds_read_b64_tr_b16 v[154:155], v238 offset:17312
    v_mfma_f32_16x16x32_bf16 a[68:71], v[136:139], a[168:171], a[68:71]
    ds_read_b64_tr_b16 v[156:157], v238 offset:17568
    v_mfma_f32_16x16x32_bf16 a[68:71], v[140:143], a[172:175], a[68:71]
    ds_read_b64_tr_b16 v[158:159], v238 offset:17824
    v_mfma_f32_16x16x32_bf16 a[72:75], v[128:131], a[144:147], a[72:75]
    buffer_load_dwordx4 a[248:251], v171, s[4:7], s48 offen offset:0 sc1
    v_mfma_f32_16x16x32_bf16 a[72:75], v[132:135], a[148:151], a[72:75]
    v_mfma_f32_16x16x32_bf16 a[72:75], v[136:139], a[176:179], a[72:75]
    v_mfma_f32_16x16x32_bf16 a[72:75], v[140:143], a[180:183], a[72:75]
    buffer_load_dwordx4 a[252:255], v171, s[4:7], s48 offen offset:1024 sc1
    v_mfma_f32_16x16x32_bf16 a[76:79], v[128:131], a[152:155], a[76:79]
    v_mfma_f32_16x16x32_bf16 a[76:79], v[132:135], a[156:159], a[76:79]
    v_mfma_f32_16x16x32_bf16 a[76:79], v[136:139], a[184:187], a[76:79]
    v_mfma_f32_16x16x32_bf16 a[76:79], v[140:143], a[188:191], a[76:79]
    s_add_u32 m0, s53, 101376
    s_mov_b32 s49, 6422528
    s_waitcnt lgkmcnt(0)
    v_mfma_f32_16x16x32_bf16 a[80:83], v[144:147], a[128:131], a[80:83]
    buffer_load_dwordx4 v164, s[12:15], s49 offen offset:0 lds
    v_mfma_f32_16x16x32_bf16 a[80:83], v[148:151], a[132:135], a[80:83]
    ds_read_b64_tr_b16 v[128:129], v238 offset:192
    ds_read_b64_tr_b16 v[130:131], v238 offset:448
    v_mfma_f32_16x16x32_bf16 a[80:83], v[152:155], a[160:163], a[80:83]
    ds_read_b64_tr_b16 v[132:133], v238 offset:704
    v_mfma_f32_16x16x32_bf16 a[80:83], v[156:159], a[164:167], a[80:83]
    ds_read_b64_tr_b16 v[134:135], v238 offset:960
    v_mfma_f32_16x16x32_bf16 a[84:87], v[144:147], a[136:139], a[84:87]
    ds_read_b64_tr_b16 v[136:137], v238 offset:17088
    v_mfma_f32_16x16x32_bf16 a[84:87], v[148:151], a[140:143], a[84:87]
    ds_read_b64_tr_b16 v[138:139], v238 offset:17344
    v_mfma_f32_16x16x32_bf16 a[84:87], v[152:155], a[168:171], a[84:87]
    ds_read_b64_tr_b16 v[140:141], v238 offset:17600
    v_mfma_f32_16x16x32_bf16 a[84:87], v[156:159], a[172:175], a[84:87]
    ds_read_b64_tr_b16 v[142:143], v238 offset:17856
    v_mfma_f32_16x16x32_bf16 a[88:91], v[144:147], a[144:147], a[88:91]
    buffer_load_dwordx4 v165, s[12:15], s49 offen offset:1056 lds
    v_mfma_f32_16x16x32_bf16 a[88:91], v[148:151], a[148:151], a[88:91]
    v_mfma_f32_16x16x32_bf16 a[88:91], v[152:155], a[176:179], a[88:91]
    buffer_load_dwordx4 v166, s[12:15], s49 offen offset:2112 lds
    v_mfma_f32_16x16x32_bf16 a[88:91], v[156:159], a[180:183], a[88:91]
    v_mfma_f32_16x16x32_bf16 a[92:95], v[144:147], a[152:155], a[92:95]
    v_mfma_f32_16x16x32_bf16 a[92:95], v[148:151], a[156:159], a[92:95]
    v_mfma_f32_16x16x32_bf16 a[92:95], v[152:155], a[184:187], a[92:95]
    v_mfma_f32_16x16x32_bf16 a[92:95], v[156:159], a[188:191], a[92:95]
    buffer_load_dwordx4 v167, s[12:15], s49 offen offset:3168 lds
    s_waitcnt lgkmcnt(0)
    v_mfma_f32_16x16x32_bf16 a[96:99], v[128:131], a[128:131], a[96:99]
    ds_read_b64_tr_b16 v[144:145], v238 offset:224
    ds_read_b64_tr_b16 v[146:147], v238 offset:480
    v_mfma_f32_16x16x32_bf16 a[96:99], v[132:135], a[132:135], a[96:99]
    ds_read_b64_tr_b16 v[148:149], v238 offset:736
    ds_read_b64_tr_b16 v[150:151], v238 offset:992
    v_mfma_f32_16x16x32_bf16 a[96:99], v[136:139], a[160:163], a[96:99]
    ds_read_b64_tr_b16 v[152:153], v238 offset:17120
    ds_read_b64_tr_b16 v[154:155], v238 offset:17376
    v_mfma_f32_16x16x32_bf16 a[96:99], v[140:143], a[164:167], a[96:99]
    ds_read_b64_tr_b16 v[156:157], v238 offset:17632
    ds_read_b64_tr_b16 v[158:159], v238 offset:17888
    v_mfma_f32_16x16x32_bf16 a[100:103], v[128:131], a[136:139], a[100:103]
    s_add_u32 m0, s53, 118272
    s_mov_b32 s49, 6881280
    v_mfma_f32_16x16x32_bf16 a[100:103], v[132:135], a[140:143], a[100:103]
    buffer_load_dwordx4 v164, s[12:15], s49 offen offset:0 lds
    v_mfma_f32_16x16x32_bf16 a[100:103], v[136:139], a[168:171], a[100:103]
    v_mfma_f32_16x16x32_bf16 a[100:103], v[140:143], a[172:175], a[100:103]
    v_mfma_f32_16x16x32_bf16 a[104:107], v[128:131], a[144:147], a[104:107]
    v_mfma_f32_16x16x32_bf16 a[104:107], v[132:135], a[148:151], a[104:107]
    buffer_load_dwordx4 v165, s[12:15], s49 offen offset:1056 lds
    v_mfma_f32_16x16x32_bf16 a[104:107], v[136:139], a[176:179], a[104:107]
    v_mfma_f32_16x16x32_bf16 a[104:107], v[140:143], a[180:183], a[104:107]
    v_mfma_f32_16x16x32_bf16 a[108:111], v[128:131], a[152:155], a[108:111]
    v_mfma_f32_16x16x32_bf16 a[108:111], v[132:135], a[156:159], a[108:111]
    v_mfma_f32_16x16x32_bf16 a[108:111], v[136:139], a[184:187], a[108:111]
    s_waitcnt vmcnt(38) lgkmcnt(0)
    s_barrier
    v_mfma_f32_16x16x32_bf16 a[108:111], v[140:143], a[188:191], a[108:111]
    buffer_load_dwordx4 v166, s[12:15], s49 offen offset:2112 lds
    v_mfma_f32_16x16x32_bf16 a[112:115], v[144:147], a[128:131], a[112:115]
    ds_read_b64_tr_b16 v[128:129], v238 offset:33792
    ds_read_b64_tr_b16 v[130:131], v238 offset:34048
    v_mfma_f32_16x16x32_bf16 a[112:115], v[148:151], a[132:135], a[112:115]
    ds_read_b64_tr_b16 v[132:133], v238 offset:34304
    ds_read_b64_tr_b16 v[134:135], v238 offset:34560
    v_mfma_f32_16x16x32_bf16 a[112:115], v[152:155], a[160:163], a[112:115]
    ds_read_b64_tr_b16 v[136:137], v238 offset:50688
    ds_read_b64_tr_b16 v[138:139], v238 offset:50944
    v_mfma_f32_16x16x32_bf16 a[112:115], v[156:159], a[164:167], a[112:115]
    ds_read_b64_tr_b16 v[140:141], v238 offset:51200
    ds_read_b64_tr_b16 v[142:143], v238 offset:51456
    v_mfma_f32_16x16x32_bf16 a[116:119], v[144:147], a[136:139], a[116:119]
    buffer_load_dwordx4 v167, s[12:15], s49 offen offset:3168 lds
    v_mfma_f32_16x16x32_bf16 a[116:119], v[148:151], a[140:143], a[116:119]
    v_mfma_f32_16x16x32_bf16 a[116:119], v[152:155], a[168:171], a[116:119]
    v_mfma_f32_16x16x32_bf16 a[116:119], v[156:159], a[172:175], a[116:119]
    v_mfma_f32_16x16x32_bf16 a[120:123], v[144:147], a[144:147], a[120:123]
    v_mfma_f32_16x16x32_bf16 a[120:123], v[148:151], a[148:151], a[120:123]
    v_mfma_f32_16x16x32_bf16 a[120:123], v[152:155], a[176:179], a[120:123]
    v_mfma_f32_16x16x32_bf16 a[120:123], v[156:159], a[180:183], a[120:123]
    v_mfma_f32_16x16x32_bf16 a[124:127], v[144:147], a[152:155], a[124:127]
    v_mfma_f32_16x16x32_bf16 a[124:127], v[148:151], a[156:159], a[124:127]
    v_mfma_f32_16x16x32_bf16 a[124:127], v[152:155], a[184:187], a[124:127]
    v_mfma_f32_16x16x32_bf16 a[124:127], v[156:159], a[188:191], a[124:127]
    s_waitcnt vmcnt(8)
    s_waitcnt lgkmcnt(0)
    v_mfma_f32_16x16x32_bf16 a[0:3], v[128:131], a[192:195], a[0:3]
    ds_read_b64_tr_b16 v[144:145], v238 offset:33824
    v_mfma_f32_16x16x32_bf16 a[0:3], v[132:135], a[196:199], a[0:3]
    ds_read_b64_tr_b16 v[146:147], v238 offset:34080
    s_mov_b32 s48, 24576
    v_mfma_f32_16x16x32_bf16 a[0:3], v[136:139], a[224:227], a[0:3]
    buffer_load_dwordx4 a[128:131], v168, s[4:7], s48 offen offset:0 sc1
    v_mfma_f32_16x16x32_bf16 a[0:3], v[140:143], a[228:231], a[0:3]
    ds_read_b64_tr_b16 v[148:149], v238 offset:34336
    ds_read_b64_tr_b16 v[150:151], v238 offset:34592
    v_mfma_f32_16x16x32_bf16 a[4:7], v[128:131], a[200:203], a[4:7]
    ds_read_b64_tr_b16 v[152:153], v238 offset:50720
    v_mfma_f32_16x16x32_bf16 a[4:7], v[132:135], a[204:207], a[4:7]
    ds_read_b64_tr_b16 v[154:155], v238 offset:50976
    v_mfma_f32_16x16x32_bf16 a[4:7], v[136:139], a[232:235], a[4:7]
    ds_read_b64_tr_b16 v[156:157], v238 offset:51232
    v_mfma_f32_16x16x32_bf16 a[4:7], v[140:143], a[236:239], a[4:7]
    ds_read_b64_tr_b16 v[158:159], v238 offset:51488
    v_mfma_f32_16x16x32_bf16 a[8:11], v[128:131], a[208:211], a[8:11]
    buffer_load_dwordx4 a[132:135], v168, s[4:7], s48 offen offset:1024 sc1
    v_mfma_f32_16x16x32_bf16 a[8:11], v[132:135], a[212:215], a[8:11]
    v_mfma_f32_16x16x32_bf16 a[8:11], v[136:139], a[240:243], a[8:11]
    buffer_load_dwordx4 a[136:139], v169, s[4:7], s48 offen offset:0 sc1
    v_mfma_f32_16x16x32_bf16 a[8:11], v[140:143], a[244:247], a[8:11]
    v_mfma_f32_16x16x32_bf16 a[12:15], v[128:131], a[216:219], a[12:15]
    v_mfma_f32_16x16x32_bf16 a[12:15], v[132:135], a[220:223], a[12:15]
    v_mfma_f32_16x16x32_bf16 a[12:15], v[136:139], a[248:251], a[12:15]
    v_mfma_f32_16x16x32_bf16 a[12:15], v[140:143], a[252:255], a[12:15]
    buffer_load_dwordx4 a[140:143], v169, s[4:7], s48 offen offset:1024 sc1
    s_waitcnt lgkmcnt(0)
    v_mfma_f32_16x16x32_bf16 a[16:19], v[144:147], a[192:195], a[16:19]
    ds_read_b64_tr_b16 v[128:129], v238 offset:33856
    v_mfma_f32_16x16x32_bf16 a[16:19], v[148:151], a[196:199], a[16:19]
    ds_read_b64_tr_b16 v[130:131], v238 offset:34112
    v_mfma_f32_16x16x32_bf16 a[16:19], v[152:155], a[224:227], a[16:19]
    ds_read_b64_tr_b16 v[132:133], v238 offset:34368
    v_mfma_f32_16x16x32_bf16 a[16:19], v[156:159], a[228:231], a[16:19]
    ds_read_b64_tr_b16 v[134:135], v238 offset:34624
    v_mfma_f32_16x16x32_bf16 a[20:23], v[144:147], a[200:203], a[20:23]
    ds_read_b64_tr_b16 v[136:137], v238 offset:50752
    v_mfma_f32_16x16x32_bf16 a[20:23], v[148:151], a[204:207], a[20:23]
    buffer_load_dwordx4 a[144:147], v170, s[4:7], s48 offen offset:0 sc1
    v_mfma_f32_16x16x32_bf16 a[20:23], v[152:155], a[232:235], a[20:23]
    ds_read_b64_tr_b16 v[138:139], v238 offset:51008
    ds_read_b64_tr_b16 v[140:141], v238 offset:51264
    v_mfma_f32_16x16x32_bf16 a[20:23], v[156:159], a[236:239], a[20:23]
    ds_read_b64_tr_b16 v[142:143], v238 offset:51520
    v_mfma_f32_16x16x32_bf16 a[24:27], v[144:147], a[208:211], a[24:27]
    v_mfma_f32_16x16x32_bf16 a[24:27], v[148:151], a[212:215], a[24:27]
    buffer_load_dwordx4 a[148:151], v170, s[4:7], s48 offen offset:1024 sc1
    v_mfma_f32_16x16x32_bf16 a[24:27], v[152:155], a[240:243], a[24:27]
    v_mfma_f32_16x16x32_bf16 a[24:27], v[156:159], a[244:247], a[24:27]
    v_mfma_f32_16x16x32_bf16 a[28:31], v[144:147], a[216:219], a[28:31]
    v_mfma_f32_16x16x32_bf16 a[28:31], v[148:151], a[220:223], a[28:31]
    v_mfma_f32_16x16x32_bf16 a[28:31], v[152:155], a[248:251], a[28:31]
    buffer_load_dwordx4 a[152:155], v171, s[4:7], s48 offen offset:0 sc1
    v_mfma_f32_16x16x32_bf16 a[28:31], v[156:159], a[252:255], a[28:31]
    s_waitcnt lgkmcnt(0)
    v_mfma_f32_16x16x32_bf16 a[32:35], v[128:131], a[192:195], a[32:35]
    ds_read_b64_tr_b16 v[144:145], v238 offset:33888
    v_mfma_f32_16x16x32_bf16 a[32:35], v[132:135], a[196:199], a[32:35]
    ds_read_b64_tr_b16 v[146:147], v238 offset:34144
    v_mfma_f32_16x16x32_bf16 a[32:35], v[136:139], a[224:227], a[32:35]
    ds_read_b64_tr_b16 v[148:149], v238 offset:34400
    v_mfma_f32_16x16x32_bf16 a[32:35], v[140:143], a[228:231], a[32:35]
    buffer_load_dwordx4 a[156:159], v171, s[4:7], s48 offen offset:1024 sc1
    v_mfma_f32_16x16x32_bf16 a[36:39], v[128:131], a[200:203], a[36:39]
    ds_read_b64_tr_b16 v[150:151], v238 offset:34656
    ds_read_b64_tr_b16 v[152:153], v238 offset:50784
    v_mfma_f32_16x16x32_bf16 a[36:39], v[132:135], a[204:207], a[36:39]
    ds_read_b64_tr_b16 v[154:155], v238 offset:51040
    v_mfma_f32_16x16x32_bf16 a[36:39], v[136:139], a[232:235], a[36:39]
    ds_read_b64_tr_b16 v[156:157], v238 offset:51296
    v_mfma_f32_16x16x32_bf16 a[36:39], v[140:143], a[236:239], a[36:39]
    ds_read_b64_tr_b16 v[158:159], v238 offset:51552
    s_mov_b32 s48, 26624
    v_mfma_f32_16x16x32_bf16 a[40:43], v[128:131], a[208:211], a[40:43]
    buffer_load_dwordx4 a[160:163], v168, s[4:7], s48 offen offset:0 sc1
    v_mfma_f32_16x16x32_bf16 a[40:43], v[132:135], a[212:215], a[40:43]
    v_mfma_f32_16x16x32_bf16 a[40:43], v[136:139], a[240:243], a[40:43]
    v_mfma_f32_16x16x32_bf16 a[40:43], v[140:143], a[244:247], a[40:43]
    v_mfma_f32_16x16x32_bf16 a[44:47], v[128:131], a[216:219], a[44:47]
    v_mfma_f32_16x16x32_bf16 a[44:47], v[132:135], a[220:223], a[44:47]
    buffer_load_dwordx4 a[164:167], v168, s[4:7], s48 offen offset:1024 sc1
    v_mfma_f32_16x16x32_bf16 a[44:47], v[136:139], a[248:251], a[44:47]
    v_mfma_f32_16x16x32_bf16 a[44:47], v[140:143], a[252:255], a[44:47]
    s_waitcnt lgkmcnt(0)
    v_mfma_f32_16x16x32_bf16 a[48:51], v[144:147], a[192:195], a[48:51]
    ds_read_b64_tr_b16 v[128:129], v238 offset:33920
    v_mfma_f32_16x16x32_bf16 a[48:51], v[148:151], a[196:199], a[48:51]
    ds_read_b64_tr_b16 v[130:131], v238 offset:34176
    v_mfma_f32_16x16x32_bf16 a[48:51], v[152:155], a[224:227], a[48:51]
    buffer_load_dwordx4 a[168:171], v169, s[4:7], s48 offen offset:0 sc1
    v_mfma_f32_16x16x32_bf16 a[48:51], v[156:159], a[228:231], a[48:51]
    ds_read_b64_tr_b16 v[132:133], v238 offset:34432
    ds_read_b64_tr_b16 v[134:135], v238 offset:34688
    v_mfma_f32_16x16x32_bf16 a[52:55], v[144:147], a[200:203], a[52:55]
    ds_read_b64_tr_b16 v[136:137], v238 offset:50816
    v_mfma_f32_16x16x32_bf16 a[52:55], v[148:151], a[204:207], a[52:55]
    ds_read_b64_tr_b16 v[138:139], v238 offset:51072
    v_mfma_f32_16x16x32_bf16 a[52:55], v[152:155], a[232:235], a[52:55]
    ds_read_b64_tr_b16 v[140:141], v238 offset:51328
    v_mfma_f32_16x16x32_bf16 a[52:55], v[156:159], a[236:239], a[52:55]
    ds_read_b64_tr_b16 v[142:143], v238 offset:51584
    v_mfma_f32_16x16x32_bf16 a[56:59], v[144:147], a[208:211], a[56:59]
    buffer_load_dwordx4 a[172:175], v169, s[4:7], s48 offen offset:1024 sc1
    v_mfma_f32_16x16x32_bf16 a[56:59], v[148:151], a[212:215], a[56:59]
    v_mfma_f32_16x16x32_bf16 a[56:59], v[152:155], a[240:243], a[56:59]
    v_mfma_f32_16x16x32_bf16 a[56:59], v[156:159], a[244:247], a[56:59]
    v_mfma_f32_16x16x32_bf16 a[60:63], v[144:147], a[216:219], a[60:63]
    buffer_load_dwordx4 a[176:179], v170, s[4:7], s48 offen offset:0 sc1
    v_mfma_f32_16x16x32_bf16 a[60:63], v[148:151], a[220:223], a[60:63]
    v_mfma_f32_16x16x32_bf16 a[60:63], v[152:155], a[248:251], a[60:63]
    v_mfma_f32_16x16x32_bf16 a[60:63], v[156:159], a[252:255], a[60:63]
    s_waitcnt lgkmcnt(0)
    v_mfma_f32_16x16x32_bf16 a[64:67], v[128:131], a[192:195], a[64:67]
    ds_read_b64_tr_b16 v[144:145], v238 offset:33952
    v_mfma_f32_16x16x32_bf16 a[64:67], v[132:135], a[196:199], a[64:67]
    buffer_load_dwordx4 a[180:183], v170, s[4:7], s48 offen offset:1024 sc1
    v_mfma_f32_16x16x32_bf16 a[64:67], v[136:139], a[224:227], a[64:67]
    ds_read_b64_tr_b16 v[146:147], v238 offset:34208
    ds_read_b64_tr_b16 v[148:149], v238 offset:34464
    v_mfma_f32_16x16x32_bf16 a[64:67], v[140:143], a[228:231], a[64:67]
    ds_read_b64_tr_b16 v[150:151], v238 offset:34720
    v_mfma_f32_16x16x32_bf16 a[68:71], v[128:131], a[200:203], a[68:71]
    ds_read_b64_tr_b16 v[152:153], v238 offset:50848
    v_mfma_f32_16x16x32_bf16 a[68:71], v[132:135], a[204:207], a[68:71]
    ds_read_b64_tr_b16 v[154:155], v238 offset:51104
    v_mfma_f32_16x16x32_bf16 a[68:71], v[136:139], a[232:235], a[68:71]
    ds_read_b64_tr_b16 v[156:157], v238 offset:51360
    v_mfma_f32_16x16x32_bf16 a[68:71], v[140:143], a[236:239], a[68:71]
    ds_read_b64_tr_b16 v[158:159], v238 offset:51616
    v_mfma_f32_16x16x32_bf16 a[72:75], v[128:131], a[208:211], a[72:75]
    buffer_load_dwordx4 a[184:187], v171, s[4:7], s48 offen offset:0 sc1
    v_mfma_f32_16x16x32_bf16 a[72:75], v[132:135], a[212:215], a[72:75]
    v_mfma_f32_16x16x32_bf16 a[72:75], v[136:139], a[240:243], a[72:75]
    v_mfma_f32_16x16x32_bf16 a[72:75], v[140:143], a[244:247], a[72:75]
    buffer_load_dwordx4 a[188:191], v171, s[4:7], s48 offen offset:1024 sc1
    v_mfma_f32_16x16x32_bf16 a[76:79], v[128:131], a[216:219], a[76:79]
    v_mfma_f32_16x16x32_bf16 a[76:79], v[132:135], a[220:223], a[76:79]
    v_mfma_f32_16x16x32_bf16 a[76:79], v[136:139], a[248:251], a[76:79]
    v_mfma_f32_16x16x32_bf16 a[76:79], v[140:143], a[252:255], a[76:79]
    s_add_u32 m0, s53, 0
    s_mov_b32 s49, 6291456
    s_waitcnt lgkmcnt(0)
    v_mfma_f32_16x16x32_bf16 a[80:83], v[144:147], a[192:195], a[80:83]
    buffer_load_dwordx4 v160, s[8:11], s49 offen offset:0 lds
    v_mfma_f32_16x16x32_bf16 a[80:83], v[148:151], a[196:199], a[80:83]
    ds_read_b64_tr_b16 v[128:129], v238 offset:33984
    ds_read_b64_tr_b16 v[130:131], v238 offset:34240
    v_mfma_f32_16x16x32_bf16 a[80:83], v[152:155], a[224:227], a[80:83]
    ds_read_b64_tr_b16 v[132:133], v238 offset:34496
    v_mfma_f32_16x16x32_bf16 a[80:83], v[156:159], a[228:231], a[80:83]
    ds_read_b64_tr_b16 v[134:135], v238 offset:34752
    v_mfma_f32_16x16x32_bf16 a[84:87], v[144:147], a[200:203], a[84:87]
    ds_read_b64_tr_b16 v[136:137], v238 offset:50880
    v_mfma_f32_16x16x32_bf16 a[84:87], v[148:151], a[204:207], a[84:87]
    ds_read_b64_tr_b16 v[138:139], v238 offset:51136
    v_mfma_f32_16x16x32_bf16 a[84:87], v[152:155], a[232:235], a[84:87]
    ds_read_b64_tr_b16 v[140:141], v238 offset:51392
    v_mfma_f32_16x16x32_bf16 a[84:87], v[156:159], a[236:239], a[84:87]
    ds_read_b64_tr_b16 v[142:143], v238 offset:51648
    v_mfma_f32_16x16x32_bf16 a[88:91], v[144:147], a[208:211], a[88:91]
    buffer_load_dwordx4 v161, s[8:11], s49 offen offset:1056 lds
    v_mfma_f32_16x16x32_bf16 a[88:91], v[148:151], a[212:215], a[88:91]
    v_mfma_f32_16x16x32_bf16 a[88:91], v[152:155], a[240:243], a[88:91]
    buffer_load_dwordx4 v162, s[8:11], s49 offen offset:2112 lds
    v_mfma_f32_16x16x32_bf16 a[88:91], v[156:159], a[244:247], a[88:91]
    v_mfma_f32_16x16x32_bf16 a[92:95], v[144:147], a[216:219], a[92:95]
    v_mfma_f32_16x16x32_bf16 a[92:95], v[148:151], a[220:223], a[92:95]
    v_mfma_f32_16x16x32_bf16 a[92:95], v[152:155], a[248:251], a[92:95]
    v_mfma_f32_16x16x32_bf16 a[92:95], v[156:159], a[252:255], a[92:95]
    buffer_load_dwordx4 v163, s[8:11], s49 offen offset:3168 lds
    s_waitcnt lgkmcnt(0)
    v_mfma_f32_16x16x32_bf16 a[96:99], v[128:131], a[192:195], a[96:99]
    ds_read_b64_tr_b16 v[144:145], v238 offset:34016
    ds_read_b64_tr_b16 v[146:147], v238 offset:34272
    v_mfma_f32_16x16x32_bf16 a[96:99], v[132:135], a[196:199], a[96:99]
    ds_read_b64_tr_b16 v[148:149], v238 offset:34528
    ds_read_b64_tr_b16 v[150:151], v238 offset:34784
    v_mfma_f32_16x16x32_bf16 a[96:99], v[136:139], a[224:227], a[96:99]
    ds_read_b64_tr_b16 v[152:153], v238 offset:50912
    ds_read_b64_tr_b16 v[154:155], v238 offset:51168
    v_mfma_f32_16x16x32_bf16 a[96:99], v[140:143], a[228:231], a[96:99]
    ds_read_b64_tr_b16 v[156:157], v238 offset:51424
    ds_read_b64_tr_b16 v[158:159], v238 offset:51680
    v_mfma_f32_16x16x32_bf16 a[100:103], v[128:131], a[200:203], a[100:103]
    s_add_u32 m0, s53, 16896
    s_mov_b32 s49, 6815744
    v_mfma_f32_16x16x32_bf16 a[100:103], v[132:135], a[204:207], a[100:103]
    buffer_load_dwordx4 v160, s[8:11], s49 offen offset:0 lds
    v_mfma_f32_16x16x32_bf16 a[100:103], v[136:139], a[232:235], a[100:103]
    v_mfma_f32_16x16x32_bf16 a[100:103], v[140:143], a[236:239], a[100:103]
    v_mfma_f32_16x16x32_bf16 a[104:107], v[128:131], a[208:211], a[104:107]
    v_mfma_f32_16x16x32_bf16 a[104:107], v[132:135], a[212:215], a[104:107]
    buffer_load_dwordx4 v161, s[8:11], s49 offen offset:1056 lds
    v_mfma_f32_16x16x32_bf16 a[104:107], v[136:139], a[240:243], a[104:107]
    v_mfma_f32_16x16x32_bf16 a[104:107], v[140:143], a[244:247], a[104:107]
    v_mfma_f32_16x16x32_bf16 a[108:111], v[128:131], a[216:219], a[108:111]
    v_mfma_f32_16x16x32_bf16 a[108:111], v[132:135], a[220:223], a[108:111]
    v_mfma_f32_16x16x32_bf16 a[108:111], v[136:139], a[248:251], a[108:111]
    s_waitcnt vmcnt(46) lgkmcnt(0)
    s_barrier
    v_mfma_f32_16x16x32_bf16 a[108:111], v[140:143], a[252:255], a[108:111]
    buffer_load_dwordx4 v162, s[8:11], s49 offen offset:2112 lds
    v_mfma_f32_16x16x32_bf16 a[112:115], v[144:147], a[192:195], a[112:115]
    ds_read_b64_tr_b16 v[128:129], v239 offset:0
    ds_read_b64_tr_b16 v[130:131], v239 offset:256
    v_mfma_f32_16x16x32_bf16 a[112:115], v[148:151], a[196:199], a[112:115]
    ds_read_b64_tr_b16 v[132:133], v239 offset:512
    ds_read_b64_tr_b16 v[134:135], v239 offset:768
    v_mfma_f32_16x16x32_bf16 a[112:115], v[152:155], a[224:227], a[112:115]
    ds_read_b64_tr_b16 v[136:137], v239 offset:16896
    ds_read_b64_tr_b16 v[138:139], v239 offset:17152
    v_mfma_f32_16x16x32_bf16 a[112:115], v[156:159], a[228:231], a[112:115]
    ds_read_b64_tr_b16 v[140:141], v239 offset:17408
    ds_read_b64_tr_b16 v[142:143], v239 offset:17664
    v_mfma_f32_16x16x32_bf16 a[116:119], v[144:147], a[200:203], a[116:119]
    buffer_load_dwordx4 v163, s[8:11], s49 offen offset:3168 lds
    v_mfma_f32_16x16x32_bf16 a[116:119], v[148:151], a[204:207], a[116:119]
    v_mfma_f32_16x16x32_bf16 a[116:119], v[152:155], a[232:235], a[116:119]
    v_mfma_f32_16x16x32_bf16 a[116:119], v[156:159], a[236:239], a[116:119]
    v_mfma_f32_16x16x32_bf16 a[120:123], v[144:147], a[208:211], a[120:123]
    v_mfma_f32_16x16x32_bf16 a[120:123], v[148:151], a[212:215], a[120:123]
    v_mfma_f32_16x16x32_bf16 a[120:123], v[152:155], a[240:243], a[120:123]
    v_mfma_f32_16x16x32_bf16 a[120:123], v[156:159], a[244:247], a[120:123]
    v_mfma_f32_16x16x32_bf16 a[124:127], v[144:147], a[216:219], a[124:127]
    v_mfma_f32_16x16x32_bf16 a[124:127], v[148:151], a[220:223], a[124:127]
    v_mfma_f32_16x16x32_bf16 a[124:127], v[152:155], a[248:251], a[124:127]
    v_mfma_f32_16x16x32_bf16 a[124:127], v[156:159], a[252:255], a[124:127]
    s_waitcnt vmcnt(8)
    s_waitcnt lgkmcnt(0)
    v_mfma_f32_16x16x32_bf16 a[0:3], v[128:131], a[128:131], a[0:3]
    ds_read_b64_tr_b16 v[144:145], v239 offset:32
    v_mfma_f32_16x16x32_bf16 a[0:3], v[132:135], a[132:135], a[0:3]
    ds_read_b64_tr_b16 v[146:147], v239 offset:288
    s_mov_b32 s48, 28672
    v_mfma_f32_16x16x32_bf16 a[0:3], v[136:139], a[160:163], a[0:3]
    buffer_load_dwordx4 a[192:195], v168, s[4:7], s48 offen offset:0 sc1
    v_mfma_f32_16x16x32_bf16 a[0:3], v[140:143], a[164:167], a[0:3]
    ds_read_b64_tr_b16 v[148:149], v239 offset:544
    ds_read_b64_tr_b16 v[150:151], v239 offset:800
    v_mfma_f32_16x16x32_bf16 a[4:7], v[128:131], a[136:139], a[4:7]
    ds_read_b64_tr_b16 v[152:153], v239 offset:16928
    v_mfma_f32_16x16x32_bf16 a[4:7], v[132:135], a[140:143], a[4:7]
    ds_read_b64_tr_b16 v[154:155], v239 offset:17184
    v_mfma_f32_16x16x32_bf16 a[4:7], v[136:139], a[168:171], a[4:7]
    ds_read_b64_tr_b16 v[156:157], v239 offset:17440
    v_mfma_f32_16x16x32_bf16 a[4:7], v[140:143], a[172:175], a[4:7]
    ds_read_b64_tr_b16 v[158:159], v239 offset:17696
    v_mfma_f32_16x16x32_bf16 a[8:11], v[128:131], a[144:147], a[8:11]
    buffer_load_dwordx4 a[196:199], v168, s[4:7], s48 offen offset:1024 sc1
    v_mfma_f32_16x16x32_bf16 a[8:11], v[132:135], a[148:151], a[8:11]
    v_mfma_f32_16x16x32_bf16 a[8:11], v[136:139], a[176:179], a[8:11]
    buffer_load_dwordx4 a[200:203], v169, s[4:7], s48 offen offset:0 sc1
    v_mfma_f32_16x16x32_bf16 a[8:11], v[140:143], a[180:183], a[8:11]
    v_mfma_f32_16x16x32_bf16 a[12:15], v[128:131], a[152:155], a[12:15]
    v_mfma_f32_16x16x32_bf16 a[12:15], v[132:135], a[156:159], a[12:15]
    v_mfma_f32_16x16x32_bf16 a[12:15], v[136:139], a[184:187], a[12:15]
    v_mfma_f32_16x16x32_bf16 a[12:15], v[140:143], a[188:191], a[12:15]
    buffer_load_dwordx4 a[204:207], v169, s[4:7], s48 offen offset:1024 sc1
    s_waitcnt lgkmcnt(0)
    v_mfma_f32_16x16x32_bf16 a[16:19], v[144:147], a[128:131], a[16:19]
    ds_read_b64_tr_b16 v[128:129], v239 offset:64
    v_mfma_f32_16x16x32_bf16 a[16:19], v[148:151], a[132:135], a[16:19]
    ds_read_b64_tr_b16 v[130:131], v239 offset:320
    v_mfma_f32_16x16x32_bf16 a[16:19], v[152:155], a[160:163], a[16:19]
    ds_read_b64_tr_b16 v[132:133], v239 offset:576
    v_mfma_f32_16x16x32_bf16 a[16:19], v[156:159], a[164:167], a[16:19]
    ds_read_b64_tr_b16 v[134:135], v239 offset:832
    v_mfma_f32_16x16x32_bf16 a[20:23], v[144:147], a[136:139], a[20:23]
    ds_read_b64_tr_b16 v[136:137], v239 offset:16960
    v_mfma_f32_16x16x32_bf16 a[20:23], v[148:151], a[140:143], a[20:23]
    buffer_load_dwordx4 a[208:211], v170, s[4:7], s48 offen offset:0 sc1
    v_mfma_f32_16x16x32_bf16 a[20:23], v[152:155], a[168:171], a[20:23]
    ds_read_b64_tr_b16 v[138:139], v239 offset:17216
    ds_read_b64_tr_b16 v[140:141], v239 offset:17472
    v_mfma_f32_16x16x32_bf16 a[20:23], v[156:159], a[172:175], a[20:23]
    ds_read_b64_tr_b16 v[142:143], v239 offset:17728
    v_mfma_f32_16x16x32_bf16 a[24:27], v[144:147], a[144:147], a[24:27]
    v_mfma_f32_16x16x32_bf16 a[24:27], v[148:151], a[148:151], a[24:27]
    buffer_load_dwordx4 a[212:215], v170, s[4:7], s48 offen offset:1024 sc1
    v_mfma_f32_16x16x32_bf16 a[24:27], v[152:155], a[176:179], a[24:27]
    v_mfma_f32_16x16x32_bf16 a[24:27], v[156:159], a[180:183], a[24:27]
    v_mfma_f32_16x16x32_bf16 a[28:31], v[144:147], a[152:155], a[28:31]
    v_mfma_f32_16x16x32_bf16 a[28:31], v[148:151], a[156:159], a[28:31]
    v_mfma_f32_16x16x32_bf16 a[28:31], v[152:155], a[184:187], a[28:31]
    buffer_load_dwordx4 a[216:219], v171, s[4:7], s48 offen offset:0 sc1
    v_mfma_f32_16x16x32_bf16 a[28:31], v[156:159], a[188:191], a[28:31]
    s_waitcnt lgkmcnt(0)
    v_mfma_f32_16x16x32_bf16 a[32:35], v[128:131], a[128:131], a[32:35]
    ds_read_b64_tr_b16 v[144:145], v239 offset:96
    v_mfma_f32_16x16x32_bf16 a[32:35], v[132:135], a[132:135], a[32:35]
    ds_read_b64_tr_b16 v[146:147], v239 offset:352
    v_mfma_f32_16x16x32_bf16 a[32:35], v[136:139], a[160:163], a[32:35]
    ds_read_b64_tr_b16 v[148:149], v239 offset:608
    v_mfma_f32_16x16x32_bf16 a[32:35], v[140:143], a[164:167], a[32:35]
    buffer_load_dwordx4 a[220:223], v171, s[4:7], s48 offen offset:1024 sc1
    v_mfma_f32_16x16x32_bf16 a[36:39], v[128:131], a[136:139], a[36:39]
    ds_read_b64_tr_b16 v[150:151], v239 offset:864
    ds_read_b64_tr_b16 v[152:153], v239 offset:16992
    v_mfma_f32_16x16x32_bf16 a[36:39], v[132:135], a[140:143], a[36:39]
    ds_read_b64_tr_b16 v[154:155], v239 offset:17248
    v_mfma_f32_16x16x32_bf16 a[36:39], v[136:139], a[168:171], a[36:39]
    ds_read_b64_tr_b16 v[156:157], v239 offset:17504
    v_mfma_f32_16x16x32_bf16 a[36:39], v[140:143], a[172:175], a[36:39]
    ds_read_b64_tr_b16 v[158:159], v239 offset:17760
    s_mov_b32 s48, 30720
    v_mfma_f32_16x16x32_bf16 a[40:43], v[128:131], a[144:147], a[40:43]
    buffer_load_dwordx4 a[224:227], v168, s[4:7], s48 offen offset:0 sc1
    v_mfma_f32_16x16x32_bf16 a[40:43], v[132:135], a[148:151], a[40:43]
    v_mfma_f32_16x16x32_bf16 a[40:43], v[136:139], a[176:179], a[40:43]
    v_mfma_f32_16x16x32_bf16 a[40:43], v[140:143], a[180:183], a[40:43]
    v_mfma_f32_16x16x32_bf16 a[44:47], v[128:131], a[152:155], a[44:47]
    v_mfma_f32_16x16x32_bf16 a[44:47], v[132:135], a[156:159], a[44:47]
    buffer_load_dwordx4 a[228:231], v168, s[4:7], s48 offen offset:1024 sc1
    v_mfma_f32_16x16x32_bf16 a[44:47], v[136:139], a[184:187], a[44:47]
    v_mfma_f32_16x16x32_bf16 a[44:47], v[140:143], a[188:191], a[44:47]
    s_waitcnt lgkmcnt(0)
    v_mfma_f32_16x16x32_bf16 a[48:51], v[144:147], a[128:131], a[48:51]
    ds_read_b64_tr_b16 v[128:129], v239 offset:128
    v_mfma_f32_16x16x32_bf16 a[48:51], v[148:151], a[132:135], a[48:51]
    ds_read_b64_tr_b16 v[130:131], v239 offset:384
    v_mfma_f32_16x16x32_bf16 a[48:51], v[152:155], a[160:163], a[48:51]
    buffer_load_dwordx4 a[232:235], v169, s[4:7], s48 offen offset:0 sc1
    v_mfma_f32_16x16x32_bf16 a[48:51], v[156:159], a[164:167], a[48:51]
    ds_read_b64_tr_b16 v[132:133], v239 offset:640
    ds_read_b64_tr_b16 v[134:135], v239 offset:896
    v_mfma_f32_16x16x32_bf16 a[52:55], v[144:147], a[136:139], a[52:55]
    ds_read_b64_tr_b16 v[136:137], v239 offset:17024
    v_mfma_f32_16x16x32_bf16 a[52:55], v[148:151], a[140:143], a[52:55]
    ds_read_b64_tr_b16 v[138:139], v239 offset:17280
    v_mfma_f32_16x16x32_bf16 a[52:55], v[152:155], a[168:171], a[52:55]
    ds_read_b64_tr_b16 v[140:141], v239 offset:17536
    v_mfma_f32_16x16x32_bf16 a[52:55], v[156:159], a[172:175], a[52:55]
    ds_read_b64_tr_b16 v[142:143], v239 offset:17792
    v_mfma_f32_16x16x32_bf16 a[56:59], v[144:147], a[144:147], a[56:59]
    buffer_load_dwordx4 a[236:239], v169, s[4:7], s48 offen offset:1024 sc1
    v_mfma_f32_16x16x32_bf16 a[56:59], v[148:151], a[148:151], a[56:59]
    v_mfma_f32_16x16x32_bf16 a[56:59], v[152:155], a[176:179], a[56:59]
    v_mfma_f32_16x16x32_bf16 a[56:59], v[156:159], a[180:183], a[56:59]
    v_mfma_f32_16x16x32_bf16 a[60:63], v[144:147], a[152:155], a[60:63]
    buffer_load_dwordx4 a[240:243], v170, s[4:7], s48 offen offset:0 sc1
    v_mfma_f32_16x16x32_bf16 a[60:63], v[148:151], a[156:159], a[60:63]
    v_mfma_f32_16x16x32_bf16 a[60:63], v[152:155], a[184:187], a[60:63]
    v_mfma_f32_16x16x32_bf16 a[60:63], v[156:159], a[188:191], a[60:63]
    s_waitcnt lgkmcnt(0)
    v_mfma_f32_16x16x32_bf16 a[64:67], v[128:131], a[128:131], a[64:67]
    ds_read_b64_tr_b16 v[144:145], v239 offset:160
    v_mfma_f32_16x16x32_bf16 a[64:67], v[132:135], a[132:135], a[64:67]
    buffer_load_dwordx4 a[244:247], v170, s[4:7], s48 offen offset:1024 sc1
    v_mfma_f32_16x16x32_bf16 a[64:67], v[136:139], a[160:163], a[64:67]
    ds_read_b64_tr_b16 v[146:147], v239 offset:416
    ds_read_b64_tr_b16 v[148:149], v239 offset:672
    v_mfma_f32_16x16x32_bf16 a[64:67], v[140:143], a[164:167], a[64:67]
    ds_read_b64_tr_b16 v[150:151], v239 offset:928
    v_mfma_f32_16x16x32_bf16 a[68:71], v[128:131], a[136:139], a[68:71]
    ds_read_b64_tr_b16 v[152:153], v239 offset:17056
    v_mfma_f32_16x16x32_bf16 a[68:71], v[132:135], a[140:143], a[68:71]
    ds_read_b64_tr_b16 v[154:155], v239 offset:17312
    v_mfma_f32_16x16x32_bf16 a[68:71], v[136:139], a[168:171], a[68:71]
    ds_read_b64_tr_b16 v[156:157], v239 offset:17568
    v_mfma_f32_16x16x32_bf16 a[68:71], v[140:143], a[172:175], a[68:71]
    ds_read_b64_tr_b16 v[158:159], v239 offset:17824
    v_mfma_f32_16x16x32_bf16 a[72:75], v[128:131], a[144:147], a[72:75]
    buffer_load_dwordx4 a[248:251], v171, s[4:7], s48 offen offset:0 sc1
    v_mfma_f32_16x16x32_bf16 a[72:75], v[132:135], a[148:151], a[72:75]
    v_mfma_f32_16x16x32_bf16 a[72:75], v[136:139], a[176:179], a[72:75]
    v_mfma_f32_16x16x32_bf16 a[72:75], v[140:143], a[180:183], a[72:75]
    buffer_load_dwordx4 a[252:255], v171, s[4:7], s48 offen offset:1024 sc1
    v_mfma_f32_16x16x32_bf16 a[76:79], v[128:131], a[152:155], a[76:79]
    v_mfma_f32_16x16x32_bf16 a[76:79], v[132:135], a[156:159], a[76:79]
    v_mfma_f32_16x16x32_bf16 a[76:79], v[136:139], a[184:187], a[76:79]
    v_mfma_f32_16x16x32_bf16 a[76:79], v[140:143], a[188:191], a[76:79]
    s_add_u32 m0, s53, 33792
    s_mov_b32 s49, 7340032
    s_waitcnt lgkmcnt(0)
    v_mfma_f32_16x16x32_bf16 a[80:83], v[144:147], a[128:131], a[80:83]
    buffer_load_dwordx4 v160, s[8:11], s49 offen offset:0 lds
    v_mfma_f32_16x16x32_bf16 a[80:83], v[148:151], a[132:135], a[80:83]
    ds_read_b64_tr_b16 v[128:129], v239 offset:192
    ds_read_b64_tr_b16 v[130:131], v239 offset:448
    v_mfma_f32_16x16x32_bf16 a[80:83], v[152:155], a[160:163], a[80:83]
    ds_read_b64_tr_b16 v[132:133], v239 offset:704
    v_mfma_f32_16x16x32_bf16 a[80:83], v[156:159], a[164:167], a[80:83]
    ds_read_b64_tr_b16 v[134:135], v239 offset:960
    v_mfma_f32_16x16x32_bf16 a[84:87], v[144:147], a[136:139], a[84:87]
    ds_read_b64_tr_b16 v[136:137], v239 offset:17088
    v_mfma_f32_16x16x32_bf16 a[84:87], v[148:151], a[140:143], a[84:87]
    ds_read_b64_tr_b16 v[138:139], v239 offset:17344
    v_mfma_f32_16x16x32_bf16 a[84:87], v[152:155], a[168:171], a[84:87]
    ds_read_b64_tr_b16 v[140:141], v239 offset:17600
    v_mfma_f32_16x16x32_bf16 a[84:87], v[156:159], a[172:175], a[84:87]
    ds_read_b64_tr_b16 v[142:143], v239 offset:17856
    v_mfma_f32_16x16x32_bf16 a[88:91], v[144:147], a[144:147], a[88:91]
    buffer_load_dwordx4 v161, s[8:11], s49 offen offset:1056 lds
    v_mfma_f32_16x16x32_bf16 a[88:91], v[148:151], a[148:151], a[88:91]
    v_mfma_f32_16x16x32_bf16 a[88:91], v[152:155], a[176:179], a[88:91]
    buffer_load_dwordx4 v162, s[8:11], s49 offen offset:2112 lds
    v_mfma_f32_16x16x32_bf16 a[88:91], v[156:159], a[180:183], a[88:91]
    v_mfma_f32_16x16x32_bf16 a[92:95], v[144:147], a[152:155], a[92:95]
    v_mfma_f32_16x16x32_bf16 a[92:95], v[148:151], a[156:159], a[92:95]
    v_mfma_f32_16x16x32_bf16 a[92:95], v[152:155], a[184:187], a[92:95]
    v_mfma_f32_16x16x32_bf16 a[92:95], v[156:159], a[188:191], a[92:95]
    buffer_load_dwordx4 v163, s[8:11], s49 offen offset:3168 lds
    s_waitcnt lgkmcnt(0)
    v_mfma_f32_16x16x32_bf16 a[96:99], v[128:131], a[128:131], a[96:99]
    ds_read_b64_tr_b16 v[144:145], v239 offset:224
    ds_read_b64_tr_b16 v[146:147], v239 offset:480
    v_mfma_f32_16x16x32_bf16 a[96:99], v[132:135], a[132:135], a[96:99]
    ds_read_b64_tr_b16 v[148:149], v239 offset:736
    ds_read_b64_tr_b16 v[150:151], v239 offset:992
    v_mfma_f32_16x16x32_bf16 a[96:99], v[136:139], a[160:163], a[96:99]
    ds_read_b64_tr_b16 v[152:153], v239 offset:17120
    ds_read_b64_tr_b16 v[154:155], v239 offset:17376
    v_mfma_f32_16x16x32_bf16 a[96:99], v[140:143], a[164:167], a[96:99]
    ds_read_b64_tr_b16 v[156:157], v239 offset:17632
    ds_read_b64_tr_b16 v[158:159], v239 offset:17888
    v_mfma_f32_16x16x32_bf16 a[100:103], v[128:131], a[136:139], a[100:103]
    s_add_u32 m0, s53, 50688
    s_mov_b32 s49, 7864320
    v_mfma_f32_16x16x32_bf16 a[100:103], v[132:135], a[140:143], a[100:103]
    buffer_load_dwordx4 v160, s[8:11], s49 offen offset:0 lds
    v_mfma_f32_16x16x32_bf16 a[100:103], v[136:139], a[168:171], a[100:103]
    v_mfma_f32_16x16x32_bf16 a[100:103], v[140:143], a[172:175], a[100:103]
    v_mfma_f32_16x16x32_bf16 a[104:107], v[128:131], a[144:147], a[104:107]
    v_mfma_f32_16x16x32_bf16 a[104:107], v[132:135], a[148:151], a[104:107]
    buffer_load_dwordx4 v161, s[8:11], s49 offen offset:1056 lds
    v_mfma_f32_16x16x32_bf16 a[104:107], v[136:139], a[176:179], a[104:107]
    v_mfma_f32_16x16x32_bf16 a[104:107], v[140:143], a[180:183], a[104:107]
    v_mfma_f32_16x16x32_bf16 a[108:111], v[128:131], a[152:155], a[108:111]
    v_mfma_f32_16x16x32_bf16 a[108:111], v[132:135], a[156:159], a[108:111]
    v_mfma_f32_16x16x32_bf16 a[108:111], v[136:139], a[184:187], a[108:111]
    s_waitcnt vmcnt(46) lgkmcnt(0)
    s_barrier
    v_mfma_f32_16x16x32_bf16 a[108:111], v[140:143], a[188:191], a[108:111]
    buffer_load_dwordx4 v162, s[8:11], s49 offen offset:2112 lds
    v_mfma_f32_16x16x32_bf16 a[112:115], v[144:147], a[128:131], a[112:115]
    ds_read_b64_tr_b16 v[128:129], v239 offset:33792
    ds_read_b64_tr_b16 v[130:131], v239 offset:34048
    v_mfma_f32_16x16x32_bf16 a[112:115], v[148:151], a[132:135], a[112:115]
    ds_read_b64_tr_b16 v[132:133], v239 offset:34304
    ds_read_b64_tr_b16 v[134:135], v239 offset:34560
    v_mfma_f32_16x16x32_bf16 a[112:115], v[152:155], a[160:163], a[112:115]
    ds_read_b64_tr_b16 v[136:137], v239 offset:50688
    ds_read_b64_tr_b16 v[138:139], v239 offset:50944
    v_mfma_f32_16x16x32_bf16 a[112:115], v[156:159], a[164:167], a[112:115]
    ds_read_b64_tr_b16 v[140:141], v239 offset:51200
    ds_read_b64_tr_b16 v[142:143], v239 offset:51456
    v_mfma_f32_16x16x32_bf16 a[116:119], v[144:147], a[136:139], a[116:119]
    buffer_load_dwordx4 v163, s[8:11], s49 offen offset:3168 lds
    v_mfma_f32_16x16x32_bf16 a[116:119], v[148:151], a[140:143], a[116:119]
    v_mfma_f32_16x16x32_bf16 a[116:119], v[152:155], a[168:171], a[116:119]
    v_mfma_f32_16x16x32_bf16 a[116:119], v[156:159], a[172:175], a[116:119]
    v_mfma_f32_16x16x32_bf16 a[120:123], v[144:147], a[144:147], a[120:123]
    v_mfma_f32_16x16x32_bf16 a[120:123], v[148:151], a[148:151], a[120:123]
    v_mfma_f32_16x16x32_bf16 a[120:123], v[152:155], a[176:179], a[120:123]
    v_mfma_f32_16x16x32_bf16 a[120:123], v[156:159], a[180:183], a[120:123]
    v_mfma_f32_16x16x32_bf16 a[124:127], v[144:147], a[152:155], a[124:127]
    v_mfma_f32_16x16x32_bf16 a[124:127], v[148:151], a[156:159], a[124:127]
    v_mfma_f32_16x16x32_bf16 a[124:127], v[152:155], a[184:187], a[124:127]
    v_mfma_f32_16x16x32_bf16 a[124:127], v[156:159], a[188:191], a[124:127]
    s_waitcnt vmcnt(8)
    s_waitcnt lgkmcnt(0)
    v_mfma_f32_16x16x32_bf16 a[0:3], v[128:131], a[192:195], a[0:3]
    ds_read_b64_tr_b16 v[144:145], v239 offset:33824
    v_mfma_f32_16x16x32_bf16 a[0:3], v[132:135], a[196:199], a[0:3]
    s_add_u32 m0, s53, 67584
    s_mov_b32 s49, 4194304
    v_mfma_f32_16x16x32_bf16 a[0:3], v[136:139], a[224:227], a[0:3]
    buffer_load_dwordx4 v160, s[8:11], s49 offen offset:0 lds
    v_mfma_f32_16x16x32_bf16 a[0:3], v[140:143], a[228:231], a[0:3]
    ds_read_b64_tr_b16 v[146:147], v239 offset:34080
    ds_read_b64_tr_b16 v[148:149], v239 offset:34336
    v_mfma_f32_16x16x32_bf16 a[4:7], v[128:131], a[200:203], a[4:7]
    ds_read_b64_tr_b16 v[150:151], v239 offset:34592
    ds_read_b64_tr_b16 v[152:153], v239 offset:50720
    v_mfma_f32_16x16x32_bf16 a[4:7], v[132:135], a[204:207], a[4:7]
    ds_read_b64_tr_b16 v[154:155], v239 offset:50976
    v_mfma_f32_16x16x32_bf16 a[4:7], v[136:139], a[232:235], a[4:7]
    ds_read_b64_tr_b16 v[156:157], v239 offset:51232
    v_mfma_f32_16x16x32_bf16 a[4:7], v[140:143], a[236:239], a[4:7]
    ds_read_b64_tr_b16 v[158:159], v239 offset:51488
    v_mfma_f32_16x16x32_bf16 a[8:11], v[128:131], a[208:211], a[8:11]
    v_mfma_f32_16x16x32_bf16 a[8:11], v[132:135], a[212:215], a[8:11]
    v_mfma_f32_16x16x32_bf16 a[8:11], v[136:139], a[240:243], a[8:11]
    v_mfma_f32_16x16x32_bf16 a[8:11], v[140:143], a[244:247], a[8:11]
    v_mfma_f32_16x16x32_bf16 a[12:15], v[128:131], a[216:219], a[12:15]
    v_mfma_f32_16x16x32_bf16 a[12:15], v[132:135], a[220:223], a[12:15]
    v_mfma_f32_16x16x32_bf16 a[12:15], v[136:139], a[248:251], a[12:15]
    v_mfma_f32_16x16x32_bf16 a[12:15], v[140:143], a[252:255], a[12:15]
    buffer_load_dwordx4 v161, s[8:11], s49 offen offset:1056 lds
    s_waitcnt lgkmcnt(0)
    v_mfma_f32_16x16x32_bf16 a[16:19], v[144:147], a[192:195], a[16:19]
    ds_read_b64_tr_b16 v[128:129], v239 offset:33856
    v_mfma_f32_16x16x32_bf16 a[16:19], v[148:151], a[196:199], a[16:19]
    ds_read_b64_tr_b16 v[130:131], v239 offset:34112
    v_mfma_f32_16x16x32_bf16 a[16:19], v[152:155], a[224:227], a[16:19]
    ds_read_b64_tr_b16 v[132:133], v239 offset:34368
    v_mfma_f32_16x16x32_bf16 a[16:19], v[156:159], a[228:231], a[16:19]
    ds_read_b64_tr_b16 v[134:135], v239 offset:34624
    v_mfma_f32_16x16x32_bf16 a[20:23], v[144:147], a[200:203], a[20:23]
    ds_read_b64_tr_b16 v[136:137], v239 offset:50752
    v_mfma_f32_16x16x32_bf16 a[20:23], v[148:151], a[204:207], a[20:23]
    ds_read_b64_tr_b16 v[138:139], v239 offset:51008
    v_mfma_f32_16x16x32_bf16 a[20:23], v[152:155], a[232:235], a[20:23]
    ds_read_b64_tr_b16 v[140:141], v239 offset:51264
    v_mfma_f32_16x16x32_bf16 a[20:23], v[156:159], a[236:239], a[20:23]
    ds_read_b64_tr_b16 v[142:143], v239 offset:51520
    v_mfma_f32_16x16x32_bf16 a[24:27], v[144:147], a[208:211], a[24:27]
    v_mfma_f32_16x16x32_bf16 a[24:27], v[148:151], a[212:215], a[24:27]
    v_mfma_f32_16x16x32_bf16 a[24:27], v[152:155], a[240:243], a[24:27]
    v_mfma_f32_16x16x32_bf16 a[24:27], v[156:159], a[244:247], a[24:27]
    v_mfma_f32_16x16x32_bf16 a[28:31], v[144:147], a[216:219], a[28:31]
    v_mfma_f32_16x16x32_bf16 a[28:31], v[148:151], a[220:223], a[28:31]
    v_mfma_f32_16x16x32_bf16 a[28:31], v[152:155], a[248:251], a[28:31]
    buffer_load_dwordx4 v162, s[8:11], s49 offen offset:2112 lds
    v_mfma_f32_16x16x32_bf16 a[28:31], v[156:159], a[252:255], a[28:31]
    s_waitcnt lgkmcnt(0)
    v_mfma_f32_16x16x32_bf16 a[32:35], v[128:131], a[192:195], a[32:35]
    ds_read_b64_tr_b16 v[144:145], v239 offset:33888
    v_mfma_f32_16x16x32_bf16 a[32:35], v[132:135], a[196:199], a[32:35]
    ds_read_b64_tr_b16 v[146:147], v239 offset:34144
    v_mfma_f32_16x16x32_bf16 a[32:35], v[136:139], a[224:227], a[32:35]
    ds_read_b64_tr_b16 v[148:149], v239 offset:34400
    v_mfma_f32_16x16x32_bf16 a[32:35], v[140:143], a[228:231], a[32:35]
    ds_read_b64_tr_b16 v[150:151], v239 offset:34656
    v_mfma_f32_16x16x32_bf16 a[36:39], v[128:131], a[200:203], a[36:39]
    ds_read_b64_tr_b16 v[152:153], v239 offset:50784
    v_mfma_f32_16x16x32_bf16 a[36:39], v[132:135], a[204:207], a[36:39]
    ds_read_b64_tr_b16 v[154:155], v239 offset:51040
    v_mfma_f32_16x16x32_bf16 a[36:39], v[136:139], a[232:235], a[36:39]
    ds_read_b64_tr_b16 v[156:157], v239 offset:51296
    v_mfma_f32_16x16x32_bf16 a[36:39], v[140:143], a[236:239], a[36:39]
    ds_read_b64_tr_b16 v[158:159], v239 offset:51552
    v_mfma_f32_16x16x32_bf16 a[40:43], v[128:131], a[208:211], a[40:43]
    v_accvgpr_read_b32 v176, a0
    v_accvgpr_read_b32 v177, a1
    v_accvgpr_read_b32 v178, a2
    v_mfma_f32_16x16x32_bf16 a[40:43], v[132:135], a[212:215], a[40:43]
    v_accvgpr_read_b32 v179, a3
    v_accvgpr_read_b32 v180, a16
    v_accvgpr_read_b32 v181, a17
    v_mfma_f32_16x16x32_bf16 a[40:43], v[136:139], a[240:243], a[40:43]
    v_accvgpr_read_b32 v182, a18
    v_accvgpr_read_b32 v183, a19
    v_mul_f32 v184, s70, v176
    v_mfma_f32_16x16x32_bf16 a[40:43], v[140:143], a[244:247], a[40:43]
    v_mul_f32 v185, s70, v177
    v_mul_f32 v186, s70, v178
    v_mul_f32 v187, s70, v179
    v_mfma_f32_16x16x32_bf16 a[44:47], v[128:131], a[216:219], a[44:47]
    v_mul_f32 v188, s70, v180
    v_mul_f32 v189, s70, v181
    v_mul_f32 v190, s70, v182
    v_mfma_f32_16x16x32_bf16 a[44:47], v[132:135], a[220:223], a[44:47]
    buffer_load_dwordx4 v163, s[8:11], s49 offen offset:3168 lds
    v_mul_f32 v191, s70, v183
    v_mfma_f32_16x16x32_bf16 a[44:47], v[136:139], a[248:251], a[44:47]
    v_exp_f32 v184, v184
    v_mfma_f32_16x16x32_bf16 a[44:47], v[140:143], a[252:255], a[44:47]
    v_exp_f32 v185, v185
    s_waitcnt lgkmcnt(0)
    v_mfma_f32_16x16x32_bf16 a[48:51], v[144:147], a[192:195], a[48:51]
    ds_read_b64_tr_b16 v[128:129], v239 offset:33920
    v_exp_f32 v186, v186
    v_mfma_f32_16x16x32_bf16 a[48:51], v[148:151], a[196:199], a[48:51]
    ds_read_b64_tr_b16 v[130:131], v239 offset:34176
    v_exp_f32 v187, v187
    v_mfma_f32_16x16x32_bf16 a[48:51], v[152:155], a[224:227], a[48:51]
    ds_read_b64_tr_b16 v[132:133], v239 offset:34432
    v_exp_f32 v188, v188
    v_mfma_f32_16x16x32_bf16 a[48:51], v[156:159], a[228:231], a[48:51]
    ds_read_b64_tr_b16 v[134:135], v239 offset:34688
    v_exp_f32 v189, v189
    v_mfma_f32_16x16x32_bf16 a[52:55], v[144:147], a[200:203], a[52:55]
    ds_read_b64_tr_b16 v[136:137], v239 offset:50816
    v_exp_f32 v190, v190
    v_mfma_f32_16x16x32_bf16 a[52:55], v[148:151], a[204:207], a[52:55]
    ds_read_b64_tr_b16 v[138:139], v239 offset:51072
    v_exp_f32 v191, v191
    v_mfma_f32_16x16x32_bf16 a[52:55], v[152:155], a[232:235], a[52:55]
    ds_read_b64_tr_b16 v[140:141], v239 offset:51328
    v_add_f32 v184, 1.0, v184
    v_add_f32 v185, 1.0, v185
    v_mfma_f32_16x16x32_bf16 a[52:55], v[156:159], a[236:239], a[52:55]
    ds_read_b64_tr_b16 v[142:143], v239 offset:51584
    v_add_f32 v186, 1.0, v186
    v_add_f32 v187, 1.0, v187
    v_mfma_f32_16x16x32_bf16 a[56:59], v[144:147], a[208:211], a[56:59]
    v_add_f32 v188, 1.0, v188
    v_add_f32 v189, 1.0, v189
    v_add_f32 v190, 1.0, v190
    v_mfma_f32_16x16x32_bf16 a[56:59], v[148:151], a[212:215], a[56:59]
    v_add_f32 v191, 1.0, v191
    v_rcp_f32 v184, v184
    v_mfma_f32_16x16x32_bf16 a[56:59], v[152:155], a[240:243], a[56:59]
    v_rcp_f32 v185, v185
    v_mfma_f32_16x16x32_bf16 a[56:59], v[156:159], a[244:247], a[56:59]
    s_add_u32 m0, s53, 84480
    s_mov_b32 s49, 4718592
    v_mfma_f32_16x16x32_bf16 a[60:63], v[144:147], a[216:219], a[60:63]
    buffer_load_dwordx4 v160, s[8:11], s49 offen offset:0 lds
    v_mfma_f32_16x16x32_bf16 a[60:63], v[148:151], a[220:223], a[60:63]
    v_rcp_f32 v186, v186
    v_mfma_f32_16x16x32_bf16 a[60:63], v[152:155], a[248:251], a[60:63]
    v_rcp_f32 v187, v187
    v_mfma_f32_16x16x32_bf16 a[60:63], v[156:159], a[252:255], a[60:63]
    v_rcp_f32 v188, v188
    s_waitcnt lgkmcnt(0)
    v_mfma_f32_16x16x32_bf16 a[64:67], v[128:131], a[192:195], a[64:67]
    ds_read_b64_tr_b16 v[144:145], v239 offset:33952
    v_rcp_f32 v189, v189
    v_mfma_f32_16x16x32_bf16 a[64:67], v[132:135], a[196:199], a[64:67]
    v_rcp_f32 v190, v190
    v_mul_f32 v176, v176, v184
    v_mfma_f32_16x16x32_bf16 a[64:67], v[136:139], a[224:227], a[64:67]
    ds_read_b64_tr_b16 v[146:147], v239 offset:34208
    v_rcp_f32 v191, v191
    v_mfma_f32_16x16x32_bf16 a[64:67], v[140:143], a[228:231], a[64:67]
    ds_read_b64_tr_b16 v[148:149], v239 offset:34464
    ds_read_b64_tr_b16 v[150:151], v239 offset:34720
    v_mul_f32 v177, v177, v185
    v_mfma_f32_16x16x32_bf16 a[68:71], v[128:131], a[200:203], a[68:71]
    ds_read_b64_tr_b16 v[152:153], v239 offset:50848
    v_mul_f32 v178, v178, v186
    v_mul_f32 v179, v179, v187
    v_mfma_f32_16x16x32_bf16 a[68:71], v[132:135], a[204:207], a[68:71]
    ds_read_b64_tr_b16 v[154:155], v239 offset:51104
    v_mul_f32 v180, v180, v188
    v_mul_f32 v181, v181, v189
    v_mfma_f32_16x16x32_bf16 a[68:71], v[136:139], a[232:235], a[68:71]
    ds_read_b64_tr_b16 v[156:157], v239 offset:51360
    v_mul_f32 v182, v182, v190
    v_mul_f32 v183, v183, v191
    v_mfma_f32_16x16x32_bf16 a[68:71], v[140:143], a[236:239], a[68:71]
    ds_read_b64_tr_b16 v[158:159], v239 offset:51616
    v_cvt_pk_bf16_f32 v192, v176, v177
    v_cvt_pk_bf16_f32 v193, v178, v179
    v_mfma_f32_16x16x32_bf16 a[72:75], v[128:131], a[208:211], a[72:75]
    v_cvt_pk_bf16_f32 v194, v180, v181
    v_cvt_pk_bf16_f32 v195, v182, v183
    v_mfma_f32_16x16x32_bf16 a[72:75], v[132:135], a[212:215], a[72:75]
    buffer_store_dwordx4 v[192:195], v253, s[24:27], 0 offen offset:0 sc1
    v_mfma_f32_16x16x32_bf16 a[72:75], v[136:139], a[240:243], a[72:75]
    v_mfma_f32_16x16x32_bf16 a[72:75], v[140:143], a[244:247], a[72:75]
    buffer_load_dwordx4 v161, s[8:11], s49 offen offset:1056 lds
    v_mfma_f32_16x16x32_bf16 a[76:79], v[128:131], a[216:219], a[76:79]
    v_accvgpr_read_b32 v196, a4
    v_accvgpr_read_b32 v197, a5
    v_accvgpr_read_b32 v198, a6
    v_mfma_f32_16x16x32_bf16 a[76:79], v[132:135], a[220:223], a[76:79]
    v_accvgpr_read_b32 v199, a7
    v_accvgpr_read_b32 v200, a20
    v_accvgpr_read_b32 v201, a21
    v_mfma_f32_16x16x32_bf16 a[76:79], v[136:139], a[248:251], a[76:79]
    v_accvgpr_read_b32 v202, a22
    v_accvgpr_read_b32 v203, a23
    v_mul_f32 v204, s70, v196
    v_mfma_f32_16x16x32_bf16 a[76:79], v[140:143], a[252:255], a[76:79]
    v_mul_f32 v205, s70, v197
    v_mul_f32 v206, s70, v198
    v_mul_f32 v207, s70, v199
    s_waitcnt lgkmcnt(0)
    v_mfma_f32_16x16x32_bf16 a[80:83], v[144:147], a[192:195], a[80:83]
    v_mul_f32 v208, s70, v200
    v_mul_f32 v209, s70, v201
    v_mul_f32 v210, s70, v202
    v_mfma_f32_16x16x32_bf16 a[80:83], v[148:151], a[196:199], a[80:83]
    ds_read_b64_tr_b16 v[128:129], v239 offset:33984
    ds_read_b64_tr_b16 v[130:131], v239 offset:34240
    v_mul_f32 v211, s70, v203
    v_mfma_f32_16x16x32_bf16 a[80:83], v[152:155], a[224:227], a[80:83]
    ds_read_b64_tr_b16 v[132:133], v239 offset:34496
    v_exp_f32 v204, v204
    v_mfma_f32_16x16x32_bf16 a[80:83], v[156:159], a[228:231], a[80:83]
    ds_read_b64_tr_b16 v[134:135], v239 offset:34752
    v_exp_f32 v205, v205
    v_mfma_f32_16x16x32_bf16 a[84:87], v[144:147], a[200:203], a[84:87]
    ds_read_b64_tr_b16 v[136:137], v239 offset:50880
    v_exp_f32 v206, v206
    v_mfma_f32_16x16x32_bf16 a[84:87], v[148:151], a[204:207], a[84:87]
    ds_read_b64_tr_b16 v[138:139], v239 offset:51136
    v_exp_f32 v207, v207
    v_mfma_f32_16x16x32_bf16 a[84:87], v[152:155], a[232:235], a[84:87]
    ds_read_b64_tr_b16 v[140:141], v239 offset:51392
    v_exp_f32 v208, v208
    v_mfma_f32_16x16x32_bf16 a[84:87], v[156:159], a[236:239], a[84:87]
    ds_read_b64_tr_b16 v[142:143], v239 offset:51648
    v_exp_f32 v209, v209
    v_mfma_f32_16x16x32_bf16 a[88:91], v[144:147], a[208:211], a[88:91]
    v_exp_f32 v210, v210
    v_add_f32 v204, 1.0, v204
    v_mfma_f32_16x16x32_bf16 a[88:91], v[148:151], a[212:215], a[88:91]
    v_exp_f32 v211, v211
    v_add_f32 v205, 1.0, v205
    v_mfma_f32_16x16x32_bf16 a[88:91], v[152:155], a[240:243], a[88:91]
    buffer_load_dwordx4 v162, s[8:11], s49 offen offset:2112 lds
    v_add_f32 v206, 1.0, v206
    v_mfma_f32_16x16x32_bf16 a[88:91], v[156:159], a[244:247], a[88:91]
    v_add_f32 v207, 1.0, v207
    v_add_f32 v208, 1.0, v208
    v_add_f32 v209, 1.0, v209
    v_mfma_f32_16x16x32_bf16 a[92:95], v[144:147], a[216:219], a[92:95]
    v_add_f32 v210, 1.0, v210
    v_add_f32 v211, 1.0, v211
    v_mfma_f32_16x16x32_bf16 a[92:95], v[148:151], a[220:223], a[92:95]
    v_rcp_f32 v204, v204
    v_mfma_f32_16x16x32_bf16 a[92:95], v[152:155], a[248:251], a[92:95]
    v_rcp_f32 v205, v205
    v_mfma_f32_16x16x32_bf16 a[92:95], v[156:159], a[252:255], a[92:95]
    v_rcp_f32 v206, v206
    s_waitcnt lgkmcnt(0)
    v_mfma_f32_16x16x32_bf16 a[96:99], v[128:131], a[192:195], a[96:99]
    ds_read_b64_tr_b16 v[144:145], v239 offset:34016
    ds_read_b64_tr_b16 v[146:147], v239 offset:34272
    v_mfma_f32_16x16x32_bf16 a[96:99], v[132:135], a[196:199], a[96:99]
    ds_read_b64_tr_b16 v[148:149], v239 offset:34528
    ds_read_b64_tr_b16 v[150:151], v239 offset:34784
    v_mfma_f32_16x16x32_bf16 a[96:99], v[136:139], a[224:227], a[96:99]
    ds_read_b64_tr_b16 v[152:153], v239 offset:50912
    ds_read_b64_tr_b16 v[154:155], v239 offset:51168
    v_mfma_f32_16x16x32_bf16 a[96:99], v[140:143], a[228:231], a[96:99]
    ds_read_b64_tr_b16 v[156:157], v239 offset:51424
    ds_read_b64_tr_b16 v[158:159], v239 offset:51680
    v_mfma_f32_16x16x32_bf16 a[100:103], v[128:131], a[200:203], a[100:103]
    v_rcp_f32 v207, v207
    v_mul_f32 v196, v196, v204
    v_mfma_f32_16x16x32_bf16 a[100:103], v[132:135], a[204:207], a[100:103]
    v_rcp_f32 v208, v208
    v_mul_f32 v197, v197, v205
    v_mfma_f32_16x16x32_bf16 a[100:103], v[136:139], a[232:235], a[100:103]
    v_rcp_f32 v209, v209
    v_mul_f32 v198, v198, v206
    v_mfma_f32_16x16x32_bf16 a[100:103], v[140:143], a[236:239], a[100:103]
    v_rcp_f32 v210, v210
    v_mul_f32 v199, v199, v207
    v_mfma_f32_16x16x32_bf16 a[104:107], v[128:131], a[208:211], a[104:107]
    v_rcp_f32 v211, v211
    v_mul_f32 v200, v200, v208
    v_mfma_f32_16x16x32_bf16 a[104:107], v[132:135], a[212:215], a[104:107]
    buffer_load_dwordx4 v163, s[8:11], s49 offen offset:3168 lds
    v_mul_f32 v201, v201, v209
    v_mfma_f32_16x16x32_bf16 a[104:107], v[136:139], a[240:243], a[104:107]
    v_mul_f32 v202, v202, v210
    v_mul_f32 v203, v203, v211
    v_cvt_pk_bf16_f32 v212, v196, v197
    v_mfma_f32_16x16x32_bf16 a[104:107], v[140:143], a[244:247], a[104:107]
    v_cvt_pk_bf16_f32 v213, v198, v199
    v_cvt_pk_bf16_f32 v214, v200, v201
    v_cvt_pk_bf16_f32 v215, v202, v203
    v_mfma_f32_16x16x32_bf16 a[108:111], v[128:131], a[216:219], a[108:111]
    buffer_store_dwordx4 v[212:215], v253, s[24:27], s62 offen offset:0 sc1
    v_mfma_f32_16x16x32_bf16 a[108:111], v[132:135], a[220:223], a[108:111]
    v_mfma_f32_16x16x32_bf16 a[108:111], v[136:139], a[248:251], a[108:111]
    s_waitcnt vmcnt(34) lgkmcnt(0)
    s_barrier
    v_mfma_f32_16x16x32_bf16 a[108:111], v[140:143], a[252:255], a[108:111]
    v_mfma_f32_16x16x32_bf16 a[112:115], v[144:147], a[192:195], a[112:115]
    v_accvgpr_read_b32 v176, a8
    v_accvgpr_read_b32 v177, a9
    v_accvgpr_read_b32 v178, a10
    v_mfma_f32_16x16x32_bf16 a[112:115], v[148:151], a[196:199], a[112:115]
    v_accvgpr_read_b32 v179, a11
    v_accvgpr_read_b32 v180, a24
    v_accvgpr_read_b32 v181, a25
    v_mfma_f32_16x16x32_bf16 a[112:115], v[152:155], a[224:227], a[112:115]
    ds_read_b64_tr_b16 v[128:129], v172 offset:0
    ds_read_b64_tr_b16 v[130:131], v172 offset:256
    v_accvgpr_read_b32 v182, a26
    v_mfma_f32_16x16x32_bf16 a[112:115], v[156:159], a[228:231], a[112:115]
    ds_read_b64_tr_b16 v[132:133], v172 offset:512
    ds_read_b64_tr_b16 v[134:135], v172 offset:768
    v_accvgpr_read_b32 v183, a27
    v_mfma_f32_16x16x32_bf16 a[116:119], v[144:147], a[200:203], a[116:119]
    ds_read_b64_tr_b16 v[136:137], v172 offset:16896
    ds_read_b64_tr_b16 v[138:139], v172 offset:17152
    ds_read_b64_tr_b16 v[140:141], v172 offset:17408
    v_mfma_f32_16x16x32_bf16 a[116:119], v[148:151], a[204:207], a[116:119]
    ds_read_b64_tr_b16 v[142:143], v172 offset:17664
    v_mul_f32 v184, s70, v176
    v_mul_f32 v185, s70, v177
    v_mfma_f32_16x16x32_bf16 a[116:119], v[152:155], a[232:235], a[116:119]
    v_mul_f32 v186, s70, v178
    v_mul_f32 v187, s70, v179
    v_mul_f32 v188, s70, v180
    v_mfma_f32_16x16x32_bf16 a[116:119], v[156:159], a[236:239], a[116:119]
    v_mul_f32 v189, s70, v181
    v_mul_f32 v190, s70, v182
    v_mul_f32 v191, s70, v183
    v_mfma_f32_16x16x32_bf16 a[120:123], v[144:147], a[208:211], a[120:123]
    v_exp_f32 v184, v184
    v_mfma_f32_16x16x32_bf16 a[120:123], v[148:151], a[212:215], a[120:123]
    v_exp_f32 v185, v185
    v_mfma_f32_16x16x32_bf16 a[120:123], v[152:155], a[240:243], a[120:123]
    v_exp_f32 v186, v186
    v_mfma_f32_16x16x32_bf16 a[120:123], v[156:159], a[244:247], a[120:123]
    v_exp_f32 v187, v187
    v_mfma_f32_16x16x32_bf16 a[124:127], v[144:147], a[216:219], a[124:127]
    v_exp_f32 v188, v188
    v_add_f32 v184, 1.0, v184
    v_mfma_f32_16x16x32_bf16 a[124:127], v[148:151], a[220:223], a[124:127]
    v_exp_f32 v189, v189
    v_add_f32 v185, 1.0, v185
    v_mfma_f32_16x16x32_bf16 a[124:127], v[152:155], a[248:251], a[124:127]
    v_exp_f32 v190, v190
    v_add_f32 v186, 1.0, v186
    v_mfma_f32_16x16x32_bf16 a[124:127], v[156:159], a[252:255], a[124:127]
    s_waitcnt vmcnt(63)
    v_exp_f32 v191, v191
    s_waitcnt lgkmcnt(0)
    v_mfma_f32_16x16x32_bf16 v[0:3], v[128:131], a[128:131], v[0:3]
    v_add_f32 v187, 1.0, v187
    v_add_f32 v188, 1.0, v188
    v_add_f32 v189, 1.0, v189
    v_mfma_f32_16x16x32_bf16 v[0:3], v[132:135], a[132:135], v[0:3]
    s_add_u32 m0, s53, 101376
    s_mov_b32 s49, 5242880
    v_add_f32 v190, 1.0, v190
    v_mfma_f32_16x16x32_bf16 v[0:3], v[136:139], a[160:163], v[0:3]
    ds_read_b64_tr_b16 v[144:145], v172 offset:8
    buffer_load_dwordx4 v160, s[8:11], s49 offen offset:0 lds
    v_mfma_f32_16x16x32_bf16 v[0:3], v[140:143], a[164:167], v[0:3]
    v_add_f32 v191, 1.0, v191
    v_rcp_f32 v184, v184
    v_mfma_f32_16x16x32_bf16 v[4:7], v[128:131], a[136:139], v[4:7]
    ds_read_b64_tr_b16 v[146:147], v172 offset:264
    ds_read_b64_tr_b16 v[148:149], v172 offset:520
    ds_read_b64_tr_b16 v[150:151], v172 offset:776
    v_mfma_f32_16x16x32_bf16 v[4:7], v[132:135], a[140:143], v[4:7]
    ds_read_b64_tr_b16 v[152:153], v172 offset:16904
    ds_read_b64_tr_b16 v[154:155], v172 offset:17160
    v_mfma_f32_16x16x32_bf16 v[4:7], v[136:139], a[168:171], v[4:7]
    ds_read_b64_tr_b16 v[156:157], v172 offset:17416
    v_rcp_f32 v185, v185
    v_mfma_f32_16x16x32_bf16 v[4:7], v[140:143], a[172:175], v[4:7]
    ds_read_b64_tr_b16 v[158:159], v172 offset:17672
    v_rcp_f32 v186, v186
    v_mfma_f32_16x16x32_bf16 v[8:11], v[128:131], a[144:147], v[8:11]
    v_rcp_f32 v187, v187
    v_mul_f32 v176, v176, v184
    v_mfma_f32_16x16x32_bf16 v[8:11], v[132:135], a[148:151], v[8:11]
    v_rcp_f32 v188, v188
    v_mul_f32 v177, v177, v185
    v_mfma_f32_16x16x32_bf16 v[8:11], v[136:139], a[176:179], v[8:11]
    v_rcp_f32 v189, v189
    v_mul_f32 v178, v178, v186
    v_mfma_f32_16x16x32_bf16 v[8:11], v[140:143], a[180:183], v[8:11]
    v_rcp_f32 v190, v190
    v_mul_f32 v179, v179, v187
    v_mfma_f32_16x16x32_bf16 v[12:15], v[128:131], a[152:155], v[12:15]
    v_rcp_f32 v191, v191
    v_mul_f32 v180, v180, v188
    v_mfma_f32_16x16x32_bf16 v[12:15], v[132:135], a[156:159], v[12:15]
    v_mul_f32 v181, v181, v189
    v_mul_f32 v182, v182, v190
    v_mul_f32 v183, v183, v191
    v_mfma_f32_16x16x32_bf16 v[12:15], v[136:139], a[184:187], v[12:15]
    v_cvt_pk_bf16_f32 v192, v176, v177
    v_cvt_pk_bf16_f32 v193, v178, v179
    v_cvt_pk_bf16_f32 v194, v180, v181
    v_mfma_f32_16x16x32_bf16 v[12:15], v[140:143], a[188:191], v[12:15]
    buffer_load_dwordx4 v161, s[8:11], s49 offen offset:1056 lds
    v_cvt_pk_bf16_f32 v195, v182, v183
    s_waitcnt lgkmcnt(0)
    v_mfma_f32_16x16x32_bf16 v[16:19], v[144:147], a[128:131], v[16:19]
    ds_read_b64_tr_b16 v[128:129], v172 offset:64
    buffer_store_dwordx4 v[192:195], v253, s[24:27], s63 offen offset:0 sc1
    v_mfma_f32_16x16x32_bf16 v[16:19], v[148:151], a[132:135], v[16:19]
    ds_read_b64_tr_b16 v[130:131], v172 offset:320
    v_mfma_f32_16x16x32_bf16 v[16:19], v[152:155], a[160:163], v[16:19]
    ds_read_b64_tr_b16 v[132:133], v172 offset:576
    v_mfma_f32_16x16x32_bf16 v[16:19], v[156:159], a[164:167], v[16:19]
    ds_read_b64_tr_b16 v[134:135], v172 offset:832
    v_mfma_f32_16x16x32_bf16 v[20:23], v[144:147], a[136:139], v[20:23]
    ds_read_b64_tr_b16 v[136:137], v172 offset:16960
    v_accvgpr_read_b32 v196, a12
    v_accvgpr_read_b32 v197, a13
    v_mfma_f32_16x16x32_bf16 v[20:23], v[148:151], a[140:143], v[20:23]
    ds_read_b64_tr_b16 v[138:139], v172 offset:17216
    v_accvgpr_read_b32 v198, a14
    v_accvgpr_read_b32 v199, a15
    v_mfma_f32_16x16x32_bf16 v[20:23], v[152:155], a[168:171], v[20:23]
    ds_read_b64_tr_b16 v[140:141], v172 offset:17472
    v_accvgpr_read_b32 v200, a28
    v_accvgpr_read_b32 v201, a29
    v_mfma_f32_16x16x32_bf16 v[20:23], v[156:159], a[172:175], v[20:23]
    ds_read_b64_tr_b16 v[142:143], v172 offset:17728
    v_accvgpr_read_b32 v202, a30
    v_accvgpr_read_b32 v203, a31
    v_mfma_f32_16x16x32_bf16 v[24:27], v[144:147], a[144:147], v[24:27]
    v_mul_f32 v204, s70, v196
    v_mul_f32 v205, s70, v197
    v_mul_f32 v206, s70, v198
    v_mfma_f32_16x16x32_bf16 v[24:27], v[148:151], a[148:151], v[24:27]
    v_mul_f32 v207, s70, v199
    v_mul_f32 v208, s70, v200
    v_mul_f32 v209, s70, v201
    v_mfma_f32_16x16x32_bf16 v[24:27], v[152:155], a[176:179], v[24:27]
    v_mul_f32 v210, s70, v202
    v_mul_f32 v211, s70, v203
    v_mfma_f32_16x16x32_bf16 v[24:27], v[156:159], a[180:183], v[24:27]
    v_exp_f32 v204, v204
    v_mfma_f32_16x16x32_bf16 v[28:31], v[144:147], a[152:155], v[28:31]
    v_exp_f32 v205, v205
    v_mfma_f32_16x16x32_bf16 v[28:31], v[148:151], a[156:159], v[28:31]
    v_exp_f32 v206, v206
    v_mfma_f32_16x16x32_bf16 v[28:31], v[152:155], a[184:187], v[28:31]
    buffer_load_dwordx4 v162, s[8:11], s49 offen offset:2112 lds
    v_mfma_f32_16x16x32_bf16 v[28:31], v[156:159], a[188:191], v[28:31]
    v_exp_f32 v207, v207
    s_waitcnt lgkmcnt(0)
    v_mfma_f32_16x16x32_bf16 v[32:35], v[128:131], a[128:131], v[32:35]
    ds_read_b64_tr_b16 v[144:145], v172 offset:72
    v_exp_f32 v208, v208
    v_mfma_f32_16x16x32_bf16 v[32:35], v[132:135], a[132:135], v[32:35]
    v_exp_f32 v209, v209
    v_add_f32 v204, 1.0, v204
    v_mfma_f32_16x16x32_bf16 v[32:35], v[136:139], a[160:163], v[32:35]
    v_exp_f32 v210, v210
    v_add_f32 v205, 1.0, v205
    v_mfma_f32_16x16x32_bf16 v[32:35], v[140:143], a[164:167], v[32:35]
    ds_read_b64_tr_b16 v[146:147], v172 offset:328
    v_exp_f32 v211, v211
    v_mfma_f32_16x16x32_bf16 v[36:39], v[128:131], a[136:139], v[36:39]
    ds_read_b64_tr_b16 v[148:149], v172 offset:584
    ds_read_b64_tr_b16 v[150:151], v172 offset:840
    ds_read_b64_tr_b16 v[152:153], v172 offset:16968
    v_mfma_f32_16x16x32_bf16 v[36:39], v[132:135], a[140:143], v[36:39]
    ds_read_b64_tr_b16 v[154:155], v172 offset:17224
    v_add_f32 v206, 1.0, v206
    v_add_f32 v207, 1.0, v207
    v_mfma_f32_16x16x32_bf16 v[36:39], v[136:139], a[168:171], v[36:39]
    ds_read_b64_tr_b16 v[156:157], v172 offset:17480
    v_add_f32 v208, 1.0, v208
    v_add_f32 v209, 1.0, v209
    v_mfma_f32_16x16x32_bf16 v[36:39], v[140:143], a[172:175], v[36:39]
    ds_read_b64_tr_b16 v[158:159], v172 offset:17736
    v_add_f32 v210, 1.0, v210
    v_add_f32 v211, 1.0, v211
    v_mfma_f32_16x16x32_bf16 v[40:43], v[128:131], a[144:147], v[40:43]
    v_rcp_f32 v204, v204
    v_mfma_f32_16x16x32_bf16 v[40:43], v[132:135], a[148:151], v[40:43]
    v_rcp_f32 v205, v205
    v_mfma_f32_16x16x32_bf16 v[40:43], v[136:139], a[176:179], v[40:43]
    v_rcp_f32 v206, v206
    v_mfma_f32_16x16x32_bf16 v[40:43], v[140:143], a[180:183], v[40:43]
    v_rcp_f32 v207, v207
    v_mfma_f32_16x16x32_bf16 v[44:47], v[128:131], a[152:155], v[44:47]
    v_rcp_f32 v208, v208
    v_mul_f32 v196, v196, v204
    v_mfma_f32_16x16x32_bf16 v[44:47], v[132:135], a[156:159], v[44:47]
    v_rcp_f32 v209, v209
    v_mul_f32 v197, v197, v205
    v_mfma_f32_16x16x32_bf16 v[44:47], v[136:139], a[184:187], v[44:47]
    buffer_load_dwordx4 v163, s[8:11], s49 offen offset:3168 lds
    v_mul_f32 v198, v198, v206
    v_mfma_f32_16x16x32_bf16 v[44:47], v[140:143], a[188:191], v[44:47]
    v_rcp_f32 v210, v210
    v_mul_f32 v199, v199, v207
    s_waitcnt lgkmcnt(0)
    v_mfma_f32_16x16x32_bf16 v[48:51], v[144:147], a[128:131], v[48:51]
    v_rcp_f32 v211, v211
    v_mul_f32 v200, v200, v208
    v_mfma_f32_16x16x32_bf16 v[48:51], v[148:151], a[132:135], v[48:51]
    ds_read_b64_tr_b16 v[128:129], v172 offset:128
    v_mul_f32 v201, v201, v209
    v_mul_f32 v202, v202, v210
    v_mfma_f32_16x16x32_bf16 v[48:51], v[152:155], a[160:163], v[48:51]
    ds_read_b64_tr_b16 v[130:131], v172 offset:384
    v_mul_f32 v203, v203, v211
    v_cvt_pk_bf16_f32 v212, v196, v197
    v_mfma_f32_16x16x32_bf16 v[48:51], v[156:159], a[164:167], v[48:51]
    ds_read_b64_tr_b16 v[132:133], v172 offset:640
    ds_read_b64_tr_b16 v[134:135], v172 offset:896
    v_cvt_pk_bf16_f32 v213, v198, v199
    v_mfma_f32_16x16x32_bf16 v[52:55], v[144:147], a[136:139], v[52:55]
    ds_read_b64_tr_b16 v[136:137], v172 offset:17024
    v_cvt_pk_bf16_f32 v214, v200, v201
    v_cvt_pk_bf16_f32 v215, v202, v203
    v_mfma_f32_16x16x32_bf16 v[52:55], v[148:151], a[140:143], v[52:55]
    ds_read_b64_tr_b16 v[138:139], v172 offset:17280
    buffer_store_dwordx4 v[212:215], v253, s[24:27], s64 offen offset:0 sc1
    v_mfma_f32_16x16x32_bf16 v[52:55], v[152:155], a[168:171], v[52:55]
    ds_read_b64_tr_b16 v[140:141], v172 offset:17536
    v_mfma_f32_16x16x32_bf16 v[52:55], v[156:159], a[172:175], v[52:55]
    ds_read_b64_tr_b16 v[142:143], v172 offset:17792
    v_mfma_f32_16x16x32_bf16 v[56:59], v[144:147], a[144:147], v[56:59]
    v_accvgpr_read_b32 v176, a32
    v_accvgpr_read_b32 v177, a33
    v_accvgpr_read_b32 v178, a34
    v_mfma_f32_16x16x32_bf16 v[56:59], v[148:151], a[148:151], v[56:59]
    v_accvgpr_read_b32 v179, a35
    v_accvgpr_read_b32 v180, a48
    v_accvgpr_read_b32 v181, a49
    v_mfma_f32_16x16x32_bf16 v[56:59], v[152:155], a[176:179], v[56:59]
    v_accvgpr_read_b32 v182, a50
    v_accvgpr_read_b32 v183, a51
    v_mul_f32 v184, s70, v176
    v_mfma_f32_16x16x32_bf16 v[56:59], v[156:159], a[180:183], v[56:59]
    s_add_u32 m0, s53, 118272
    s_mov_b32 s49, 5767168
    v_mul_f32 v185, s70, v177
    v_mfma_f32_16x16x32_bf16 v[60:63], v[144:147], a[152:155], v[60:63]
    buffer_load_dwordx4 v160, s[8:11], s49 offen offset:0 lds
    v_mul_f32 v186, s70, v178
    v_mfma_f32_16x16x32_bf16 v[60:63], v[148:151], a[156:159], v[60:63]
    v_mul_f32 v187, s70, v179
    v_mul_f32 v188, s70, v180
    v_mul_f32 v189, s70, v181
    v_mfma_f32_16x16x32_bf16 v[60:63], v[152:155], a[184:187], v[60:63]
    v_mul_f32 v190, s70, v182
    v_mul_f32 v191, s70, v183
    v_mfma_f32_16x16x32_bf16 v[60:63], v[156:159], a[188:191], v[60:63]
    v_exp_f32 v184, v184
    s_waitcnt lgkmcnt(0)
    v_mfma_f32_16x16x32_bf16 v[64:67], v[128:131], a[128:131], v[64:67]
    ds_read_b64_tr_b16 v[144:145], v172 offset:136
    v_exp_f32 v185, v185
    v_mfma_f32_16x16x32_bf16 v[64:67], v[132:135], a[132:135], v[64:67]
    ds_read_b64_tr_b16 v[146:147], v172 offset:392
    v_exp_f32 v186, v186
    v_mfma_f32_16x16x32_bf16 v[64:67], v[136:139], a[160:163], v[64:67]
    ds_read_b64_tr_b16 v[148:149], v172 offset:648
    v_exp_f32 v187, v187
    v_mfma_f32_16x16x32_bf16 v[64:67], v[140:143], a[164:167], v[64:67]
    ds_read_b64_tr_b16 v[150:151], v172 offset:904
    v_exp_f32 v188, v188
    v_mfma_f32_16x16x32_bf16 v[68:71], v[128:131], a[136:139], v[68:71]
    ds_read_b64_tr_b16 v[152:153], v172 offset:17032
    v_exp_f32 v189, v189
    v_mfma_f32_16x16x32_bf16 v[68:71], v[132:135], a[140:143], v[68:71]
    ds_read_b64_tr_b16 v[154:155], v172 offset:17288
    v_exp_f32 v190, v190
    v_mfma_f32_16x16x32_bf16 v[68:71], v[136:139], a[168:171], v[68:71]
    ds_read_b64_tr_b16 v[156:157], v172 offset:17544
    v_exp_f32 v191, v191
    v_mfma_f32_16x16x32_bf16 v[68:71], v[140:143], a[172:175], v[68:71]
    ds_read_b64_tr_b16 v[158:159], v172 offset:17800
    v_add_f32 v184, 1.0, v184
    v_add_f32 v185, 1.0, v185
    v_mfma_f32_16x16x32_bf16 v[72:75], v[128:131], a[144:147], v[72:75]
    v_add_f32 v186, 1.0, v186
    v_add_f32 v187, 1.0, v187
    v_add_f32 v188, 1.0, v188
    v_mfma_f32_16x16x32_bf16 v[72:75], v[132:135], a[148:151], v[72:75]
    v_add_f32 v189, 1.0, v189
    v_add_f32 v190, 1.0, v190
    v_add_f32 v191, 1.0, v191
    v_mfma_f32_16x16x32_bf16 v[72:75], v[136:139], a[176:179], v[72:75]
    v_rcp_f32 v184, v184
    v_mfma_f32_16x16x32_bf16 v[72:75], v[140:143], a[180:183], v[72:75]
    buffer_load_dwordx4 v161, s[8:11], s49 offen offset:1056 lds
    v_mfma_f32_16x16x32_bf16 v[76:79], v[128:131], a[152:155], v[76:79]
    v_rcp_f32 v185, v185
    v_mfma_f32_16x16x32_bf16 v[76:79], v[132:135], a[156:159], v[76:79]
    v_rcp_f32 v186, v186
    v_mfma_f32_16x16x32_bf16 v[76:79], v[136:139], a[184:187], v[76:79]
    v_rcp_f32 v187, v187
    v_mfma_f32_16x16x32_bf16 v[76:79], v[140:143], a[188:191], v[76:79]
    v_rcp_f32 v188, v188
    s_waitcnt lgkmcnt(0)
    v_mfma_f32_16x16x32_bf16 v[80:83], v[144:147], a[128:131], v[80:83]
    ds_read_b64_tr_b16 v[128:129], v172 offset:192
    v_rcp_f32 v189, v189
    v_mfma_f32_16x16x32_bf16 v[80:83], v[148:151], a[132:135], v[80:83]
    v_rcp_f32 v190, v190
    v_mul_f32 v176, v176, v184
    v_mfma_f32_16x16x32_bf16 v[80:83], v[152:155], a[160:163], v[80:83]
    ds_read_b64_tr_b16 v[130:131], v172 offset:448
    v_rcp_f32 v191, v191
    v_mfma_f32_16x16x32_bf16 v[80:83], v[156:159], a[164:167], v[80:83]
    ds_read_b64_tr_b16 v[132:133], v172 offset:704
    ds_read_b64_tr_b16 v[134:135], v172 offset:960
    v_mul_f32 v177, v177, v185
    v_mfma_f32_16x16x32_bf16 v[84:87], v[144:147], a[136:139], v[84:87]
    ds_read_b64_tr_b16 v[136:137], v172 offset:17088
    v_mul_f32 v178, v178, v186
    v_mul_f32 v179, v179, v187
    v_mfma_f32_16x16x32_bf16 v[84:87], v[148:151], a[140:143], v[84:87]
    ds_read_b64_tr_b16 v[138:139], v172 offset:17344
    v_mul_f32 v180, v180, v188
    v_mul_f32 v181, v181, v189
    v_mfma_f32_16x16x32_bf16 v[84:87], v[152:155], a[168:171], v[84:87]
    ds_read_b64_tr_b16 v[140:141], v172 offset:17600
    v_mul_f32 v182, v182, v190
    v_mul_f32 v183, v183, v191
    v_mfma_f32_16x16x32_bf16 v[84:87], v[156:159], a[172:175], v[84:87]
    ds_read_b64_tr_b16 v[142:143], v172 offset:17856
    v_cvt_pk_bf16_f32 v192, v176, v177
    v_cvt_pk_bf16_f32 v193, v178, v179
    v_mfma_f32_16x16x32_bf16 v[88:91], v[144:147], a[144:147], v[88:91]
    v_cvt_pk_bf16_f32 v194, v180, v181
    v_cvt_pk_bf16_f32 v195, v182, v183
    v_mfma_f32_16x16x32_bf16 v[88:91], v[148:151], a[148:151], v[88:91]
    buffer_store_dwordx4 v[192:195], v253, s[24:27], 0 offen offset:1024 sc1
    v_mfma_f32_16x16x32_bf16 v[88:91], v[152:155], a[176:179], v[88:91]
    buffer_load_dwordx4 v162, s[8:11], s49 offen offset:2112 lds
    v_mfma_f32_16x16x32_bf16 v[88:91], v[156:159], a[180:183], v[88:91]
    v_mfma_f32_16x16x32_bf16 v[92:95], v[144:147], a[152:155], v[92:95]
    v_accvgpr_read_b32 v196, a36
    v_accvgpr_read_b32 v197, a37
    v_accvgpr_read_b32 v198, a38
    v_mfma_f32_16x16x32_bf16 v[92:95], v[148:151], a[156:159], v[92:95]
    v_accvgpr_read_b32 v199, a39
    v_accvgpr_read_b32 v200, a52
    v_accvgpr_read_b32 v201, a53
    v_mfma_f32_16x16x32_bf16 v[92:95], v[152:155], a[184:187], v[92:95]
    v_accvgpr_read_b32 v202, a54
    v_accvgpr_read_b32 v203, a55
    v_mul_f32 v204, s70, v196
    v_mfma_f32_16x16x32_bf16 v[92:95], v[156:159], a[188:191], v[92:95]
    v_mul_f32 v205, s70, v197
    v_mul_f32 v206, s70, v198
    v_mul_f32 v207, s70, v199
    s_waitcnt lgkmcnt(0)
    v_mfma_f32_16x16x32_bf16 v[96:99], v[128:131], a[128:131], v[96:99]
    ds_read_b64_tr_b16 v[144:145], v172 offset:200
    ds_read_b64_tr_b16 v[146:147], v172 offset:456
    v_mul_f32 v208, s70, v200
    v_mfma_f32_16x16x32_bf16 v[96:99], v[132:135], a[132:135], v[96:99]
    ds_read_b64_tr_b16 v[148:149], v172 offset:712
    ds_read_b64_tr_b16 v[150:151], v172 offset:968
    v_mul_f32 v209, s70, v201
    v_mfma_f32_16x16x32_bf16 v[96:99], v[136:139], a[160:163], v[96:99]
    ds_read_b64_tr_b16 v[152:153], v172 offset:17096
    ds_read_b64_tr_b16 v[154:155], v172 offset:17352
    v_mul_f32 v210, s70, v202
    v_mfma_f32_16x16x32_bf16 v[96:99], v[140:143], a[164:167], v[96:99]
    ds_read_b64_tr_b16 v[156:157], v172 offset:17608
    ds_read_b64_tr_b16 v[158:159], v172 offset:17864
    v_mul_f32 v211, s70, v203
    v_mfma_f32_16x16x32_bf16 v[100:103], v[128:131], a[136:139], v[100:103]
    v_exp_f32 v204, v204
    v_mfma_f32_16x16x32_bf16 v[100:103], v[132:135], a[140:143], v[100:103]
    v_exp_f32 v205, v205
    v_mfma_f32_16x16x32_bf16 v[100:103], v[136:139], a[168:171], v[100:103]
    v_exp_f32 v206, v206
    v_mfma_f32_16x16x32_bf16 v[100:103], v[140:143], a[172:175], v[100:103]
    v_exp_f32 v207, v207
    v_mfma_f32_16x16x32_bf16 v[104:107], v[128:131], a[144:147], v[104:107]
    v_exp_f32 v208, v208
    v_add_f32 v204, 1.0, v204
    v_mfma_f32_16x16x32_bf16 v[104:107], v[132:135], a[148:151], v[104:107]
    v_exp_f32 v209, v209
    v_add_f32 v205, 1.0, v205
    v_mfma_f32_16x16x32_bf16 v[104:107], v[136:139], a[176:179], v[104:107]
    buffer_load_dwordx4 v163, s[8:11], s49 offen offset:3168 lds
    v_add_f32 v206, 1.0, v206
    v_mfma_f32_16x16x32_bf16 v[104:107], v[140:143], a[180:183], v[104:107]
    v_exp_f32 v210, v210
    v_add_f32 v207, 1.0, v207
    v_mfma_f32_16x16x32_bf16 v[108:111], v[128:131], a[152:155], v[108:111]
    v_exp_f32 v211, v211
    v_add_f32 v208, 1.0, v208
    v_mfma_f32_16x16x32_bf16 v[108:111], v[132:135], a[156:159], v[108:111]
    v_add_f32 v209, 1.0, v209
    v_add_f32 v210, 1.0, v210
    v_add_f32 v211, 1.0, v211
    v_mfma_f32_16x16x32_bf16 v[108:111], v[136:139], a[184:187], v[108:111]
    s_waitcnt vmcnt(21) lgkmcnt(0)
    s_barrier
    v_mfma_f32_16x16x32_bf16 v[108:111], v[140:143], a[188:191], v[108:111]
    v_rcp_f32 v204, v204
    v_mfma_f32_16x16x32_bf16 v[112:115], v[144:147], a[128:131], v[112:115]
    ds_read_b64_tr_b16 v[128:129], v172 offset:33792
    v_rcp_f32 v205, v205
    v_mfma_f32_16x16x32_bf16 v[112:115], v[148:151], a[132:135], v[112:115]
    ds_read_b64_tr_b16 v[130:131], v172 offset:34048
    v_rcp_f32 v206, v206
    v_mfma_f32_16x16x32_bf16 v[112:115], v[152:155], a[160:163], v[112:115]
    ds_read_b64_tr_b16 v[132:133], v172 offset:34304
    v_rcp_f32 v207, v207
    v_mfma_f32_16x16x32_bf16 v[112:115], v[156:159], a[164:167], v[112:115]
    ds_read_b64_tr_b16 v[134:135], v172 offset:34560
    ds_read_b64_tr_b16 v[136:137], v172 offset:50688
    ds_read_b64_tr_b16 v[138:139], v172 offset:50944
    v_mfma_f32_16x16x32_bf16 v[116:119], v[144:147], a[136:139], v[116:119]
    ds_read_b64_tr_b16 v[140:141], v172 offset:51200
    ds_read_b64_tr_b16 v[142:143], v172 offset:51456
    v_mul_f32 v196, v196, v204
    v_mfma_f32_16x16x32_bf16 v[116:119], v[148:151], a[140:143], v[116:119]
    v_rcp_f32 v208, v208
    v_mul_f32 v197, v197, v205
    v_mfma_f32_16x16x32_bf16 v[116:119], v[152:155], a[168:171], v[116:119]
    v_rcp_f32 v209, v209
    v_mul_f32 v198, v198, v206
    v_mfma_f32_16x16x32_bf16 v[116:119], v[156:159], a[172:175], v[116:119]
    v_rcp_f32 v210, v210
    v_mul_f32 v199, v199, v207
    v_mfma_f32_16x16x32_bf16 v[120:123], v[144:147], a[144:147], v[120:123]
    v_rcp_f32 v211, v211
    v_mul_f32 v200, v200, v208
    v_mfma_f32_16x16x32_bf16 v[120:123], v[148:151], a[148:151], v[120:123]
    v_mul_f32 v201, v201, v209
    v_mul_f32 v202, v202, v210
    v_mul_f32 v203, v203, v211
    v_mfma_f32_16x16x32_bf16 v[120:123], v[152:155], a[176:179], v[120:123]
    v_cvt_pk_bf16_f32 v212, v196, v197
    v_cvt_pk_bf16_f32 v213, v198, v199
    v_cvt_pk_bf16_f32 v214, v200, v201
    v_mfma_f32_16x16x32_bf16 v[120:123], v[156:159], a[180:183], v[120:123]
    v_cvt_pk_bf16_f32 v215, v202, v203
    v_mfma_f32_16x16x32_bf16 v[124:127], v[144:147], a[152:155], v[124:127]
    buffer_store_dwordx4 v[212:215], v253, s[24:27], s62 offen offset:1024 sc1
    v_mfma_f32_16x16x32_bf16 v[124:127], v[148:151], a[156:159], v[124:127]
    v_mfma_f32_16x16x32_bf16 v[124:127], v[152:155], a[184:187], v[124:127]
    v_mfma_f32_16x16x32_bf16 v[124:127], v[156:159], a[188:191], v[124:127]
    s_waitcnt vmcnt(63)
    s_waitcnt lgkmcnt(0)
    v_mfma_f32_16x16x32_bf16 v[0:3], v[128:131], a[192:195], v[0:3]
    v_accvgpr_read_b32 v176, a40
    v_accvgpr_read_b32 v177, a41
    v_accvgpr_read_b32 v178, a42
    v_mfma_f32_16x16x32_bf16 v[0:3], v[132:135], a[196:199], v[0:3]
    s_mov_b32 s48, 16384
    v_accvgpr_read_b32 v179, a43
    v_accvgpr_read_b32 v180, a56
    v_mfma_f32_16x16x32_bf16 v[0:3], v[136:139], a[224:227], v[0:3]
    buffer_load_dwordx4 a[128:131], v168, s[4:7], s48 offen offset:0 sc1
    v_accvgpr_read_b32 v181, a57
    v_mfma_f32_16x16x32_bf16 v[0:3], v[140:143], a[228:231], v[0:3]
    ds_read_b64_tr_b16 v[144:145], v172 offset:33800
    v_accvgpr_read_b32 v182, a58
    v_accvgpr_read_b32 v183, a59
    v_mfma_f32_16x16x32_bf16 v[4:7], v[128:131], a[200:203], v[4:7]
    ds_read_b64_tr_b16 v[146:147], v172 offset:34056
    v_mul_f32 v184, s70, v176
    v_mul_f32 v185, s70, v177
    v_mfma_f32_16x16x32_bf16 v[4:7], v[132:135], a[204:207], v[4:7]
    ds_read_b64_tr_b16 v[148:149], v172 offset:34312
    ds_read_b64_tr_b16 v[150:151], v172 offset:34568
    ds_read_b64_tr_b16 v[152:153], v172 offset:50696
    v_mfma_f32_16x16x32_bf16 v[4:7], v[136:139], a[232:235], v[4:7]
    ds_read_b64_tr_b16 v[154:155], v172 offset:50952
    ds_read_b64_tr_b16 v[156:157], v172 offset:51208
    v_mul_f32 v186, s70, v178
    v_mfma_f32_16x16x32_bf16 v[4:7], v[140:143], a[236:239], v[4:7]
    ds_read_b64_tr_b16 v[158:159], v172 offset:51464
    v_mul_f32 v187, s70, v179
    v_mul_f32 v188, s70, v180
    v_mfma_f32_16x16x32_bf16 v[8:11], v[128:131], a[208:211], v[8:11]
    buffer_load_dwordx4 a[132:135], v168, s[4:7], s48 offen offset:1024 sc1
    v_mul_f32 v189, s70, v181
    v_mfma_f32_16x16x32_bf16 v[8:11], v[132:135], a[212:215], v[8:11]
    v_mul_f32 v190, s70, v182
    v_mul_f32 v191, s70, v183
    v_mfma_f32_16x16x32_bf16 v[8:11], v[136:139], a[240:243], v[8:11]
    v_exp_f32 v184, v184
    v_mfma_f32_16x16x32_bf16 v[8:11], v[140:143], a[244:247], v[8:11]
    v_exp_f32 v185, v185
    v_mfma_f32_16x16x32_bf16 v[12:15], v[128:131], a[216:219], v[12:15]
    v_exp_f32 v186, v186
    v_add_f32 v184, 1.0, v184
    v_mfma_f32_16x16x32_bf16 v[12:15], v[132:135], a[220:223], v[12:15]
    v_exp_f32 v187, v187
    v_add_f32 v185, 1.0, v185
    v_mfma_f32_16x16x32_bf16 v[12:15], v[136:139], a[248:251], v[12:15]
    v_exp_f32 v188, v188
    v_add_f32 v186, 1.0, v186
    v_mfma_f32_16x16x32_bf16 v[12:15], v[140:143], a[252:255], v[12:15]
    buffer_load_dwordx4 a[136:139], v169, s[4:7], s48 offen offset:0 sc1
    v_add_f32 v187, 1.0, v187
    s_waitcnt lgkmcnt(0)
    v_mfma_f32_16x16x32_bf16 v[16:19], v[144:147], a[192:195], v[16:19]
    v_exp_f32 v189, v189
    v_add_f32 v188, 1.0, v188
    v_mfma_f32_16x16x32_bf16 v[16:19], v[148:151], a[196:199], v[16:19]
    v_exp_f32 v190, v190
    v_add_f32 v189, 1.0, v189
    v_mfma_f32_16x16x32_bf16 v[16:19], v[152:155], a[224:227], v[16:19]
    v_exp_f32 v191, v191
    v_add_f32 v190, 1.0, v190
    v_mfma_f32_16x16x32_bf16 v[16:19], v[156:159], a[228:231], v[16:19]
    ds_read_b64_tr_b16 v[128:129], v172 offset:33856
    buffer_load_dwordx4 a[140:143], v169, s[4:7], s48 offen offset:1024 sc1
    v_mfma_f32_16x16x32_bf16 v[20:23], v[144:147], a[200:203], v[20:23]
    v_add_f32 v191, 1.0, v191
    v_rcp_f32 v184, v184
    v_mfma_f32_16x16x32_bf16 v[20:23], v[148:151], a[204:207], v[20:23]
    ds_read_b64_tr_b16 v[130:131], v172 offset:34112
    ds_read_b64_tr_b16 v[132:133], v172 offset:34368
    ds_read_b64_tr_b16 v[134:135], v172 offset:34624
    v_mfma_f32_16x16x32_bf16 v[20:23], v[152:155], a[232:235], v[20:23]
    ds_read_b64_tr_b16 v[136:137], v172 offset:50752
    ds_read_b64_tr_b16 v[138:139], v172 offset:51008
    ds_read_b64_tr_b16 v[140:141], v172 offset:51264
    v_mfma_f32_16x16x32_bf16 v[20:23], v[156:159], a[236:239], v[20:23]
    ds_read_b64_tr_b16 v[142:143], v172 offset:51520
    v_rcp_f32 v185, v185
    v_mfma_f32_16x16x32_bf16 v[24:27], v[144:147], a[208:211], v[24:27]
    v_rcp_f32 v186, v186
    v_mul_f32 v176, v176, v184
    v_mfma_f32_16x16x32_bf16 v[24:27], v[148:151], a[212:215], v[24:27]
    v_rcp_f32 v187, v187
    v_mul_f32 v177, v177, v185
    v_mfma_f32_16x16x32_bf16 v[24:27], v[152:155], a[240:243], v[24:27]
    v_rcp_f32 v188, v188
    v_mul_f32 v178, v178, v186
    v_mfma_f32_16x16x32_bf16 v[24:27], v[156:159], a[244:247], v[24:27]
    buffer_load_dwordx4 a[144:147], v170, s[4:7], s48 offen offset:0 sc1
    v_mul_f32 v179, v179, v187
    v_mfma_f32_16x16x32_bf16 v[28:31], v[144:147], a[216:219], v[28:31]
    v_rcp_f32 v189, v189
    v_mul_f32 v180, v180, v188
    v_mfma_f32_16x16x32_bf16 v[28:31], v[148:151], a[220:223], v[28:31]
    v_rcp_f32 v190, v190
    v_mul_f32 v181, v181, v189
    v_mfma_f32_16x16x32_bf16 v[28:31], v[152:155], a[248:251], v[28:31]
    v_rcp_f32 v191, v191
    v_mul_f32 v182, v182, v190
    v_mfma_f32_16x16x32_bf16 v[28:31], v[156:159], a[252:255], v[28:31]
    buffer_load_dwordx4 a[148:151], v170, s[4:7], s48 offen offset:1024 sc1
    v_mul_f32 v183, v183, v191
    s_waitcnt lgkmcnt(0)
    v_mfma_f32_16x16x32_bf16 v[32:35], v[128:131], a[192:195], v[32:35]
    v_cvt_pk_bf16_f32 v192, v176, v177
    v_cvt_pk_bf16_f32 v193, v178, v179
    v_cvt_pk_bf16_f32 v194, v180, v181
    v_mfma_f32_16x16x32_bf16 v[32:35], v[132:135], a[196:199], v[32:35]
    ds_read_b64_tr_b16 v[144:145], v172 offset:33864
    ds_read_b64_tr_b16 v[146:147], v172 offset:34120
    v_cvt_pk_bf16_f32 v195, v182, v183
    v_mfma_f32_16x16x32_bf16 v[32:35], v[136:139], a[224:227], v[32:35]
    ds_read_b64_tr_b16 v[148:149], v172 offset:34376
    buffer_store_dwordx4 v[192:195], v253, s[24:27], s63 offen offset:1024 sc1
    v_mfma_f32_16x16x32_bf16 v[32:35], v[140:143], a[228:231], v[32:35]
    ds_read_b64_tr_b16 v[150:151], v172 offset:34632
    v_mfma_f32_16x16x32_bf16 v[36:39], v[128:131], a[200:203], v[36:39]
    ds_read_b64_tr_b16 v[152:153], v172 offset:50760
    buffer_load_dwordx4 a[152:155], v171, s[4:7], s48 offen offset:0 sc1
    v_mfma_f32_16x16x32_bf16 v[36:39], v[132:135], a[204:207], v[36:39]
    ds_read_b64_tr_b16 v[154:155], v172 offset:51016
    v_accvgpr_read_b32 v196, a44
    v_accvgpr_read_b32 v197, a45
    v_mfma_f32_16x16x32_bf16 v[36:39], v[136:139], a[232:235], v[36:39]
    ds_read_b64_tr_b16 v[156:157], v172 offset:51272
    v_accvgpr_read_b32 v198, a46
    v_accvgpr_read_b32 v199, a47
    v_mfma_f32_16x16x32_bf16 v[36:39], v[140:143], a[236:239], v[36:39]
    ds_read_b64_tr_b16 v[158:159], v172 offset:51528
    v_accvgpr_read_b32 v200, a60
    v_accvgpr_read_b32 v201, a61
    v_mfma_f32_16x16x32_bf16 v[40:43], v[128:131], a[208:211], v[40:43]
    v_accvgpr_read_b32 v202, a62
    v_accvgpr_read_b32 v203, a63
    v_mul_f32 v204, s70, v196
    v_mfma_f32_16x16x32_bf16 v[40:43], v[132:135], a[212:215], v[40:43]
    v_mul_f32 v205, s70, v197
    v_mul_f32 v206, s70, v198
    v_mul_f32 v207, s70, v199
    v_mfma_f32_16x16x32_bf16 v[40:43], v[136:139], a[240:243], v[40:43]
    v_mul_f32 v208, s70, v200
    v_mul_f32 v209, s70, v201
    v_mul_f32 v210, s70, v202
    v_mfma_f32_16x16x32_bf16 v[40:43], v[140:143], a[244:247], v[40:43]
    buffer_load_dwordx4 a[156:159], v171, s[4:7], s48 offen offset:1024 sc1
    v_mul_f32 v211, s70, v203
    v_mfma_f32_16x16x32_bf16 v[44:47], v[128:131], a[216:219], v[44:47]
    v_exp_f32 v204, v204
    v_mfma_f32_16x16x32_bf16 v[44:47], v[132:135], a[220:223], v[44:47]
    v_exp_f32 v205, v205
    v_mfma_f32_16x16x32_bf16 v[44:47], v[136:139], a[248:251], v[44:47]
    v_exp_f32 v206, v206
    v_mfma_f32_16x16x32_bf16 v[44:47], v[140:143], a[252:255], v[44:47]
    s_mov_b32 s48, 18432
    v_exp_f32 v207, v207
    s_waitcnt lgkmcnt(0)
    v_mfma_f32_16x16x32_bf16 v[48:51], v[144:147], a[192:195], v[48:51]
    ds_read_b64_tr_b16 v[128:129], v172 offset:33920
    v_exp_f32 v208, v208
    v_mfma_f32_16x16x32_bf16 v[48:51], v[148:151], a[196:199], v[48:51]
    buffer_load_dwordx4 a[160:163], v168, s[4:7], s48 offen offset:0 sc1
    v_add_f32 v204, 1.0, v204
    v_mfma_f32_16x16x32_bf16 v[48:51], v[152:155], a[224:227], v[48:51]
    v_exp_f32 v209, v209
    v_add_f32 v205, 1.0, v205
    v_mfma_f32_16x16x32_bf16 v[48:51], v[156:159], a[228:231], v[48:51]
    ds_read_b64_tr_b16 v[130:131], v172 offset:34176
    v_exp_f32 v210, v210
    v_mfma_f32_16x16x32_bf16 v[52:55], v[144:147], a[200:203], v[52:55]
    ds_read_b64_tr_b16 v[132:133], v172 offset:34432
    v_exp_f32 v211, v211
    v_mfma_f32_16x16x32_bf16 v[52:55], v[148:151], a[204:207], v[52:55]
    ds_read_b64_tr_b16 v[134:135], v172 offset:34688
    ds_read_b64_tr_b16 v[136:137], v172 offset:50816
    ds_read_b64_tr_b16 v[138:139], v172 offset:51072
    v_mfma_f32_16x16x32_bf16 v[52:55], v[152:155], a[232:235], v[52:55]
    ds_read_b64_tr_b16 v[140:141], v172 offset:51328
    v_add_f32 v206, 1.0, v206
    v_add_f32 v207, 1.0, v207
    v_mfma_f32_16x16x32_bf16 v[52:55], v[156:159], a[236:239], v[52:55]
    ds_read_b64_tr_b16 v[142:143], v172 offset:51584
    v_add_f32 v208, 1.0, v208
    v_add_f32 v209, 1.0, v209
    v_mfma_f32_16x16x32_bf16 v[56:59], v[144:147], a[208:211], v[56:59]
    buffer_load_dwordx4 a[164:167], v168, s[4:7], s48 offen offset:1024 sc1
    v_add_f32 v210, 1.0, v210
    v_mfma_f32_16x16x32_bf16 v[56:59], v[148:151], a[212:215], v[56:59]
    v_add_f32 v211, 1.0, v211
    v_rcp_f32 v204, v204
    v_mfma_f32_16x16x32_bf16 v[56:59], v[152:155], a[240:243], v[56:59]
    v_rcp_f32 v205, v205
    v_mfma_f32_16x16x32_bf16 v[56:59], v[156:159], a[244:247], v[56:59]
    v_rcp_f32 v206, v206
    v_mfma_f32_16x16x32_bf16 v[60:63], v[144:147], a[216:219], v[60:63]
    v_rcp_f32 v207, v207
    v_mul_f32 v196, v196, v204
    v_mfma_f32_16x16x32_bf16 v[60:63], v[148:151], a[220:223], v[60:63]
    v_rcp_f32 v208, v208
    v_mul_f32 v197, v197, v205
    v_mfma_f32_16x16x32_bf16 v[60:63], v[152:155], a[248:251], v[60:63]
    buffer_load_dwordx4 a[168:171], v169, s[4:7], s48 offen offset:0 sc1
    v_mul_f32 v198, v198, v206
    v_mfma_f32_16x16x32_bf16 v[60:63], v[156:159], a[252:255], v[60:63]
    v_rcp_f32 v209, v209
    v_mul_f32 v199, v199, v207
    s_waitcnt lgkmcnt(0)
    v_mfma_f32_16x16x32_bf16 v[64:67], v[128:131], a[192:195], v[64:67]
    v_rcp_f32 v210, v210
    v_mul_f32 v200, v200, v208
    v_mfma_f32_16x16x32_bf16 v[64:67], v[132:135], a[196:199], v[64:67]
    v_rcp_f32 v211, v211
    v_mul_f32 v201, v201, v209
    v_mfma_f32_16x16x32_bf16 v[64:67], v[136:139], a[224:227], v[64:67]
    buffer_load_dwordx4 a[172:175], v169, s[4:7], s48 offen offset:1024 sc1
    v_mul_f32 v202, v202, v210
    v_mfma_f32_16x16x32_bf16 v[64:67], v[140:143], a[228:231], v[64:67]
    ds_read_b64_tr_b16 v[144:145], v172 offset:33928
    v_mul_f32 v203, v203, v211
    v_cvt_pk_bf16_f32 v212, v196, v197
    v_mfma_f32_16x16x32_bf16 v[68:71], v[128:131], a[200:203], v[68:71]
    ds_read_b64_tr_b16 v[146:147], v172 offset:34184
    ds_read_b64_tr_b16 v[148:149], v172 offset:34440
    ds_read_b64_tr_b16 v[150:151], v172 offset:34696
    v_mfma_f32_16x16x32_bf16 v[68:71], v[132:135], a[204:207], v[68:71]
    ds_read_b64_tr_b16 v[152:153], v172 offset:50824
    ds_read_b64_tr_b16 v[154:155], v172 offset:51080
    v_cvt_pk_bf16_f32 v213, v198, v199
    v_mfma_f32_16x16x32_bf16 v[68:71], v[136:139], a[232:235], v[68:71]
    ds_read_b64_tr_b16 v[156:157], v172 offset:51336
    v_cvt_pk_bf16_f32 v214, v200, v201
    v_cvt_pk_bf16_f32 v215, v202, v203
    v_mfma_f32_16x16x32_bf16 v[68:71], v[140:143], a[236:239], v[68:71]
    ds_read_b64_tr_b16 v[158:159], v172 offset:51592
    buffer_store_dwordx4 v[212:215], v253, s[24:27], s64 offen offset:1024 sc1
    v_mfma_f32_16x16x32_bf16 v[72:75], v[128:131], a[208:211], v[72:75]
    buffer_load_dwordx4 a[176:179], v170, s[4:7], s48 offen offset:0 sc1
    v_accvgpr_read_b32 v176, a64
    v_mfma_f32_16x16x32_bf16 v[72:75], v[132:135], a[212:215], v[72:75]
    v_accvgpr_read_b32 v177, a65
    v_accvgpr_read_b32 v178, a66
    v_accvgpr_read_b32 v179, a67
    v_mfma_f32_16x16x32_bf16 v[72:75], v[136:139], a[240:243], v[72:75]
    v_accvgpr_read_b32 v180, a80
    v_accvgpr_read_b32 v181, a81
    v_accvgpr_read_b32 v182, a82
    v_mfma_f32_16x16x32_bf16 v[72:75], v[140:143], a[244:247], v[72:75]
    v_accvgpr_read_b32 v183, a83
    v_mul_f32 v184, s70, v176
    v_mul_f32 v185, s70, v177
    v_mfma_f32_16x16x32_bf16 v[76:79], v[128:131], a[216:219], v[76:79]
    v_mul_f32 v186, s70, v178
    v_mul_f32 v187, s70, v179
    v_mul_f32 v188, s70, v180
    v_mfma_f32_16x16x32_bf16 v[76:79], v[132:135], a[220:223], v[76:79]
    v_mul_f32 v189, s70, v181
    v_mul_f32 v190, s70, v182
    v_mul_f32 v191, s70, v183
    v_mfma_f32_16x16x32_bf16 v[76:79], v[136:139], a[248:251], v[76:79]
    buffer_load_dwordx4 a[180:183], v170, s[4:7], s48 offen offset:1024 sc1
    v_mfma_f32_16x16x32_bf16 v[76:79], v[140:143], a[252:255], v[76:79]
    v_exp_f32 v184, v184
    s_waitcnt lgkmcnt(0)
    v_mfma_f32_16x16x32_bf16 v[80:83], v[144:147], a[192:195], v[80:83]
    ds_read_b64_tr_b16 v[128:129], v172 offset:33984
    v_exp_f32 v185, v185
    v_mfma_f32_16x16x32_bf16 v[80:83], v[148:151], a[196:199], v[80:83]
    ds_read_b64_tr_b16 v[130:131], v172 offset:34240
    v_exp_f32 v186, v186
    v_mfma_f32_16x16x32_bf16 v[80:83], v[152:155], a[224:227], v[80:83]
    ds_read_b64_tr_b16 v[132:133], v172 offset:34496
    v_exp_f32 v187, v187
    v_mfma_f32_16x16x32_bf16 v[80:83], v[156:159], a[228:231], v[80:83]
    ds_read_b64_tr_b16 v[134:135], v172 offset:34752
    v_exp_f32 v188, v188
    v_mfma_f32_16x16x32_bf16 v[84:87], v[144:147], a[200:203], v[84:87]
    ds_read_b64_tr_b16 v[136:137], v172 offset:50880
    buffer_load_dwordx4 a[184:187], v171, s[4:7], s48 offen offset:0 sc1
    v_mfma_f32_16x16x32_bf16 v[84:87], v[148:151], a[204:207], v[84:87]
    ds_read_b64_tr_b16 v[138:139], v172 offset:51136
    v_exp_f32 v189, v189
    v_mfma_f32_16x16x32_bf16 v[84:87], v[152:155], a[232:235], v[84:87]
    ds_read_b64_tr_b16 v[140:141], v172 offset:51392
    v_exp_f32 v190, v190
    v_mfma_f32_16x16x32_bf16 v[84:87], v[156:159], a[236:239], v[84:87]
    ds_read_b64_tr_b16 v[142:143], v172 offset:51648
    v_exp_f32 v191, v191
    v_mfma_f32_16x16x32_bf16 v[88:91], v[144:147], a[208:211], v[88:91]
    v_add_f32 v184, 1.0, v184
    v_add_f32 v185, 1.0, v185
    v_add_f32 v186, 1.0, v186
    v_mfma_f32_16x16x32_bf16 v[88:91], v[148:151], a[212:215], v[88:91]
    v_add_f32 v187, 1.0, v187
    v_add_f32 v188, 1.0, v188
    v_add_f32 v189, 1.0, v189
    v_mfma_f32_16x16x32_bf16 v[88:91], v[152:155], a[240:243], v[88:91]
    buffer_load_dwordx4 a[188:191], v171, s[4:7], s48 offen offset:1024 sc1
    v_add_f32 v190, 1.0, v190
    v_mfma_f32_16x16x32_bf16 v[88:91], v[156:159], a[244:247], v[88:91]
    v_add_f32 v191, 1.0, v191
    v_rcp_f32 v184, v184
    v_mfma_f32_16x16x32_bf16 v[92:95], v[144:147], a[216:219], v[92:95]
    v_rcp_f32 v185, v185
    v_mfma_f32_16x16x32_bf16 v[92:95], v[148:151], a[220:223], v[92:95]
    v_rcp_f32 v186, v186
    v_mfma_f32_16x16x32_bf16 v[92:95], v[152:155], a[248:251], v[92:95]
    v_rcp_f32 v187, v187
    v_mfma_f32_16x16x32_bf16 v[92:95], v[156:159], a[252:255], v[92:95]
    s_add_u32 m0, s53, 0
    v_rcp_f32 v188, v188
    s_waitcnt lgkmcnt(0)
    v_mfma_f32_16x16x32_bf16 v[96:99], v[128:131], a[192:195], v[96:99]
    ds_read_b64_tr_b16 v[144:145], v172 offset:33992
    buffer_load_dwordx4 v240, s[16:19], s51 offen offset:0 lds
    v_mfma_f32_16x16x32_bf16 v[96:99], v[132:135], a[196:199], v[96:99]
    ds_read_b64_tr_b16 v[146:147], v172 offset:34248
    v_rcp_f32 v189, v189
    v_mfma_f32_16x16x32_bf16 v[96:99], v[136:139], a[224:227], v[96:99]
    ds_read_b64_tr_b16 v[148:149], v172 offset:34504
    ds_read_b64_tr_b16 v[150:151], v172 offset:34760
    ds_read_b64_tr_b16 v[152:153], v172 offset:50888
    v_mfma_f32_16x16x32_bf16 v[96:99], v[140:143], a[228:231], v[96:99]
    ds_read_b64_tr_b16 v[154:155], v172 offset:51144
    ds_read_b64_tr_b16 v[156:157], v172 offset:51400
    ds_read_b64_tr_b16 v[158:159], v172 offset:51656
    v_mfma_f32_16x16x32_bf16 v[100:103], v[128:131], a[200:203], v[100:103]
    v_rcp_f32 v190, v190
    v_mul_f32 v176, v176, v184
    v_mfma_f32_16x16x32_bf16 v[100:103], v[132:135], a[204:207], v[100:103]
    s_add_u32 m0, s53, 800
    v_rcp_f32 v191, v191
    v_mfma_f32_16x16x32_bf16 v[100:103], v[136:139], a[232:235], v[100:103]
    v_mul_f32 v177, v177, v185
    v_mul_f32 v178, v178, v186
    v_mul_f32 v179, v179, v187
    v_mfma_f32_16x16x32_bf16 v[100:103], v[140:143], a[236:239], v[100:103]
    buffer_load_dwordx4 v240, s[16:19], s51 offen offset:256 lds
    v_mul_f32 v180, v180, v188
    v_mfma_f32_16x16x32_bf16 v[104:107], v[128:131], a[208:211], v[104:107]
    v_mul_f32 v181, v181, v189
    v_mul_f32 v182, v182, v190
    v_mul_f32 v183, v183, v191
    v_mfma_f32_16x16x32_bf16 v[104:107], v[132:135], a[212:215], v[104:107]
    v_cvt_pk_bf16_f32 v192, v176, v177
    v_cvt_pk_bf16_f32 v193, v178, v179
    v_cvt_pk_bf16_f32 v194, v180, v181
    v_mfma_f32_16x16x32_bf16 v[104:107], v[136:139], a[240:243], v[104:107]
    v_cvt_pk_bf16_f32 v195, v182, v183
    v_mfma_f32_16x16x32_bf16 v[104:107], v[140:143], a[244:247], v[104:107]
    s_add_u32 m0, s53, 1600
    buffer_store_dwordx4 v[192:195], v253, s[24:27], 0 offen offset:2048 sc1
    v_mfma_f32_16x16x32_bf16 v[108:111], v[128:131], a[216:219], v[108:111]
    buffer_load_dwordx4 v240, s[16:19], s51 offen offset:512 lds
    v_accvgpr_read_b32 v196, a68
    v_mfma_f32_16x16x32_bf16 v[108:111], v[132:135], a[220:223], v[108:111]
    v_accvgpr_read_b32 v197, a69
    v_accvgpr_read_b32 v198, a70
    v_accvgpr_read_b32 v199, a71
    v_mfma_f32_16x16x32_bf16 v[108:111], v[136:139], a[248:251], v[108:111]
    s_waitcnt vmcnt(35) lgkmcnt(0)
    s_barrier
    v_accvgpr_read_b32 v200, a84
    v_mfma_f32_16x16x32_bf16 v[108:111], v[140:143], a[252:255], v[108:111]
    v_accvgpr_read_b32 v201, a85
    v_accvgpr_read_b32 v202, a86
    v_accvgpr_read_b32 v203, a87
    v_mfma_f32_16x16x32_bf16 v[112:115], v[144:147], a[192:195], v[112:115]
    v_mul_f32 v204, s70, v196
    v_mul_f32 v205, s70, v197
    v_mul_f32 v206, s70, v198
    v_mfma_f32_16x16x32_bf16 v[112:115], v[148:151], a[196:199], v[112:115]
    s_add_u32 m0, s53, 2400
    v_mul_f32 v207, s70, v199
    v_mul_f32 v208, s70, v200
    v_mfma_f32_16x16x32_bf16 v[112:115], v[152:155], a[224:227], v[112:115]
    buffer_load_dwordx4 v240, s[16:19], s51 offen offset:768 lds
    v_mul_f32 v209, s70, v201
    v_mfma_f32_16x16x32_bf16 v[112:115], v[156:159], a[228:231], v[112:115]
    ds_read_b64_tr_b16 v[128:129], v173 offset:0
    v_mul_f32 v210, s70, v202
    v_mul_f32 v211, s70, v203
    v_mfma_f32_16x16x32_bf16 v[116:119], v[144:147], a[200:203], v[116:119]
    ds_read_b64_tr_b16 v[130:131], v173 offset:256
    ds_read_b64_tr_b16 v[132:133], v173 offset:512
    ds_read_b64_tr_b16 v[134:135], v173 offset:768
    v_mfma_f32_16x16x32_bf16 v[116:119], v[148:151], a[204:207], v[116:119]
    ds_read_b64_tr_b16 v[136:137], v173 offset:16896
    ds_read_b64_tr_b16 v[138:139], v173 offset:17152
    ds_read_b64_tr_b16 v[140:141], v173 offset:17408
    v_mfma_f32_16x16x32_bf16 v[116:119], v[152:155], a[232:235], v[116:119]
    ds_read_b64_tr_b16 v[142:143], v173 offset:17664
    s_add_u32 s51, s51, 16384
    v_mfma_f32_16x16x32_bf16 v[116:119], v[156:159], a[236:239], v[116:119]
    v_exp_f32 v204, v204
    v_mfma_f32_16x16x32_bf16 v[120:123], v[144:147], a[208:211], v[120:123]
    v_exp_f32 v205, v205
    v_add_f32 v204, 1.0, v204
    v_mfma_f32_16x16x32_bf16 v[120:123], v[148:151], a[212:215], v[120:123]
    v_exp_f32 v206, v206
    v_add_f32 v205, 1.0, v205
    v_mfma_f32_16x16x32_bf16 v[120:123], v[152:155], a[240:243], v[120:123]
    v_exp_f32 v207, v207
    v_add_f32 v206, 1.0, v206
    v_mfma_f32_16x16x32_bf16 v[120:123], v[156:159], a[244:247], v[120:123]
    v_exp_f32 v208, v208
    v_add_f32 v207, 1.0, v207
    v_mfma_f32_16x16x32_bf16 v[124:127], v[144:147], a[216:219], v[124:127]
    v_exp_f32 v209, v209
    v_add_f32 v208, 1.0, v208
    v_mfma_f32_16x16x32_bf16 v[124:127], v[148:151], a[220:223], v[124:127]
    v_exp_f32 v210, v210
    v_add_f32 v209, 1.0, v209
    v_mfma_f32_16x16x32_bf16 v[124:127], v[152:155], a[248:251], v[124:127]
    v_exp_f32 v211, v211
    v_add_f32 v210, 1.0, v210
    v_mfma_f32_16x16x32_bf16 v[124:127], v[156:159], a[252:255], v[124:127]
    s_waitcnt vmcnt(5)
    v_add_f32 v211, 1.0, v211
    s_waitcnt lgkmcnt(0)
    v_mfma_f32_16x16x32_bf16 v[0:3], v[128:131], a[128:131], v[0:3]
    ds_read_b64_tr_b16 v[144:145], v173 offset:8
    v_rcp_f32 v204, v204
    v_mfma_f32_16x16x32_bf16 v[0:3], v[132:135], a[132:135], v[0:3]
    s_mov_b32 s48, 20480
    v_rcp_f32 v205, v205
    v_mfma_f32_16x16x32_bf16 v[0:3], v[136:139], a[160:163], v[0:3]
    ds_read_b64_tr_b16 v[146:147], v173 offset:264
    buffer_load_dwordx4 a[192:195], v168, s[4:7], s48 offen offset:0 sc1
    v_mfma_f32_16x16x32_bf16 v[0:3], v[140:143], a[164:167], v[0:3]
    ds_read_b64_tr_b16 v[148:149], v173 offset:520
    v_rcp_f32 v206, v206
    v_mfma_f32_16x16x32_bf16 v[4:7], v[128:131], a[136:139], v[4:7]
    ds_read_b64_tr_b16 v[150:151], v173 offset:776
    v_rcp_f32 v207, v207
    v_mfma_f32_16x16x32_bf16 v[4:7], v[132:135], a[140:143], v[4:7]
    ds_read_b64_tr_b16 v[152:153], v173 offset:16904
    v_rcp_f32 v208, v208
    v_mfma_f32_16x16x32_bf16 v[4:7], v[136:139], a[168:171], v[4:7]
    ds_read_b64_tr_b16 v[154:155], v173 offset:17160
    ds_read_b64_tr_b16 v[156:157], v173 offset:17416
    v_mul_f32 v196, v196, v204
    v_mfma_f32_16x16x32_bf16 v[4:7], v[140:143], a[172:175], v[4:7]
    ds_read_b64_tr_b16 v[158:159], v173 offset:17672
    v_rcp_f32 v209, v209
    v_mfma_f32_16x16x32_bf16 v[8:11], v[128:131], a[144:147], v[8:11]
    v_rcp_f32 v210, v210
    v_mul_f32 v197, v197, v205
    v_mfma_f32_16x16x32_bf16 v[8:11], v[132:135], a[148:151], v[8:11]
    buffer_load_dwordx4 a[196:199], v168, s[4:7], s48 offen offset:1024 sc1
    v_mul_f32 v198, v198, v206
    v_mfma_f32_16x16x32_bf16 v[8:11], v[136:139], a[176:179], v[8:11]
    v_rcp_f32 v211, v211
    v_mul_f32 v199, v199, v207
    v_mfma_f32_16x16x32_bf16 v[8:11], v[140:143], a[180:183], v[8:11]
    v_mul_f32 v200, v200, v208
    v_mul_f32 v201, v201, v209
    v_mul_f32 v202, v202, v210
    v_mfma_f32_16x16x32_bf16 v[12:15], v[128:131], a[152:155], v[12:15]
    v_mul_f32 v203, v203, v211
    v_cvt_pk_bf16_f32 v212, v196, v197
    v_cvt_pk_bf16_f32 v213, v198, v199
    v_mfma_f32_16x16x32_bf16 v[12:15], v[132:135], a[156:159], v[12:15]
    buffer_load_dwordx4 a[200:203], v169, s[4:7], s48 offen offset:0 sc1
    v_cvt_pk_bf16_f32 v214, v200, v201
    v_mfma_f32_16x16x32_bf16 v[12:15], v[136:139], a[184:187], v[12:15]
    v_cvt_pk_bf16_f32 v215, v202, v203
    v_mfma_f32_16x16x32_bf16 v[12:15], v[140:143], a[188:191], v[12:15]
    buffer_store_dwordx4 v[212:215], v253, s[24:27], s62 offen offset:2048 sc1
    s_waitcnt lgkmcnt(0)
    v_mfma_f32_16x16x32_bf16 v[16:19], v[144:147], a[128:131], v[16:19]
    v_accvgpr_read_b32 v176, a72
    v_accvgpr_read_b32 v177, a73
    v_accvgpr_read_b32 v178, a74
    v_mfma_f32_16x16x32_bf16 v[16:19], v[148:151], a[132:135], v[16:19]
    v_accvgpr_read_b32 v179, a75
    v_accvgpr_read_b32 v180, a88
    v_accvgpr_read_b32 v181, a89
    v_mfma_f32_16x16x32_bf16 v[16:19], v[152:155], a[160:163], v[16:19]
    buffer_load_dwordx4 a[204:207], v169, s[4:7], s48 offen offset:1024 sc1
    v_accvgpr_read_b32 v182, a90
    v_mfma_f32_16x16x32_bf16 v[16:19], v[156:159], a[164:167], v[16:19]
    ds_read_b64_tr_b16 v[128:129], v173 offset:64
    v_accvgpr_read_b32 v183, a91
    v_mul_f32 v184, s70, v176
    v_mfma_f32_16x16x32_bf16 v[20:23], v[144:147], a[136:139], v[20:23]
    ds_read_b64_tr_b16 v[130:131], v173 offset:320
    ds_read_b64_tr_b16 v[132:133], v173 offset:576
    v_mul_f32 v185, s70, v177
    v_mfma_f32_16x16x32_bf16 v[20:23], v[148:151], a[140:143], v[20:23]
    ds_read_b64_tr_b16 v[134:135], v173 offset:832
    ds_read_b64_tr_b16 v[136:137], v173 offset:16960
    ds_read_b64_tr_b16 v[138:139], v173 offset:17216
    v_mfma_f32_16x16x32_bf16 v[20:23], v[152:155], a[168:171], v[20:23]
    ds_read_b64_tr_b16 v[140:141], v173 offset:17472
    v_mul_f32 v186, s70, v178
    v_mul_f32 v187, s70, v179
    v_mfma_f32_16x16x32_bf16 v[20:23], v[156:159], a[172:175], v[20:23]
    ds_read_b64_tr_b16 v[142:143], v173 offset:17728
    v_mul_f32 v188, s70, v180
    v_mul_f32 v189, s70, v181
    v_mfma_f32_16x16x32_bf16 v[24:27], v[144:147], a[144:147], v[24:27]
    v_mul_f32 v190, s70, v182
    v_mul_f32 v191, s70, v183
    v_mfma_f32_16x16x32_bf16 v[24:27], v[148:151], a[148:151], v[24:27]
    v_exp_f32 v184, v184
    v_mfma_f32_16x16x32_bf16 v[24:27], v[152:155], a[176:179], v[24:27]
    buffer_load_dwordx4 a[208:211], v170, s[4:7], s48 offen offset:0 sc1
    v_mfma_f32_16x16x32_bf16 v[24:27], v[156:159], a[180:183], v[24:27]
    v_exp_f32 v185, v185
    v_mfma_f32_16x16x32_bf16 v[28:31], v[144:147], a[152:155], v[28:31]
    v_exp_f32 v186, v186
    v_add_f32 v184, 1.0, v184
    v_mfma_f32_16x16x32_bf16 v[28:31], v[148:151], a[156:159], v[28:31]
    v_exp_f32 v187, v187
    v_add_f32 v185, 1.0, v185
    v_mfma_f32_16x16x32_bf16 v[28:31], v[152:155], a[184:187], v[28:31]
    v_exp_f32 v188, v188
    v_add_f32 v186, 1.0, v186
    v_mfma_f32_16x16x32_bf16 v[28:31], v[156:159], a[188:191], v[28:31]
    v_exp_f32 v189, v189
    v_add_f32 v187, 1.0, v187
    s_waitcnt lgkmcnt(0)
    v_mfma_f32_16x16x32_bf16 v[32:35], v[128:131], a[128:131], v[32:35]
    v_exp_f32 v190, v190
    v_add_f32 v188, 1.0, v188
    v_mfma_f32_16x16x32_bf16 v[32:35], v[132:135], a[132:135], v[32:35]
    buffer_load_dwordx4 a[212:215], v170, s[4:7], s48 offen offset:1024 sc1
    v_add_f32 v189, 1.0, v189
    v_mfma_f32_16x16x32_bf16 v[32:35], v[136:139], a[160:163], v[32:35]
    v_exp_f32 v191, v191
    v_add_f32 v190, 1.0, v190
    v_mfma_f32_16x16x32_bf16 v[32:35], v[140:143], a[164:167], v[32:35]
    ds_read_b64_tr_b16 v[144:145], v173 offset:72
    ds_read_b64_tr_b16 v[146:147], v173 offset:328
    v_add_f32 v191, 1.0, v191
    v_mfma_f32_16x16x32_bf16 v[36:39], v[128:131], a[136:139], v[36:39]
    ds_read_b64_tr_b16 v[148:149], v173 offset:584
    v_rcp_f32 v184, v184
    v_mfma_f32_16x16x32_bf16 v[36:39], v[132:135], a[140:143], v[36:39]
    ds_read_b64_tr_b16 v[150:151], v173 offset:840
    ds_read_b64_tr_b16 v[152:153], v173 offset:16968
    ds_read_b64_tr_b16 v[154:155], v173 offset:17224
    v_mfma_f32_16x16x32_bf16 v[36:39], v[136:139], a[168:171], v[36:39]
    ds_read_b64_tr_b16 v[156:157], v173 offset:17480
    buffer_load_dwordx4 a[216:219], v171, s[4:7], s48 offen offset:0 sc1
    v_mfma_f32_16x16x32_bf16 v[36:39], v[140:143], a[172:175], v[36:39]
    ds_read_b64_tr_b16 v[158:159], v173 offset:17736
    v_rcp_f32 v185, v185
    v_mfma_f32_16x16x32_bf16 v[40:43], v[128:131], a[144:147], v[40:43]
    v_rcp_f32 v186, v186
    v_mul_f32 v176, v176, v184
    v_mfma_f32_16x16x32_bf16 v[40:43], v[132:135], a[148:151], v[40:43]
    v_rcp_f32 v187, v187
    v_mul_f32 v177, v177, v185
    v_mfma_f32_16x16x32_bf16 v[40:43], v[136:139], a[176:179], v[40:43]
    v_rcp_f32 v188, v188
    v_mul_f32 v178, v178, v186
    v_mfma_f32_16x16x32_bf16 v[40:43], v[140:143], a[180:183], v[40:43]
    v_rcp_f32 v189, v189
    v_mul_f32 v179, v179, v187
    v_mfma_f32_16x16x32_bf16 v[44:47], v[128:131], a[152:155], v[44:47]
    v_rcp_f32 v190, v190
    v_mul_f32 v180, v180, v188
    v_mfma_f32_16x16x32_bf16 v[44:47], v[132:135], a[156:159], v[44:47]
    buffer_load_dwordx4 a[220:223], v171, s[4:7], s48 offen offset:1024 sc1
    v_mul_f32 v181, v181, v189
    v_mfma_f32_16x16x32_bf16 v[44:47], v[136:139], a[184:187], v[44:47]
    v_rcp_f32 v191, v191
    v_mul_f32 v182, v182, v190
    v_mfma_f32_16x16x32_bf16 v[44:47], v[140:143], a[188:191], v[44:47]
    s_mov_b32 s48, 22528
    v_mul_f32 v183, v183, v191
    v_cvt_pk_bf16_f32 v192, v176, v177
    s_waitcnt lgkmcnt(0)
    v_mfma_f32_16x16x32_bf16 v[48:51], v[144:147], a[128:131], v[48:51]
    buffer_load_dwordx4 a[224:227], v168, s[4:7], s48 offen offset:0 sc1
    v_cvt_pk_bf16_f32 v193, v178, v179
    v_mfma_f32_16x16x32_bf16 v[48:51], v[148:151], a[132:135], v[48:51]
    ds_read_b64_tr_b16 v[128:129], v173 offset:128
    v_cvt_pk_bf16_f32 v194, v180, v181
    v_cvt_pk_bf16_f32 v195, v182, v183
    v_mfma_f32_16x16x32_bf16 v[48:51], v[152:155], a[160:163], v[48:51]
    ds_read_b64_tr_b16 v[130:131], v173 offset:384
    buffer_store_dwordx4 v[192:195], v253, s[24:27], s63 offen offset:2048 sc1
    v_mfma_f32_16x16x32_bf16 v[48:51], v[156:159], a[164:167], v[48:51]
    ds_read_b64_tr_b16 v[132:133], v173 offset:640
    ds_read_b64_tr_b16 v[134:135], v173 offset:896
    v_mfma_f32_16x16x32_bf16 v[52:55], v[144:147], a[136:139], v[52:55]
    ds_read_b64_tr_b16 v[136:137], v173 offset:17024
    v_accvgpr_read_b32 v196, a76
    v_accvgpr_read_b32 v197, a77
    v_mfma_f32_16x16x32_bf16 v[52:55], v[148:151], a[140:143], v[52:55]
    ds_read_b64_tr_b16 v[138:139], v173 offset:17280
    v_accvgpr_read_b32 v198, a78
    v_accvgpr_read_b32 v199, a79
    v_mfma_f32_16x16x32_bf16 v[52:55], v[152:155], a[168:171], v[52:55]
    ds_read_b64_tr_b16 v[140:141], v173 offset:17536
    v_accvgpr_read_b32 v200, a92
    v_accvgpr_read_b32 v201, a93
    v_mfma_f32_16x16x32_bf16 v[52:55], v[156:159], a[172:175], v[52:55]
    ds_read_b64_tr_b16 v[142:143], v173 offset:17792
    buffer_load_dwordx4 a[228:231], v168, s[4:7], s48 offen offset:1024 sc1
    v_mfma_f32_16x16x32_bf16 v[56:59], v[144:147], a[144:147], v[56:59]
    v_accvgpr_read_b32 v202, a94
    v_accvgpr_read_b32 v203, a95
    v_mul_f32 v204, s70, v196
    v_mfma_f32_16x16x32_bf16 v[56:59], v[148:151], a[148:151], v[56:59]
    v_mul_f32 v205, s70, v197
    v_mul_f32 v206, s70, v198
    v_mul_f32 v207, s70, v199
    v_mfma_f32_16x16x32_bf16 v[56:59], v[152:155], a[176:179], v[56:59]
    v_mul_f32 v208, s70, v200
    v_mul_f32 v209, s70, v201
    v_mul_f32 v210, s70, v202
    v_mfma_f32_16x16x32_bf16 v[56:59], v[156:159], a[180:183], v[56:59]
    v_mul_f32 v211, s70, v203
    v_exp_f32 v204, v204
    v_mfma_f32_16x16x32_bf16 v[60:63], v[144:147], a[152:155], v[60:63]
    buffer_load_dwordx4 a[232:235], v169, s[4:7], s48 offen offset:0 sc1
    v_mfma_f32_16x16x32_bf16 v[60:63], v[148:151], a[156:159], v[60:63]
    v_exp_f32 v205, v205
    v_mfma_f32_16x16x32_bf16 v[60:63], v[152:155], a[184:187], v[60:63]
    v_exp_f32 v206, v206
    v_mfma_f32_16x16x32_bf16 v[60:63], v[156:159], a[188:191], v[60:63]
    v_exp_f32 v207, v207
    s_waitcnt lgkmcnt(0)
    v_mfma_f32_16x16x32_bf16 v[64:67], v[128:131], a[128:131], v[64:67]
    ds_read_b64_tr_b16 v[144:145], v173 offset:136
    v_exp_f32 v208, v208
    v_mfma_f32_16x16x32_bf16 v[64:67], v[132:135], a[132:135], v[64:67]
    v_exp_f32 v209, v209
    v_add_f32 v204, 1.0, v204
    v_mfma_f32_16x16x32_bf16 v[64:67], v[136:139], a[160:163], v[64:67]
    v_exp_f32 v210, v210
    v_add_f32 v205, 1.0, v205
    v_mfma_f32_16x16x32_bf16 v[64:67], v[140:143], a[164:167], v[64:67]
    ds_read_b64_tr_b16 v[146:147], v173 offset:392
    buffer_load_dwordx4 a[236:239], v169, s[4:7], s48 offen offset:1024 sc1
    v_mfma_f32_16x16x32_bf16 v[68:71], v[128:131], a[136:139], v[68:71]
    ds_read_b64_tr_b16 v[148:149], v173 offset:648
    v_exp_f32 v211, v211
    v_mfma_f32_16x16x32_bf16 v[68:71], v[132:135], a[140:143], v[68:71]
    ds_read_b64_tr_b16 v[150:151], v173 offset:904
    ds_read_b64_tr_b16 v[152:153], v173 offset:17032
    ds_read_b64_tr_b16 v[154:155], v173 offset:17288
    v_mfma_f32_16x16x32_bf16 v[68:71], v[136:139], a[168:171], v[68:71]
    ds_read_b64_tr_b16 v[156:157], v173 offset:17544
    v_add_f32 v206, 1.0, v206
    v_add_f32 v207, 1.0, v207
    v_mfma_f32_16x16x32_bf16 v[68:71], v[140:143], a[172:175], v[68:71]
    ds_read_b64_tr_b16 v[158:159], v173 offset:17800
    v_add_f32 v208, 1.0, v208
    v_add_f32 v209, 1.0, v209
    v_mfma_f32_16x16x32_bf16 v[72:75], v[128:131], a[144:147], v[72:75]
    v_add_f32 v210, 1.0, v210
    v_add_f32 v211, 1.0, v211
    v_mfma_f32_16x16x32_bf16 v[72:75], v[132:135], a[148:151], v[72:75]
    v_rcp_f32 v204, v204
    v_mfma_f32_16x16x32_bf16 v[72:75], v[136:139], a[176:179], v[72:75]
    buffer_load_dwordx4 a[240:243], v170, s[4:7], s48 offen offset:0 sc1
    v_mfma_f32_16x16x32_bf16 v[72:75], v[140:143], a[180:183], v[72:75]
    v_rcp_f32 v205, v205
    v_mfma_f32_16x16x32_bf16 v[76:79], v[128:131], a[152:155], v[76:79]
    v_rcp_f32 v206, v206
    v_mul_f32 v196, v196, v204
    v_mfma_f32_16x16x32_bf16 v[76:79], v[132:135], a[156:159], v[76:79]
    v_rcp_f32 v207, v207
    v_mul_f32 v197, v197, v205
    v_mfma_f32_16x16x32_bf16 v[76:79], v[136:139], a[184:187], v[76:79]
    v_rcp_f32 v208, v208
    v_mul_f32 v198, v198, v206
    v_mfma_f32_16x16x32_bf16 v[76:79], v[140:143], a[188:191], v[76:79]
    v_rcp_f32 v209, v209
    v_mul_f32 v199, v199, v207
    s_waitcnt lgkmcnt(0)
    v_mfma_f32_16x16x32_bf16 v[80:83], v[144:147], a[128:131], v[80:83]
    v_rcp_f32 v210, v210
    v_mul_f32 v200, v200, v208
    v_mfma_f32_16x16x32_bf16 v[80:83], v[148:151], a[132:135], v[80:83]
    buffer_load_dwordx4 a[244:247], v170, s[4:7], s48 offen offset:1024 sc1
    v_mul_f32 v201, v201, v209
    v_mfma_f32_16x16x32_bf16 v[80:83], v[152:155], a[160:163], v[80:83]
    v_rcp_f32 v211, v211
    v_mul_f32 v202, v202, v210
    v_mfma_f32_16x16x32_bf16 v[80:83], v[156:159], a[164:167], v[80:83]
    ds_read_b64_tr_b16 v[128:129], v173 offset:192
    v_mul_f32 v203, v203, v211
    v_cvt_pk_bf16_f32 v212, v196, v197
    v_mfma_f32_16x16x32_bf16 v[84:87], v[144:147], a[136:139], v[84:87]
    ds_read_b64_tr_b16 v[130:131], v173 offset:448
    ds_read_b64_tr_b16 v[132:133], v173 offset:704
    ds_read_b64_tr_b16 v[134:135], v173 offset:960
    v_mfma_f32_16x16x32_bf16 v[84:87], v[148:151], a[140:143], v[84:87]
    ds_read_b64_tr_b16 v[136:137], v173 offset:17088
    buffer_load_dwordx4 a[248:251], v171, s[4:7], s48 offen offset:0 sc1
    v_mfma_f32_16x16x32_bf16 v[84:87], v[152:155], a[168:171], v[84:87]
    ds_read_b64_tr_b16 v[138:139], v173 offset:17344
    ds_read_b64_tr_b16 v[140:141], v173 offset:17600
    v_cvt_pk_bf16_f32 v213, v198, v199
    v_mfma_f32_16x16x32_bf16 v[84:87], v[156:159], a[172:175], v[84:87]
    ds_read_b64_tr_b16 v[142:143], v173 offset:17856
    v_cvt_pk_bf16_f32 v214, v200, v201
    v_cvt_pk_bf16_f32 v215, v202, v203
    v_mfma_f32_16x16x32_bf16 v[88:91], v[144:147], a[144:147], v[88:91]
    buffer_store_dwordx4 v[212:215], v253, s[24:27], s64 offen offset:2048 sc1
    v_accvgpr_read_b32 v176, a96
    v_mfma_f32_16x16x32_bf16 v[88:91], v[148:151], a[148:151], v[88:91]
    v_accvgpr_read_b32 v177, a97
    v_accvgpr_read_b32 v178, a98
    v_accvgpr_read_b32 v179, a99
    v_mfma_f32_16x16x32_bf16 v[88:91], v[152:155], a[176:179], v[88:91]
    v_accvgpr_read_b32 v180, a112
    v_accvgpr_read_b32 v181, a113
    v_accvgpr_read_b32 v182, a114
    v_mfma_f32_16x16x32_bf16 v[88:91], v[156:159], a[180:183], v[88:91]
    buffer_load_dwordx4 a[252:255], v171, s[4:7], s48 offen offset:1024 sc1
    v_accvgpr_read_b32 v183, a115
    v_mfma_f32_16x16x32_bf16 v[92:95], v[144:147], a[152:155], v[92:95]
    v_mul_f32 v184, s70, v176
    v_mul_f32 v185, s70, v177
    v_mul_f32 v186, s70, v178
    v_mfma_f32_16x16x32_bf16 v[92:95], v[148:151], a[156:159], v[92:95]
    v_mul_f32 v187, s70, v179
    v_mul_f32 v188, s70, v180
    v_mul_f32 v189, s70, v181
    v_mfma_f32_16x16x32_bf16 v[92:95], v[152:155], a[184:187], v[92:95]
    v_mul_f32 v190, s70, v182
    v_mul_f32 v191, s70, v183
    v_mfma_f32_16x16x32_bf16 v[92:95], v[156:159], a[188:191], v[92:95]
    s_add_u32 m0, s53, 33792
    v_exp_f32 v184, v184
    s_waitcnt lgkmcnt(0)
    v_mfma_f32_16x16x32_bf16 v[96:99], v[128:131], a[128:131], v[96:99]
    ds_read_b64_tr_b16 v[144:145], v173 offset:200
    buffer_load_dwordx4 v240, s[16:19], s51 offen offset:0 lds
    v_mfma_f32_16x16x32_bf16 v[96:99], v[132:135], a[132:135], v[96:99]
    ds_read_b64_tr_b16 v[146:147], v173 offset:456
    v_exp_f32 v185, v185
    v_mfma_f32_16x16x32_bf16 v[96:99], v[136:139], a[160:163], v[96:99]
    ds_read_b64_tr_b16 v[148:149], v173 offset:712
    ds_read_b64_tr_b16 v[150:151], v173 offset:968
    ds_read_b64_tr_b16 v[152:153], v173 offset:17096
    v_mfma_f32_16x16x32_bf16 v[96:99], v[140:143], a[164:167], v[96:99]
    ds_read_b64_tr_b16 v[154:155], v173 offset:17352
    ds_read_b64_tr_b16 v[156:157], v173 offset:17608
    ds_read_b64_tr_b16 v[158:159], v173 offset:17864
    v_mfma_f32_16x16x32_bf16 v[100:103], v[128:131], a[136:139], v[100:103]
    v_exp_f32 v186, v186
    v_add_f32 v184, 1.0, v184
    v_mfma_f32_16x16x32_bf16 v[100:103], v[132:135], a[140:143], v[100:103]
    s_add_u32 m0, s53, 34592
    v_exp_f32 v187, v187
    v_mfma_f32_16x16x32_bf16 v[100:103], v[136:139], a[168:171], v[100:103]
    v_exp_f32 v188, v188
    v_add_f32 v185, 1.0, v185
    v_mfma_f32_16x16x32_bf16 v[100:103], v[140:143], a[172:175], v[100:103]
    v_exp_f32 v189, v189
    v_add_f32 v186, 1.0, v186
    v_mfma_f32_16x16x32_bf16 v[104:107], v[128:131], a[144:147], v[104:107]
    v_exp_f32 v190, v190
    v_add_f32 v187, 1.0, v187
    v_mfma_f32_16x16x32_bf16 v[104:107], v[132:135], a[148:151], v[104:107]
    buffer_load_dwordx4 v240, s[16:19], s51 offen offset:256 lds
    v_add_f32 v188, 1.0, v188
    v_mfma_f32_16x16x32_bf16 v[104:107], v[136:139], a[176:179], v[104:107]
    v_exp_f32 v191, v191
    v_add_f32 v189, 1.0, v189
    v_mfma_f32_16x16x32_bf16 v[104:107], v[140:143], a[180:183], v[104:107]
    s_add_u32 m0, s53, 35392
    v_add_f32 v190, 1.0, v190
    v_add_f32 v191, 1.0, v191
    v_mfma_f32_16x16x32_bf16 v[108:111], v[128:131], a[152:155], v[108:111]
    v_rcp_f32 v184, v184
    v_mfma_f32_16x16x32_bf16 v[108:111], v[132:135], a[156:159], v[108:111]
    buffer_load_dwordx4 v240, s[16:19], s51 offen offset:512 lds
    v_mfma_f32_16x16x32_bf16 v[108:111], v[136:139], a[184:187], v[108:111]
    s_waitcnt vmcnt(46) lgkmcnt(0)
    s_barrier
    v_mfma_f32_16x16x32_bf16 v[108:111], v[140:143], a[188:191], v[108:111]
    v_rcp_f32 v185, v185
    v_mfma_f32_16x16x32_bf16 v[112:115], v[144:147], a[128:131], v[112:115]
    ds_read_b64_tr_b16 v[128:129], v173 offset:33792
    v_rcp_f32 v186, v186
    v_mfma_f32_16x16x32_bf16 v[112:115], v[148:151], a[132:135], v[112:115]
    s_add_u32 m0, s53, 36192
    v_rcp_f32 v187, v187
    v_mfma_f32_16x16x32_bf16 v[112:115], v[152:155], a[160:163], v[112:115]
    ds_read_b64_tr_b16 v[130:131], v173 offset:34048
    v_rcp_f32 v188, v188
    v_mfma_f32_16x16x32_bf16 v[112:115], v[156:159], a[164:167], v[112:115]
    ds_read_b64_tr_b16 v[132:133], v173 offset:34304
    v_rcp_f32 v189, v189
    v_mfma_f32_16x16x32_bf16 v[116:119], v[144:147], a[136:139], v[116:119]
    ds_read_b64_tr_b16 v[134:135], v173 offset:34560
    v_rcp_f32 v190, v190
    v_mfma_f32_16x16x32_bf16 v[116:119], v[148:151], a[140:143], v[116:119]
    ds_read_b64_tr_b16 v[136:137], v173 offset:50688
    buffer_load_dwordx4 v240, s[16:19], s51 offen offset:768 lds
    v_mfma_f32_16x16x32_bf16 v[116:119], v[152:155], a[168:171], v[116:119]
    ds_read_b64_tr_b16 v[138:139], v173 offset:50944
    v_rcp_f32 v191, v191
    v_mfma_f32_16x16x32_bf16 v[116:119], v[156:159], a[172:175], v[116:119]
    ds_read_b64_tr_b16 v[140:141], v173 offset:51200
    ds_read_b64_tr_b16 v[142:143], v173 offset:51456
    s_add_u32 s51, s51, 16384
    v_mfma_f32_16x16x32_bf16 v[120:123], v[144:147], a[144:147], v[120:123]
    v_mul_f32 v176, v176, v184
    v_mul_f32 v177, v177, v185
    v_mul_f32 v178, v178, v186
    v_mfma_f32_16x16x32_bf16 v[120:123], v[148:151], a[148:151], v[120:123]
    v_mul_f32 v179, v179, v187
    v_mul_f32 v180, v180, v188
    v_mul_f32 v181, v181, v189
    v_mfma_f32_16x16x32_bf16 v[120:123], v[152:155], a[176:179], v[120:123]
    v_mul_f32 v182, v182, v190
    v_mul_f32 v183, v183, v191
    v_cvt_pk_bf16_f32 v192, v176, v177
    v_mfma_f32_16x16x32_bf16 v[120:123], v[156:159], a[180:183], v[120:123]
    v_cvt_pk_bf16_f32 v193, v178, v179
    v_cvt_pk_bf16_f32 v194, v180, v181
    v_cvt_pk_bf16_f32 v195, v182, v183
    v_mfma_f32_16x16x32_bf16 v[124:127], v[144:147], a[152:155], v[124:127]
    buffer_store_dwordx4 v[192:195], v253, s[24:27], 0 offen offset:3072 sc1
    v_accvgpr_read_b32 v196, a100
    v_mfma_f32_16x16x32_bf16 v[124:127], v[148:151], a[156:159], v[124:127]
    v_accvgpr_read_b32 v197, a101
    v_accvgpr_read_b32 v198, a102
    v_accvgpr_read_b32 v199, a103
    v_mfma_f32_16x16x32_bf16 v[124:127], v[152:155], a[184:187], v[124:127]
    v_accvgpr_read_b32 v200, a116
    v_accvgpr_read_b32 v201, a117
    v_accvgpr_read_b32 v202, a118
    v_mfma_f32_16x16x32_bf16 v[124:127], v[156:159], a[188:191], v[124:127]
    s_waitcnt vmcnt(5)
    v_accvgpr_read_b32 v203, a119
    v_mul_f32 v204, s70, v196
    s_waitcnt lgkmcnt(0)
    v_mfma_f32_16x16x32_bf16 v[0:3], v[128:131], a[192:195], v[0:3]
    v_mul_f32 v205, s70, v197
    v_mul_f32 v206, s70, v198
    v_mul_f32 v207, s70, v199
    v_mfma_f32_16x16x32_bf16 v[0:3], v[132:135], a[196:199], v[0:3]
    s_add_u32 m0, s53, 67584
    v_mul_f32 v208, s70, v200
    v_mul_f32 v209, s70, v201
    v_mfma_f32_16x16x32_bf16 v[0:3], v[136:139], a[224:227], v[0:3]
    buffer_load_dwordx4 v240, s[16:19], s51 offen offset:0 lds
    v_mul_f32 v210, s70, v202
    v_mfma_f32_16x16x32_bf16 v[0:3], v[140:143], a[228:231], v[0:3]
    ds_read_b64_tr_b16 v[144:145], v173 offset:33800
    ds_read_b64_tr_b16 v[146:147], v173 offset:34056
    v_mul_f32 v211, s70, v203
    v_mfma_f32_16x16x32_bf16 v[4:7], v[128:131], a[200:203], v[4:7]
    ds_read_b64_tr_b16 v[148:149], v173 offset:34312
    v_exp_f32 v204, v204
    v_mfma_f32_16x16x32_bf16 v[4:7], v[132:135], a[204:207], v[4:7]
    ds_read_b64_tr_b16 v[150:151], v173 offset:34568
    ds_read_b64_tr_b16 v[152:153], v173 offset:50696
    ds_read_b64_tr_b16 v[154:155], v173 offset:50952
    v_mfma_f32_16x16x32_bf16 v[4:7], v[136:139], a[232:235], v[4:7]
    ds_read_b64_tr_b16 v[156:157], v173 offset:51208
    v_exp_f32 v205, v205
    v_mfma_f32_16x16x32_bf16 v[4:7], v[140:143], a[236:239], v[4:7]
    ds_read_b64_tr_b16 v[158:159], v173 offset:51464
    v_exp_f32 v206, v206
    v_mfma_f32_16x16x32_bf16 v[8:11], v[128:131], a[208:211], v[8:11]
    v_exp_f32 v207, v207
    v_add_f32 v204, 1.0, v204
    v_mfma_f32_16x16x32_bf16 v[8:11], v[132:135], a[212:215], v[8:11]
    v_exp_f32 v208, v208
    v_add_f32 v205, 1.0, v205
    v_mfma_f32_16x16x32_bf16 v[8:11], v[136:139], a[240:243], v[8:11]
    v_exp_f32 v209, v209
    v_add_f32 v206, 1.0, v206
    v_mfma_f32_16x16x32_bf16 v[8:11], v[140:143], a[244:247], v[8:11]
    v_exp_f32 v210, v210
    v_add_f32 v207, 1.0, v207
    v_mfma_f32_16x16x32_bf16 v[12:15], v[128:131], a[216:219], v[12:15]
    v_exp_f32 v211, v211
    v_add_f32 v208, 1.0, v208
    v_mfma_f32_16x16x32_bf16 v[12:15], v[132:135], a[220:223], v[12:15]
    v_add_f32 v209, 1.0, v209
    v_add_f32 v210, 1.0, v210
    v_add_f32 v211, 1.0, v211
    v_mfma_f32_16x16x32_bf16 v[12:15], v[136:139], a[248:251], v[12:15]
    s_add_u32 m0, s53, 68384
    v_rcp_f32 v204, v204
    v_mfma_f32_16x16x32_bf16 v[12:15], v[140:143], a[252:255], v[12:15]
    buffer_load_dwordx4 v240, s[16:19], s51 offen offset:256 lds
    s_waitcnt lgkmcnt(0)
    v_mfma_f32_16x16x32_bf16 v[16:19], v[144:147], a[192:195], v[16:19]
    ds_read_b64_tr_b16 v[128:129], v173 offset:33856
    v_rcp_f32 v205, v205
    v_mfma_f32_16x16x32_bf16 v[16:19], v[148:151], a[196:199], v[16:19]
    ds_read_b64_tr_b16 v[130:131], v173 offset:34112
    v_rcp_f32 v206, v206
    v_mfma_f32_16x16x32_bf16 v[16:19], v[152:155], a[224:227], v[16:19]
    ds_read_b64_tr_b16 v[132:133], v173 offset:34368
    v_rcp_f32 v207, v207
    v_mfma_f32_16x16x32_bf16 v[16:19], v[156:159], a[228:231], v[16:19]
    ds_read_b64_tr_b16 v[134:135], v173 offset:34624
    v_rcp_f32 v208, v208
    v_mfma_f32_16x16x32_bf16 v[20:23], v[144:147], a[200:203], v[20:23]
    ds_read_b64_tr_b16 v[136:137], v173 offset:50752
    v_rcp_f32 v209, v209
    v_mfma_f32_16x16x32_bf16 v[20:23], v[148:151], a[204:207], v[20:23]
    ds_read_b64_tr_b16 v[138:139], v173 offset:51008
    v_rcp_f32 v210, v210
    v_mfma_f32_16x16x32_bf16 v[20:23], v[152:155], a[232:235], v[20:23]
    ds_read_b64_tr_b16 v[140:141], v173 offset:51264
    v_rcp_f32 v211, v211
    v_mfma_f32_16x16x32_bf16 v[20:23], v[156:159], a[236:239], v[20:23]
    ds_read_b64_tr_b16 v[142:143], v173 offset:51520
    v_mul_f32 v196, v196, v204
    v_mul_f32 v197, v197, v205
    v_mfma_f32_16x16x32_bf16 v[24:27], v[144:147], a[208:211], v[24:27]
    v_mul_f32 v198, v198, v206
    v_mul_f32 v199, v199, v207
    v_mul_f32 v200, v200, v208
    v_mfma_f32_16x16x32_bf16 v[24:27], v[148:151], a[212:215], v[24:27]
    v_mul_f32 v201, v201, v209
    v_mul_f32 v202, v202, v210
    v_mul_f32 v203, v203, v211
    v_mfma_f32_16x16x32_bf16 v[24:27], v[152:155], a[240:243], v[24:27]
    v_cvt_pk_bf16_f32 v212, v196, v197
    v_cvt_pk_bf16_f32 v213, v198, v199
    v_cvt_pk_bf16_f32 v214, v200, v201
    v_mfma_f32_16x16x32_bf16 v[24:27], v[156:159], a[244:247], v[24:27]
    v_cvt_pk_bf16_f32 v215, v202, v203
    v_mfma_f32_16x16x32_bf16 v[28:31], v[144:147], a[216:219], v[28:31]
    buffer_store_dwordx4 v[212:215], v253, s[24:27], s62 offen offset:3072 sc1
    v_mfma_f32_16x16x32_bf16 v[28:31], v[148:151], a[220:223], v[28:31]
    s_add_u32 m0, s53, 69184
    v_mfma_f32_16x16x32_bf16 v[28:31], v[152:155], a[248:251], v[28:31]
    buffer_load_dwordx4 v240, s[16:19], s51 offen offset:512 lds
    v_mfma_f32_16x16x32_bf16 v[28:31], v[156:159], a[252:255], v[28:31]
    s_waitcnt lgkmcnt(0)
    v_mfma_f32_16x16x32_bf16 v[32:35], v[128:131], a[192:195], v[32:35]
    v_accvgpr_read_b32 v176, a104
    v_accvgpr_read_b32 v177, a105
    v_accvgpr_read_b32 v178, a106
    v_mfma_f32_16x16x32_bf16 v[32:35], v[132:135], a[196:199], v[32:35]
    v_accvgpr_read_b32 v179, a107
    v_accvgpr_read_b32 v180, a120
    v_accvgpr_read_b32 v181, a121
    v_mfma_f32_16x16x32_bf16 v[32:35], v[136:139], a[224:227], v[32:35]
    ds_read_b64_tr_b16 v[144:145], v173 offset:33864
    v_accvgpr_read_b32 v182, a122
    v_accvgpr_read_b32 v183, a123
    v_mfma_f32_16x16x32_bf16 v[32:35], v[140:143], a[228:231], v[32:35]
    ds_read_b64_tr_b16 v[146:147], v173 offset:34120
    v_mul_f32 v184, s70, v176
    v_mul_f32 v185, s70, v177
    v_mfma_f32_16x16x32_bf16 v[36:39], v[128:131], a[200:203], v[36:39]
    ds_read_b64_tr_b16 v[148:149], v173 offset:34376
    ds_read_b64_tr_b16 v[150:151], v173 offset:34632
    ds_read_b64_tr_b16 v[152:153], v173 offset:50760
    v_mfma_f32_16x16x32_bf16 v[36:39], v[132:135], a[204:207], v[36:39]
    ds_read_b64_tr_b16 v[154:155], v173 offset:51016
    v_mul_f32 v186, s70, v178
    v_mul_f32 v187, s70, v179
    v_mfma_f32_16x16x32_bf16 v[36:39], v[136:139], a[232:235], v[36:39]
    ds_read_b64_tr_b16 v[156:157], v173 offset:51272
    v_mul_f32 v188, s70, v180
    v_mul_f32 v189, s70, v181
    v_mfma_f32_16x16x32_bf16 v[36:39], v[140:143], a[236:239], v[36:39]
    ds_read_b64_tr_b16 v[158:159], v173 offset:51528
    v_mul_f32 v190, s70, v182
    v_mul_f32 v191, s70, v183
    v_mfma_f32_16x16x32_bf16 v[40:43], v[128:131], a[208:211], v[40:43]
    v_exp_f32 v184, v184
    v_mul_f32 v0, s66, v0
    v_mfma_f32_16x16x32_bf16 v[40:43], v[132:135], a[212:215], v[40:43]
    v_exp_f32 v185, v185
    v_mul_f32 v1, s66, v1
    v_mfma_f32_16x16x32_bf16 v[40:43], v[136:139], a[240:243], v[40:43]
    v_exp_f32 v186, v186
    v_mul_f32 v2, s66, v2
    v_mfma_f32_16x16x32_bf16 v[40:43], v[140:143], a[244:247], v[40:43]
    v_exp_f32 v187, v187
    v_mul_f32 v3, s66, v3
    v_mfma_f32_16x16x32_bf16 v[44:47], v[128:131], a[216:219], v[44:47]
    s_add_u32 m0, s53, 69984
    v_exp_f32 v188, v188
    v_mfma_f32_16x16x32_bf16 v[44:47], v[132:135], a[220:223], v[44:47]
    v_exp_f32 v189, v189
    v_add_f32 v184, 1.0, v184
    v_mfma_f32_16x16x32_bf16 v[44:47], v[136:139], a[248:251], v[44:47]
    buffer_load_dwordx4 v240, s[16:19], s51 offen offset:768 lds
    s_add_u32 s51, s51, 16384
    v_mfma_f32_16x16x32_bf16 v[44:47], v[140:143], a[252:255], v[44:47]
    v_exp_f32 v190, v190
    v_add_f32 v185, 1.0, v185
    s_waitcnt lgkmcnt(0)
    v_mfma_f32_16x16x32_bf16 v[48:51], v[144:147], a[192:195], v[48:51]
    v_exp_f32 v191, v191
    v_add_f32 v186, 1.0, v186
    v_mfma_f32_16x16x32_bf16 v[48:51], v[148:151], a[196:199], v[48:51]
    v_mul_f32 v16, s66, v16
    v_mul_f32 v17, s66, v17
    v_mul_f32 v18, s66, v18
    v_mfma_f32_16x16x32_bf16 v[48:51], v[152:155], a[224:227], v[48:51]
    v_mul_f32 v19, s66, v19
    v_add_f32 v187, 1.0, v187
    v_add_f32 v188, 1.0, v188
    v_mfma_f32_16x16x32_bf16 v[48:51], v[156:159], a[228:231], v[48:51]
    ds_read_b64_tr_b16 v[128:129], v173 offset:33920
    v_add_f32 v189, 1.0, v189
    v_add_f32 v190, 1.0, v190
    v_mfma_f32_16x16x32_bf16 v[52:55], v[144:147], a[200:203], v[52:55]
    v_add_f32 v191, 1.0, v191
    v_rcp_f32 v184, v184
    v_mfma_f32_16x16x32_bf16 v[52:55], v[148:151], a[204:207], v[52:55]
    ds_read_b64_tr_b16 v[130:131], v173 offset:34176
    ds_read_b64_tr_b16 v[132:133], v173 offset:34432
    ds_read_b64_tr_b16 v[134:135], v173 offset:34688
    v_mfma_f32_16x16x32_bf16 v[52:55], v[152:155], a[232:235], v[52:55]
    ds_read_b64_tr_b16 v[136:137], v173 offset:50816
    ds_read_b64_tr_b16 v[138:139], v173 offset:51072
    ds_read_b64_tr_b16 v[140:141], v173 offset:51328
    v_mfma_f32_16x16x32_bf16 v[52:55], v[156:159], a[236:239], v[52:55]
    ds_read_b64_tr_b16 v[142:143], v173 offset:51584
    v_cvt_pk_bf16_f32 v0, v0, v1
    v_cvt_pk_bf16_f32 v2, v2, v3
    v_mfma_f32_16x16x32_bf16 v[56:59], v[144:147], a[208:211], v[56:59]
    v_cvt_pk_bf16_f32 v16, v16, v17
    v_cvt_pk_bf16_f32 v18, v18, v19
    v_mul_f32 v4, s66, v4
    v_mfma_f32_16x16x32_bf16 v[56:59], v[148:151], a[212:215], v[56:59]
    v_rcp_f32 v185, v185
    v_mul_f32 v5, s66, v5
    v_mfma_f32_16x16x32_bf16 v[56:59], v[152:155], a[240:243], v[56:59]
    v_rcp_f32 v186, v186
    v_mul_f32 v6, s66, v6
    v_mfma_f32_16x16x32_bf16 v[56:59], v[156:159], a[244:247], v[56:59]
    v_mul_f32 v7, s66, v7
    v_mul_f32 v20, s66, v20
    v_mul_f32 v21, s66, v21
    v_mfma_f32_16x16x32_bf16 v[60:63], v[144:147], a[216:219], v[60:63]
    v_mul_f32 v22, s66, v22
    v_mul_f32 v23, s66, v23
    v_accvgpr_write_b32 a128, v0
    v_mfma_f32_16x16x32_bf16 v[60:63], v[148:151], a[220:223], v[60:63]
    v_rcp_f32 v187, v187
    v_accvgpr_write_b32 a129, v2
    v_mfma_f32_16x16x32_bf16 v[60:63], v[152:155], a[248:251], v[60:63]
    v_accvgpr_write_b32 a130, v16
    v_accvgpr_write_b32 a131, v18
    v_rcp_f32 v188, v188
    v_mfma_f32_16x16x32_bf16 v[60:63], v[156:159], a[252:255], v[60:63]
    v_rcp_f32 v189, v189
    v_cvt_pk_bf16_f32 v4, v4, v5
    s_waitcnt lgkmcnt(0)
    v_mfma_f32_16x16x32_bf16 v[64:67], v[128:131], a[192:195], v[64:67]
    s_add_u32 m0, s53, 84480
    v_cvt_pk_bf16_f32 v6, v6, v7
    v_cvt_pk_bf16_f32 v20, v20, v21
    v_cvt_pk_bf16_f32 v22, v22, v23
    v_rcp_f32 v190, v190
    v_mfma_f32_16x16x32_bf16 v[64:67], v[132:135], a[196:199], v[64:67]
    v_rcp_f32 v191, v191
    v_mul_f32 v8, s66, v8
    v_mfma_f32_16x16x32_bf16 v[64:67], v[136:139], a[224:227], v[64:67]
    buffer_load_dwordx4 v240, s[20:23], s52 offen offset:0 lds
    v_mul_f32 v9, s66, v9
    v_mul_f32 v10, s66, v10
    v_mul_f32 v11, s66, v11
    v_mul_f32 v24, s66, v24
    v_mul_f32 v25, s66, v25
    v_mul_f32 v26, s66, v26
    v_mul_f32 v27, s66, v27
    v_mul_f32 v176, v176, v184
    v_mfma_f32_16x16x32_bf16 v[64:67], v[140:143], a[228:231], v[64:67]
    v_accvgpr_write_b32 a144, v4
    v_accvgpr_write_b32 a145, v6
    v_accvgpr_write_b32 a146, v20
    v_accvgpr_write_b32 a147, v22
    v_mul_f32 v177, v177, v185
    v_mul_f32 v178, v178, v186
    v_mfma_f32_16x16x32_bf16 v[68:71], v[128:131], a[200:203], v[68:71]
    v_mul_f32 v179, v179, v187
    v_mul_f32 v180, v180, v188
    v_cvt_pk_bf16_f32 v8, v8, v9
    v_mfma_f32_16x16x32_bf16 v[68:71], v[132:135], a[204:207], v[68:71]
    v_cvt_pk_bf16_f32 v10, v10, v11
    v_cvt_pk_bf16_f32 v24, v24, v25
    v_cvt_pk_bf16_f32 v26, v26, v27
    v_mul_f32 v181, v181, v189
    v_mul_f32 v182, v182, v190
    v_mfma_f32_16x16x32_bf16 v[68:71], v[136:139], a[232:235], v[68:71]
    v_mul_f32 v183, v183, v191
    v_cvt_pk_bf16_f32 v192, v176, v177
    v_mul_f32 v12, s66, v12
    v_mfma_f32_16x16x32_bf16 v[68:71], v[140:143], a[236:239], v[68:71]
    v_mul_f32 v13, s66, v13
    v_mul_f32 v14, s66, v14
    v_mul_f32 v15, s66, v15
    v_mul_f32 v28, s66, v28
    v_mul_f32 v29, s66, v29
    v_mul_f32 v30, s66, v30
    v_mul_f32 v31, s66, v31
    v_cvt_pk_bf16_f32 v193, v178, v179
    v_cvt_pk_bf16_f32 v194, v180, v181
    v_mfma_f32_16x16x32_bf16 v[72:75], v[128:131], a[208:211], v[72:75]
    v_accvgpr_write_b32 a160, v8
    v_accvgpr_write_b32 a161, v10
    v_accvgpr_write_b32 a162, v24
    v_accvgpr_write_b32 a163, v26
    v_cvt_pk_bf16_f32 v195, v182, v183
    v_mfma_f32_16x16x32_bf16 v[72:75], v[132:135], a[212:215], v[72:75]
    buffer_store_dwordx4 v[192:195], v253, s[24:27], s63 offen offset:3072 sc1
    v_cvt_pk_bf16_f32 v12, v12, v13
    v_mfma_f32_16x16x32_bf16 v[72:75], v[136:139], a[240:243], v[72:75]
    ds_read_b64_tr_b16 v[144:145], v173 offset:33928
    ds_read_b64_tr_b16 v[146:147], v173 offset:34184
    ds_read_b64_tr_b16 v[148:149], v173 offset:34440
    ds_read_b64_tr_b16 v[150:151], v173 offset:34696
    ds_read_b64_tr_b16 v[152:153], v173 offset:50824
    ds_read_b64_tr_b16 v[154:155], v173 offset:51080
    ds_read_b64_tr_b16 v[156:157], v173 offset:51336
    ds_read_b64_tr_b16 v[158:159], v173 offset:51592
    v_cvt_pk_bf16_f32 v14, v14, v15
    v_cvt_pk_bf16_f32 v28, v28, v29
    v_cvt_pk_bf16_f32 v30, v30, v31
    v_accvgpr_read_b32 v196, a108
    v_accvgpr_read_b32 v197, a109
    v_mfma_f32_16x16x32_bf16 v[72:75], v[140:143], a[244:247], v[72:75]
    v_accvgpr_read_b32 v198, a110
    v_accvgpr_read_b32 v199, a111
    v_accvgpr_read_b32 v200, a124
    v_mfma_f32_16x16x32_bf16 v[76:79], v[128:131], a[216:219], v[76:79]
    v_accvgpr_read_b32 v201, a125
    v_accvgpr_write_b32 a176, v12
    v_accvgpr_write_b32 a177, v14
    v_mfma_f32_16x16x32_bf16 v[76:79], v[132:135], a[220:223], v[76:79]
    v_accvgpr_write_b32 a178, v28
    v_accvgpr_write_b32 a179, v30
    v_accvgpr_read_b32 v202, a126
    v_accvgpr_read_b32 v203, a127
    v_mfma_f32_16x16x32_bf16 v[76:79], v[136:139], a[248:251], v[76:79]
    v_mul_f32 v204, s70, v196
    v_mul_f32 v205, s70, v197
    v_mul_f32 v206, s70, v198
    v_mfma_f32_16x16x32_bf16 v[76:79], v[140:143], a[252:255], v[76:79]
    s_add_u32 m0, s53, 85280
    v_mul_f32 v207, s70, v199
    v_mul_f32 v208, s70, v200
    s_waitcnt lgkmcnt(6)
    v_mfma_f32_16x16x32_bf16 v[80:83], v[144:147], a[192:195], v[80:83]
    v_mul_f32 v209, s70, v201
    v_mul_f32 v210, s70, v202
    v_mul_f32 v211, s70, v203
    s_waitcnt lgkmcnt(0)
    v_mfma_f32_16x16x32_bf16 v[80:83], v[148:151], a[196:199], v[80:83]
    buffer_load_dwordx4 v240, s[20:23], s52 offen offset:256 lds
    v_mul_f32 v32, s66, v32
    v_mfma_f32_16x16x32_bf16 v[80:83], v[152:155], a[224:227], v[80:83]
    v_exp_f32 v204, v204
    v_mul_f32 v33, s66, v33
    v_mfma_f32_16x16x32_bf16 v[80:83], v[156:159], a[228:231], v[80:83]
    v_exp_f32 v205, v205
    v_mul_f32 v34, s66, v34
    v_mfma_f32_16x16x32_bf16 v[84:87], v[144:147], a[200:203], v[84:87]
    v_exp_f32 v206, v206
    v_mul_f32 v35, s66, v35
    v_mfma_f32_16x16x32_bf16 v[84:87], v[148:151], a[204:207], v[84:87]
    v_exp_f32 v207, v207
    v_mul_f32 v48, s66, v48
    v_mfma_f32_16x16x32_bf16 v[84:87], v[152:155], a[232:235], v[84:87]
    v_exp_f32 v208, v208
    v_mul_f32 v49, s66, v49
    v_mfma_f32_16x16x32_bf16 v[84:87], v[156:159], a[236:239], v[84:87]
    v_exp_f32 v209, v209
    v_mul_f32 v50, s66, v50
    v_mfma_f32_16x16x32_bf16 v[88:91], v[144:147], a[208:211], v[88:91]
    v_mul_f32 v51, s66, v51
    v_exp_f32 v210, v210
    v_mfma_f32_16x16x32_bf16 v[88:91], v[148:151], a[212:215], v[88:91]
    ds_read_b64_tr_b16 v[128:129], v173 offset:33984
    v_exp_f32 v211, v211
    v_mfma_f32_16x16x32_bf16 v[88:91], v[152:155], a[240:243], v[88:91]
    ds_read_b64_tr_b16 v[130:131], v173 offset:34240
    ds_read_b64_tr_b16 v[132:133], v173 offset:34496
    ds_read_b64_tr_b16 v[134:135], v173 offset:34752
    ds_read_b64_tr_b16 v[136:137], v173 offset:50880
    ds_read_b64_tr_b16 v[138:139], v173 offset:51136
    ds_read_b64_tr_b16 v[140:141], v173 offset:51392
    ds_read_b64_tr_b16 v[142:143], v173 offset:51648
    v_add_f32 v204, 1.0, v204
    v_add_f32 v205, 1.0, v205
    v_mfma_f32_16x16x32_bf16 v[88:91], v[156:159], a[244:247], v[88:91]
    v_cvt_pk_bf16_f32 v32, v32, v33
    v_cvt_pk_bf16_f32 v34, v34, v35
    v_cvt_pk_bf16_f32 v48, v48, v49
    v_cvt_pk_bf16_f32 v50, v50, v51
    v_add_f32 v206, 1.0, v206
    v_mfma_f32_16x16x32_bf16 v[92:95], v[144:147], a[216:219], v[92:95]
    v_add_f32 v207, 1.0, v207
    v_add_f32 v208, 1.0, v208
    v_mul_f32 v36, s66, v36
    v_mfma_f32_16x16x32_bf16 v[92:95], v[148:151], a[220:223], v[92:95]
    v_mul_f32 v37, s66, v37
    v_mul_f32 v38, s66, v38
    v_mul_f32 v39, s66, v39
    v_mul_f32 v52, s66, v52
    v_mul_f32 v53, s66, v53
    v_mul_f32 v54, s66, v54
    v_mul_f32 v55, s66, v55
    v_add_f32 v209, 1.0, v209
    v_add_f32 v210, 1.0, v210
    v_mfma_f32_16x16x32_bf16 v[92:95], v[152:155], a[248:251], v[92:95]
    s_add_u32 m0, s53, 86080
    v_accvgpr_write_b32 a132, v32
    v_accvgpr_write_b32 a133, v34
    v_accvgpr_write_b32 a134, v48
    v_accvgpr_write_b32 a135, v50
    v_add_f32 v211, 1.0, v211
    v_rcp_f32 v204, v204
    v_mfma_f32_16x16x32_bf16 v[92:95], v[156:159], a[252:255], v[92:95]
    v_rcp_f32 v205, v205
    v_cvt_pk_bf16_f32 v36, v36, v37
    s_waitcnt lgkmcnt(6)
    v_mfma_f32_16x16x32_bf16 v[96:99], v[128:131], a[192:195], v[96:99]
    buffer_load_dwordx4 v240, s[20:23], s52 offen offset:512 lds
    v_cvt_pk_bf16_f32 v38, v38, v39
    v_cvt_pk_bf16_f32 v52, v52, v53
    v_cvt_pk_bf16_f32 v54, v54, v55
    v_rcp_f32 v206, v206
    s_waitcnt lgkmcnt(0)
    v_mfma_f32_16x16x32_bf16 v[96:99], v[132:135], a[196:199], v[96:99]
    v_rcp_f32 v207, v207
    v_mul_f32 v40, s66, v40
    v_mfma_f32_16x16x32_bf16 v[96:99], v[136:139], a[224:227], v[96:99]
    v_mul_f32 v41, s66, v41
    v_mul_f32 v42, s66, v42
    v_mul_f32 v43, s66, v43
    v_mul_f32 v56, s66, v56
    v_mul_f32 v57, s66, v57
    v_mul_f32 v58, s66, v58
    v_mul_f32 v59, s66, v59
    v_rcp_f32 v208, v208
    v_mfma_f32_16x16x32_bf16 v[96:99], v[140:143], a[228:231], v[96:99]
    v_accvgpr_write_b32 a148, v36
    v_accvgpr_write_b32 a149, v38
    v_accvgpr_write_b32 a150, v52
    v_accvgpr_write_b32 a151, v54
    v_rcp_f32 v209, v209
    v_mfma_f32_16x16x32_bf16 v[100:103], v[128:131], a[200:203], v[100:103]
    v_rcp_f32 v210, v210
    v_cvt_pk_bf16_f32 v40, v40, v41
    v_mfma_f32_16x16x32_bf16 v[100:103], v[132:135], a[204:207], v[100:103]
    v_cvt_pk_bf16_f32 v42, v42, v43
    v_cvt_pk_bf16_f32 v56, v56, v57
    v_cvt_pk_bf16_f32 v58, v58, v59
    v_rcp_f32 v211, v211
    v_mfma_f32_16x16x32_bf16 v[100:103], v[136:139], a[232:235], v[100:103]
    v_mul_f32 v196, v196, v204
    v_mul_f32 v44, s66, v44
    v_mul_f32 v45, s66, v45
    v_mfma_f32_16x16x32_bf16 v[100:103], v[140:143], a[236:239], v[100:103]
    ds_read_b64_tr_b16 v[144:145], v173 offset:33992
    ds_read_b64_tr_b16 v[146:147], v173 offset:34248
    ds_read_b64_tr_b16 v[148:149], v173 offset:34504
    ds_read_b64_tr_b16 v[150:151], v173 offset:34760
    ds_read_b64_tr_b16 v[152:153], v173 offset:50888
    ds_read_b64_tr_b16 v[154:155], v173 offset:51144
    ds_read_b64_tr_b16 v[156:157], v173 offset:51400
    ds_read_b64_tr_b16 v[158:159], v173 offset:51656
    v_mul_f32 v46, s66, v46
    v_mul_f32 v47, s66, v47
    v_mul_f32 v60, s66, v60
    v_mul_f32 v61, s66, v61
    v_mul_f32 v62, s66, v62
    v_mul_f32 v63, s66, v63
    v_mul_f32 v197, v197, v205
    v_mul_f32 v198, v198, v206
    v_mfma_f32_16x16x32_bf16 v[104:107], v[128:131], a[208:211], v[104:107]
    v_accvgpr_write_b32 a164, v40
    v_accvgpr_write_b32 a165, v42
    v_accvgpr_write_b32 a166, v56
    v_accvgpr_write_b32 a167, v58
    v_mul_f32 v199, v199, v207
    v_mul_f32 v200, v200, v208
    v_mfma_f32_16x16x32_bf16 v[104:107], v[132:135], a[212:215], v[104:107]
    v_mul_f32 v201, v201, v209
    v_mul_f32 v202, v202, v210
    v_cvt_pk_bf16_f32 v44, v44, v45
    v_mfma_f32_16x16x32_bf16 v[104:107], v[136:139], a[240:243], v[104:107]
    v_cvt_pk_bf16_f32 v46, v46, v47
    v_cvt_pk_bf16_f32 v60, v60, v61
    v_cvt_pk_bf16_f32 v62, v62, v63
    v_mul_f32 v203, v203, v211
    v_cvt_pk_bf16_f32 v212, v196, v197
    v_mfma_f32_16x16x32_bf16 v[104:107], v[140:143], a[244:247], v[104:107]
    v_cvt_pk_bf16_f32 v213, v198, v199
    v_cvt_pk_bf16_f32 v214, v200, v201
    v_cvt_pk_bf16_f32 v215, v202, v203
    v_mfma_f32_16x16x32_bf16 v[108:111], v[128:131], a[216:219], v[108:111]
    v_accvgpr_write_b32 a180, v44
    v_accvgpr_write_b32 a181, v46
    v_accvgpr_write_b32 a182, v60
    v_mfma_f32_16x16x32_bf16 v[108:111], v[132:135], a[220:223], v[108:111]
    s_add_u32 m0, s53, 86880
    v_accvgpr_write_b32 a183, v62
    v_mul_f32 v64, s66, v64
    v_mfma_f32_16x16x32_bf16 v[108:111], v[136:139], a[248:251], v[108:111]
    s_waitcnt vmcnt(33) lgkmcnt(0)
    s_barrier
    buffer_store_dwordx4 v[212:215], v253, s[24:27], s64 offen offset:3072 sc1
    v_mfma_f32_16x16x32_bf16 v[108:111], v[140:143], a[252:255], v[108:111]
    buffer_load_dwordx4 v240, s[20:23], s52 offen offset:768 lds
    s_add_u32 s52, s52, 16384
    v_mfma_f32_16x16x32_bf16 v[112:115], v[144:147], a[192:195], v[112:115]
    v_mul_f32 v65, s66, v65
    v_mul_f32 v66, s66, v66
    v_mul_f32 v67, s66, v67
    v_mfma_f32_16x16x32_bf16 v[112:115], v[148:151], a[196:199], v[112:115]
    v_mul_f32 v80, s66, v80
    v_mul_f32 v81, s66, v81
    v_mul_f32 v82, s66, v82
    v_mfma_f32_16x16x32_bf16 v[112:115], v[152:155], a[224:227], v[112:115]
    v_mul_f32 v83, s66, v83
    v_mul_f32 v68, s66, v68
    v_mul_f32 v69, s66, v69
    v_mfma_f32_16x16x32_bf16 v[112:115], v[156:159], a[228:231], v[112:115]
    v_mul_f32 v70, s66, v70
    v_mul_f32 v71, s66, v71
    v_mul_f32 v84, s66, v84
    v_mfma_f32_16x16x32_bf16 v[116:119], v[144:147], a[200:203], v[116:119]
    v_mul_f32 v85, s66, v85
    v_mul_f32 v86, s66, v86
    v_mul_f32 v87, s66, v87
    v_mfma_f32_16x16x32_bf16 v[116:119], v[148:151], a[204:207], v[116:119]
    v_mul_f32 v72, s66, v72
    v_mul_f32 v73, s66, v73
    v_mul_f32 v74, s66, v74
    v_mfma_f32_16x16x32_bf16 v[116:119], v[152:155], a[232:235], v[116:119]
    v_mul_f32 v75, s66, v75
    v_mul_f32 v88, s66, v88
    v_mul_f32 v89, s66, v89
    v_mul_f32 v90, s66, v90
    v_mul_f32 v91, s66, v91
    v_mfma_f32_16x16x32_bf16 v[116:119], v[156:159], a[236:239], v[116:119]
    v_mul_f32 v76, s66, v76
    v_mul_f32 v77, s66, v77
    v_mul_f32 v78, s66, v78
    v_mul_f32 v79, s66, v79
    v_mul_f32 v92, s66, v92
    v_mul_f32 v93, s66, v93
    v_mul_f32 v94, s66, v94
    v_mul_f32 v95, s66, v95
    v_mfma_f32_16x16x32_bf16 v[120:123], v[144:147], a[208:211], v[120:123]
    v_cvt_pk_bf16_f32 v64, v64, v65
    v_cvt_pk_bf16_f32 v66, v66, v67
    v_cvt_pk_bf16_f32 v80, v80, v81
    v_mfma_f32_16x16x32_bf16 v[120:123], v[148:151], a[212:215], v[120:123]
    v_cvt_pk_bf16_f32 v82, v82, v83
    v_cvt_pk_bf16_f32 v68, v68, v69
    v_cvt_pk_bf16_f32 v70, v70, v71
    v_cvt_pk_bf16_f32 v84, v84, v85
    v_cvt_pk_bf16_f32 v86, v86, v87
    v_cvt_pk_bf16_f32 v72, v72, v73
    v_cvt_pk_bf16_f32 v74, v74, v75
    v_cvt_pk_bf16_f32 v88, v88, v89
    v_cvt_pk_bf16_f32 v90, v90, v91
    v_cvt_pk_bf16_f32 v76, v76, v77
    v_cvt_pk_bf16_f32 v78, v78, v79
    v_cvt_pk_bf16_f32 v92, v92, v93
    v_cvt_pk_bf16_f32 v94, v94, v95
    v_mfma_f32_16x16x32_bf16 v[120:123], v[152:155], a[240:243], v[120:123]
    v_accvgpr_write_b32 a136, v64
    v_accvgpr_write_b32 a137, v66
    v_accvgpr_write_b32 a138, v80
    v_mfma_f32_16x16x32_bf16 v[120:123], v[156:159], a[244:247], v[120:123]
    v_accvgpr_write_b32 a139, v82
    v_accvgpr_write_b32 a152, v68
    v_accvgpr_write_b32 a153, v70
    v_mfma_f32_16x16x32_bf16 v[124:127], v[144:147], a[216:219], v[124:127]
    v_accvgpr_write_b32 a154, v84
    v_accvgpr_write_b32 a155, v86
    v_accvgpr_write_b32 a168, v72
    v_accvgpr_write_b32 a169, v74
    v_accvgpr_write_b32 a170, v88
    v_accvgpr_write_b32 a171, v90
    v_accvgpr_write_b32 a184, v76
    v_accvgpr_write_b32 a185, v78
    v_accvgpr_write_b32 a186, v92
    v_accvgpr_write_b32 a187, v94
    v_mfma_f32_16x16x32_bf16 v[124:127], v[148:151], a[220:223], v[124:127]
    v_mfma_f32_16x16x32_bf16 v[124:127], v[152:155], a[248:251], v[124:127]
    v_mfma_f32_16x16x32_bf16 v[124:127], v[156:159], a[252:255], v[124:127]
    ds_read_b128 a[192:195], v236 offset:0
    ds_read_b128 a[196:199], v236 offset:64
    ds_read_b128 a[200:203], v236 offset:128
    ds_read_b128 a[204:207], v236 offset:192
    ds_read_b128 a[208:211], v236 offset:256
    ds_read_b128 a[212:215], v236 offset:320
    ds_read_b128 a[216:219], v236 offset:384
    ds_read_b128 a[220:223], v236 offset:448
    s_nop 7
    v_pk_mul_f32 v[96:97], v[96:97], s[66:67]
    v_pk_mul_f32 v[98:99], v[98:99], s[66:67]
    v_cvt_pk_bf16_f32 v96, v96, v97
    v_cvt_pk_bf16_f32 v97, v98, v99
    v_accvgpr_write_b32 a140, v96
    v_accvgpr_write_b32 a141, v97
    v_pk_mul_f32 v[112:113], v[112:113], s[66:67]
    v_pk_mul_f32 v[114:115], v[114:115], s[66:67]
    v_cvt_pk_bf16_f32 v112, v112, v113
    v_cvt_pk_bf16_f32 v113, v114, v115
    v_accvgpr_write_b32 a142, v112
    v_accvgpr_write_b32 a143, v113
    v_pk_mul_f32 v[100:101], v[100:101], s[66:67]
    v_pk_mul_f32 v[102:103], v[102:103], s[66:67]
    v_cvt_pk_bf16_f32 v100, v100, v101
    v_cvt_pk_bf16_f32 v101, v102, v103
    v_accvgpr_write_b32 a156, v100
    v_accvgpr_write_b32 a157, v101
    v_pk_mul_f32 v[116:117], v[116:117], s[66:67]
    v_pk_mul_f32 v[118:119], v[118:119], s[66:67]
    v_cvt_pk_bf16_f32 v116, v116, v117
    v_cvt_pk_bf16_f32 v117, v118, v119
    v_accvgpr_write_b32 a158, v116
    v_accvgpr_write_b32 a159, v117
    v_pk_mul_f32 v[104:105], v[104:105], s[66:67]
    v_pk_mul_f32 v[106:107], v[106:107], s[66:67]
    v_cvt_pk_bf16_f32 v104, v104, v105
    v_cvt_pk_bf16_f32 v105, v106, v107
    v_accvgpr_write_b32 a172, v104
    v_accvgpr_write_b32 a173, v105
    v_pk_mul_f32 v[120:121], v[120:121], s[66:67]
    v_pk_mul_f32 v[122:123], v[122:123], s[66:67]
    v_cvt_pk_bf16_f32 v120, v120, v121
    v_cvt_pk_bf16_f32 v121, v122, v123
    v_accvgpr_write_b32 a174, v120
    v_accvgpr_write_b32 a175, v121
    v_pk_mul_f32 v[108:109], v[108:109], s[66:67]
    v_pk_mul_f32 v[110:111], v[110:111], s[66:67]
    v_cvt_pk_bf16_f32 v108, v108, v109
    v_cvt_pk_bf16_f32 v109, v110, v111
    v_accvgpr_write_b32 a188, v108
    v_accvgpr_write_b32 a189, v109
    v_pk_mul_f32 v[124:125], v[124:125], s[66:67]
    v_pk_mul_f32 v[126:127], v[126:127], s[66:67]
    v_cvt_pk_bf16_f32 v124, v124, v125
    v_cvt_pk_bf16_f32 v125, v126, v127
    v_accvgpr_write_b32 a190, v124
    v_accvgpr_write_b32 a191, v125
    s_and_b32 s56, s2, 3
    s_mov_b32 s26, 14680064
    s_mul_i32 s48, s56, 28672
    s_lshl_b32 s49, s48, 6
    s_lshl_b32 s50, s56, 15
    s_lshl_b32 s66, s50, 6
    s_lshl_b32 s58, s57, 5
    s_add_u32 s58, s58, s3
    s_lshl_b32 s58, s58, 2
    s_add_u32 s58, s58, s54
    s_mul_i32 s58, s58, 24576
    s_add_u32 s58, s58, 67108864
    v_add_u32 v253, s58, v243
    s_mov_b32 s62, 0
    s_nop 1
    s_waitcnt lgkmcnt(7)
    v_mfma_f32_16x16x32_bf16 v[0:3], a[192:195], a[128:131], 0
    s_add_u32 m0, s53, 101376
    s_waitcnt lgkmcnt(6)
    v_mfma_f32_16x16x32_bf16 v[0:3], a[196:199], a[132:135], v[0:3]
    buffer_load_dwordx4 v240, s[16:19], s51 offen offset:0 lds
    s_waitcnt lgkmcnt(5)
    v_mfma_f32_16x16x32_bf16 v[0:3], a[200:203], a[136:139], v[0:3]
    s_waitcnt lgkmcnt(4)
    v_mfma_f32_16x16x32_bf16 v[0:3], a[204:207], a[140:143], v[0:3]
    v_mfma_f32_16x16x32_bf16 v[4:7], a[192:195], a[144:147], 0
    v_mfma_f32_16x16x32_bf16 v[4:7], a[196:199], a[148:151], v[4:7]
    v_mfma_f32_16x16x32_bf16 v[4:7], a[200:203], a[152:155], v[4:7]
    s_add_u32 m0, s53, 102176
    v_mfma_f32_16x16x32_bf16 v[4:7], a[204:207], a[156:159], v[4:7]
    buffer_load_dwordx4 v240, s[16:19], s51 offen offset:256 lds
    v_mfma_f32_16x16x32_bf16 v[8:11], a[192:195], a[160:163], 0
    v_mfma_f32_16x16x32_bf16 v[8:11], a[196:199], a[164:167], v[8:11]
    v_mfma_f32_16x16x32_bf16 v[8:11], a[200:203], a[168:171], v[8:11]
    v_mfma_f32_16x16x32_bf16 v[8:11], a[204:207], a[172:175], v[8:11]
    v_mfma_f32_16x16x32_bf16 v[12:15], a[192:195], a[176:179], 0
    v_mfma_f32_16x16x32_bf16 v[12:15], a[196:199], a[180:183], v[12:15]
    s_add_u32 m0, s53, 102976
    v_mfma_f32_16x16x32_bf16 v[12:15], a[200:203], a[184:187], v[12:15]
    buffer_load_dwordx4 v240, s[16:19], s51 offen offset:512 lds
    v_mfma_f32_16x16x32_bf16 v[12:15], a[204:207], a[188:191], v[12:15]
    ds_read_b128 a[192:195], v236 offset:512
    ds_read_b128 a[196:199], v236 offset:576
    s_waitcnt lgkmcnt(2)
    v_mfma_f32_16x16x32_bf16 v[16:19], a[208:211], a[128:131], 0
    ds_read_b128 a[200:203], v236 offset:640
    ds_read_b128 a[204:207], v236 offset:704
    v_mfma_f32_16x16x32_bf16 v[16:19], a[212:215], a[132:135], v[16:19]
    v_mfma_f32_16x16x32_bf16 v[16:19], a[216:219], a[136:139], v[16:19]
    v_mfma_f32_16x16x32_bf16 v[16:19], a[220:223], a[140:143], v[16:19]
    v_mfma_f32_16x16x32_bf16 v[20:23], a[208:211], a[144:147], 0
    s_add_u32 m0, s53, 103776
    v_mfma_f32_16x16x32_bf16 v[20:23], a[212:215], a[148:151], v[20:23]
    buffer_load_dwordx4 v240, s[16:19], s51 offen offset:768 lds
    v_mfma_f32_16x16x32_bf16 v[20:23], a[216:219], a[152:155], v[20:23]
    s_add_u32 s51, s51, 16384
    v_mfma_f32_16x16x32_bf16 v[20:23], a[220:223], a[156:159], v[20:23]
    v_mfma_f32_16x16x32_bf16 v[24:27], a[208:211], a[160:163], 0
    v_mfma_f32_16x16x32_bf16 v[24:27], a[212:215], a[164:167], v[24:27]
    v_mfma_f32_16x16x32_bf16 v[24:27], a[216:219], a[168:171], v[24:27]
    v_mfma_f32_16x16x32_bf16 v[24:27], a[220:223], a[172:175], v[24:27]
    s_add_u32 m0, s53, 118272
    v_mfma_f32_16x16x32_bf16 v[28:31], a[208:211], a[176:179], 0
    buffer_load_dwordx4 v240, s[20:23], s52 offen offset:0 lds
    v_mfma_f32_16x16x32_bf16 v[28:31], a[212:215], a[180:183], v[28:31]
    v_mfma_f32_16x16x32_bf16 v[28:31], a[216:219], a[184:187], v[28:31]
    v_mfma_f32_16x16x32_bf16 v[28:31], a[220:223], a[188:191], v[28:31]
    ds_read_b128 a[208:211], v236 offset:768
    ds_read_b128 a[212:215], v236 offset:832
    s_waitcnt lgkmcnt(2)
    v_mfma_f32_16x16x32_bf16 v[32:35], a[192:195], a[128:131], 0
    ds_read_b128 a[216:219], v236 offset:896
    ds_read_b128 a[220:223], v236 offset:960
    v_mfma_f32_16x16x32_bf16 v[32:35], a[196:199], a[132:135], v[32:35]
    v_mfma_f32_16x16x32_bf16 v[32:35], a[200:203], a[136:139], v[32:35]
    s_add_u32 m0, s53, 119072
    v_mfma_f32_16x16x32_bf16 v[32:35], a[204:207], a[140:143], v[32:35]
    buffer_load_dwordx4 v240, s[20:23], s52 offen offset:256 lds
    v_mfma_f32_16x16x32_bf16 v[36:39], a[192:195], a[144:147], 0
    v_mfma_f32_16x16x32_bf16 v[36:39], a[196:199], a[148:151], v[36:39]
    v_mfma_f32_16x16x32_bf16 v[36:39], a[200:203], a[152:155], v[36:39]
    v_mfma_f32_16x16x32_bf16 v[36:39], a[204:207], a[156:159], v[36:39]
    v_mfma_f32_16x16x32_bf16 v[40:43], a[192:195], a[160:163], 0
    v_mfma_f32_16x16x32_bf16 v[40:43], a[196:199], a[164:167], v[40:43]
    s_add_u32 m0, s53, 119872
    v_mfma_f32_16x16x32_bf16 v[40:43], a[200:203], a[168:171], v[40:43]
    buffer_load_dwordx4 v240, s[20:23], s52 offen offset:512 lds
    v_mfma_f32_16x16x32_bf16 v[40:43], a[204:207], a[172:175], v[40:43]
    v_mfma_f32_16x16x32_bf16 v[44:47], a[192:195], a[176:179], 0
    s_waitcnt vmcnt(19) lgkmcnt(0)
    s_barrier
    v_mfma_f32_16x16x32_bf16 v[44:47], a[196:199], a[180:183], v[44:47]
    v_mfma_f32_16x16x32_bf16 v[44:47], a[200:203], a[184:187], v[44:47]
    v_mfma_f32_16x16x32_bf16 v[44:47], a[204:207], a[188:191], v[44:47]
    ds_read_b128 a[192:195], v236 offset:33792
    ds_read_b128 a[196:199], v236 offset:33856
    v_mfma_f32_16x16x32_bf16 v[48:51], a[208:211], a[128:131], 0
    ds_read_b128 a[200:203], v236 offset:33920
    s_add_u32 m0, s53, 120672
    v_mfma_f32_16x16x32_bf16 v[48:51], a[212:215], a[132:135], v[48:51]
    buffer_load_dwordx4 v240, s[20:23], s52 offen offset:768 lds
    v_mfma_f32_16x16x32_bf16 v[48:51], a[216:219], a[136:139], v[48:51]
    ds_read_b128 a[204:207], v236 offset:33984
    s_add_u32 s52, s52, 16384
    v_mfma_f32_16x16x32_bf16 v[48:51], a[220:223], a[140:143], v[48:51]
    v_mfma_f32_16x16x32_bf16 v[52:55], a[208:211], a[144:147], 0
    v_mfma_f32_16x16x32_bf16 v[52:55], a[212:215], a[148:151], v[52:55]
    v_mfma_f32_16x16x32_bf16 v[52:55], a[216:219], a[152:155], v[52:55]
    v_mfma_f32_16x16x32_bf16 v[52:55], a[220:223], a[156:159], v[52:55]
    v_mfma_f32_16x16x32_bf16 v[56:59], a[208:211], a[160:163], 0
    v_mfma_f32_16x16x32_bf16 v[56:59], a[212:215], a[164:167], v[56:59]
    v_mfma_f32_16x16x32_bf16 v[56:59], a[216:219], a[168:171], v[56:59]
    v_mfma_f32_16x16x32_bf16 v[56:59], a[220:223], a[172:175], v[56:59]
    v_mfma_f32_16x16x32_bf16 v[60:63], a[208:211], a[176:179], 0
    v_mfma_f32_16x16x32_bf16 v[60:63], a[212:215], a[180:183], v[60:63]
    v_mfma_f32_16x16x32_bf16 v[60:63], a[216:219], a[184:187], v[60:63]
    v_mfma_f32_16x16x32_bf16 v[60:63], a[220:223], a[188:191], v[60:63]
    s_nop 7
    v_max3_f32 v228, v0, v1, v2
    v_max3_f32 v228, v228, v3, v16
    v_max3_f32 v228, v228, v17, v18
    v_max3_f32 v228, v228, v19, v32
    v_max3_f32 v228, v228, v33, v34
    v_max3_f32 v228, v228, v35, v48
    v_max3_f32 v228, v228, v49, v50
    v_max_f32 v228, v228, v51
    v_max3_f32 v229, v4, v5, v6
    v_max3_f32 v229, v229, v7, v20
    v_max3_f32 v229, v229, v21, v22
    v_max3_f32 v229, v229, v23, v36
    v_max3_f32 v229, v229, v37, v38
    v_max3_f32 v229, v229, v39, v52
    v_max3_f32 v229, v229, v53, v54
    v_max_f32 v229, v229, v55
    v_max3_f32 v230, v8, v9, v10
    v_max3_f32 v230, v230, v11, v24
    v_max3_f32 v230, v230, v25, v26
    v_max3_f32 v230, v230, v27, v40
    v_max3_f32 v230, v230, v41, v42
    v_max3_f32 v230, v230, v43, v56
    v_max3_f32 v230, v230, v57, v58
    v_max_f32 v230, v230, v59
    v_max3_f32 v231, v12, v13, v14
    v_max3_f32 v231, v231, v15, v28
    v_max3_f32 v231, v231, v29, v30
    v_max3_f32 v231, v231, v31, v44
    v_max3_f32 v231, v231, v45, v46
    v_max3_f32 v231, v231, v47, v60
    v_max3_f32 v231, v231, v61, v62
    v_max_f32 v231, v231, v63
    v_mov_b32 v232, v228
    v_mov_b32 v233, v229
    v_mov_b32 v234, v230
    v_mov_b32 v235, v231
    s_nop 1
    v_permlane16_swap_b32 v228, v232
    v_permlane16_swap_b32 v229, v233
    v_permlane16_swap_b32 v230, v234
    v_permlane16_swap_b32 v231, v235
    v_max_f32 v228, v228, v232
    v_max_f32 v229, v229, v233
    v_max_f32 v230, v230, v234
    v_max_f32 v231, v231, v235
    v_mov_b32 v232, v228
    v_mov_b32 v233, v229
    v_mov_b32 v234, v230
    v_mov_b32 v235, v231
    s_nop 1
    v_permlane32_swap_b32 v228, v232
    v_permlane32_swap_b32 v229, v233
    v_permlane32_swap_b32 v230, v234
    v_permlane32_swap_b32 v231, v235
    v_max_f32 v228, v228, v232
    v_max_f32 v229, v229, v233
    v_max_f32 v230, v230, v234
    v_max_f32 v231, v231, v235
    v_add_f32 v228, 0x42c40000, v228
    v_add_f32 v229, 0x42c40000, v229
    v_add_f32 v230, 0x42c40000, v230
    v_add_f32 v231, 0x42c40000, v231
    v_sub_f32 v192, 0, v228
    v_sub_f32 v193, 0, v228
    v_sub_f32 v194, 0, v228
    v_sub_f32 v195, 0, v228
    v_sub_f32 v196, 0, v229
    v_sub_f32 v197, 0, v229
    v_sub_f32 v198, 0, v229
    v_sub_f32 v199, 0, v229
    v_sub_f32 v200, 0, v230
    v_sub_f32 v201, 0, v230
    v_sub_f32 v202, 0, v230
    v_sub_f32 v203, 0, v230
    v_sub_f32 v204, 0, v231
    v_sub_f32 v205, 0, v231
    v_sub_f32 v206, 0, v231
    v_sub_f32 v207, 0, v231
    v_sub_f32 v0, v0, v228
    v_sub_f32 v1, v1, v228
    v_sub_f32 v2, v2, v228
    v_sub_f32 v3, v3, v228
    v_sub_f32 v4, v4, v229
    v_sub_f32 v5, v5, v229
    v_sub_f32 v6, v6, v229
    v_sub_f32 v7, v7, v229
    v_sub_f32 v8, v8, v230
    v_sub_f32 v9, v9, v230
    v_sub_f32 v10, v10, v230
    v_sub_f32 v11, v11, v230
    v_sub_f32 v12, v12, v231
    v_sub_f32 v13, v13, v231
    v_sub_f32 v14, v14, v231
    v_sub_f32 v15, v15, v231
    v_sub_f32 v16, v16, v228
    v_sub_f32 v17, v17, v228
    v_sub_f32 v18, v18, v228
    v_sub_f32 v19, v19, v228
    v_sub_f32 v20, v20, v229
    v_sub_f32 v21, v21, v229
    v_sub_f32 v22, v22, v229
    v_sub_f32 v23, v23, v229
    v_sub_f32 v24, v24, v230
    v_sub_f32 v25, v25, v230
    v_sub_f32 v26, v26, v230
    v_sub_f32 v27, v27, v230
    v_sub_f32 v28, v28, v231
    v_sub_f32 v29, v29, v231
    v_sub_f32 v30, v30, v231
    v_sub_f32 v31, v31, v231
    v_sub_f32 v32, v32, v228
    v_sub_f32 v33, v33, v228
    v_sub_f32 v34, v34, v228
    v_sub_f32 v35, v35, v228
    v_sub_f32 v36, v36, v229
    v_sub_f32 v37, v37, v229
    v_sub_f32 v38, v38, v229
    v_sub_f32 v39, v39, v229
    v_sub_f32 v40, v40, v230
    v_sub_f32 v41, v41, v230
    v_sub_f32 v42, v42, v230
    v_sub_f32 v43, v43, v230
    v_sub_f32 v44, v44, v231
    v_sub_f32 v45, v45, v231
    v_sub_f32 v46, v46, v231
    v_sub_f32 v47, v47, v231
    v_sub_f32 v48, v48, v228
    v_sub_f32 v49, v49, v228
    v_sub_f32 v50, v50, v228
    v_sub_f32 v51, v51, v228
    v_sub_f32 v52, v52, v229
    v_sub_f32 v53, v53, v229
    v_sub_f32 v54, v54, v229
    v_sub_f32 v55, v55, v229
    v_sub_f32 v56, v56, v230
    v_sub_f32 v57, v57, v230
    v_sub_f32 v58, v58, v230
    v_sub_f32 v59, v59, v230
    v_sub_f32 v60, v60, v231
    v_sub_f32 v61, v61, v231
    v_sub_f32 v62, v62, v231
    v_sub_f32 v63, v63, v231
    s_waitcnt lgkmcnt(0)
    v_mfma_f32_16x16x32_bf16 v[64:67], a[192:195], a[128:131], v[192:195]
    v_exp_f32 v228, v0
    v_exp_f32 v229, v1
    v_mfma_f32_16x16x32_bf16 v[64:67], a[196:199], a[132:135], v[64:67]
    v_exp_f32 v230, v2
    v_exp_f32 v231, v3
    v_mfma_f32_16x16x32_bf16 v[64:67], a[200:203], a[136:139], v[64:67]
    v_exp_f32 v232, v16
    v_exp_f32 v233, v17
    v_mfma_f32_16x16x32_bf16 v[64:67], a[204:207], a[140:143], v[64:67]
    s_add_u32 m0, s53, 0
    v_exp_f32 v234, v18
    v_cvt_pk_bf16_f32 v128, v228, v229
    v_mfma_f32_16x16x32_bf16 v[68:71], a[192:195], a[144:147], v[196:199]
    v_exp_f32 v235, v19
    v_exp_f32 v228, v32
    v_mfma_f32_16x16x32_bf16 v[68:71], a[196:199], a[148:151], v[68:71]
    buffer_load_dwordx4 v240, s[16:19], s51 offen offset:0 lds
    v_exp_f32 v229, v33
    v_mfma_f32_16x16x32_bf16 v[68:71], a[200:203], a[152:155], v[68:71]
    v_cvt_pk_bf16_f32 v129, v230, v231
    v_exp_f32 v230, v34
    v_cvt_pk_bf16_f32 v130, v232, v233
    v_mfma_f32_16x16x32_bf16 v[68:71], a[204:207], a[156:159], v[68:71]
    ds_read_b128 a[208:211], v236 offset:34048
    ds_read_b128 a[212:215], v236 offset:34112
    v_exp_f32 v231, v35
    v_mfma_f32_16x16x32_bf16 v[72:75], a[192:195], a[160:163], v[200:203]
    ds_read_b128 a[216:219], v236 offset:34176
    ds_read_b128 a[220:223], v236 offset:34240
    v_exp_f32 v232, v48
    v_mfma_f32_16x16x32_bf16 v[72:75], a[196:199], a[164:167], v[72:75]
    v_exp_f32 v233, v49
    v_cvt_pk_bf16_f32 v131, v234, v235
    v_cvt_pk_bf16_f32 v132, v228, v229
    v_mfma_f32_16x16x32_bf16 v[72:75], a[200:203], a[168:171], v[72:75]
    v_exp_f32 v234, v50
    v_exp_f32 v235, v51
    v_mfma_f32_16x16x32_bf16 v[72:75], a[204:207], a[172:175], v[72:75]
    v_exp_f32 v228, v4
    v_exp_f32 v229, v5
    v_mfma_f32_16x16x32_bf16 v[76:79], a[192:195], a[176:179], v[204:207]
    s_add_u32 m0, s53, 800
    v_cvt_pk_bf16_f32 v133, v230, v231
    v_exp_f32 v230, v6
    v_mfma_f32_16x16x32_bf16 v[76:79], a[196:199], a[180:183], v[76:79]
    v_cvt_pk_bf16_f32 v134, v232, v233
    v_exp_f32 v231, v7
    v_cvt_pk_bf16_f32 v135, v234, v235
    v_mfma_f32_16x16x32_bf16 v[76:79], a[200:203], a[184:187], v[76:79]
    buffer_load_dwordx4 v240, s[16:19], s51 offen offset:256 lds
    v_exp_f32 v232, v20
    v_mfma_f32_16x16x32_bf16 v[76:79], a[204:207], a[188:191], v[76:79]
    v_exp_f32 v233, v21
    v_exp_f32 v234, v22
    s_waitcnt lgkmcnt(0)
    v_mfma_f32_16x16x32_bf16 v[80:83], a[208:211], a[128:131], v[192:195]
    v_exp_f32 v235, v23
    v_cvt_pk_bf16_f32 v136, v228, v229
    v_cvt_pk_bf16_f32 v137, v230, v231
    v_mfma_f32_16x16x32_bf16 v[80:83], a[212:215], a[132:135], v[80:83]
    v_exp_f32 v228, v36
    v_exp_f32 v229, v37
    v_mfma_f32_16x16x32_bf16 v[80:83], a[216:219], a[136:139], v[80:83]
    v_exp_f32 v230, v38
    v_exp_f32 v231, v39
    v_mfma_f32_16x16x32_bf16 v[80:83], a[220:223], a[140:143], v[80:83]
    v_cvt_pk_bf16_f32 v138, v232, v233
    v_exp_f32 v232, v52
    v_cvt_pk_bf16_f32 v139, v234, v235
    v_mfma_f32_16x16x32_bf16 v[84:87], a[208:211], a[144:147], v[196:199]
    s_add_u32 m0, s53, 1600
    v_exp_f32 v233, v53
    v_cvt_pk_bf16_f32 v140, v228, v229
    v_mfma_f32_16x16x32_bf16 v[84:87], a[212:215], a[148:151], v[84:87]
    v_exp_f32 v234, v54
    v_exp_f32 v235, v55
    v_mfma_f32_16x16x32_bf16 v[84:87], a[216:219], a[152:155], v[84:87]
    buffer_load_dwordx4 v240, s[16:19], s51 offen offset:512 lds
    v_exp_f32 v228, v8
    v_mfma_f32_16x16x32_bf16 v[84:87], a[220:223], a[156:159], v[84:87]
    v_exp_f32 v229, v9
    v_cvt_pk_bf16_f32 v141, v230, v231
    v_cvt_pk_bf16_f32 v142, v232, v233
    v_mfma_f32_16x16x32_bf16 v[88:91], a[208:211], a[160:163], v[200:203]
    v_exp_f32 v230, v10
    v_exp_f32 v231, v11
    v_mfma_f32_16x16x32_bf16 v[88:91], a[212:215], a[164:167], v[88:91]
    v_exp_f32 v232, v24
    v_exp_f32 v233, v25
    v_mfma_f32_16x16x32_bf16 v[88:91], a[216:219], a[168:171], v[88:91]
    ds_read_b128 a[192:195], v236 offset:34304
    ds_read_b128 a[196:199], v236 offset:34368
    ds_read_b128 a[200:203], v236 offset:34432
    ds_read_b128 a[204:207], v236 offset:34496
    v_cvt_pk_bf16_f32 v143, v234, v235
    v_mfma_f32_16x16x32_bf16 v[88:91], a[220:223], a[172:175], v[88:91]
    v_exp_f32 v234, v26
    v_exp_f32 v235, v27
    v_cvt_pk_bf16_f32 v144, v228, v229
    v_mfma_f32_16x16x32_bf16 v[92:95], a[208:211], a[176:179], v[204:207]
    s_add_u32 m0, s53, 2400
    v_exp_f32 v228, v40
    v_cvt_pk_bf16_f32 v145, v230, v231
    v_mfma_f32_16x16x32_bf16 v[92:95], a[212:215], a[180:183], v[92:95]
    v_exp_f32 v229, v41
    v_exp_f32 v230, v42
    v_mfma_f32_16x16x32_bf16 v[92:95], a[216:219], a[184:187], v[92:95]
    buffer_load_dwordx4 v240, s[16:19], s51 offen offset:768 lds
    v_exp_f32 v231, v43
    v_cvt_pk_bf16_f32 v146, v232, v233
    v_mfma_f32_16x16x32_bf16 v[92:95], a[220:223], a[188:191], v[92:95]
    v_exp_f32 v232, v56
    v_exp_f32 v233, v57
    v_cvt_pk_bf16_f32 v147, v234, v235
    v_mfma_f32_16x16x32_bf16 v[208:211], v[244:247], v[128:131], 0
    s_add_u32 s51, s51, 16384
    v_exp_f32 v234, v58
    v_cvt_pk_bf16_f32 v148, v228, v229
    v_mfma_f32_16x16x32_bf16 v[208:211], v[244:247], v[132:135], v[208:211]
    v_exp_f32 v235, v59
    v_exp_f32 v228, v12
    s_waitcnt lgkmcnt(0)
    v_mfma_f32_16x16x32_bf16 v[96:99], a[192:195], a[128:131], v[192:195]
    v_exp_f32 v229, v13
    v_cvt_pk_bf16_f32 v149, v230, v231
    v_cvt_pk_bf16_f32 v150, v232, v233
    v_mfma_f32_16x16x32_bf16 v[96:99], a[196:199], a[132:135], v[96:99]
    v_exp_f32 v230, v14
    v_exp_f32 v231, v15
    v_mfma_f32_16x16x32_bf16 v[96:99], a[200:203], a[136:139], v[96:99]
    s_add_u32 m0, s53, 16896
    v_exp_f32 v232, v28
    v_cvt_pk_bf16_f32 v151, v234, v235
    v_mfma_f32_16x16x32_bf16 v[96:99], a[204:207], a[140:143], v[96:99]
    v_exp_f32 v233, v29
    v_exp_f32 v234, v30
    v_mfma_f32_16x16x32_bf16 v[100:103], a[192:195], a[144:147], v[196:199]
    buffer_load_dwordx4 v240, s[20:23], s52 offen offset:0 lds
    v_exp_f32 v235, v31
    v_cvt_pk_bf16_f32 v152, v228, v229
    v_mfma_f32_16x16x32_bf16 v[100:103], a[196:199], a[148:151], v[100:103]
    v_exp_f32 v228, v44
    v_exp_f32 v229, v45
    v_mfma_f32_16x16x32_bf16 v[100:103], a[200:203], a[152:155], v[100:103]
    v_cvt_pk_bf16_f32 v153, v230, v231
    v_exp_f32 v230, v46
    v_cvt_pk_bf16_f32 v154, v232, v233
    v_mfma_f32_16x16x32_bf16 v[100:103], a[204:207], a[156:159], v[100:103]
    v_exp_f32 v231, v47
    v_exp_f32 v232, v60
    v_mfma_f32_16x16x32_bf16 v[104:107], a[192:195], a[160:163], v[200:203]
    v_exp_f32 v233, v61
    v_cvt_pk_bf16_f32 v155, v234, v235
    v_cvt_pk_bf16_f32 v156, v228, v229
    v_mfma_f32_16x16x32_bf16 v[104:107], a[196:199], a[164:167], v[104:107]
    v_exp_f32 v234, v62
    v_exp_f32 v235, v63
    v_mfma_f32_16x16x32_bf16 v[104:107], a[200:203], a[168:171], v[104:107]
    s_add_u32 m0, s53, 17696
    v_cvt_pk_bf16_f32 v157, v230, v231
    v_cvt_pk_bf16_f32 v158, v232, v233
    v_cvt_pk_bf16_f32 v159, v234, v235
    v_mfma_f32_16x16x32_bf16 v[104:107], a[204:207], a[172:175], v[104:107]
    ds_read_b128 a[208:211], v236 offset:34560
    ds_read_b128 a[212:215], v236 offset:34624
    buffer_load_dwordx4 v240, s[20:23], s52 offen offset:256 lds
    v_mfma_f32_16x16x32_bf16 v[108:111], a[192:195], a[176:179], v[204:207]
    ds_read_b128 a[216:219], v236 offset:34688
    ds_read_b128 a[220:223], v236 offset:34752
    v_mfma_f32_16x16x32_bf16 v[108:111], a[196:199], a[180:183], v[108:111]
    s_add_u32 m0, s53, 18496
    v_mfma_f32_16x16x32_bf16 v[108:111], a[200:203], a[184:187], v[108:111]
    buffer_load_dwordx4 v240, s[20:23], s52 offen offset:512 lds
    v_mfma_f32_16x16x32_bf16 v[108:111], a[204:207], a[188:191], v[108:111]
    v_mfma_f32_16x16x32_bf16 v[212:215], v[244:247], v[136:139], 0
    v_mfma_f32_16x16x32_bf16 v[212:215], v[244:247], v[140:143], v[212:215]
    v_mfma_f32_16x16x32_bf16 v[216:219], v[244:247], v[144:147], 0
    v_mfma_f32_16x16x32_bf16 v[216:219], v[244:247], v[148:151], v[216:219]
    v_mfma_f32_16x16x32_bf16 v[220:223], v[244:247], v[152:155], 0
    v_mfma_f32_16x16x32_bf16 v[220:223], v[244:247], v[156:159], v[220:223]
    s_waitcnt vmcnt(15) lgkmcnt(0)
    s_barrier
    s_nop 9
    v_max3_f32 v241, v208, v212, v216
    v_max_f32 v241, v241, v220
    v_cmp_lt_f32 vcc, s61, v241
    s_cbranch_vccnz L_fb0
L_fb0_ret:
    v_mfma_f32_16x16x32_bf16 v[112:115], a[208:211], a[128:131], v[192:195]
    v_exp_f32 v228, v64
    v_exp_f32 v229, v65
    v_mfma_f32_16x16x32_bf16 v[112:115], a[212:215], a[132:135], v[112:115]
    s_add_u32 m0, s53, 19296
    v_exp_f32 v230, v66
    v_cvt_pk_bf16_f32 v160, v228, v229
    v_mfma_f32_16x16x32_bf16 v[112:115], a[216:219], a[136:139], v[112:115]
    buffer_load_dwordx4 v240, s[20:23], s52 offen offset:768 lds
    v_exp_f32 v231, v67
    v_mfma_f32_16x16x32_bf16 v[112:115], a[220:223], a[140:143], v[112:115]
    ds_read_b128 a[192:195], v237 offset:0
    ds_read_b128 a[196:199], v237 offset:64
    ds_read_b128 a[200:203], v237 offset:128
    s_add_u32 s52, s52, 16384
    v_mfma_f32_16x16x32_bf16 v[116:119], a[208:211], a[144:147], v[196:199]
    ds_read_b128 a[204:207], v237 offset:192
    v_exp_f32 v232, v80
    v_cvt_pk_bf16_f32 v161, v230, v231
    v_mfma_f32_16x16x32_bf16 v[116:119], a[212:215], a[148:151], v[116:119]
    ds_read_b64_tr_b16 a[224:225], v239 offset:16896
    ds_read_b64_tr_b16 a[226:227], v239 offset:17152
    v_exp_f32 v233, v81
    v_mfma_f32_16x16x32_bf16 v[116:119], a[216:219], a[152:155], v[116:119]
    ds_read_b64_tr_b16 a[228:229], v239 offset:17408
    ds_read_b64_tr_b16 a[230:231], v239 offset:17664
    ds_read_b64_tr_b16 a[232:233], v239 offset:16928
    v_cvt_pk_bf16_f32 v162, v232, v233
    v_mfma_f32_16x16x32_bf16 v[116:119], a[220:223], a[156:159], v[116:119]
    ds_read_b64_tr_b16 a[234:235], v239 offset:17184
    ds_read_b64_tr_b16 a[236:237], v239 offset:17440
    v_exp_f32 v234, v82
    v_mfma_f32_16x16x32_bf16 v[120:123], a[208:211], a[160:163], v[200:203]
    ds_read_b64_tr_b16 a[238:239], v239 offset:17696
    v_add_f32 v224, v224, v208
    v_add_f32 v225, v225, v212
    v_add_f32 v226, v226, v216
    v_mfma_f32_16x16x32_bf16 v[120:123], a[212:215], a[164:167], v[120:123]
    v_exp_f32 v235, v83
    v_add_f32 v227, v227, v220
    v_mfma_f32_16x16x32_bf16 v[120:123], a[216:219], a[168:171], v[120:123]
    v_cvt_pk_bf16_f32 v163, v234, v235
    v_mfma_f32_16x16x32_bf16 v[120:123], a[220:223], a[172:175], v[120:123]
    v_mfma_f32_16x16x32_bf16 v[124:127], a[208:211], a[176:179], v[204:207]
    v_mfma_f32_16x16x32_bf16 v[124:127], a[212:215], a[180:183], v[124:127]
    v_mfma_f32_16x16x32_bf16 v[124:127], a[216:219], a[184:187], v[124:127]
    v_mfma_f32_16x16x32_bf16 v[124:127], a[220:223], a[188:191], v[124:127]
    s_waitcnt lgkmcnt(0)
    v_mfma_f32_16x16x32_bf16 v[0:3], a[192:195], a[128:131], v[192:195]
    v_exp_f32 v228, v96
    v_mfma_f32_16x16x32_bf16 v[0:3], a[196:199], a[132:135], v[0:3]
    v_exp_f32 v229, v97
    v_mfma_f32_16x16x32_bf16 v[0:3], a[200:203], a[136:139], v[0:3]
    s_add_u32 m0, s53, 33792
    v_cvt_pk_bf16_f32 v164, v228, v229
    v_mfma_f32_16x16x32_bf16 v[0:3], a[204:207], a[140:143], v[0:3]
    v_exp_f32 v230, v98
    v_mfma_f32_16x16x32_bf16 v[4:7], a[192:195], a[144:147], v[196:199]
    buffer_load_dwordx4 v240, s[16:19], s51 offen offset:0 lds
    v_mfma_f32_16x16x32_bf16 v[4:7], a[196:199], a[148:151], v[4:7]
    v_exp_f32 v231, v99
    v_mfma_f32_16x16x32_bf16 v[4:7], a[200:203], a[152:155], v[4:7]
    ds_read_b128 a[208:211], v237 offset:256
    v_cvt_pk_bf16_f32 v165, v230, v231
    v_mfma_f32_16x16x32_bf16 v[4:7], a[204:207], a[156:159], v[4:7]
    v_exp_f32 v232, v112
    v_mfma_f32_16x16x32_bf16 v[8:11], a[192:195], a[160:163], v[200:203]
    ds_read_b128 a[212:215], v237 offset:320
    ds_read_b128 a[216:219], v237 offset:384
    v_mfma_f32_16x16x32_bf16 v[8:11], a[196:199], a[164:167], v[8:11]
    ds_read_b128 a[220:223], v237 offset:448
    ds_read_b64_tr_b16 a[240:241], v239 offset:16960
    v_mfma_f32_16x16x32_bf16 v[8:11], a[200:203], a[168:171], v[8:11]
    v_exp_f32 v233, v113
    v_mfma_f32_16x16x32_bf16 v[8:11], a[204:207], a[172:175], v[8:11]
    s_add_u32 m0, s53, 34592
    v_cvt_pk_bf16_f32 v166, v232, v233
    v_mfma_f32_16x16x32_bf16 v[12:15], a[192:195], a[176:179], v[204:207]
    v_exp_f32 v234, v114
    v_mfma_f32_16x16x32_bf16 v[12:15], a[196:199], a[180:183], v[12:15]
    buffer_load_dwordx4 v240, s[16:19], s51 offen offset:256 lds
    v_mfma_f32_16x16x32_bf16 v[12:15], a[200:203], a[184:187], v[12:15]
    ds_read_b64_tr_b16 a[242:243], v239 offset:17216
    ds_read_b64_tr_b16 a[244:245], v239 offset:17472
    v_mfma_f32_16x16x32_bf16 v[12:15], a[204:207], a[188:191], v[12:15]
    v_exp_f32 v235, v115
    v_mfma_f32_16x16x32_bf16 a[0:3], a[224:227], v[128:131], 0
    ds_read_b64_tr_b16 a[246:247], v239 offset:17728
    v_cvt_pk_bf16_f32 v167, v234, v235
    v_mfma_f32_16x16x32_bf16 a[0:3], a[228:231], v[132:135], a[0:3]
    ds_read_b64_tr_b16 a[248:249], v239 offset:16992
    ds_read_b64_tr_b16 a[250:251], v239 offset:17248
    v_mfma_f32_16x16x32_bf16 a[4:7], a[224:227], v[136:139], 0
    ds_read_b64_tr_b16 a[252:253], v239 offset:17504
    ds_read_b64_tr_b16 a[254:255], v239 offset:17760
    v_mfma_f32_16x16x32_bf16 a[4:7], a[228:231], v[140:143], a[4:7]
    ds_read_b128 a[192:195], v237 offset:512
    ds_read_b128 a[196:199], v237 offset:576
    v_mfma_f32_16x16x32_bf16 a[8:11], a[224:227], v[144:147], 0
    ds_read_b128 a[200:203], v237 offset:640
    ds_read_b128 a[204:207], v237 offset:704
    v_mfma_f32_16x16x32_bf16 a[8:11], a[228:231], v[148:151], a[8:11]
    s_add_u32 m0, s53, 35392
    v_mfma_f32_16x16x32_bf16 a[12:15], a[224:227], v[152:155], 0
    v_exp_f32 v228, v68
    v_mfma_f32_16x16x32_bf16 a[12:15], a[228:231], v[156:159], a[12:15]
    v_exp_f32 v229, v69
    v_mfma_f32_16x16x32_bf16 v[208:211], v[244:247], v[160:163], 0
    v_exp_f32 v230, v70
    v_mfma_f32_16x16x32_bf16 v[208:211], v[244:247], v[164:167], v[208:211]
    v_exp_f32 v231, v71
    v_mfma_f32_16x16x32_bf16 a[16:19], a[232:235], v[128:131], 0
    v_cvt_pk_bf16_f32 v168, v228, v229
    v_cvt_pk_bf16_f32 v169, v230, v231
    v_mfma_f32_16x16x32_bf16 a[16:19], a[236:239], v[132:135], a[16:19]
    buffer_load_dwordx4 v240, s[16:19], s51 offen offset:512 lds
    v_mfma_f32_16x16x32_bf16 a[20:23], a[232:235], v[136:139], 0
    v_exp_f32 v232, v84
    v_mfma_f32_16x16x32_bf16 a[20:23], a[236:239], v[140:143], a[20:23]
    v_exp_f32 v233, v85
    v_mfma_f32_16x16x32_bf16 a[24:27], a[232:235], v[144:147], 0
    v_exp_f32 v234, v86
    v_mfma_f32_16x16x32_bf16 a[24:27], a[236:239], v[148:151], a[24:27]
    v_exp_f32 v235, v87
    v_mfma_f32_16x16x32_bf16 a[28:31], a[232:235], v[152:155], 0
    v_cvt_pk_bf16_f32 v170, v232, v233
    v_cvt_pk_bf16_f32 v171, v234, v235
    v_mfma_f32_16x16x32_bf16 a[28:31], a[236:239], v[156:159], a[28:31]
    v_exp_f32 v228, v100
    s_waitcnt lgkmcnt(0)
    v_mfma_f32_16x16x32_bf16 v[16:19], a[208:211], a[128:131], v[192:195]
    v_exp_f32 v229, v101
    v_mfma_f32_16x16x32_bf16 v[16:19], a[212:215], a[132:135], v[16:19]
    v_exp_f32 v230, v102
    v_mfma_f32_16x16x32_bf16 v[16:19], a[216:219], a[136:139], v[16:19]
    s_add_u32 m0, s53, 36192
    v_cvt_pk_bf16_f32 v172, v228, v229
    v_mfma_f32_16x16x32_bf16 v[16:19], a[220:223], a[140:143], v[16:19]
    v_exp_f32 v231, v103
    v_mfma_f32_16x16x32_bf16 v[20:23], a[208:211], a[144:147], v[196:199]
    buffer_load_dwordx4 v240, s[16:19], s51 offen offset:768 lds
    v_mfma_f32_16x16x32_bf16 v[20:23], a[212:215], a[148:151], v[20:23]
    v_exp_f32 v232, v116
    v_mfma_f32_16x16x32_bf16 v[20:23], a[216:219], a[152:155], v[20:23]
    s_add_u32 s51, s51, 16384
    v_cvt_pk_bf16_f32 v173, v230, v231
    v_mfma_f32_16x16x32_bf16 v[20:23], a[220:223], a[156:159], v[20:23]
    v_exp_f32 v233, v117
    v_mfma_f32_16x16x32_bf16 v[24:27], a[208:211], a[160:163], v[200:203]
    v_exp_f32 v234, v118
    v_mfma_f32_16x16x32_bf16 v[24:27], a[212:215], a[164:167], v[24:27]
    v_exp_f32 v235, v119
    v_mfma_f32_16x16x32_bf16 v[24:27], a[216:219], a[168:171], v[24:27]
    v_cvt_pk_bf16_f32 v174, v232, v233
    v_cvt_pk_bf16_f32 v175, v234, v235
    v_mfma_f32_16x16x32_bf16 v[24:27], a[220:223], a[172:175], v[24:27]
    ds_read_b64_tr_b16 a[224:225], v239 offset:17024
    s_add_u32 m0, s53, 50688
    v_mfma_f32_16x16x32_bf16 v[28:31], a[208:211], a[176:179], v[204:207]
    buffer_load_dwordx4 v240, s[20:23], s52 offen offset:0 lds
    v_mfma_f32_16x16x32_bf16 v[28:31], a[212:215], a[180:183], v[28:31]
    ds_read_b64_tr_b16 a[226:227], v239 offset:17280
    ds_read_b64_tr_b16 a[228:229], v239 offset:17536
    v_mfma_f32_16x16x32_bf16 v[28:31], a[216:219], a[184:187], v[28:31]
    v_exp_f32 v228, v72
    v_mfma_f32_16x16x32_bf16 v[28:31], a[220:223], a[188:191], v[28:31]
    v_exp_f32 v229, v73
    v_mfma_f32_16x16x32_bf16 v[212:215], v[244:247], v[168:171], 0
    v_exp_f32 v230, v74
    v_mfma_f32_16x16x32_bf16 v[212:215], v[244:247], v[172:175], v[212:215]
    v_exp_f32 v231, v75
    v_mfma_f32_16x16x32_bf16 a[32:35], a[240:243], v[128:131], 0
    v_cvt_pk_bf16_f32 v176, v228, v229
    v_cvt_pk_bf16_f32 v177, v230, v231
    v_mfma_f32_16x16x32_bf16 a[32:35], a[244:247], v[132:135], a[32:35]
    v_exp_f32 v232, v88
    v_mfma_f32_16x16x32_bf16 a[36:39], a[240:243], v[136:139], 0
    ds_read_b64_tr_b16 a[230:231], v239 offset:17792
    ds_read_b64_tr_b16 a[232:233], v239 offset:17056
    v_mfma_f32_16x16x32_bf16 a[36:39], a[244:247], v[140:143], a[36:39]
    v_exp_f32 v233, v89
    v_mfma_f32_16x16x32_bf16 a[40:43], a[240:243], v[144:147], 0
    s_add_u32 m0, s53, 51488
    v_cvt_pk_bf16_f32 v178, v232, v233
    v_mfma_f32_16x16x32_bf16 a[40:43], a[244:247], v[148:151], a[40:43]
    v_exp_f32 v234, v90
    v_mfma_f32_16x16x32_bf16 a[44:47], a[240:243], v[152:155], 0
    buffer_load_dwordx4 v240, s[20:23], s52 offen offset:256 lds
    v_mfma_f32_16x16x32_bf16 a[44:47], a[244:247], v[156:159], a[44:47]
    v_exp_f32 v235, v91
    v_mfma_f32_16x16x32_bf16 a[48:51], a[248:251], v[128:131], 0
    ds_read_b64_tr_b16 a[234:235], v239 offset:17312
    v_cvt_pk_bf16_f32 v179, v234, v235
    v_mfma_f32_16x16x32_bf16 a[48:51], a[252:255], v[132:135], a[48:51]
    v_exp_f32 v228, v104
    v_mfma_f32_16x16x32_bf16 a[52:55], a[248:251], v[136:139], 0
    ds_read_b64_tr_b16 a[236:237], v239 offset:17568
    ds_read_b64_tr_b16 a[238:239], v239 offset:17824
    v_mfma_f32_16x16x32_bf16 a[52:55], a[252:255], v[140:143], a[52:55]
    v_exp_f32 v229, v105
    v_mfma_f32_16x16x32_bf16 a[56:59], a[248:251], v[144:147], 0
    ds_read_b128 a[208:211], v237 offset:768
    v_cvt_pk_bf16_f32 v180, v228, v229
    v_mfma_f32_16x16x32_bf16 a[56:59], a[252:255], v[148:151], a[56:59]
    v_exp_f32 v230, v106
    v_mfma_f32_16x16x32_bf16 a[60:63], a[248:251], v[152:155], 0
    ds_read_b128 a[212:215], v237 offset:832
    ds_read_b128 a[216:219], v237 offset:896
    v_mfma_f32_16x16x32_bf16 a[60:63], a[252:255], v[156:159], a[60:63]
    v_exp_f32 v231, v107
    v_mfma_f32_16x16x32_bf16 v[32:35], a[192:195], a[128:131], v[192:195]
    s_add_u32 m0, s53, 52288
    v_cvt_pk_bf16_f32 v181, v230, v231
    v_mfma_f32_16x16x32_bf16 v[32:35], a[196:199], a[132:135], v[32:35]
    v_exp_f32 v232, v120
    v_mfma_f32_16x16x32_bf16 v[32:35], a[200:203], a[136:139], v[32:35]
    buffer_load_dwordx4 v240, s[20:23], s52 offen offset:512 lds
    v_mfma_f32_16x16x32_bf16 v[32:35], a[204:207], a[140:143], v[32:35]
    v_exp_f32 v233, v121
    v_mfma_f32_16x16x32_bf16 v[36:39], a[192:195], a[144:147], v[196:199]
    ds_read_b128 a[220:223], v237 offset:960
    v_cvt_pk_bf16_f32 v182, v232, v233
    v_mfma_f32_16x16x32_bf16 v[36:39], a[196:199], a[148:151], v[36:39]
    v_exp_f32 v234, v122
    v_mfma_f32_16x16x32_bf16 v[36:39], a[200:203], a[152:155], v[36:39]
    ds_read_b64_tr_b16 a[240:241], v239 offset:17088
    ds_read_b64_tr_b16 a[242:243], v239 offset:17344
    v_mfma_f32_16x16x32_bf16 v[36:39], a[204:207], a[156:159], v[36:39]
    v_exp_f32 v235, v123
    v_mfma_f32_16x16x32_bf16 v[40:43], a[192:195], a[160:163], v[200:203]
    ds_read_b64_tr_b16 a[244:245], v239 offset:17600
    v_cvt_pk_bf16_f32 v183, v234, v235
    v_mfma_f32_16x16x32_bf16 v[40:43], a[196:199], a[164:167], v[40:43]
    ds_read_b64_tr_b16 a[246:247], v239 offset:17856
    ds_read_b64_tr_b16 a[248:249], v239 offset:17120
    v_mfma_f32_16x16x32_bf16 v[40:43], a[200:203], a[168:171], v[40:43]
    ds_read_b64_tr_b16 a[250:251], v239 offset:17376
    ds_read_b64_tr_b16 a[252:253], v239 offset:17632
    v_mfma_f32_16x16x32_bf16 v[40:43], a[204:207], a[172:175], v[40:43]
    ds_read_b64_tr_b16 a[254:255], v239 offset:17888
    s_add_u32 m0, s53, 53088
    v_mfma_f32_16x16x32_bf16 v[44:47], a[192:195], a[176:179], v[204:207]
    buffer_load_dwordx4 v240, s[20:23], s52 offen offset:768 lds
    v_mfma_f32_16x16x32_bf16 v[44:47], a[196:199], a[180:183], v[44:47]
    s_add_u32 s52, s52, 16384
    v_mfma_f32_16x16x32_bf16 v[44:47], a[200:203], a[184:187], v[44:47]
    v_exp_f32 v228, v76
    v_mfma_f32_16x16x32_bf16 v[44:47], a[204:207], a[188:191], v[44:47]
    v_exp_f32 v229, v77
    v_mfma_f32_16x16x32_bf16 v[216:219], v[244:247], v[176:179], 0
    v_exp_f32 v230, v78
    v_mfma_f32_16x16x32_bf16 v[216:219], v[244:247], v[180:183], v[216:219]
    v_exp_f32 v231, v79
    s_waitcnt lgkmcnt(0)
    v_mfma_f32_16x16x32_bf16 a[64:67], a[224:227], v[128:131], 0
    v_cvt_pk_bf16_f32 v184, v228, v229
    v_cvt_pk_bf16_f32 v185, v230, v231
    v_mfma_f32_16x16x32_bf16 a[64:67], a[228:231], v[132:135], a[64:67]
    v_exp_f32 v232, v92
    v_mfma_f32_16x16x32_bf16 a[68:71], a[224:227], v[136:139], 0
    v_exp_f32 v233, v93
    v_mfma_f32_16x16x32_bf16 a[68:71], a[228:231], v[140:143], a[68:71]
    v_exp_f32 v234, v94
    v_mfma_f32_16x16x32_bf16 a[72:75], a[224:227], v[144:147], 0
    v_exp_f32 v235, v95
    v_mfma_f32_16x16x32_bf16 a[72:75], a[228:231], v[148:151], a[72:75]
    v_cvt_pk_bf16_f32 v186, v232, v233
    v_cvt_pk_bf16_f32 v187, v234, v235
    v_mfma_f32_16x16x32_bf16 a[76:79], a[224:227], v[152:155], 0
    v_exp_f32 v228, v108
    v_mfma_f32_16x16x32_bf16 a[76:79], a[228:231], v[156:159], a[76:79]
    v_exp_f32 v229, v109
    v_mfma_f32_16x16x32_bf16 a[80:83], a[232:235], v[128:131], 0
    buffer_store_dwordx4 v[248:251], v253, s[4:7], s62 offen sc1
    v_mfma_f32_16x16x32_bf16 a[80:83], a[236:239], v[132:135], a[80:83]
    v_exp_f32 v230, v110
    v_mfma_f32_16x16x32_bf16 a[84:87], a[232:235], v[136:139], 0
    s_add_u32 s62, s62, 1024
    v_cvt_pk_bf16_f32 v188, v228, v229
    v_mfma_f32_16x16x32_bf16 a[84:87], a[236:239], v[140:143], a[84:87]
    v_exp_f32 v231, v111
    v_mfma_f32_16x16x32_bf16 a[88:91], a[232:235], v[144:147], 0
    v_exp_f32 v232, v124
    v_mfma_f32_16x16x32_bf16 a[88:91], a[236:239], v[148:151], a[88:91]
    v_exp_f32 v233, v125
    v_mfma_f32_16x16x32_bf16 a[92:95], a[232:235], v[152:155], 0
    v_exp_f32 v234, v126
    v_mfma_f32_16x16x32_bf16 a[92:95], a[236:239], v[156:159], a[92:95]
    s_waitcnt vmcnt(17) lgkmcnt(0)
    s_barrier
    s_lshl_b32 s59, s55, 2
    s_add_u32 s59, s59, s98
    s_cmp_lg_u32 s54, 0
    s_cbranch_scc1 L_sgh
    v_mov_b32 v241, 1
    s_mov_b64 exec, 1
    buffer_store_dword v241, off, s[36:39], s59 sc1
    s_mov_b64 exec, -1
L_sgh:
    v_mfma_f32_16x16x32_bf16 a[96:99], a[240:243], v[128:131], 0
    v_cvt_pk_bf16_f32 v189, v230, v231
    v_cvt_pk_bf16_f32 v190, v232, v233
    v_mfma_f32_16x16x32_bf16 a[96:99], a[244:247], v[132:135], a[96:99]
    v_exp_f32 v235, v127
    v_mfma_f32_16x16x32_bf16 a[100:103], a[240:243], v[136:139], 0
    v_cvt_pk_bf16_f32 v191, v234, v235
    v_max3_f32 v241, v208, v212, v216
    v_mfma_f32_16x16x32_bf16 a[100:103], a[244:247], v[140:143], a[100:103]
    buffer_store_dwordx4 v[248:251], v253, s[4:7], s62 offen sc1
    v_mfma_f32_16x16x32_bf16 a[104:107], a[240:243], v[144:147], 0
    ds_read_b128 a[192:195], v237 offset:33792
    s_add_u32 s62, s62, 1024
    v_mfma_f32_16x16x32_bf16 a[104:107], a[244:247], v[148:151], a[104:107]
    ds_read_b128 a[196:199], v237 offset:33856
    ds_read_b128 a[200:203], v237 offset:33920
    v_mfma_f32_16x16x32_bf16 a[108:111], a[240:243], v[152:155], 0
    ds_read_b128 a[204:207], v237 offset:33984
    ds_read_b64_tr_b16 a[224:225], v239 offset:50688
    v_mfma_f32_16x16x32_bf16 a[108:111], a[244:247], v[156:159], a[108:111]
    ds_read_b64_tr_b16 a[226:227], v239 offset:50944
    ds_read_b64_tr_b16 a[228:229], v239 offset:51200
    v_mfma_f32_16x16x32_bf16 v[220:223], v[244:247], v[184:187], 0
    ds_read_b64_tr_b16 a[230:231], v239 offset:51456
    ds_read_b64_tr_b16 a[232:233], v239 offset:50720
    v_mfma_f32_16x16x32_bf16 v[220:223], v[244:247], v[188:191], v[220:223]
    ds_read_b64_tr_b16 a[234:235], v239 offset:50976
    ds_read_b64_tr_b16 a[236:237], v239 offset:51232
    v_mfma_f32_16x16x32_bf16 a[112:115], a[248:251], v[128:131], 0
    ds_read_b64_tr_b16 a[238:239], v239 offset:51488
    v_mfma_f32_16x16x32_bf16 a[112:115], a[252:255], v[132:135], a[112:115]
    v_mfma_f32_16x16x32_bf16 a[116:119], a[248:251], v[136:139], 0
    buffer_store_dwordx4 v[248:251], v253, s[4:7], s62 offen sc1
    v_mfma_f32_16x16x32_bf16 a[116:119], a[252:255], v[140:143], a[116:119]
    s_add_u32 s62, s62, 1024
    v_mfma_f32_16x16x32_bf16 a[120:123], a[248:251], v[144:147], 0
    v_mfma_f32_16x16x32_bf16 a[120:123], a[252:255], v[148:151], a[120:123]
    v_mfma_f32_16x16x32_bf16 a[124:127], a[248:251], v[152:155], 0
    v_mfma_f32_16x16x32_bf16 a[124:127], a[252:255], v[156:159], a[124:127]
    s_nop 1
    v_max_f32 v241, v241, v220
    v_cmp_lt_f32 vcc, s61, v241
    s_cbranch_vccnz L_fb1
L_fb1_ret:
    v_mfma_f32_16x16x32_bf16 v[48:51], a[208:211], a[128:131], v[192:195]
    v_exp_f32 v228, v0
    v_mfma_f32_16x16x32_bf16 v[48:51], a[212:215], a[132:135], v[48:51]
    v_exp_f32 v229, v1
    v_mfma_f32_16x16x32_bf16 v[48:51], a[216:219], a[136:139], v[48:51]
    v_exp_f32 v230, v2
    v_mfma_f32_16x16x32_bf16 v[48:51], a[220:223], a[140:143], v[48:51]
    v_exp_f32 v231, v3
    v_mfma_f32_16x16x32_bf16 v[52:55], a[208:211], a[144:147], v[196:199]
    v_cvt_pk_bf16_f32 v128, v228, v229
    v_cvt_pk_bf16_f32 v129, v230, v231
    v_mfma_f32_16x16x32_bf16 v[52:55], a[212:215], a[148:151], v[52:55]
    v_exp_f32 v232, v16
    v_mfma_f32_16x16x32_bf16 v[52:55], a[216:219], a[152:155], v[52:55]
    v_exp_f32 v233, v17
    v_mfma_f32_16x16x32_bf16 v[52:55], a[220:223], a[156:159], v[52:55]
    v_exp_f32 v234, v18
    v_mfma_f32_16x16x32_bf16 v[56:59], a[208:211], a[160:163], v[200:203]
    v_cvt_pk_bf16_f32 v130, v232, v233
    v_add_f32 v224, v224, v208
    v_mfma_f32_16x16x32_bf16 v[56:59], a[212:215], a[164:167], v[56:59]
    v_exp_f32 v235, v19
    v_mfma_f32_16x16x32_bf16 v[56:59], a[216:219], a[168:171], v[56:59]
    v_cvt_pk_bf16_f32 v131, v234, v235
    v_add_f32 v225, v225, v212
    v_mfma_f32_16x16x32_bf16 v[56:59], a[220:223], a[172:175], v[56:59]
    v_add_f32 v226, v226, v216
    v_add_f32 v227, v227, v220
    v_mfma_f32_16x16x32_bf16 v[60:63], a[208:211], a[176:179], v[204:207]
    v_mfma_f32_16x16x32_bf16 v[60:63], a[212:215], a[180:183], v[60:63]
    v_mfma_f32_16x16x32_bf16 v[60:63], a[216:219], a[184:187], v[60:63]
    v_mfma_f32_16x16x32_bf16 v[60:63], a[220:223], a[188:191], v[60:63]
    s_mov_b32 s60, 7
L_att:
    s_waitcnt lgkmcnt(0)
    v_mfma_f32_16x16x32_bf16 v[64:67], a[192:195], a[128:131], v[192:195]
    v_exp_f32 v228, v32
    v_mfma_f32_16x16x32_bf16 v[64:67], a[196:199], a[132:135], v[64:67]
    v_exp_f32 v229, v33
    v_mfma_f32_16x16x32_bf16 v[64:67], a[200:203], a[136:139], v[64:67]
    s_add_u32 m0, s53, 67584
    v_cvt_pk_bf16_f32 v132, v228, v229
    v_mfma_f32_16x16x32_bf16 v[64:67], a[204:207], a[140:143], v[64:67]
    v_exp_f32 v230, v34
    v_mfma_f32_16x16x32_bf16 v[68:71], a[192:195], a[144:147], v[196:199]
    buffer_load_dwordx4 v240, s[16:19], s51 offen offset:0 lds
    v_mfma_f32_16x16x32_bf16 v[68:71], a[196:199], a[148:151], v[68:71]
    v_exp_f32 v231, v35
    v_mfma_f32_16x16x32_bf16 v[68:71], a[200:203], a[152:155], v[68:71]
    ds_read_b128 a[208:211], v237 offset:34048
    v_cvt_pk_bf16_f32 v133, v230, v231
    v_mfma_f32_16x16x32_bf16 v[68:71], a[204:207], a[156:159], v[68:71]
    v_exp_f32 v232, v48
    v_mfma_f32_16x16x32_bf16 v[72:75], a[192:195], a[160:163], v[200:203]
    ds_read_b128 a[212:215], v237 offset:34112
    ds_read_b128 a[216:219], v237 offset:34176
    v_mfma_f32_16x16x32_bf16 v[72:75], a[196:199], a[164:167], v[72:75]
    ds_read_b128 a[220:223], v237 offset:34240
    ds_read_b64_tr_b16 a[240:241], v239 offset:50752
    v_mfma_f32_16x16x32_bf16 v[72:75], a[200:203], a[168:171], v[72:75]
    v_exp_f32 v233, v49
    v_mfma_f32_16x16x32_bf16 v[72:75], a[204:207], a[172:175], v[72:75]
    s_add_u32 m0, s53, 68384
    v_cvt_pk_bf16_f32 v134, v232, v233
    v_mfma_f32_16x16x32_bf16 v[76:79], a[192:195], a[176:179], v[204:207]
    v_exp_f32 v234, v50
    v_mfma_f32_16x16x32_bf16 v[76:79], a[196:199], a[180:183], v[76:79]
    buffer_load_dwordx4 v240, s[16:19], s51 offen offset:256 lds
    v_mfma_f32_16x16x32_bf16 v[76:79], a[200:203], a[184:187], v[76:79]
    ds_read_b64_tr_b16 a[242:243], v239 offset:51008
    ds_read_b64_tr_b16 a[244:245], v239 offset:51264
    v_mfma_f32_16x16x32_bf16 v[76:79], a[204:207], a[188:191], v[76:79]
    v_exp_f32 v235, v51
    v_mfma_f32_16x16x32_bf16 a[0:3], a[224:227], v[160:163], a[0:3]
    ds_read_b64_tr_b16 a[246:247], v239 offset:51520
    v_cvt_pk_bf16_f32 v135, v234, v235
    v_mfma_f32_16x16x32_bf16 a[0:3], a[228:231], v[164:167], a[0:3]
    ds_read_b64_tr_b16 a[248:249], v239 offset:50784
    ds_read_b64_tr_b16 a[250:251], v239 offset:51040
    v_mfma_f32_16x16x32_bf16 a[4:7], a[224:227], v[168:171], a[4:7]
    ds_read_b64_tr_b16 a[252:253], v239 offset:51296
    ds_read_b64_tr_b16 a[254:255], v239 offset:51552
    v_mfma_f32_16x16x32_bf16 a[4:7], a[228:231], v[172:175], a[4:7]
    ds_read_b128 a[192:195], v237 offset:34304
    ds_read_b128 a[196:199], v237 offset:34368
    v_mfma_f32_16x16x32_bf16 a[8:11], a[224:227], v[176:179], a[8:11]
    ds_read_b128 a[200:203], v237 offset:34432
    ds_read_b128 a[204:207], v237 offset:34496
    v_mfma_f32_16x16x32_bf16 a[8:11], a[228:231], v[180:183], a[8:11]
    v_mfma_f32_16x16x32_bf16 a[12:15], a[224:227], v[184:187], a[12:15]
    v_exp_f32 v228, v4
    v_mfma_f32_16x16x32_bf16 a[12:15], a[228:231], v[188:191], a[12:15]
    v_exp_f32 v229, v5
    v_mfma_f32_16x16x32_bf16 v[208:211], v[244:247], v[128:131], 0
    v_exp_f32 v230, v6
    v_mfma_f32_16x16x32_bf16 v[208:211], v[244:247], v[132:135], v[208:211]
    v_exp_f32 v231, v7
    v_mfma_f32_16x16x32_bf16 a[16:19], a[232:235], v[160:163], a[16:19]
    s_add_u32 m0, s53, 69184
    v_cvt_pk_bf16_f32 v136, v228, v229
    v_mfma_f32_16x16x32_bf16 a[16:19], a[236:239], v[164:167], a[16:19]
    v_exp_f32 v232, v20
    v_mfma_f32_16x16x32_bf16 a[20:23], a[232:235], v[168:171], a[20:23]
    v_exp_f32 v233, v21
    v_mfma_f32_16x16x32_bf16 a[20:23], a[236:239], v[172:175], a[20:23]
    v_cvt_pk_bf16_f32 v137, v230, v231
    v_cvt_pk_bf16_f32 v138, v232, v233
    v_mfma_f32_16x16x32_bf16 a[24:27], a[232:235], v[176:179], a[24:27]
    buffer_load_dwordx4 v240, s[16:19], s51 offen offset:512 lds
    v_mfma_f32_16x16x32_bf16 a[24:27], a[236:239], v[180:183], a[24:27]
    v_exp_f32 v234, v22
    v_mfma_f32_16x16x32_bf16 a[28:31], a[232:235], v[184:187], a[28:31]
    v_exp_f32 v235, v23
    v_mfma_f32_16x16x32_bf16 a[28:31], a[236:239], v[188:191], a[28:31]
    v_exp_f32 v228, v36
    s_waitcnt lgkmcnt(0)
    v_mfma_f32_16x16x32_bf16 v[80:83], a[208:211], a[128:131], v[192:195]
    v_exp_f32 v229, v37
    v_mfma_f32_16x16x32_bf16 v[80:83], a[212:215], a[132:135], v[80:83]
    v_cvt_pk_bf16_f32 v139, v234, v235
    v_cvt_pk_bf16_f32 v140, v228, v229
    v_mfma_f32_16x16x32_bf16 v[80:83], a[216:219], a[136:139], v[80:83]
    v_exp_f32 v230, v38
    v_mfma_f32_16x16x32_bf16 v[80:83], a[220:223], a[140:143], v[80:83]
    v_exp_f32 v231, v39
    v_mfma_f32_16x16x32_bf16 v[84:87], a[208:211], a[144:147], v[196:199]
    v_exp_f32 v232, v52
    v_mfma_f32_16x16x32_bf16 v[84:87], a[212:215], a[148:151], v[84:87]
    s_add_u32 m0, s53, 69984
    v_cvt_pk_bf16_f32 v141, v230, v231
    v_mfma_f32_16x16x32_bf16 v[84:87], a[216:219], a[152:155], v[84:87]
    v_exp_f32 v233, v53
    v_mfma_f32_16x16x32_bf16 v[84:87], a[220:223], a[156:159], v[84:87]
    buffer_load_dwordx4 v240, s[16:19], s51 offen offset:768 lds
    v_mfma_f32_16x16x32_bf16 v[88:91], a[208:211], a[160:163], v[200:203]
    v_exp_f32 v234, v54
    v_mfma_f32_16x16x32_bf16 v[88:91], a[212:215], a[164:167], v[88:91]
    s_add_u32 s51, s51, 16384
    v_cvt_pk_bf16_f32 v142, v232, v233
    v_mfma_f32_16x16x32_bf16 v[88:91], a[216:219], a[168:171], v[88:91]
    v_exp_f32 v235, v55
    v_mfma_f32_16x16x32_bf16 v[88:91], a[220:223], a[172:175], v[88:91]
    ds_read_b64_tr_b16 a[224:225], v239 offset:50816
    v_cvt_pk_bf16_f32 v143, v234, v235
    v_mfma_f32_16x16x32_bf16 v[92:95], a[208:211], a[176:179], v[204:207]
    ds_read_b64_tr_b16 a[226:227], v239 offset:51072
    ds_read_b64_tr_b16 a[228:229], v239 offset:51328
    v_mfma_f32_16x16x32_bf16 v[92:95], a[212:215], a[180:183], v[92:95]
    ds_read_b64_tr_b16 a[230:231], v239 offset:51584
    ds_read_b64_tr_b16 a[232:233], v239 offset:50848
    v_mfma_f32_16x16x32_bf16 v[92:95], a[216:219], a[184:187], v[92:95]
    v_exp_f32 v228, v8
    v_mfma_f32_16x16x32_bf16 v[92:95], a[220:223], a[188:191], v[92:95]
    v_exp_f32 v229, v9
    v_mfma_f32_16x16x32_bf16 v[212:215], v[244:247], v[136:139], 0
    v_exp_f32 v230, v10
    v_mfma_f32_16x16x32_bf16 v[212:215], v[244:247], v[140:143], v[212:215]
    s_add_u32 m0, s53, 84480
    v_cvt_pk_bf16_f32 v144, v228, v229
    v_mfma_f32_16x16x32_bf16 a[32:35], a[240:243], v[160:163], a[32:35]
    v_exp_f32 v231, v11
    v_mfma_f32_16x16x32_bf16 a[32:35], a[244:247], v[164:167], a[32:35]
    buffer_load_dwordx4 v240, s[20:23], s52 offen offset:0 lds
    v_mfma_f32_16x16x32_bf16 a[36:39], a[240:243], v[168:171], a[36:39]
    v_exp_f32 v232, v24
    v_mfma_f32_16x16x32_bf16 a[36:39], a[244:247], v[172:175], a[36:39]
    v_exp_f32 v233, v25
    v_mfma_f32_16x16x32_bf16 a[40:43], a[240:243], v[176:179], a[40:43]
    v_cvt_pk_bf16_f32 v145, v230, v231
    v_cvt_pk_bf16_f32 v146, v232, v233
    v_mfma_f32_16x16x32_bf16 a[40:43], a[244:247], v[180:183], a[40:43]
    v_exp_f32 v234, v26
    v_mfma_f32_16x16x32_bf16 a[44:47], a[240:243], v[184:187], a[44:47]
    ds_read_b64_tr_b16 a[234:235], v239 offset:51104
    ds_read_b64_tr_b16 a[236:237], v239 offset:51360
    v_mfma_f32_16x16x32_bf16 a[44:47], a[244:247], v[188:191], a[44:47]
    v_exp_f32 v235, v27
    v_mfma_f32_16x16x32_bf16 a[48:51], a[248:251], v[160:163], a[48:51]
    ds_read_b64_tr_b16 a[238:239], v239 offset:51616
    v_cvt_pk_bf16_f32 v147, v234, v235
    v_mfma_f32_16x16x32_bf16 a[48:51], a[252:255], v[164:167], a[48:51]
    v_exp_f32 v228, v40
    v_mfma_f32_16x16x32_bf16 a[52:55], a[248:251], v[168:171], a[52:55]
    ds_read_b128 a[208:211], v237 offset:34560
    s_add_u32 m0, s53, 85280
    v_mfma_f32_16x16x32_bf16 a[52:55], a[252:255], v[172:175], a[52:55]
    v_exp_f32 v229, v41
    v_mfma_f32_16x16x32_bf16 a[56:59], a[248:251], v[176:179], a[56:59]
    buffer_load_dwordx4 v240, s[20:23], s52 offen offset:256 lds
    v_mfma_f32_16x16x32_bf16 a[56:59], a[252:255], v[180:183], a[56:59]
    v_exp_f32 v230, v42
    v_mfma_f32_16x16x32_bf16 a[60:63], a[248:251], v[184:187], a[60:63]
    ds_read_b128 a[212:215], v237 offset:34624
    v_cvt_pk_bf16_f32 v148, v228, v229
    v_mfma_f32_16x16x32_bf16 a[60:63], a[252:255], v[188:191], a[60:63]
    v_exp_f32 v231, v43
    v_mfma_f32_16x16x32_bf16 v[96:99], a[192:195], a[128:131], v[192:195]
    ds_read_b128 a[216:219], v237 offset:34688
    v_cvt_pk_bf16_f32 v149, v230, v231
    v_mfma_f32_16x16x32_bf16 v[96:99], a[196:199], a[132:135], v[96:99]
    v_exp_f32 v232, v56
    v_mfma_f32_16x16x32_bf16 v[96:99], a[200:203], a[136:139], v[96:99]
    ds_read_b128 a[220:223], v237 offset:34752
    ds_read_b64_tr_b16 a[240:241], v239 offset:50880
    v_mfma_f32_16x16x32_bf16 v[96:99], a[204:207], a[140:143], v[96:99]
    v_exp_f32 v233, v57
    v_mfma_f32_16x16x32_bf16 v[100:103], a[192:195], a[144:147], v[196:199]
    ds_read_b64_tr_b16 a[242:243], v239 offset:51136
    v_cvt_pk_bf16_f32 v150, v232, v233
    v_mfma_f32_16x16x32_bf16 v[100:103], a[196:199], a[148:151], v[100:103]
    v_exp_f32 v234, v58
    v_mfma_f32_16x16x32_bf16 v[100:103], a[200:203], a[152:155], v[100:103]
    ds_read_b64_tr_b16 a[244:245], v239 offset:51392
    s_add_u32 m0, s53, 86080
    v_mfma_f32_16x16x32_bf16 v[100:103], a[204:207], a[156:159], v[100:103]
    v_exp_f32 v235, v59
    v_mfma_f32_16x16x32_bf16 v[104:107], a[192:195], a[160:163], v[200:203]
    buffer_load_dwordx4 v240, s[20:23], s52 offen offset:512 lds
    v_mfma_f32_16x16x32_bf16 v[104:107], a[196:199], a[164:167], v[104:107]
    ds_read_b64_tr_b16 a[246:247], v239 offset:51648
    v_cvt_pk_bf16_f32 v151, v234, v235
    v_mfma_f32_16x16x32_bf16 v[104:107], a[200:203], a[168:171], v[104:107]
    ds_read_b64_tr_b16 a[248:249], v239 offset:50912
    ds_read_b64_tr_b16 a[250:251], v239 offset:51168
    v_mfma_f32_16x16x32_bf16 v[104:107], a[204:207], a[172:175], v[104:107]
    ds_read_b64_tr_b16 a[252:253], v239 offset:51424
    ds_read_b64_tr_b16 a[254:255], v239 offset:51680
    v_mfma_f32_16x16x32_bf16 v[108:111], a[192:195], a[176:179], v[204:207]
    v_mfma_f32_16x16x32_bf16 v[108:111], a[196:199], a[180:183], v[108:111]
    v_mfma_f32_16x16x32_bf16 v[108:111], a[200:203], a[184:187], v[108:111]
    v_exp_f32 v228, v12
    v_mfma_f32_16x16x32_bf16 v[108:111], a[204:207], a[188:191], v[108:111]
    v_exp_f32 v229, v13
    v_mfma_f32_16x16x32_bf16 v[216:219], v[244:247], v[144:147], 0
    v_exp_f32 v230, v14
    v_mfma_f32_16x16x32_bf16 v[216:219], v[244:247], v[148:151], v[216:219]
    v_exp_f32 v231, v15
    s_waitcnt lgkmcnt(0)
    v_mfma_f32_16x16x32_bf16 a[64:67], a[224:227], v[160:163], a[64:67]
    v_cvt_pk_bf16_f32 v152, v228, v229
    v_cvt_pk_bf16_f32 v153, v230, v231
    v_mfma_f32_16x16x32_bf16 a[64:67], a[228:231], v[164:167], a[64:67]
    v_exp_f32 v232, v28
    v_mfma_f32_16x16x32_bf16 a[68:71], a[224:227], v[168:171], a[68:71]
    v_exp_f32 v233, v29
    v_mfma_f32_16x16x32_bf16 a[68:71], a[228:231], v[172:175], a[68:71]
    v_exp_f32 v234, v30
    v_mfma_f32_16x16x32_bf16 a[72:75], a[224:227], v[176:179], a[72:75]
    s_add_u32 m0, s53, 86880
    v_cvt_pk_bf16_f32 v154, v232, v233
    v_mfma_f32_16x16x32_bf16 a[72:75], a[228:231], v[180:183], a[72:75]
    v_exp_f32 v235, v31
    v_mfma_f32_16x16x32_bf16 a[76:79], a[224:227], v[184:187], a[76:79]
    buffer_load_dwordx4 v240, s[20:23], s52 offen offset:768 lds
    v_mfma_f32_16x16x32_bf16 a[76:79], a[228:231], v[188:191], a[76:79]
    v_exp_f32 v228, v44
    v_mfma_f32_16x16x32_bf16 a[80:83], a[232:235], v[160:163], a[80:83]
    s_add_u32 s52, s52, 16384
    v_cvt_pk_bf16_f32 v155, v234, v235
    v_mfma_f32_16x16x32_bf16 a[80:83], a[236:239], v[164:167], a[80:83]
    v_exp_f32 v229, v45
    v_mfma_f32_16x16x32_bf16 a[84:87], a[232:235], v[168:171], a[84:87]
    v_exp_f32 v230, v46
    v_mfma_f32_16x16x32_bf16 a[84:87], a[236:239], v[172:175], a[84:87]
    v_exp_f32 v231, v47
    v_mfma_f32_16x16x32_bf16 a[88:91], a[232:235], v[176:179], a[88:91]
    v_exp_f32 v232, v60
    v_mfma_f32_16x16x32_bf16 a[88:91], a[236:239], v[180:183], a[88:91]
    v_cvt_pk_bf16_f32 v156, v228, v229
    v_cvt_pk_bf16_f32 v157, v230, v231
    v_mfma_f32_16x16x32_bf16 a[92:95], a[232:235], v[184:187], a[92:95]
    v_exp_f32 v233, v61
    v_mfma_f32_16x16x32_bf16 a[92:95], a[236:239], v[188:191], a[92:95]
    s_waitcnt vmcnt(18) lgkmcnt(0)
    s_barrier
    v_mfma_f32_16x16x32_bf16 a[96:99], a[240:243], v[160:163], a[96:99]
    v_exp_f32 v234, v62
    v_mfma_f32_16x16x32_bf16 a[96:99], a[244:247], v[164:167], a[96:99]
    v_exp_f32 v235, v63
    v_mfma_f32_16x16x32_bf16 a[100:103], a[240:243], v[168:171], a[100:103]
    buffer_store_dwordx4 v[248:251], v253, s[4:7], s62 offen sc1
    v_mfma_f32_16x16x32_bf16 a[100:103], a[244:247], v[172:175], a[100:103]
    s_add_u32 s62, s62, 1024
    v_cvt_pk_bf16_f32 v158, v232, v233
    v_mfma_f32_16x16x32_bf16 a[104:107], a[240:243], v[176:179], a[104:107]
    v_cvt_pk_bf16_f32 v159, v234, v235
    v_max3_f32 v241, v208, v212, v216
    v_mfma_f32_16x16x32_bf16 a[104:107], a[244:247], v[180:183], a[104:107]
    ds_read_b128 a[192:195], v236 offset:0
    ds_read_b128 a[196:199], v236 offset:64
    v_mfma_f32_16x16x32_bf16 a[108:111], a[240:243], v[184:187], a[108:111]
    ds_read_b128 a[200:203], v236 offset:128
    ds_read_b128 a[204:207], v236 offset:192
    v_mfma_f32_16x16x32_bf16 a[108:111], a[244:247], v[188:191], a[108:111]
    ds_read_b64_tr_b16 a[224:225], v238 offset:16896
    ds_read_b64_tr_b16 a[226:227], v238 offset:17152
    v_mfma_f32_16x16x32_bf16 v[220:223], v[244:247], v[152:155], 0
    ds_read_b64_tr_b16 a[228:229], v238 offset:17408
    ds_read_b64_tr_b16 a[230:231], v238 offset:17664
    v_mfma_f32_16x16x32_bf16 v[220:223], v[244:247], v[156:159], v[220:223]
    ds_read_b64_tr_b16 a[232:233], v238 offset:16928
    ds_read_b64_tr_b16 a[234:235], v238 offset:17184
    v_mfma_f32_16x16x32_bf16 a[112:115], a[248:251], v[160:163], a[112:115]
    ds_read_b64_tr_b16 a[236:237], v238 offset:17440
    ds_read_b64_tr_b16 a[238:239], v238 offset:17696
    v_mfma_f32_16x16x32_bf16 a[112:115], a[252:255], v[164:167], a[112:115]
    buffer_load_dword v255, v254, s[40:43], s65 offen
    v_mfma_f32_16x16x32_bf16 a[116:119], a[248:251], v[168:171], a[116:119]
    v_mfma_f32_16x16x32_bf16 a[116:119], a[252:255], v[172:175], a[116:119]
    v_mfma_f32_16x16x32_bf16 a[120:123], a[248:251], v[176:179], a[120:123]
    v_mfma_f32_16x16x32_bf16 a[120:123], a[252:255], v[180:183], a[120:123]
    v_mfma_f32_16x16x32_bf16 a[124:127], a[248:251], v[184:187], a[124:127]
    v_mfma_f32_16x16x32_bf16 a[124:127], a[252:255], v[188:191], a[124:127]
    s_nop 1
    v_max_f32 v241, v241, v220
    v_cmp_lt_f32 vcc, s61, v241
    s_cbranch_vccnz L_fbL0
L_fbL0_ret:
    v_mfma_f32_16x16x32_bf16 v[112:115], a[208:211], a[128:131], v[192:195]
    v_exp_f32 v228, v64
    v_mfma_f32_16x16x32_bf16 v[112:115], a[212:215], a[132:135], v[112:115]
    v_exp_f32 v229, v65
    v_mfma_f32_16x16x32_bf16 v[112:115], a[216:219], a[136:139], v[112:115]
    v_exp_f32 v230, v66
    v_mfma_f32_16x16x32_bf16 v[112:115], a[220:223], a[140:143], v[112:115]
    v_exp_f32 v231, v67
    v_mfma_f32_16x16x32_bf16 v[116:119], a[208:211], a[144:147], v[196:199]
    v_cvt_pk_bf16_f32 v160, v228, v229
    v_cvt_pk_bf16_f32 v161, v230, v231
    v_mfma_f32_16x16x32_bf16 v[116:119], a[212:215], a[148:151], v[116:119]
    v_exp_f32 v232, v80
    v_mfma_f32_16x16x32_bf16 v[116:119], a[216:219], a[152:155], v[116:119]
    v_exp_f32 v233, v81
    v_mfma_f32_16x16x32_bf16 v[116:119], a[220:223], a[156:159], v[116:119]
    v_exp_f32 v234, v82
    v_mfma_f32_16x16x32_bf16 v[120:123], a[208:211], a[160:163], v[200:203]
    v_cvt_pk_bf16_f32 v162, v232, v233
    v_add_f32 v224, v224, v208
    v_mfma_f32_16x16x32_bf16 v[120:123], a[212:215], a[164:167], v[120:123]
    v_exp_f32 v235, v83
    v_mfma_f32_16x16x32_bf16 v[120:123], a[216:219], a[168:171], v[120:123]
    v_cvt_pk_bf16_f32 v163, v234, v235
    v_add_f32 v225, v225, v212
    v_mfma_f32_16x16x32_bf16 v[120:123], a[220:223], a[172:175], v[120:123]
    v_add_f32 v226, v226, v216
    v_add_f32 v227, v227, v220
    v_mfma_f32_16x16x32_bf16 v[124:127], a[208:211], a[176:179], v[204:207]
    v_mfma_f32_16x16x32_bf16 v[124:127], a[212:215], a[180:183], v[124:127]
    v_mfma_f32_16x16x32_bf16 v[124:127], a[216:219], a[184:187], v[124:127]
    v_mfma_f32_16x16x32_bf16 v[124:127], a[220:223], a[188:191], v[124:127]
    s_waitcnt lgkmcnt(0)
    v_mfma_f32_16x16x32_bf16 v[0:3], a[192:195], a[128:131], v[192:195]
    v_exp_f32 v228, v96
    v_mfma_f32_16x16x32_bf16 v[0:3], a[196:199], a[132:135], v[0:3]
    v_exp_f32 v229, v97
    v_mfma_f32_16x16x32_bf16 v[0:3], a[200:203], a[136:139], v[0:3]
    s_add_u32 m0, s53, 101376
    v_cvt_pk_bf16_f32 v164, v228, v229
    v_mfma_f32_16x16x32_bf16 v[0:3], a[204:207], a[140:143], v[0:3]
    v_exp_f32 v230, v98
    v_mfma_f32_16x16x32_bf16 v[4:7], a[192:195], a[144:147], v[196:199]
    buffer_load_dwordx4 v240, s[16:19], s51 offen offset:0 lds
    v_mfma_f32_16x16x32_bf16 v[4:7], a[196:199], a[148:151], v[4:7]
    v_exp_f32 v231, v99
    v_mfma_f32_16x16x32_bf16 v[4:7], a[200:203], a[152:155], v[4:7]
    ds_read_b128 a[208:211], v236 offset:256
    v_cvt_pk_bf16_f32 v165, v230, v231
    v_mfma_f32_16x16x32_bf16 v[4:7], a[204:207], a[156:159], v[4:7]
    v_exp_f32 v232, v112
    v_mfma_f32_16x16x32_bf16 v[8:11], a[192:195], a[160:163], v[200:203]
    ds_read_b128 a[212:215], v236 offset:320
    ds_read_b128 a[216:219], v236 offset:384
    v_mfma_f32_16x16x32_bf16 v[8:11], a[196:199], a[164:167], v[8:11]
    ds_read_b128 a[220:223], v236 offset:448
    ds_read_b64_tr_b16 a[240:241], v238 offset:16960
    v_mfma_f32_16x16x32_bf16 v[8:11], a[200:203], a[168:171], v[8:11]
    v_exp_f32 v233, v113
    v_mfma_f32_16x16x32_bf16 v[8:11], a[204:207], a[172:175], v[8:11]
    ds_read_b64_tr_b16 a[242:243], v238 offset:17216
    v_cvt_pk_bf16_f32 v166, v232, v233
    v_mfma_f32_16x16x32_bf16 v[12:15], a[192:195], a[176:179], v[204:207]
    v_exp_f32 v234, v114
    v_mfma_f32_16x16x32_bf16 v[12:15], a[196:199], a[180:183], v[12:15]
    ds_read_b64_tr_b16 a[244:245], v238 offset:17472
    s_add_u32 m0, s53, 102176
    v_mfma_f32_16x16x32_bf16 v[12:15], a[200:203], a[184:187], v[12:15]
    buffer_load_dwordx4 v240, s[16:19], s51 offen offset:256 lds
    v_mfma_f32_16x16x32_bf16 v[12:15], a[204:207], a[188:191], v[12:15]
    v_exp_f32 v235, v115
    v_mfma_f32_16x16x32_bf16 a[0:3], a[224:227], v[128:131], a[0:3]
    ds_read_b64_tr_b16 a[246:247], v238 offset:17728
    v_cvt_pk_bf16_f32 v167, v234, v235
    v_mfma_f32_16x16x32_bf16 a[0:3], a[228:231], v[132:135], a[0:3]
    ds_read_b64_tr_b16 a[248:249], v238 offset:16992
    ds_read_b64_tr_b16 a[250:251], v238 offset:17248
    v_mfma_f32_16x16x32_bf16 a[4:7], a[224:227], v[136:139], a[4:7]
    ds_read_b64_tr_b16 a[252:253], v238 offset:17504
    ds_read_b64_tr_b16 a[254:255], v238 offset:17760
    v_mfma_f32_16x16x32_bf16 a[4:7], a[228:231], v[140:143], a[4:7]
    ds_read_b128 a[192:195], v236 offset:512
    ds_read_b128 a[196:199], v236 offset:576
    v_mfma_f32_16x16x32_bf16 a[8:11], a[224:227], v[144:147], a[8:11]
    ds_read_b128 a[200:203], v236 offset:640
    ds_read_b128 a[204:207], v236 offset:704
    v_mfma_f32_16x16x32_bf16 a[8:11], a[228:231], v[148:151], a[8:11]
    v_mfma_f32_16x16x32_bf16 a[12:15], a[224:227], v[152:155], a[12:15]
    v_exp_f32 v228, v68
    v_mfma_f32_16x16x32_bf16 a[12:15], a[228:231], v[156:159], a[12:15]
    v_exp_f32 v229, v69
    v_mfma_f32_16x16x32_bf16 v[208:211], v[244:247], v[160:163], 0
    v_exp_f32 v230, v70
    v_mfma_f32_16x16x32_bf16 v[208:211], v[244:247], v[164:167], v[208:211]
    v_exp_f32 v231, v71
    v_mfma_f32_16x16x32_bf16 a[16:19], a[232:235], v[128:131], a[16:19]
    v_cvt_pk_bf16_f32 v168, v228, v229
    v_cvt_pk_bf16_f32 v169, v230, v231
    v_mfma_f32_16x16x32_bf16 a[16:19], a[236:239], v[132:135], a[16:19]
    v_exp_f32 v232, v84
    v_mfma_f32_16x16x32_bf16 a[20:23], a[232:235], v[136:139], a[20:23]
    v_exp_f32 v233, v85
    v_mfma_f32_16x16x32_bf16 a[20:23], a[236:239], v[140:143], a[20:23]
    v_exp_f32 v234, v86
    v_mfma_f32_16x16x32_bf16 a[24:27], a[232:235], v[144:147], a[24:27]
    s_add_u32 m0, s53, 102976
    v_cvt_pk_bf16_f32 v170, v232, v233
    v_mfma_f32_16x16x32_bf16 a[24:27], a[236:239], v[148:151], a[24:27]
    v_exp_f32 v235, v87
    v_mfma_f32_16x16x32_bf16 a[28:31], a[232:235], v[152:155], a[28:31]
    buffer_load_dwordx4 v240, s[16:19], s51 offen offset:512 lds
    v_mfma_f32_16x16x32_bf16 a[28:31], a[236:239], v[156:159], a[28:31]
    v_exp_f32 v228, v100
    s_waitcnt lgkmcnt(0)
    v_mfma_f32_16x16x32_bf16 v[16:19], a[208:211], a[128:131], v[192:195]
    v_exp_f32 v229, v101
    v_mfma_f32_16x16x32_bf16 v[16:19], a[212:215], a[132:135], v[16:19]
    v_cvt_pk_bf16_f32 v171, v234, v235
    v_cvt_pk_bf16_f32 v172, v228, v229
    v_mfma_f32_16x16x32_bf16 v[16:19], a[216:219], a[136:139], v[16:19]
    v_exp_f32 v230, v102
    v_mfma_f32_16x16x32_bf16 v[16:19], a[220:223], a[140:143], v[16:19]
    v_exp_f32 v231, v103
    v_mfma_f32_16x16x32_bf16 v[20:23], a[208:211], a[144:147], v[196:199]
    v_exp_f32 v232, v116
    v_mfma_f32_16x16x32_bf16 v[20:23], a[212:215], a[148:151], v[20:23]
    v_exp_f32 v233, v117
    v_mfma_f32_16x16x32_bf16 v[20:23], a[216:219], a[152:155], v[20:23]
    v_exp_f32 v234, v118
    v_mfma_f32_16x16x32_bf16 v[20:23], a[220:223], a[156:159], v[20:23]
    s_add_u32 m0, s53, 103776
    v_cvt_pk_bf16_f32 v173, v230, v231
    v_mfma_f32_16x16x32_bf16 v[24:27], a[208:211], a[160:163], v[200:203]
    v_exp_f32 v235, v119
    v_mfma_f32_16x16x32_bf16 v[24:27], a[212:215], a[164:167], v[24:27]
    v_cvt_pk_bf16_f32 v174, v232, v233
    v_cvt_pk_bf16_f32 v175, v234, v235
    v_mfma_f32_16x16x32_bf16 v[24:27], a[216:219], a[168:171], v[24:27]
    buffer_load_dwordx4 v240, s[16:19], s51 offen offset:768 lds
    v_mfma_f32_16x16x32_bf16 v[24:27], a[220:223], a[172:175], v[24:27]
    ds_read_b64_tr_b16 a[224:225], v238 offset:17024
    s_add_u32 s51, s51, 16384
    v_mfma_f32_16x16x32_bf16 v[28:31], a[208:211], a[176:179], v[204:207]
    ds_read_b64_tr_b16 a[226:227], v238 offset:17280
    ds_read_b64_tr_b16 a[228:229], v238 offset:17536
    v_mfma_f32_16x16x32_bf16 v[28:31], a[212:215], a[180:183], v[28:31]
    ds_read_b64_tr_b16 a[230:231], v238 offset:17792
    ds_read_b64_tr_b16 a[232:233], v238 offset:17056
    v_mfma_f32_16x16x32_bf16 v[28:31], a[216:219], a[184:187], v[28:31]
    v_exp_f32 v228, v72
    v_mfma_f32_16x16x32_bf16 v[28:31], a[220:223], a[188:191], v[28:31]
    v_exp_f32 v229, v73
    v_mfma_f32_16x16x32_bf16 v[212:215], v[244:247], v[168:171], 0
    v_exp_f32 v230, v74
    v_mfma_f32_16x16x32_bf16 v[212:215], v[244:247], v[172:175], v[212:215]
    v_exp_f32 v231, v75
    v_mfma_f32_16x16x32_bf16 a[32:35], a[240:243], v[128:131], a[32:35]
    v_cvt_pk_bf16_f32 v176, v228, v229
    v_cvt_pk_bf16_f32 v177, v230, v231
    v_mfma_f32_16x16x32_bf16 a[32:35], a[244:247], v[132:135], a[32:35]
    v_exp_f32 v232, v88
    v_mfma_f32_16x16x32_bf16 a[36:39], a[240:243], v[136:139], a[36:39]
    ds_read_b64_tr_b16 a[234:235], v238 offset:17312
    ds_read_b64_tr_b16 a[236:237], v238 offset:17568
    v_mfma_f32_16x16x32_bf16 a[36:39], a[244:247], v[140:143], a[36:39]
    v_exp_f32 v233, v89
    v_mfma_f32_16x16x32_bf16 a[40:43], a[240:243], v[144:147], a[40:43]
    s_add_u32 m0, s53, 118272
    v_cvt_pk_bf16_f32 v178, v232, v233
    v_mfma_f32_16x16x32_bf16 a[40:43], a[244:247], v[148:151], a[40:43]
    v_exp_f32 v234, v90
    v_mfma_f32_16x16x32_bf16 a[44:47], a[240:243], v[152:155], a[44:47]
    buffer_load_dwordx4 v240, s[20:23], s52 offen offset:0 lds
    v_mfma_f32_16x16x32_bf16 a[44:47], a[244:247], v[156:159], a[44:47]
    v_exp_f32 v235, v91
    v_mfma_f32_16x16x32_bf16 a[48:51], a[248:251], v[128:131], a[48:51]
    ds_read_b64_tr_b16 a[238:239], v238 offset:17824
    v_cvt_pk_bf16_f32 v179, v234, v235
    v_mfma_f32_16x16x32_bf16 a[48:51], a[252:255], v[132:135], a[48:51]
    v_exp_f32 v228, v104
    v_mfma_f32_16x16x32_bf16 a[52:55], a[248:251], v[136:139], a[52:55]
    ds_read_b128 a[208:211], v236 offset:768
    ds_read_b128 a[212:215], v236 offset:832
    v_mfma_f32_16x16x32_bf16 a[52:55], a[252:255], v[140:143], a[52:55]
    v_exp_f32 v229, v105
    v_mfma_f32_16x16x32_bf16 a[56:59], a[248:251], v[144:147], a[56:59]
    ds_read_b128 a[216:219], v236 offset:896
    v_cvt_pk_bf16_f32 v180, v228, v229
    v_mfma_f32_16x16x32_bf16 a[56:59], a[252:255], v[148:151], a[56:59]
    v_exp_f32 v230, v106
    v_mfma_f32_16x16x32_bf16 a[60:63], a[248:251], v[152:155], a[60:63]
    ds_read_b128 a[220:223], v236 offset:960
    ds_read_b64_tr_b16 a[240:241], v238 offset:17088
    v_mfma_f32_16x16x32_bf16 a[60:63], a[252:255], v[156:159], a[60:63]
    v_exp_f32 v231, v107
    v_mfma_f32_16x16x32_bf16 v[32:35], a[192:195], a[128:131], v[192:195]
    ds_read_b64_tr_b16 a[242:243], v238 offset:17344
    v_cvt_pk_bf16_f32 v181, v230, v231
    v_mfma_f32_16x16x32_bf16 v[32:35], a[196:199], a[132:135], v[32:35]
    v_exp_f32 v232, v120
    v_mfma_f32_16x16x32_bf16 v[32:35], a[200:203], a[136:139], v[32:35]
    ds_read_b64_tr_b16 a[244:245], v238 offset:17600
    s_add_u32 m0, s53, 119072
    v_mfma_f32_16x16x32_bf16 v[32:35], a[204:207], a[140:143], v[32:35]
    v_exp_f32 v233, v121
    v_mfma_f32_16x16x32_bf16 v[36:39], a[192:195], a[144:147], v[196:199]
    buffer_load_dwordx4 v240, s[20:23], s52 offen offset:256 lds
    v_mfma_f32_16x16x32_bf16 v[36:39], a[196:199], a[148:151], v[36:39]
    v_exp_f32 v234, v122
    v_mfma_f32_16x16x32_bf16 v[36:39], a[200:203], a[152:155], v[36:39]
    ds_read_b64_tr_b16 a[246:247], v238 offset:17856
    v_cvt_pk_bf16_f32 v182, v232, v233
    v_mfma_f32_16x16x32_bf16 v[36:39], a[204:207], a[156:159], v[36:39]
    v_exp_f32 v235, v123
    v_mfma_f32_16x16x32_bf16 v[40:43], a[192:195], a[160:163], v[200:203]
    ds_read_b64_tr_b16 a[248:249], v238 offset:17120
    v_cvt_pk_bf16_f32 v183, v234, v235
    v_mfma_f32_16x16x32_bf16 v[40:43], a[196:199], a[164:167], v[40:43]
    ds_read_b64_tr_b16 a[250:251], v238 offset:17376
    ds_read_b64_tr_b16 a[252:253], v238 offset:17632
    v_mfma_f32_16x16x32_bf16 v[40:43], a[200:203], a[168:171], v[40:43]
    ds_read_b64_tr_b16 a[254:255], v238 offset:17888
    v_mfma_f32_16x16x32_bf16 v[40:43], a[204:207], a[172:175], v[40:43]
    v_mfma_f32_16x16x32_bf16 v[44:47], a[192:195], a[176:179], v[204:207]
    v_mfma_f32_16x16x32_bf16 v[44:47], a[196:199], a[180:183], v[44:47]
    v_mfma_f32_16x16x32_bf16 v[44:47], a[200:203], a[184:187], v[44:47]
    v_exp_f32 v228, v76
    v_mfma_f32_16x16x32_bf16 v[44:47], a[204:207], a[188:191], v[44:47]
    v_exp_f32 v229, v77
    v_mfma_f32_16x16x32_bf16 v[216:219], v[244:247], v[176:179], 0
    v_exp_f32 v230, v78
    v_mfma_f32_16x16x32_bf16 v[216:219], v[244:247], v[180:183], v[216:219]
    v_exp_f32 v231, v79
    s_waitcnt lgkmcnt(0)
    v_mfma_f32_16x16x32_bf16 a[64:67], a[224:227], v[128:131], a[64:67]
    s_add_u32 m0, s53, 119872
    v_cvt_pk_bf16_f32 v184, v228, v229
    v_mfma_f32_16x16x32_bf16 a[64:67], a[228:231], v[132:135], a[64:67]
    v_exp_f32 v232, v92
    v_mfma_f32_16x16x32_bf16 a[68:71], a[224:227], v[136:139], a[68:71]
    v_exp_f32 v233, v93
    v_mfma_f32_16x16x32_bf16 a[68:71], a[228:231], v[140:143], a[68:71]
    buffer_load_dwordx4 v240, s[20:23], s52 offen offset:512 lds
    v_mfma_f32_16x16x32_bf16 a[72:75], a[224:227], v[144:147], a[72:75]
    v_cvt_pk_bf16_f32 v185, v230, v231
    v_cvt_pk_bf16_f32 v186, v232, v233
    v_mfma_f32_16x16x32_bf16 a[72:75], a[228:231], v[148:151], a[72:75]
    v_exp_f32 v234, v94
    v_mfma_f32_16x16x32_bf16 a[76:79], a[224:227], v[152:155], a[76:79]
    v_exp_f32 v235, v95
    v_mfma_f32_16x16x32_bf16 a[76:79], a[228:231], v[156:159], a[76:79]
    v_exp_f32 v228, v108
    v_mfma_f32_16x16x32_bf16 a[80:83], a[232:235], v[128:131], a[80:83]
    v_exp_f32 v229, v109
    v_mfma_f32_16x16x32_bf16 a[80:83], a[236:239], v[132:135], a[80:83]
    v_cvt_pk_bf16_f32 v187, v234, v235
    v_cvt_pk_bf16_f32 v188, v228, v229
    v_mfma_f32_16x16x32_bf16 a[84:87], a[232:235], v[136:139], a[84:87]
    v_exp_f32 v230, v110
    v_mfma_f32_16x16x32_bf16 a[84:87], a[236:239], v[140:143], a[84:87]
    v_exp_f32 v231, v111
    v_mfma_f32_16x16x32_bf16 a[88:91], a[232:235], v[144:147], a[88:91]
    v_exp_f32 v232, v124
    v_mfma_f32_16x16x32_bf16 a[88:91], a[236:239], v[148:151], a[88:91]
    s_add_u32 m0, s53, 120672
    v_cvt_pk_bf16_f32 v189, v230, v231
    v_mfma_f32_16x16x32_bf16 a[92:95], a[232:235], v[152:155], a[92:95]
    v_exp_f32 v233, v125
    v_mfma_f32_16x16x32_bf16 a[92:95], a[236:239], v[156:159], a[92:95]
    s_waitcnt vmcnt(18) lgkmcnt(0)
    s_barrier
    v_mfma_f32_16x16x32_bf16 a[96:99], a[240:243], v[128:131], a[96:99]
    v_exp_f32 v234, v126
    v_mfma_f32_16x16x32_bf16 a[96:99], a[244:247], v[132:135], a[96:99]
    buffer_load_dwordx4 v240, s[20:23], s52 offen offset:768 lds
    v_mfma_f32_16x16x32_bf16 a[100:103], a[240:243], v[136:139], a[100:103]
    v_exp_f32 v235, v127
    v_mfma_f32_16x16x32_bf16 a[100:103], a[244:247], v[140:143], a[100:103]
    s_add_u32 s52, s52, 16384
    v_cvt_pk_bf16_f32 v190, v232, v233
    v_mfma_f32_16x16x32_bf16 a[104:107], a[240:243], v[144:147], a[104:107]
    v_cvt_pk_bf16_f32 v191, v234, v235
    v_max3_f32 v241, v208, v212, v216
    v_mfma_f32_16x16x32_bf16 a[104:107], a[244:247], v[148:151], a[104:107]
    ds_read_b128 a[192:195], v236 offset:33792
    ds_read_b128 a[196:199], v236 offset:33856
    v_mfma_f32_16x16x32_bf16 a[108:111], a[240:243], v[152:155], a[108:111]
    ds_read_b128 a[200:203], v236 offset:33920
    ds_read_b128 a[204:207], v236 offset:33984
    v_mfma_f32_16x16x32_bf16 a[108:111], a[244:247], v[156:159], a[108:111]
    ds_read_b64_tr_b16 a[224:225], v238 offset:50688
    ds_read_b64_tr_b16 a[226:227], v238 offset:50944
    v_mfma_f32_16x16x32_bf16 v[220:223], v[244:247], v[184:187], 0
    ds_read_b64_tr_b16 a[228:229], v238 offset:51200
    ds_read_b64_tr_b16 a[230:231], v238 offset:51456
    v_mfma_f32_16x16x32_bf16 v[220:223], v[244:247], v[188:191], v[220:223]
    ds_read_b64_tr_b16 a[232:233], v238 offset:50720
    ds_read_b64_tr_b16 a[234:235], v238 offset:50976
    v_mfma_f32_16x16x32_bf16 a[112:115], a[248:251], v[128:131], a[112:115]
    buffer_store_dwordx4 v[248:251], v253, s[4:7], s62 offen sc1
    v_mfma_f32_16x16x32_bf16 a[112:115], a[252:255], v[132:135], a[112:115]
    ds_read_b64_tr_b16 a[236:237], v238 offset:51232
    s_add_u32 s62, s62, 1024
    v_mfma_f32_16x16x32_bf16 a[116:119], a[248:251], v[136:139], a[116:119]
    ds_read_b64_tr_b16 a[238:239], v238 offset:51488
    v_mfma_f32_16x16x32_bf16 a[116:119], a[252:255], v[140:143], a[116:119]
    v_mfma_f32_16x16x32_bf16 a[120:123], a[248:251], v[144:147], a[120:123]
    v_mfma_f32_16x16x32_bf16 a[120:123], a[252:255], v[148:151], a[120:123]
    v_mfma_f32_16x16x32_bf16 a[124:127], a[248:251], v[152:155], a[124:127]
    v_mfma_f32_16x16x32_bf16 a[124:127], a[252:255], v[156:159], a[124:127]
    s_nop 1
    v_max_f32 v241, v241, v220
    v_cmp_lt_f32 vcc, s61, v241
    s_cbranch_vccnz L_fbL1
L_fbL1_ret:
    v_mfma_f32_16x16x32_bf16 v[48:51], a[208:211], a[128:131], v[192:195]
    v_exp_f32 v228, v0
    v_mfma_f32_16x16x32_bf16 v[48:51], a[212:215], a[132:135], v[48:51]
    v_exp_f32 v229, v1
    v_mfma_f32_16x16x32_bf16 v[48:51], a[216:219], a[136:139], v[48:51]
    v_exp_f32 v230, v2
    v_mfma_f32_16x16x32_bf16 v[48:51], a[220:223], a[140:143], v[48:51]
    v_exp_f32 v231, v3
    v_mfma_f32_16x16x32_bf16 v[52:55], a[208:211], a[144:147], v[196:199]
    v_cvt_pk_bf16_f32 v128, v228, v229
    v_cvt_pk_bf16_f32 v129, v230, v231
    v_mfma_f32_16x16x32_bf16 v[52:55], a[212:215], a[148:151], v[52:55]
    v_exp_f32 v232, v16
    v_mfma_f32_16x16x32_bf16 v[52:55], a[216:219], a[152:155], v[52:55]
    v_exp_f32 v233, v17
    v_mfma_f32_16x16x32_bf16 v[52:55], a[220:223], a[156:159], v[52:55]
    v_exp_f32 v234, v18
    v_mfma_f32_16x16x32_bf16 v[56:59], a[208:211], a[160:163], v[200:203]
    v_cvt_pk_bf16_f32 v130, v232, v233
    v_add_f32 v224, v224, v208
    v_mfma_f32_16x16x32_bf16 v[56:59], a[212:215], a[164:167], v[56:59]
    v_exp_f32 v235, v19
    v_mfma_f32_16x16x32_bf16 v[56:59], a[216:219], a[168:171], v[56:59]
    v_cvt_pk_bf16_f32 v131, v234, v235
    v_add_f32 v225, v225, v212
    v_mfma_f32_16x16x32_bf16 v[56:59], a[220:223], a[172:175], v[56:59]
    v_add_f32 v226, v226, v216
    v_add_f32 v227, v227, v220
    v_mfma_f32_16x16x32_bf16 v[60:63], a[208:211], a[176:179], v[204:207]
    v_mfma_f32_16x16x32_bf16 v[60:63], a[212:215], a[180:183], v[60:63]
    v_mfma_f32_16x16x32_bf16 v[60:63], a[216:219], a[184:187], v[60:63]
    v_mfma_f32_16x16x32_bf16 v[60:63], a[220:223], a[188:191], v[60:63]
    s_waitcnt lgkmcnt(0)
    v_mfma_f32_16x16x32_bf16 v[64:67], a[192:195], a[128:131], v[192:195]
    v_exp_f32 v228, v32
    v_mfma_f32_16x16x32_bf16 v[64:67], a[196:199], a[132:135], v[64:67]
    v_exp_f32 v229, v33
    v_mfma_f32_16x16x32_bf16 v[64:67], a[200:203], a[136:139], v[64:67]
    s_add_u32 m0, s53, 0
    v_cvt_pk_bf16_f32 v132, v228, v229
    v_mfma_f32_16x16x32_bf16 v[64:67], a[204:207], a[140:143], v[64:67]
    v_exp_f32 v230, v34
    v_mfma_f32_16x16x32_bf16 v[68:71], a[192:195], a[144:147], v[196:199]
    buffer_load_dwordx4 v240, s[16:19], s51 offen offset:0 lds
    v_mfma_f32_16x16x32_bf16 v[68:71], a[196:199], a[148:151], v[68:71]
    v_exp_f32 v231, v35
    v_mfma_f32_16x16x32_bf16 v[68:71], a[200:203], a[152:155], v[68:71]
    ds_read_b128 a[208:211], v236 offset:34048
    v_cvt_pk_bf16_f32 v133, v230, v231
    v_mfma_f32_16x16x32_bf16 v[68:71], a[204:207], a[156:159], v[68:71]
    v_exp_f32 v232, v48
    v_mfma_f32_16x16x32_bf16 v[72:75], a[192:195], a[160:163], v[200:203]
    ds_read_b128 a[212:215], v236 offset:34112
    ds_read_b128 a[216:219], v236 offset:34176
    v_mfma_f32_16x16x32_bf16 v[72:75], a[196:199], a[164:167], v[72:75]
    ds_read_b128 a[220:223], v236 offset:34240
    ds_read_b64_tr_b16 a[240:241], v238 offset:50752
    v_mfma_f32_16x16x32_bf16 v[72:75], a[200:203], a[168:171], v[72:75]
    v_exp_f32 v233, v49
    v_mfma_f32_16x16x32_bf16 v[72:75], a[204:207], a[172:175], v[72:75]
    ds_read_b64_tr_b16 a[242:243], v238 offset:51008
    v_cvt_pk_bf16_f32 v134, v232, v233
    v_mfma_f32_16x16x32_bf16 v[76:79], a[192:195], a[176:179], v[204:207]
    v_exp_f32 v234, v50
    v_mfma_f32_16x16x32_bf16 v[76:79], a[196:199], a[180:183], v[76:79]
    ds_read_b64_tr_b16 a[244:245], v238 offset:51264
    s_add_u32 m0, s53, 800
    v_mfma_f32_16x16x32_bf16 v[76:79], a[200:203], a[184:187], v[76:79]
    buffer_load_dwordx4 v240, s[16:19], s51 offen offset:256 lds
    v_mfma_f32_16x16x32_bf16 v[76:79], a[204:207], a[188:191], v[76:79]
    v_exp_f32 v235, v51
    v_mfma_f32_16x16x32_bf16 a[0:3], a[224:227], v[160:163], a[0:3]
    ds_read_b64_tr_b16 a[246:247], v238 offset:51520
    v_cvt_pk_bf16_f32 v135, v234, v235
    v_mfma_f32_16x16x32_bf16 a[0:3], a[228:231], v[164:167], a[0:3]
    ds_read_b64_tr_b16 a[248:249], v238 offset:50784
    ds_read_b64_tr_b16 a[250:251], v238 offset:51040
    v_mfma_f32_16x16x32_bf16 a[4:7], a[224:227], v[168:171], a[4:7]
    ds_read_b64_tr_b16 a[252:253], v238 offset:51296
    ds_read_b64_tr_b16 a[254:255], v238 offset:51552
    v_mfma_f32_16x16x32_bf16 a[4:7], a[228:231], v[172:175], a[4:7]
    ds_read_b128 a[192:195], v236 offset:34304
    ds_read_b128 a[196:199], v236 offset:34368
    v_mfma_f32_16x16x32_bf16 a[8:11], a[224:227], v[176:179], a[8:11]
    ds_read_b128 a[200:203], v236 offset:34432
    ds_read_b128 a[204:207], v236 offset:34496
    v_mfma_f32_16x16x32_bf16 a[8:11], a[228:231], v[180:183], a[8:11]
    v_mfma_f32_16x16x32_bf16 a[12:15], a[224:227], v[184:187], a[12:15]
    v_exp_f32 v228, v4
    v_mfma_f32_16x16x32_bf16 a[12:15], a[228:231], v[188:191], a[12:15]
    v_exp_f32 v229, v5
    v_mfma_f32_16x16x32_bf16 v[208:211], v[244:247], v[128:131], 0
    v_exp_f32 v230, v6
    v_mfma_f32_16x16x32_bf16 v[208:211], v[244:247], v[132:135], v[208:211]
    v_exp_f32 v231, v7
    v_mfma_f32_16x16x32_bf16 a[16:19], a[232:235], v[160:163], a[16:19]
    v_cvt_pk_bf16_f32 v136, v228, v229
    v_cvt_pk_bf16_f32 v137, v230, v231
    v_mfma_f32_16x16x32_bf16 a[16:19], a[236:239], v[164:167], a[16:19]
    v_exp_f32 v232, v20
    v_mfma_f32_16x16x32_bf16 a[20:23], a[232:235], v[168:171], a[20:23]
    v_exp_f32 v233, v21
    v_mfma_f32_16x16x32_bf16 a[20:23], a[236:239], v[172:175], a[20:23]
    v_exp_f32 v234, v22
    v_mfma_f32_16x16x32_bf16 a[24:27], a[232:235], v[176:179], a[24:27]
    s_add_u32 m0, s53, 1600
    v_cvt_pk_bf16_f32 v138, v232, v233
    v_mfma_f32_16x16x32_bf16 a[24:27], a[236:239], v[180:183], a[24:27]
    v_exp_f32 v235, v23
    v_mfma_f32_16x16x32_bf16 a[28:31], a[232:235], v[184:187], a[28:31]
    buffer_load_dwordx4 v240, s[16:19], s51 offen offset:512 lds
    v_mfma_f32_16x16x32_bf16 a[28:31], a[236:239], v[188:191], a[28:31]
    v_exp_f32 v228, v36
    s_waitcnt lgkmcnt(0)
    v_mfma_f32_16x16x32_bf16 v[80:83], a[208:211], a[128:131], v[192:195]
    v_exp_f32 v229, v37
    v_mfma_f32_16x16x32_bf16 v[80:83], a[212:215], a[132:135], v[80:83]
    v_cvt_pk_bf16_f32 v139, v234, v235
    v_cvt_pk_bf16_f32 v140, v228, v229
    v_mfma_f32_16x16x32_bf16 v[80:83], a[216:219], a[136:139], v[80:83]
    v_exp_f32 v230, v38
    v_mfma_f32_16x16x32_bf16 v[80:83], a[220:223], a[140:143], v[80:83]
    v_exp_f32 v231, v39
    v_mfma_f32_16x16x32_bf16 v[84:87], a[208:211], a[144:147], v[196:199]
    v_exp_f32 v232, v52
    v_mfma_f32_16x16x32_bf16 v[84:87], a[212:215], a[148:151], v[84:87]
    v_exp_f32 v233, v53
    v_mfma_f32_16x16x32_bf16 v[84:87], a[216:219], a[152:155], v[84:87]
    v_exp_f32 v234, v54
    v_mfma_f32_16x16x32_bf16 v[84:87], a[220:223], a[156:159], v[84:87]
    s_add_u32 m0, s53, 2400
    v_cvt_pk_bf16_f32 v141, v230, v231
    v_mfma_f32_16x16x32_bf16 v[88:91], a[208:211], a[160:163], v[200:203]
    v_exp_f32 v235, v55
    v_mfma_f32_16x16x32_bf16 v[88:91], a[212:215], a[164:167], v[88:91]
    v_cvt_pk_bf16_f32 v142, v232, v233
    v_cvt_pk_bf16_f32 v143, v234, v235
    v_mfma_f32_16x16x32_bf16 v[88:91], a[216:219], a[168:171], v[88:91]
    buffer_load_dwordx4 v240, s[16:19], s51 offen offset:768 lds
    v_mfma_f32_16x16x32_bf16 v[88:91], a[220:223], a[172:175], v[88:91]
    ds_read_b64_tr_b16 a[224:225], v238 offset:50816
    s_add_u32 s51, s51, 16384
    v_mfma_f32_16x16x32_bf16 v[92:95], a[208:211], a[176:179], v[204:207]
    ds_read_b64_tr_b16 a[226:227], v238 offset:51072
    ds_read_b64_tr_b16 a[228:229], v238 offset:51328
    v_mfma_f32_16x16x32_bf16 v[92:95], a[212:215], a[180:183], v[92:95]
    ds_read_b64_tr_b16 a[230:231], v238 offset:51584
    ds_read_b64_tr_b16 a[232:233], v238 offset:50848
    v_mfma_f32_16x16x32_bf16 v[92:95], a[216:219], a[184:187], v[92:95]
    v_exp_f32 v228, v8
    v_mfma_f32_16x16x32_bf16 v[92:95], a[220:223], a[188:191], v[92:95]
    v_exp_f32 v229, v9
    v_mfma_f32_16x16x32_bf16 v[212:215], v[244:247], v[136:139], 0
    v_exp_f32 v230, v10
    v_mfma_f32_16x16x32_bf16 v[212:215], v[244:247], v[140:143], v[212:215]
    v_exp_f32 v231, v11
    v_mfma_f32_16x16x32_bf16 a[32:35], a[240:243], v[160:163], a[32:35]
    v_cvt_pk_bf16_f32 v144, v228, v229
    v_cvt_pk_bf16_f32 v145, v230, v231
    v_mfma_f32_16x16x32_bf16 a[32:35], a[244:247], v[164:167], a[32:35]
    v_exp_f32 v232, v24
    v_mfma_f32_16x16x32_bf16 a[36:39], a[240:243], v[168:171], a[36:39]
    ds_read_b64_tr_b16 a[234:235], v238 offset:51104
    ds_read_b64_tr_b16 a[236:237], v238 offset:51360
    v_mfma_f32_16x16x32_bf16 a[36:39], a[244:247], v[172:175], a[36:39]
    v_exp_f32 v233, v25
    v_mfma_f32_16x16x32_bf16 a[40:43], a[240:243], v[176:179], a[40:43]
    s_add_u32 m0, s53, 16896
    v_cvt_pk_bf16_f32 v146, v232, v233
    v_mfma_f32_16x16x32_bf16 a[40:43], a[244:247], v[180:183], a[40:43]
    v_exp_f32 v234, v26
    v_mfma_f32_16x16x32_bf16 a[44:47], a[240:243], v[184:187], a[44:47]
    buffer_load_dwordx4 v240, s[20:23], s52 offen offset:0 lds
    v_mfma_f32_16x16x32_bf16 a[44:47], a[244:247], v[188:191], a[44:47]
    v_exp_f32 v235, v27
    v_mfma_f32_16x16x32_bf16 a[48:51], a[248:251], v[160:163], a[48:51]
    ds_read_b64_tr_b16 a[238:239], v238 offset:51616
    v_cvt_pk_bf16_f32 v147, v234, v235
    v_mfma_f32_16x16x32_bf16 a[48:51], a[252:255], v[164:167], a[48:51]
    v_exp_f32 v228, v40
    v_mfma_f32_16x16x32_bf16 a[52:55], a[248:251], v[168:171], a[52:55]
    ds_read_b128 a[208:211], v236 offset:34560
    ds_read_b128 a[212:215], v236 offset:34624
    v_mfma_f32_16x16x32_bf16 a[52:55], a[252:255], v[172:175], a[52:55]
    v_exp_f32 v229, v41
    v_mfma_f32_16x16x32_bf16 a[56:59], a[248:251], v[176:179], a[56:59]
    ds_read_b128 a[216:219], v236 offset:34688
    v_cvt_pk_bf16_f32 v148, v228, v229
    v_mfma_f32_16x16x32_bf16 a[56:59], a[252:255], v[180:183], a[56:59]
    v_exp_f32 v230, v42
    v_mfma_f32_16x16x32_bf16 a[60:63], a[248:251], v[184:187], a[60:63]
    ds_read_b128 a[220:223], v236 offset:34752
    ds_read_b64_tr_b16 a[240:241], v238 offset:50880
    v_mfma_f32_16x16x32_bf16 a[60:63], a[252:255], v[188:191], a[60:63]
    v_exp_f32 v231, v43
    v_mfma_f32_16x16x32_bf16 v[96:99], a[192:195], a[128:131], v[192:195]
    ds_read_b64_tr_b16 a[242:243], v238 offset:51136
    v_cvt_pk_bf16_f32 v149, v230, v231
    v_mfma_f32_16x16x32_bf16 v[96:99], a[196:199], a[132:135], v[96:99]
    v_exp_f32 v232, v56
    v_mfma_f32_16x16x32_bf16 v[96:99], a[200:203], a[136:139], v[96:99]
    ds_read_b64_tr_b16 a[244:245], v238 offset:51392
    s_add_u32 m0, s53, 17696
    v_mfma_f32_16x16x32_bf16 v[96:99], a[204:207], a[140:143], v[96:99]
    v_exp_f32 v233, v57
    v_mfma_f32_16x16x32_bf16 v[100:103], a[192:195], a[144:147], v[196:199]
    buffer_load_dwordx4 v240, s[20:23], s52 offen offset:256 lds
    v_mfma_f32_16x16x32_bf16 v[100:103], a[196:199], a[148:151], v[100:103]
    v_exp_f32 v234, v58
    v_mfma_f32_16x16x32_bf16 v[100:103], a[200:203], a[152:155], v[100:103]
    ds_read_b64_tr_b16 a[246:247], v238 offset:51648
    v_cvt_pk_bf16_f32 v150, v232, v233
    v_mfma_f32_16x16x32_bf16 v[100:103], a[204:207], a[156:159], v[100:103]
    v_exp_f32 v235, v59
    v_mfma_f32_16x16x32_bf16 v[104:107], a[192:195], a[160:163], v[200:203]
    ds_read_b64_tr_b16 a[248:249], v238 offset:50912
    v_cvt_pk_bf16_f32 v151, v234, v235
    v_mfma_f32_16x16x32_bf16 v[104:107], a[196:199], a[164:167], v[104:107]
    ds_read_b64_tr_b16 a[250:251], v238 offset:51168
    ds_read_b64_tr_b16 a[252:253], v238 offset:51424
    v_mfma_f32_16x16x32_bf16 v[104:107], a[200:203], a[168:171], v[104:107]
    ds_read_b64_tr_b16 a[254:255], v238 offset:51680
    v_mfma_f32_16x16x32_bf16 v[104:107], a[204:207], a[172:175], v[104:107]
    v_mfma_f32_16x16x32_bf16 v[108:111], a[192:195], a[176:179], v[204:207]
    v_mfma_f32_16x16x32_bf16 v[108:111], a[196:199], a[180:183], v[108:111]
    v_mfma_f32_16x16x32_bf16 v[108:111], a[200:203], a[184:187], v[108:111]
    v_exp_f32 v228, v12
    v_mfma_f32_16x16x32_bf16 v[108:111], a[204:207], a[188:191], v[108:111]
    v_exp_f32 v229, v13
    v_mfma_f32_16x16x32_bf16 v[216:219], v[244:247], v[144:147], 0
    v_exp_f32 v230, v14
    v_mfma_f32_16x16x32_bf16 v[216:219], v[244:247], v[148:151], v[216:219]
    v_exp_f32 v231, v15
    s_waitcnt lgkmcnt(0)
    v_mfma_f32_16x16x32_bf16 a[64:67], a[224:227], v[160:163], a[64:67]
    s_add_u32 m0, s53, 18496
    v_cvt_pk_bf16_f32 v152, v228, v229
    v_mfma_f32_16x16x32_bf16 a[64:67], a[228:231], v[164:167], a[64:67]
    v_exp_f32 v232, v28
    v_mfma_f32_16x16x32_bf16 a[68:71], a[224:227], v[168:171], a[68:71]
    v_exp_f32 v233, v29
    v_mfma_f32_16x16x32_bf16 a[68:71], a[228:231], v[172:175], a[68:71]
    buffer_load_dwordx4 v240, s[20:23], s52 offen offset:512 lds
    v_mfma_f32_16x16x32_bf16 a[72:75], a[224:227], v[176:179], a[72:75]
    v_cvt_pk_bf16_f32 v153, v230, v231
    v_cvt_pk_bf16_f32 v154, v232, v233
    v_mfma_f32_16x16x32_bf16 a[72:75], a[228:231], v[180:183], a[72:75]
    v_exp_f32 v234, v30
    v_mfma_f32_16x16x32_bf16 a[76:79], a[224:227], v[184:187], a[76:79]
    v_exp_f32 v235, v31
    v_mfma_f32_16x16x32_bf16 a[76:79], a[228:231], v[188:191], a[76:79]
    v_exp_f32 v228, v44
    v_mfma_f32_16x16x32_bf16 a[80:83], a[232:235], v[160:163], a[80:83]
    v_exp_f32 v229, v45
    v_mfma_f32_16x16x32_bf16 a[80:83], a[236:239], v[164:167], a[80:83]
    v_cvt_pk_bf16_f32 v155, v234, v235
    v_cvt_pk_bf16_f32 v156, v228, v229
    v_mfma_f32_16x16x32_bf16 a[84:87], a[232:235], v[168:171], a[84:87]
    v_exp_f32 v230, v46
    v_mfma_f32_16x16x32_bf16 a[84:87], a[236:239], v[172:175], a[84:87]
    v_exp_f32 v231, v47
    v_mfma_f32_16x16x32_bf16 a[88:91], a[232:235], v[176:179], a[88:91]
    v_exp_f32 v232, v60
    v_mfma_f32_16x16x32_bf16 a[88:91], a[236:239], v[180:183], a[88:91]
    s_add_u32 m0, s53, 19296
    v_cvt_pk_bf16_f32 v157, v230, v231
    v_mfma_f32_16x16x32_bf16 a[92:95], a[232:235], v[184:187], a[92:95]
    v_exp_f32 v233, v61
    v_mfma_f32_16x16x32_bf16 a[92:95], a[236:239], v[188:191], a[92:95]
    s_waitcnt vmcnt(18) lgkmcnt(0)
    s_barrier
    v_mfma_f32_16x16x32_bf16 a[96:99], a[240:243], v[160:163], a[96:99]
    v_exp_f32 v234, v62
    v_mfma_f32_16x16x32_bf16 a[96:99], a[244:247], v[164:167], a[96:99]
    buffer_load_dwordx4 v240, s[20:23], s52 offen offset:768 lds
    v_mfma_f32_16x16x32_bf16 a[100:103], a[240:243], v[168:171], a[100:103]
    v_exp_f32 v235, v63
    v_mfma_f32_16x16x32_bf16 a[100:103], a[244:247], v[172:175], a[100:103]
    s_add_u32 s52, s52, 16384
    v_cvt_pk_bf16_f32 v158, v232, v233
    v_mfma_f32_16x16x32_bf16 a[104:107], a[240:243], v[176:179], a[104:107]
    v_cvt_pk_bf16_f32 v159, v234, v235
    v_max3_f32 v241, v208, v212, v216
    v_mfma_f32_16x16x32_bf16 a[104:107], a[244:247], v[180:183], a[104:107]
    ds_read_b128 a[192:195], v237 offset:0
    ds_read_b128 a[196:199], v237 offset:64
    v_mfma_f32_16x16x32_bf16 a[108:111], a[240:243], v[184:187], a[108:111]
    ds_read_b128 a[200:203], v237 offset:128
    ds_read_b128 a[204:207], v237 offset:192
    v_mfma_f32_16x16x32_bf16 a[108:111], a[244:247], v[188:191], a[108:111]
    ds_read_b64_tr_b16 a[224:225], v239 offset:16896
    ds_read_b64_tr_b16 a[226:227], v239 offset:17152
    v_mfma_f32_16x16x32_bf16 v[220:223], v[244:247], v[152:155], 0
    ds_read_b64_tr_b16 a[228:229], v239 offset:17408
    ds_read_b64_tr_b16 a[230:231], v239 offset:17664
    v_mfma_f32_16x16x32_bf16 v[220:223], v[244:247], v[156:159], v[220:223]
    ds_read_b64_tr_b16 a[232:233], v239 offset:16928
    ds_read_b64_tr_b16 a[234:235], v239 offset:17184
    v_mfma_f32_16x16x32_bf16 a[112:115], a[248:251], v[160:163], a[112:115]
    buffer_load_dword v255, v254, s[44:47], s65 offen
    v_mfma_f32_16x16x32_bf16 a[112:115], a[252:255], v[164:167], a[112:115]
    ds_read_b64_tr_b16 a[236:237], v239 offset:17440
    s_add_u32 s65, s65, 1280
    v_mfma_f32_16x16x32_bf16 a[116:119], a[248:251], v[168:171], a[116:119]
    ds_read_b64_tr_b16 a[238:239], v239 offset:17696
    v_mfma_f32_16x16x32_bf16 a[116:119], a[252:255], v[172:175], a[116:119]
    v_mfma_f32_16x16x32_bf16 a[120:123], a[248:251], v[176:179], a[120:123]
    v_mfma_f32_16x16x32_bf16 a[120:123], a[252:255], v[180:183], a[120:123]
    v_mfma_f32_16x16x32_bf16 a[124:127], a[248:251], v[184:187], a[124:127]
    v_mfma_f32_16x16x32_bf16 a[124:127], a[252:255], v[188:191], a[124:127]
    s_nop 1
    v_max_f32 v241, v241, v220
    v_cmp_lt_f32 vcc, s61, v241
    s_cbranch_vccnz L_fbL2
L_fbL2_ret:
    v_mfma_f32_16x16x32_bf16 v[112:115], a[208:211], a[128:131], v[192:195]
    v_exp_f32 v228, v64
    v_mfma_f32_16x16x32_bf16 v[112:115], a[212:215], a[132:135], v[112:115]
    v_exp_f32 v229, v65
    v_mfma_f32_16x16x32_bf16 v[112:115], a[216:219], a[136:139], v[112:115]
    v_exp_f32 v230, v66
    v_mfma_f32_16x16x32_bf16 v[112:115], a[220:223], a[140:143], v[112:115]
    v_exp_f32 v231, v67
    v_mfma_f32_16x16x32_bf16 v[116:119], a[208:211], a[144:147], v[196:199]
    v_cvt_pk_bf16_f32 v160, v228, v229
    v_cvt_pk_bf16_f32 v161, v230, v231
    v_mfma_f32_16x16x32_bf16 v[116:119], a[212:215], a[148:151], v[116:119]
    v_exp_f32 v232, v80
    v_mfma_f32_16x16x32_bf16 v[116:119], a[216:219], a[152:155], v[116:119]
    v_exp_f32 v233, v81
    v_mfma_f32_16x16x32_bf16 v[116:119], a[220:223], a[156:159], v[116:119]
    v_exp_f32 v234, v82
    v_mfma_f32_16x16x32_bf16 v[120:123], a[208:211], a[160:163], v[200:203]
    v_cvt_pk_bf16_f32 v162, v232, v233
    v_add_f32 v224, v224, v208
    v_mfma_f32_16x16x32_bf16 v[120:123], a[212:215], a[164:167], v[120:123]
    v_exp_f32 v235, v83
    v_mfma_f32_16x16x32_bf16 v[120:123], a[216:219], a[168:171], v[120:123]
    v_cvt_pk_bf16_f32 v163, v234, v235
    v_add_f32 v225, v225, v212
    v_mfma_f32_16x16x32_bf16 v[120:123], a[220:223], a[172:175], v[120:123]
    v_add_f32 v226, v226, v216
    v_add_f32 v227, v227, v220
    v_mfma_f32_16x16x32_bf16 v[124:127], a[208:211], a[176:179], v[204:207]
    v_mfma_f32_16x16x32_bf16 v[124:127], a[212:215], a[180:183], v[124:127]
    v_mfma_f32_16x16x32_bf16 v[124:127], a[216:219], a[184:187], v[124:127]
    v_mfma_f32_16x16x32_bf16 v[124:127], a[220:223], a[188:191], v[124:127]
    s_waitcnt lgkmcnt(0)
    v_mfma_f32_16x16x32_bf16 v[0:3], a[192:195], a[128:131], v[192:195]
    v_exp_f32 v228, v96
    v_mfma_f32_16x16x32_bf16 v[0:3], a[196:199], a[132:135], v[0:3]
    v_exp_f32 v229, v97
    v_mfma_f32_16x16x32_bf16 v[0:3], a[200:203], a[136:139], v[0:3]
    s_add_u32 m0, s53, 33792
    v_cvt_pk_bf16_f32 v164, v228, v229
    v_mfma_f32_16x16x32_bf16 v[0:3], a[204:207], a[140:143], v[0:3]
    v_exp_f32 v230, v98
    v_mfma_f32_16x16x32_bf16 v[4:7], a[192:195], a[144:147], v[196:199]
    buffer_load_dwordx4 v240, s[16:19], s51 offen offset:0 lds
    v_mfma_f32_16x16x32_bf16 v[4:7], a[196:199], a[148:151], v[4:7]
    v_exp_f32 v231, v99
    v_mfma_f32_16x16x32_bf16 v[4:7], a[200:203], a[152:155], v[4:7]
    ds_read_b128 a[208:211], v237 offset:256
    v_cvt_pk_bf16_f32 v165, v230, v231
    v_mfma_f32_16x16x32_bf16 v[4:7], a[204:207], a[156:159], v[4:7]
    v_exp_f32 v232, v112
    v_mfma_f32_16x16x32_bf16 v[8:11], a[192:195], a[160:163], v[200:203]
    ds_read_b128 a[212:215], v237 offset:320
    ds_read_b128 a[216:219], v237 offset:384
    v_mfma_f32_16x16x32_bf16 v[8:11], a[196:199], a[164:167], v[8:11]
    ds_read_b128 a[220:223], v237 offset:448
    ds_read_b64_tr_b16 a[240:241], v239 offset:16960
    v_mfma_f32_16x16x32_bf16 v[8:11], a[200:203], a[168:171], v[8:11]
    v_exp_f32 v233, v113
    v_mfma_f32_16x16x32_bf16 v[8:11], a[204:207], a[172:175], v[8:11]
    ds_read_b64_tr_b16 a[242:243], v239 offset:17216
    v_cvt_pk_bf16_f32 v166, v232, v233
    v_mfma_f32_16x16x32_bf16 v[12:15], a[192:195], a[176:179], v[204:207]
    v_exp_f32 v234, v114
    v_mfma_f32_16x16x32_bf16 v[12:15], a[196:199], a[180:183], v[12:15]
    ds_read_b64_tr_b16 a[244:245], v239 offset:17472
    s_add_u32 m0, s53, 34592
    v_mfma_f32_16x16x32_bf16 v[12:15], a[200:203], a[184:187], v[12:15]
    buffer_load_dwordx4 v240, s[16:19], s51 offen offset:256 lds
    v_mfma_f32_16x16x32_bf16 v[12:15], a[204:207], a[188:191], v[12:15]
    v_exp_f32 v235, v115
    v_mfma_f32_16x16x32_bf16 a[0:3], a[224:227], v[128:131], a[0:3]
    ds_read_b64_tr_b16 a[246:247], v239 offset:17728
    v_cvt_pk_bf16_f32 v167, v234, v235
    v_mfma_f32_16x16x32_bf16 a[0:3], a[228:231], v[132:135], a[0:3]
    ds_read_b64_tr_b16 a[248:249], v239 offset:16992
    ds_read_b64_tr_b16 a[250:251], v239 offset:17248
    v_mfma_f32_16x16x32_bf16 a[4:7], a[224:227], v[136:139], a[4:7]
    ds_read_b64_tr_b16 a[252:253], v239 offset:17504
    ds_read_b64_tr_b16 a[254:255], v239 offset:17760
    v_mfma_f32_16x16x32_bf16 a[4:7], a[228:231], v[140:143], a[4:7]
    ds_read_b128 a[192:195], v237 offset:512
    ds_read_b128 a[196:199], v237 offset:576
    v_mfma_f32_16x16x32_bf16 a[8:11], a[224:227], v[144:147], a[8:11]
    ds_read_b128 a[200:203], v237 offset:640
    ds_read_b128 a[204:207], v237 offset:704
    v_mfma_f32_16x16x32_bf16 a[8:11], a[228:231], v[148:151], a[8:11]
    v_mfma_f32_16x16x32_bf16 a[12:15], a[224:227], v[152:155], a[12:15]
    v_exp_f32 v228, v68
    v_mfma_f32_16x16x32_bf16 a[12:15], a[228:231], v[156:159], a[12:15]
    v_exp_f32 v229, v69
    v_mfma_f32_16x16x32_bf16 v[208:211], v[244:247], v[160:163], 0
    v_exp_f32 v230, v70
    v_mfma_f32_16x16x32_bf16 v[208:211], v[244:247], v[164:167], v[208:211]
    v_exp_f32 v231, v71
    v_mfma_f32_16x16x32_bf16 a[16:19], a[232:235], v[128:131], a[16:19]
    v_cvt_pk_bf16_f32 v168, v228, v229
    v_cvt_pk_bf16_f32 v169, v230, v231
    v_mfma_f32_16x16x32_bf16 a[16:19], a[236:239], v[132:135], a[16:19]
    v_exp_f32 v232, v84
    v_mfma_f32_16x16x32_bf16 a[20:23], a[232:235], v[136:139], a[20:23]
    v_exp_f32 v233, v85
    v_mfma_f32_16x16x32_bf16 a[20:23], a[236:239], v[140:143], a[20:23]
    v_exp_f32 v234, v86
    v_mfma_f32_16x16x32_bf16 a[24:27], a[232:235], v[144:147], a[24:27]
    s_add_u32 m0, s53, 35392
    v_cvt_pk_bf16_f32 v170, v232, v233
    v_mfma_f32_16x16x32_bf16 a[24:27], a[236:239], v[148:151], a[24:27]
    v_exp_f32 v235, v87
    v_mfma_f32_16x16x32_bf16 a[28:31], a[232:235], v[152:155], a[28:31]
    buffer_load_dwordx4 v240, s[16:19], s51 offen offset:512 lds
    v_mfma_f32_16x16x32_bf16 a[28:31], a[236:239], v[156:159], a[28:31]
    v_exp_f32 v228, v100
    s_waitcnt lgkmcnt(0)
    v_mfma_f32_16x16x32_bf16 v[16:19], a[208:211], a[128:131], v[192:195]
    v_exp_f32 v229, v101
    v_mfma_f32_16x16x32_bf16 v[16:19], a[212:215], a[132:135], v[16:19]
    v_cvt_pk_bf16_f32 v171, v234, v235
    v_cvt_pk_bf16_f32 v172, v228, v229
    v_mfma_f32_16x16x32_bf16 v[16:19], a[216:219], a[136:139], v[16:19]
    v_exp_f32 v230, v102
    v_mfma_f32_16x16x32_bf16 v[16:19], a[220:223], a[140:143], v[16:19]
    v_exp_f32 v231, v103
    v_mfma_f32_16x16x32_bf16 v[20:23], a[208:211], a[144:147], v[196:199]
    v_exp_f32 v232, v116
    v_mfma_f32_16x16x32_bf16 v[20:23], a[212:215], a[148:151], v[20:23]
    v_exp_f32 v233, v117
    v_mfma_f32_16x16x32_bf16 v[20:23], a[216:219], a[152:155], v[20:23]
    v_exp_f32 v234, v118
    v_mfma_f32_16x16x32_bf16 v[20:23], a[220:223], a[156:159], v[20:23]
    s_add_u32 m0, s53, 36192
    v_cvt_pk_bf16_f32 v173, v230, v231
    v_mfma_f32_16x16x32_bf16 v[24:27], a[208:211], a[160:163], v[200:203]
    v_exp_f32 v235, v119
    v_mfma_f32_16x16x32_bf16 v[24:27], a[212:215], a[164:167], v[24:27]
    v_cvt_pk_bf16_f32 v174, v232, v233
    v_cvt_pk_bf16_f32 v175, v234, v235
    v_mfma_f32_16x16x32_bf16 v[24:27], a[216:219], a[168:171], v[24:27]
    buffer_load_dwordx4 v240, s[16:19], s51 offen offset:768 lds
    v_mfma_f32_16x16x32_bf16 v[24:27], a[220:223], a[172:175], v[24:27]
    ds_read_b64_tr_b16 a[224:225], v239 offset:17024
    s_add_u32 s51, s51, 16384
    v_mfma_f32_16x16x32_bf16 v[28:31], a[208:211], a[176:179], v[204:207]
    ds_read_b64_tr_b16 a[226:227], v239 offset:17280
    ds_read_b64_tr_b16 a[228:229], v239 offset:17536
    v_mfma_f32_16x16x32_bf16 v[28:31], a[212:215], a[180:183], v[28:31]
    ds_read_b64_tr_b16 a[230:231], v239 offset:17792
    ds_read_b64_tr_b16 a[232:233], v239 offset:17056
    v_mfma_f32_16x16x32_bf16 v[28:31], a[216:219], a[184:187], v[28:31]
    v_exp_f32 v228, v72
    v_mfma_f32_16x16x32_bf16 v[28:31], a[220:223], a[188:191], v[28:31]
    v_exp_f32 v229, v73
    v_mfma_f32_16x16x32_bf16 v[212:215], v[244:247], v[168:171], 0
    v_exp_f32 v230, v74
    v_mfma_f32_16x16x32_bf16 v[212:215], v[244:247], v[172:175], v[212:215]
    v_exp_f32 v231, v75
    v_mfma_f32_16x16x32_bf16 a[32:35], a[240:243], v[128:131], a[32:35]
    v_cvt_pk_bf16_f32 v176, v228, v229
    v_cvt_pk_bf16_f32 v177, v230, v231
    v_mfma_f32_16x16x32_bf16 a[32:35], a[244:247], v[132:135], a[32:35]
    v_exp_f32 v232, v88
    v_mfma_f32_16x16x32_bf16 a[36:39], a[240:243], v[136:139], a[36:39]
    ds_read_b64_tr_b16 a[234:235], v239 offset:17312
    ds_read_b64_tr_b16 a[236:237], v239 offset:17568
    v_mfma_f32_16x16x32_bf16 a[36:39], a[244:247], v[140:143], a[36:39]
    v_exp_f32 v233, v89
    v_mfma_f32_16x16x32_bf16 a[40:43], a[240:243], v[144:147], a[40:43]
    s_add_u32 m0, s53, 50688
    v_cvt_pk_bf16_f32 v178, v232, v233
    v_mfma_f32_16x16x32_bf16 a[40:43], a[244:247], v[148:151], a[40:43]
    v_exp_f32 v234, v90
    v_mfma_f32_16x16x32_bf16 a[44:47], a[240:243], v[152:155], a[44:47]
    buffer_load_dwordx4 v240, s[20:23], s52 offen offset:0 lds
    v_mfma_f32_16x16x32_bf16 a[44:47], a[244:247], v[156:159], a[44:47]
    v_exp_f32 v235, v91
    v_mfma_f32_16x16x32_bf16 a[48:51], a[248:251], v[128:131], a[48:51]
    ds_read_b64_tr_b16 a[238:239], v239 offset:17824
    v_cvt_pk_bf16_f32 v179, v234, v235
    v_mfma_f32_16x16x32_bf16 a[48:51], a[252:255], v[132:135], a[48:51]
    v_exp_f32 v228, v104
    v_mfma_f32_16x16x32_bf16 a[52:55], a[248:251], v[136:139], a[52:55]
    ds_read_b128 a[208:211], v237 offset:768
    ds_read_b128 a[212:215], v237 offset:832
    v_mfma_f32_16x16x32_bf16 a[52:55], a[252:255], v[140:143], a[52:55]
    v_exp_f32 v229, v105
    v_mfma_f32_16x16x32_bf16 a[56:59], a[248:251], v[144:147], a[56:59]
    ds_read_b128 a[216:219], v237 offset:896
    v_cvt_pk_bf16_f32 v180, v228, v229
    v_mfma_f32_16x16x32_bf16 a[56:59], a[252:255], v[148:151], a[56:59]
    v_exp_f32 v230, v106
    v_mfma_f32_16x16x32_bf16 a[60:63], a[248:251], v[152:155], a[60:63]
    ds_read_b128 a[220:223], v237 offset:960
    ds_read_b64_tr_b16 a[240:241], v239 offset:17088
    v_mfma_f32_16x16x32_bf16 a[60:63], a[252:255], v[156:159], a[60:63]
    v_exp_f32 v231, v107
    v_mfma_f32_16x16x32_bf16 v[32:35], a[192:195], a[128:131], v[192:195]
    ds_read_b64_tr_b16 a[242:243], v239 offset:17344
    v_cvt_pk_bf16_f32 v181, v230, v231
    v_mfma_f32_16x16x32_bf16 v[32:35], a[196:199], a[132:135], v[32:35]
    v_exp_f32 v232, v120
    v_mfma_f32_16x16x32_bf16 v[32:35], a[200:203], a[136:139], v[32:35]
    ds_read_b64_tr_b16 a[244:245], v239 offset:17600
    s_add_u32 m0, s53, 51488
    v_mfma_f32_16x16x32_bf16 v[32:35], a[204:207], a[140:143], v[32:35]
    v_exp_f32 v233, v121
    v_mfma_f32_16x16x32_bf16 v[36:39], a[192:195], a[144:147], v[196:199]
    buffer_load_dwordx4 v240, s[20:23], s52 offen offset:256 lds
    v_mfma_f32_16x16x32_bf16 v[36:39], a[196:199], a[148:151], v[36:39]
    v_exp_f32 v234, v122
    v_mfma_f32_16x16x32_bf16 v[36:39], a[200:203], a[152:155], v[36:39]
    ds_read_b64_tr_b16 a[246:247], v239 offset:17856
    v_cvt_pk_bf16_f32 v182, v232, v233
    v_mfma_f32_16x16x32_bf16 v[36:39], a[204:207], a[156:159], v[36:39]
    v_exp_f32 v235, v123
    v_mfma_f32_16x16x32_bf16 v[40:43], a[192:195], a[160:163], v[200:203]
    ds_read_b64_tr_b16 a[248:249], v239 offset:17120
    v_cvt_pk_bf16_f32 v183, v234, v235
    v_mfma_f32_16x16x32_bf16 v[40:43], a[196:199], a[164:167], v[40:43]
    ds_read_b64_tr_b16 a[250:251], v239 offset:17376
    ds_read_b64_tr_b16 a[252:253], v239 offset:17632
    v_mfma_f32_16x16x32_bf16 v[40:43], a[200:203], a[168:171], v[40:43]
    ds_read_b64_tr_b16 a[254:255], v239 offset:17888
    s_sub_u32 s60, s60, 1
    v_mfma_f32_16x16x32_bf16 v[40:43], a[204:207], a[172:175], v[40:43]
    v_mfma_f32_16x16x32_bf16 v[44:47], a[192:195], a[176:179], v[204:207]
    v_mfma_f32_16x16x32_bf16 v[44:47], a[196:199], a[180:183], v[44:47]
    v_mfma_f32_16x16x32_bf16 v[44:47], a[200:203], a[184:187], v[44:47]
    v_exp_f32 v228, v76
    v_mfma_f32_16x16x32_bf16 v[44:47], a[204:207], a[188:191], v[44:47]
    v_exp_f32 v229, v77
    v_mfma_f32_16x16x32_bf16 v[216:219], v[244:247], v[176:179], 0
    v_exp_f32 v230, v78
    v_mfma_f32_16x16x32_bf16 v[216:219], v[244:247], v[180:183], v[216:219]
    v_exp_f32 v231, v79
    s_waitcnt lgkmcnt(0)
    v_mfma_f32_16x16x32_bf16 a[64:67], a[224:227], v[128:131], a[64:67]
    s_add_u32 m0, s53, 52288
    v_cvt_pk_bf16_f32 v184, v228, v229
    v_mfma_f32_16x16x32_bf16 a[64:67], a[228:231], v[132:135], a[64:67]
    v_exp_f32 v232, v92
    v_mfma_f32_16x16x32_bf16 a[68:71], a[224:227], v[136:139], a[68:71]
    v_exp_f32 v233, v93
    v_mfma_f32_16x16x32_bf16 a[68:71], a[228:231], v[140:143], a[68:71]
    buffer_load_dwordx4 v240, s[20:23], s52 offen offset:512 lds
    v_mfma_f32_16x16x32_bf16 a[72:75], a[224:227], v[144:147], a[72:75]
    v_cvt_pk_bf16_f32 v185, v230, v231
    v_cvt_pk_bf16_f32 v186, v232, v233
    v_mfma_f32_16x16x32_bf16 a[72:75], a[228:231], v[148:151], a[72:75]
    v_exp_f32 v234, v94
    v_mfma_f32_16x16x32_bf16 a[76:79], a[224:227], v[152:155], a[76:79]
    v_exp_f32 v235, v95
    v_mfma_f32_16x16x32_bf16 a[76:79], a[228:231], v[156:159], a[76:79]
    v_exp_f32 v228, v108
    v_mfma_f32_16x16x32_bf16 a[80:83], a[232:235], v[128:131], a[80:83]
    v_exp_f32 v229, v109
    v_mfma_f32_16x16x32_bf16 a[80:83], a[236:239], v[132:135], a[80:83]
    v_cvt_pk_bf16_f32 v187, v234, v235
    v_cvt_pk_bf16_f32 v188, v228, v229
    v_mfma_f32_16x16x32_bf16 a[84:87], a[232:235], v[136:139], a[84:87]
    v_exp_f32 v230, v110
    v_mfma_f32_16x16x32_bf16 a[84:87], a[236:239], v[140:143], a[84:87]
    v_exp_f32 v231, v111
    v_mfma_f32_16x16x32_bf16 a[88:91], a[232:235], v[144:147], a[88:91]
    v_exp_f32 v232, v124
    v_mfma_f32_16x16x32_bf16 a[88:91], a[236:239], v[148:151], a[88:91]
    s_add_u32 m0, s53, 53088
    v_cvt_pk_bf16_f32 v189, v230, v231
    v_mfma_f32_16x16x32_bf16 a[92:95], a[232:235], v[152:155], a[92:95]
    v_exp_f32 v233, v125
    v_mfma_f32_16x16x32_bf16 a[92:95], a[236:239], v[156:159], a[92:95]
    s_waitcnt vmcnt(17) lgkmcnt(0)
    s_barrier
    v_mfma_f32_16x16x32_bf16 a[96:99], a[240:243], v[128:131], a[96:99]
    v_exp_f32 v234, v126
    v_mfma_f32_16x16x32_bf16 a[96:99], a[244:247], v[132:135], a[96:99]
    buffer_load_dwordx4 v240, s[20:23], s52 offen offset:768 lds
    v_mfma_f32_16x16x32_bf16 a[100:103], a[240:243], v[136:139], a[100:103]
    v_exp_f32 v235, v127
    v_mfma_f32_16x16x32_bf16 a[100:103], a[244:247], v[140:143], a[100:103]
    s_add_u32 s52, s52, 16384
    v_cvt_pk_bf16_f32 v190, v232, v233
    v_mfma_f32_16x16x32_bf16 a[104:107], a[240:243], v[144:147], a[104:107]
    v_cvt_pk_bf16_f32 v191, v234, v235
    v_max3_f32 v241, v208, v212, v216
    v_mfma_f32_16x16x32_bf16 a[104:107], a[244:247], v[148:151], a[104:107]
    ds_read_b128 a[192:195], v237 offset:33792
    ds_read_b128 a[196:199], v237 offset:33856
    v_mfma_f32_16x16x32_bf16 a[108:111], a[240:243], v[152:155], a[108:111]
    ds_read_b128 a[200:203], v237 offset:33920
    ds_read_b128 a[204:207], v237 offset:33984
    v_mfma_f32_16x16x32_bf16 a[108:111], a[244:247], v[156:159], a[108:111]
    ds_read_b64_tr_b16 a[224:225], v239 offset:50688
    ds_read_b64_tr_b16 a[226:227], v239 offset:50944
    v_mfma_f32_16x16x32_bf16 v[220:223], v[244:247], v[184:187], 0
    ds_read_b64_tr_b16 a[228:229], v239 offset:51200
    ds_read_b64_tr_b16 a[230:231], v239 offset:51456
    v_mfma_f32_16x16x32_bf16 v[220:223], v[244:247], v[188:191], v[220:223]
    ds_read_b64_tr_b16 a[232:233], v239 offset:50720
    ds_read_b64_tr_b16 a[234:235], v239 offset:50976
    v_mfma_f32_16x16x32_bf16 a[112:115], a[248:251], v[128:131], a[112:115]
    buffer_store_dwordx4 v[248:251], v253, s[4:7], s62 offen sc1
    v_mfma_f32_16x16x32_bf16 a[112:115], a[252:255], v[132:135], a[112:115]
    ds_read_b64_tr_b16 a[236:237], v239 offset:51232
    s_add_u32 s62, s62, 1024
    v_mfma_f32_16x16x32_bf16 a[116:119], a[248:251], v[136:139], a[116:119]
    ds_read_b64_tr_b16 a[238:239], v239 offset:51488
    v_mfma_f32_16x16x32_bf16 a[116:119], a[252:255], v[140:143], a[116:119]
    v_mfma_f32_16x16x32_bf16 a[120:123], a[248:251], v[144:147], a[120:123]
    v_mfma_f32_16x16x32_bf16 a[120:123], a[252:255], v[148:151], a[120:123]
    v_mfma_f32_16x16x32_bf16 a[124:127], a[248:251], v[152:155], a[124:127]
    v_mfma_f32_16x16x32_bf16 a[124:127], a[252:255], v[156:159], a[124:127]
    s_nop 1
    v_max_f32 v241, v241, v220
    v_cmp_lt_f32 vcc, s61, v241
    s_cbranch_vccnz L_fbL3
L_fbL3_ret:
    v_mfma_f32_16x16x32_bf16 v[48:51], a[208:211], a[128:131], v[192:195]
    v_exp_f32 v228, v0
    v_mfma_f32_16x16x32_bf16 v[48:51], a[212:215], a[132:135], v[48:51]
    v_exp_f32 v229, v1
    v_mfma_f32_16x16x32_bf16 v[48:51], a[216:219], a[136:139], v[48:51]
    v_exp_f32 v230, v2
    v_mfma_f32_16x16x32_bf16 v[48:51], a[220:223], a[140:143], v[48:51]
    v_exp_f32 v231, v3
    v_mfma_f32_16x16x32_bf16 v[52:55], a[208:211], a[144:147], v[196:199]
    v_cvt_pk_bf16_f32 v128, v228, v229
    v_cvt_pk_bf16_f32 v129, v230, v231
    v_mfma_f32_16x16x32_bf16 v[52:55], a[212:215], a[148:151], v[52:55]
    v_exp_f32 v232, v16
    v_mfma_f32_16x16x32_bf16 v[52:55], a[216:219], a[152:155], v[52:55]
    v_exp_f32 v233, v17
    v_mfma_f32_16x16x32_bf16 v[52:55], a[220:223], a[156:159], v[52:55]
    v_exp_f32 v234, v18
    v_mfma_f32_16x16x32_bf16 v[56:59], a[208:211], a[160:163], v[200:203]
    v_cvt_pk_bf16_f32 v130, v232, v233
    v_add_f32 v224, v224, v208
    v_mfma_f32_16x16x32_bf16 v[56:59], a[212:215], a[164:167], v[56:59]
    v_exp_f32 v235, v19
    v_mfma_f32_16x16x32_bf16 v[56:59], a[216:219], a[168:171], v[56:59]
    v_cvt_pk_bf16_f32 v131, v234, v235
    v_add_f32 v225, v225, v212
    v_mfma_f32_16x16x32_bf16 v[56:59], a[220:223], a[172:175], v[56:59]
    v_add_f32 v226, v226, v216
    v_add_f32 v227, v227, v220
    v_mfma_f32_16x16x32_bf16 v[60:63], a[208:211], a[176:179], v[204:207]
    v_mfma_f32_16x16x32_bf16 v[60:63], a[212:215], a[180:183], v[60:63]
    v_mfma_f32_16x16x32_bf16 v[60:63], a[216:219], a[184:187], v[60:63]
    v_mfma_f32_16x16x32_bf16 v[60:63], a[220:223], a[188:191], v[60:63]
    s_cmp_lg_u32 s60, 0
    s_cbranch_scc1 L_att
    v_lshlrev_b32 v240, 2, v242
    v_and_b32 v248, 15, v242
    v_lshlrev_b32 v248, 4, v248
    v_lshl_add_u32 v248, v252, 15, v248
    s_lshr_b32 s58, s3, 2
    s_lshl_b32 s58, s58, 8
    s_lshl_b32 s59, s54, 13
    s_add_u32 s58, s58, s59
    v_add_u32 v248, s58, v248
    v_add_u32 v249, 992, v248
    v_add_u32 v250, 1984, v248
    v_add_u32 v251, 2976, v248
    s_waitcnt lgkmcnt(0)
    v_mfma_f32_16x16x32_bf16 v[64:67], a[192:195], a[128:131], v[192:195]
    v_exp_f32 v228, v32
    v_mfma_f32_16x16x32_bf16 v[64:67], a[196:199], a[132:135], v[64:67]
    v_exp_f32 v229, v33
    v_mfma_f32_16x16x32_bf16 v[64:67], a[200:203], a[136:139], v[64:67]
    s_add_u32 m0, s53, 67584
    v_cvt_pk_bf16_f32 v132, v228, v229
    v_mfma_f32_16x16x32_bf16 v[64:67], a[204:207], a[140:143], v[64:67]
    v_exp_f32 v230, v34
    v_mfma_f32_16x16x32_bf16 v[68:71], a[192:195], a[144:147], v[196:199]
    buffer_load_dwordx4 v248, s[44:47], s49 offen offset:0 lds
    v_mfma_f32_16x16x32_bf16 v[68:71], a[196:199], a[148:151], v[68:71]
    v_exp_f32 v231, v35
    v_mfma_f32_16x16x32_bf16 v[68:71], a[200:203], a[152:155], v[68:71]
    ds_read_b128 a[208:211], v237 offset:34048
    v_cvt_pk_bf16_f32 v133, v230, v231
    v_mfma_f32_16x16x32_bf16 v[68:71], a[204:207], a[156:159], v[68:71]
    v_exp_f32 v232, v48
    v_mfma_f32_16x16x32_bf16 v[72:75], a[192:195], a[160:163], v[200:203]
    ds_read_b128 a[212:215], v237 offset:34112
    ds_read_b128 a[216:219], v237 offset:34176
    v_mfma_f32_16x16x32_bf16 v[72:75], a[196:199], a[164:167], v[72:75]
    ds_read_b128 a[220:223], v237 offset:34240
    ds_read_b64_tr_b16 a[240:241], v239 offset:50752
    v_mfma_f32_16x16x32_bf16 v[72:75], a[200:203], a[168:171], v[72:75]
    v_exp_f32 v233, v49
    v_mfma_f32_16x16x32_bf16 v[72:75], a[204:207], a[172:175], v[72:75]
    ds_read_b64_tr_b16 a[242:243], v239 offset:51008
    v_cvt_pk_bf16_f32 v134, v232, v233
    v_mfma_f32_16x16x32_bf16 v[76:79], a[192:195], a[176:179], v[204:207]
    v_exp_f32 v234, v50
    v_mfma_f32_16x16x32_bf16 v[76:79], a[196:199], a[180:183], v[76:79]
    ds_read_b64_tr_b16 a[244:245], v239 offset:51264
    ds_read_b64_tr_b16 a[246:247], v239 offset:51520
    v_mfma_f32_16x16x32_bf16 v[76:79], a[200:203], a[184:187], v[76:79]
    buffer_load_dwordx4 v249, s[44:47], s49 offen offset:1056 lds
    v_mfma_f32_16x16x32_bf16 v[76:79], a[204:207], a[188:191], v[76:79]
    v_exp_f32 v235, v51
    v_mfma_f32_16x16x32_bf16 a[0:3], a[224:227], v[160:163], a[0:3]
    ds_read_b64_tr_b16 a[248:249], v239 offset:50784
    v_cvt_pk_bf16_f32 v135, v234, v235
    v_mfma_f32_16x16x32_bf16 a[0:3], a[228:231], v[164:167], a[0:3]
    ds_read_b64_tr_b16 a[250:251], v239 offset:51040
    ds_read_b64_tr_b16 a[252:253], v239 offset:51296
    v_mfma_f32_16x16x32_bf16 a[4:7], a[224:227], v[168:171], a[4:7]
    ds_read_b64_tr_b16 a[254:255], v239 offset:51552
    ds_read_b128 a[192:195], v237 offset:34304
    v_mfma_f32_16x16x32_bf16 a[4:7], a[228:231], v[172:175], a[4:7]
    ds_read_b128 a[196:199], v237 offset:34368
    ds_read_b128 a[200:203], v237 offset:34432
    v_mfma_f32_16x16x32_bf16 a[8:11], a[224:227], v[176:179], a[8:11]
    ds_read_b128 a[204:207], v237 offset:34496
    v_mfma_f32_16x16x32_bf16 a[8:11], a[228:231], v[180:183], a[8:11]
    v_mfma_f32_16x16x32_bf16 a[12:15], a[224:227], v[184:187], a[12:15]
    v_exp_f32 v228, v4
    v_mfma_f32_16x16x32_bf16 a[12:15], a[228:231], v[188:191], a[12:15]
    v_exp_f32 v229, v5
    v_mfma_f32_16x16x32_bf16 v[208:211], v[244:247], v[128:131], 0
    v_exp_f32 v230, v6
    v_mfma_f32_16x16x32_bf16 v[208:211], v[244:247], v[132:135], v[208:211]
    v_exp_f32 v231, v7
    v_mfma_f32_16x16x32_bf16 a[16:19], a[232:235], v[160:163], a[16:19]
    v_cvt_pk_bf16_f32 v136, v228, v229
    v_cvt_pk_bf16_f32 v137, v230, v231
    v_mfma_f32_16x16x32_bf16 a[16:19], a[236:239], v[164:167], a[16:19]
    v_exp_f32 v232, v20
    v_mfma_f32_16x16x32_bf16 a[20:23], a[232:235], v[168:171], a[20:23]
    v_exp_f32 v233, v21
    v_mfma_f32_16x16x32_bf16 a[20:23], a[236:239], v[172:175], a[20:23]
    v_exp_f32 v234, v22
    v_mfma_f32_16x16x32_bf16 a[24:27], a[232:235], v[176:179], a[24:27]
    v_exp_f32 v235, v23
    v_mfma_f32_16x16x32_bf16 a[24:27], a[236:239], v[180:183], a[24:27]
    v_cvt_pk_bf16_f32 v138, v232, v233
    v_cvt_pk_bf16_f32 v139, v234, v235
    v_mfma_f32_16x16x32_bf16 a[28:31], a[232:235], v[184:187], a[28:31]
    buffer_load_dwordx4 v250, s[44:47], s49 offen offset:2112 lds
    v_mfma_f32_16x16x32_bf16 a[28:31], a[236:239], v[188:191], a[28:31]
    v_exp_f32 v228, v36
    s_waitcnt lgkmcnt(0)
    v_mfma_f32_16x16x32_bf16 v[80:83], a[208:211], a[128:131], v[192:195]
    v_exp_f32 v229, v37
    v_mfma_f32_16x16x32_bf16 v[80:83], a[212:215], a[132:135], v[80:83]
    v_exp_f32 v230, v38
    v_mfma_f32_16x16x32_bf16 v[80:83], a[216:219], a[136:139], v[80:83]
    v_exp_f32 v231, v39
    v_mfma_f32_16x16x32_bf16 v[80:83], a[220:223], a[140:143], v[80:83]
    v_exp_f32 v232, v52
    v_mfma_f32_16x16x32_bf16 v[84:87], a[208:211], a[144:147], v[196:199]
    v_cvt_pk_bf16_f32 v140, v228, v229
    v_cvt_pk_bf16_f32 v141, v230, v231
    v_mfma_f32_16x16x32_bf16 v[84:87], a[212:215], a[148:151], v[84:87]
    v_exp_f32 v233, v53
    v_mfma_f32_16x16x32_bf16 v[84:87], a[216:219], a[152:155], v[84:87]
    v_exp_f32 v234, v54
    v_mfma_f32_16x16x32_bf16 v[84:87], a[220:223], a[156:159], v[84:87]
    ds_read_b64_tr_b16 a[224:225], v239 offset:50816
    v_cvt_pk_bf16_f32 v142, v232, v233
    v_mfma_f32_16x16x32_bf16 v[88:91], a[208:211], a[160:163], v[200:203]
    v_exp_f32 v235, v55
    v_mfma_f32_16x16x32_bf16 v[88:91], a[212:215], a[164:167], v[88:91]
    ds_read_b64_tr_b16 a[226:227], v239 offset:51072
    v_cvt_pk_bf16_f32 v143, v234, v235
    v_mfma_f32_16x16x32_bf16 v[88:91], a[216:219], a[168:171], v[88:91]
    buffer_load_dwordx4 v251, s[44:47], s49 offen offset:3168 lds
    v_mfma_f32_16x16x32_bf16 v[88:91], a[220:223], a[172:175], v[88:91]
    ds_read_b64_tr_b16 a[228:229], v239 offset:51328
    s_add_u32 s49, s49, 131072
    v_mfma_f32_16x16x32_bf16 v[92:95], a[208:211], a[176:179], v[204:207]
    ds_read_b64_tr_b16 a[230:231], v239 offset:51584
    ds_read_b64_tr_b16 a[232:233], v239 offset:50848
    v_mfma_f32_16x16x32_bf16 v[92:95], a[212:215], a[180:183], v[92:95]
    ds_read_b64_tr_b16 a[234:235], v239 offset:51104
    ds_read_b64_tr_b16 a[236:237], v239 offset:51360
    v_mfma_f32_16x16x32_bf16 v[92:95], a[216:219], a[184:187], v[92:95]
    v_exp_f32 v228, v8
    v_mfma_f32_16x16x32_bf16 v[92:95], a[220:223], a[188:191], v[92:95]
    v_exp_f32 v229, v9
    v_mfma_f32_16x16x32_bf16 v[212:215], v[244:247], v[136:139], 0
    v_exp_f32 v230, v10
    v_mfma_f32_16x16x32_bf16 v[212:215], v[244:247], v[140:143], v[212:215]
    v_exp_f32 v231, v11
    v_mfma_f32_16x16x32_bf16 a[32:35], a[240:243], v[160:163], a[32:35]
    v_cvt_pk_bf16_f32 v144, v228, v229
    v_cvt_pk_bf16_f32 v145, v230, v231
    v_mfma_f32_16x16x32_bf16 a[32:35], a[244:247], v[164:167], a[32:35]
    v_exp_f32 v232, v24
    v_mfma_f32_16x16x32_bf16 a[36:39], a[240:243], v[168:171], a[36:39]
    ds_read_b64_tr_b16 a[238:239], v239 offset:51616
    ds_read_b128 a[208:211], v237 offset:34560
    v_mfma_f32_16x16x32_bf16 a[36:39], a[244:247], v[172:175], a[36:39]
    v_exp_f32 v233, v25
    v_mfma_f32_16x16x32_bf16 a[40:43], a[240:243], v[176:179], a[40:43]
    s_add_u32 m0, s53, 84480
    v_cvt_pk_bf16_f32 v146, v232, v233
    v_mfma_f32_16x16x32_bf16 a[40:43], a[244:247], v[180:183], a[40:43]
    v_exp_f32 v234, v26
    v_mfma_f32_16x16x32_bf16 a[44:47], a[240:243], v[184:187], a[44:47]
    buffer_load_dwordx4 v248, s[44:47], s49 offen offset:0 lds
    v_mfma_f32_16x16x32_bf16 a[44:47], a[244:247], v[188:191], a[44:47]
    v_exp_f32 v235, v27
    v_mfma_f32_16x16x32_bf16 a[48:51], a[248:251], v[160:163], a[48:51]
    ds_read_b128 a[212:215], v237 offset:34624
    v_cvt_pk_bf16_f32 v147, v234, v235
    v_mfma_f32_16x16x32_bf16 a[48:51], a[252:255], v[164:167], a[48:51]
    v_exp_f32 v228, v40
    v_mfma_f32_16x16x32_bf16 a[52:55], a[248:251], v[168:171], a[52:55]
    ds_read_b128 a[216:219], v237 offset:34688
    ds_read_b128 a[220:223], v237 offset:34752
    v_mfma_f32_16x16x32_bf16 a[52:55], a[252:255], v[172:175], a[52:55]
    v_exp_f32 v229, v41
    v_mfma_f32_16x16x32_bf16 a[56:59], a[248:251], v[176:179], a[56:59]
    ds_read_b64_tr_b16 a[240:241], v239 offset:50880
    v_cvt_pk_bf16_f32 v148, v228, v229
    v_mfma_f32_16x16x32_bf16 a[56:59], a[252:255], v[180:183], a[56:59]
    v_exp_f32 v230, v42
    v_mfma_f32_16x16x32_bf16 a[60:63], a[248:251], v[184:187], a[60:63]
    ds_read_b64_tr_b16 a[242:243], v239 offset:51136
    ds_read_b64_tr_b16 a[244:245], v239 offset:51392
    v_mfma_f32_16x16x32_bf16 a[60:63], a[252:255], v[188:191], a[60:63]
    v_exp_f32 v231, v43
    v_mfma_f32_16x16x32_bf16 v[96:99], a[192:195], a[128:131], v[192:195]
    ds_read_b64_tr_b16 a[246:247], v239 offset:51648
    v_cvt_pk_bf16_f32 v149, v230, v231
    v_mfma_f32_16x16x32_bf16 v[96:99], a[196:199], a[132:135], v[96:99]
    v_exp_f32 v232, v56
    v_mfma_f32_16x16x32_bf16 v[96:99], a[200:203], a[136:139], v[96:99]
    buffer_load_dwordx4 v249, s[44:47], s49 offen offset:1056 lds
    v_mfma_f32_16x16x32_bf16 v[96:99], a[204:207], a[140:143], v[96:99]
    v_exp_f32 v233, v57
    v_mfma_f32_16x16x32_bf16 v[100:103], a[192:195], a[144:147], v[196:199]
    ds_read_b64_tr_b16 a[248:249], v239 offset:50912
    v_cvt_pk_bf16_f32 v150, v232, v233
    v_mfma_f32_16x16x32_bf16 v[100:103], a[196:199], a[148:151], v[100:103]
    v_exp_f32 v234, v58
    v_mfma_f32_16x16x32_bf16 v[100:103], a[200:203], a[152:155], v[100:103]
    ds_read_b64_tr_b16 a[250:251], v239 offset:51168
    ds_read_b64_tr_b16 a[252:253], v239 offset:51424
    v_mfma_f32_16x16x32_bf16 v[100:103], a[204:207], a[156:159], v[100:103]
    v_exp_f32 v235, v59
    v_mfma_f32_16x16x32_bf16 v[104:107], a[192:195], a[160:163], v[200:203]
    ds_read_b64_tr_b16 a[254:255], v239 offset:51680
    v_cvt_pk_bf16_f32 v151, v234, v235
    v_mfma_f32_16x16x32_bf16 v[104:107], a[196:199], a[164:167], v[104:107]
    v_mfma_f32_16x16x32_bf16 v[104:107], a[200:203], a[168:171], v[104:107]
    v_mfma_f32_16x16x32_bf16 v[104:107], a[204:207], a[172:175], v[104:107]
    v_mfma_f32_16x16x32_bf16 v[108:111], a[192:195], a[176:179], v[204:207]
    v_mfma_f32_16x16x32_bf16 v[108:111], a[196:199], a[180:183], v[108:111]
    v_mfma_f32_16x16x32_bf16 v[108:111], a[200:203], a[184:187], v[108:111]
    v_exp_f32 v228, v12
    v_mfma_f32_16x16x32_bf16 v[108:111], a[204:207], a[188:191], v[108:111]
    v_exp_f32 v229, v13
    v_mfma_f32_16x16x32_bf16 v[216:219], v[244:247], v[144:147], 0
    v_exp_f32 v230, v14
    v_mfma_f32_16x16x32_bf16 v[216:219], v[244:247], v[148:151], v[216:219]
    v_exp_f32 v231, v15
    s_waitcnt lgkmcnt(0)
    v_mfma_f32_16x16x32_bf16 a[64:67], a[224:227], v[160:163], a[64:67]
    v_cvt_pk_bf16_f32 v152, v228, v229
    v_cvt_pk_bf16_f32 v153, v230, v231
    v_mfma_f32_16x16x32_bf16 a[64:67], a[228:231], v[164:167], a[64:67]
    v_exp_f32 v232, v28
    v_mfma_f32_16x16x32_bf16 a[68:71], a[224:227], v[168:171], a[68:71]
    v_exp_f32 v233, v29
    v_mfma_f32_16x16x32_bf16 a[68:71], a[228:231], v[172:175], a[68:71]
    buffer_load_dwordx4 v250, s[44:47], s49 offen offset:2112 lds
    v_mfma_f32_16x16x32_bf16 a[72:75], a[224:227], v[176:179], a[72:75]
    v_exp_f32 v234, v30
    v_mfma_f32_16x16x32_bf16 a[72:75], a[228:231], v[180:183], a[72:75]
    v_exp_f32 v235, v31
    v_mfma_f32_16x16x32_bf16 a[76:79], a[224:227], v[184:187], a[76:79]
    v_cvt_pk_bf16_f32 v154, v232, v233
    v_cvt_pk_bf16_f32 v155, v234, v235
    v_mfma_f32_16x16x32_bf16 a[76:79], a[228:231], v[188:191], a[76:79]
    v_exp_f32 v228, v44
    v_mfma_f32_16x16x32_bf16 a[80:83], a[232:235], v[160:163], a[80:83]
    v_exp_f32 v229, v45
    v_mfma_f32_16x16x32_bf16 a[80:83], a[236:239], v[164:167], a[80:83]
    v_exp_f32 v230, v46
    v_mfma_f32_16x16x32_bf16 a[84:87], a[232:235], v[168:171], a[84:87]
    v_exp_f32 v231, v47
    v_mfma_f32_16x16x32_bf16 a[84:87], a[236:239], v[172:175], a[84:87]
    v_exp_f32 v232, v60
    v_mfma_f32_16x16x32_bf16 a[88:91], a[232:235], v[176:179], a[88:91]
    v_cvt_pk_bf16_f32 v156, v228, v229
    v_cvt_pk_bf16_f32 v157, v230, v231
    v_mfma_f32_16x16x32_bf16 a[88:91], a[236:239], v[180:183], a[88:91]
    v_exp_f32 v233, v61
    v_mfma_f32_16x16x32_bf16 a[92:95], a[232:235], v[184:187], a[92:95]
    v_exp_f32 v234, v62
    v_mfma_f32_16x16x32_bf16 a[92:95], a[236:239], v[188:191], a[92:95]
    s_waitcnt vmcnt(17) lgkmcnt(0)
    s_barrier
    v_mfma_f32_16x16x32_bf16 a[96:99], a[240:243], v[160:163], a[96:99]
    buffer_load_dwordx4 v251, s[44:47], s49 offen offset:3168 lds
    v_mfma_f32_16x16x32_bf16 a[96:99], a[244:247], v[164:167], a[96:99]
    v_exp_f32 v235, v63
    v_mfma_f32_16x16x32_bf16 a[100:103], a[240:243], v[168:171], a[100:103]
    s_add_u32 s49, s49, 131072
    v_cvt_pk_bf16_f32 v158, v232, v233
    v_mfma_f32_16x16x32_bf16 a[100:103], a[244:247], v[172:175], a[100:103]
    v_cvt_pk_bf16_f32 v159, v234, v235
    v_max3_f32 v241, v208, v212, v216
    v_mfma_f32_16x16x32_bf16 a[104:107], a[240:243], v[176:179], a[104:107]
    ds_read_b64_tr_b16 a[224:225], v238 offset:16896
    ds_read_b64_tr_b16 a[226:227], v238 offset:17152
    v_mfma_f32_16x16x32_bf16 a[104:107], a[244:247], v[180:183], a[104:107]
    ds_read_b64_tr_b16 a[228:229], v238 offset:17408
    ds_read_b64_tr_b16 a[230:231], v238 offset:17664
    v_mfma_f32_16x16x32_bf16 a[108:111], a[240:243], v[184:187], a[108:111]
    ds_read_b64_tr_b16 a[232:233], v238 offset:16928
    ds_read_b64_tr_b16 a[234:235], v238 offset:17184
    v_mfma_f32_16x16x32_bf16 a[108:111], a[244:247], v[188:191], a[108:111]
    ds_read_b64_tr_b16 a[236:237], v238 offset:17440
    ds_read_b64_tr_b16 a[238:239], v238 offset:17696
    v_mfma_f32_16x16x32_bf16 v[220:223], v[244:247], v[152:155], 0
    v_mfma_f32_16x16x32_bf16 v[220:223], v[244:247], v[156:159], v[220:223]
    v_mfma_f32_16x16x32_bf16 a[112:115], a[248:251], v[160:163], a[112:115]
    buffer_load_dword v254, v240, s[36:39], s98 offen offset:0 sc1
    v_mfma_f32_16x16x32_bf16 a[112:115], a[252:255], v[164:167], a[112:115]
    v_mfma_f32_16x16x32_bf16 a[116:119], a[248:251], v[168:171], a[116:119]
    v_mfma_f32_16x16x32_bf16 a[116:119], a[252:255], v[172:175], a[116:119]
    v_mfma_f32_16x16x32_bf16 a[120:123], a[248:251], v[176:179], a[120:123]
    v_mfma_f32_16x16x32_bf16 a[120:123], a[252:255], v[180:183], a[120:123]
    v_mfma_f32_16x16x32_bf16 a[124:127], a[248:251], v[184:187], a[124:127]
    v_mfma_f32_16x16x32_bf16 a[124:127], a[252:255], v[188:191], a[124:127]
    s_nop 1
    v_max_f32 v241, v241, v220
    v_cmp_lt_f32 vcc, s61, v241
    s_cbranch_vccnz L_fb30
L_fb30_ret:
    v_mfma_f32_16x16x32_bf16 v[112:115], a[208:211], a[128:131], v[192:195]
    v_exp_f32 v228, v64
    v_mfma_f32_16x16x32_bf16 v[112:115], a[212:215], a[132:135], v[112:115]
    v_exp_f32 v229, v65
    v_mfma_f32_16x16x32_bf16 v[112:115], a[216:219], a[136:139], v[112:115]
    v_exp_f32 v230, v66
    v_mfma_f32_16x16x32_bf16 v[112:115], a[220:223], a[140:143], v[112:115]
    v_exp_f32 v231, v67
    v_mfma_f32_16x16x32_bf16 v[116:119], a[208:211], a[144:147], v[196:199]
    v_cvt_pk_bf16_f32 v160, v228, v229
    v_cvt_pk_bf16_f32 v161, v230, v231
    v_mfma_f32_16x16x32_bf16 v[116:119], a[212:215], a[148:151], v[116:119]
    v_exp_f32 v232, v80
    v_mfma_f32_16x16x32_bf16 v[116:119], a[216:219], a[152:155], v[116:119]
    v_exp_f32 v233, v81
    v_mfma_f32_16x16x32_bf16 v[116:119], a[220:223], a[156:159], v[116:119]
    v_exp_f32 v234, v82
    v_mfma_f32_16x16x32_bf16 v[120:123], a[208:211], a[160:163], v[200:203]
    v_cvt_pk_bf16_f32 v162, v232, v233
    v_add_f32 v224, v224, v208
    v_mfma_f32_16x16x32_bf16 v[120:123], a[212:215], a[164:167], v[120:123]
    v_exp_f32 v235, v83
    v_mfma_f32_16x16x32_bf16 v[120:123], a[216:219], a[168:171], v[120:123]
    v_cvt_pk_bf16_f32 v163, v234, v235
    v_add_f32 v225, v225, v212
    v_mfma_f32_16x16x32_bf16 v[120:123], a[220:223], a[172:175], v[120:123]
    v_add_f32 v226, v226, v216
    v_add_f32 v227, v227, v220
    v_mfma_f32_16x16x32_bf16 v[124:127], a[208:211], a[176:179], v[204:207]
    v_mfma_f32_16x16x32_bf16 v[124:127], a[212:215], a[180:183], v[124:127]
    v_mfma_f32_16x16x32_bf16 v[124:127], a[216:219], a[184:187], v[124:127]
    v_mfma_f32_16x16x32_bf16 v[124:127], a[220:223], a[188:191], v[124:127]
    s_add_u32 s58, s56, 1
    s_and_b32 s58, s58, 3
    s_lshl2_add_u32 s58, s99, s58
    s_mul_i32 s58, s58, 114688
    v_add_u32 v48, s58, v243
    s_add_u32 s58, s56, 2
    s_and_b32 s58, s58, 3
    s_lshl2_add_u32 s58, s99, s58
    s_mul_i32 s58, s58, 114688
    v_add_u32 v49, s58, v243
    s_add_u32 s58, s56, 3
    s_and_b32 s58, s58, 3
    s_lshl2_add_u32 s58, s99, s58
    s_mul_i32 s58, s58, 114688
    v_add_u32 v50, s58, v243
    s_add_u32 s58, s56, 4
    s_and_b32 s58, s58, 3
    s_lshl2_add_u32 s58, s99, s58
    s_mul_i32 s58, s58, 114688
    v_add_u32 v51, s58, v243
    s_getpc_b64 s[68:69]
L_pcc:
    s_mul_i32 s58, s54, 16384
    v_lshlrev_b32 v56, 7, v242
    v_add_u32 v56, s58, v56
    v_mov_b32 v58, s69
    v_add_u32 v57, 0, v56
    v_min_u32 v57, L_last - L_pcc, v57
    v_add_co_u32 v60, vcc, s68, v57
    s_nop 1
    v_addc_co_u32 v61, vcc, 0, v58, vcc
    global_load_dword v62, v[60:61], off
    v_add_u32 v57, 8192, v56
    v_min_u32 v57, L_last - L_pcc, v57
    v_add_co_u32 v60, vcc, s68, v57
    s_nop 1
    v_addc_co_u32 v61, vcc, 0, v58, vcc
    global_load_dword v63, v[60:61], off
    s_waitcnt lgkmcnt(0)
    v_mfma_f32_16x16x32_bf16 a[0:3], a[224:227], v[128:131], a[0:3]
    v_exp_f32 v228, v96
    v_exp_f32 v229, v97
    v_mfma_f32_16x16x32_bf16 a[0:3], a[228:231], v[132:135], a[0:3]
    v_exp_f32 v230, v98
    v_exp_f32 v231, v99
    v_mfma_f32_16x16x32_bf16 a[4:7], a[224:227], v[136:139], a[4:7]
    s_add_u32 m0, s53, 101376
    v_exp_f32 v232, v112
    v_cvt_pk_bf16_f32 v164, v228, v229
    v_mfma_f32_16x16x32_bf16 a[4:7], a[228:231], v[140:143], a[4:7]
    buffer_load_dwordx4 v248, s[44:47], s49 offen offset:0 lds
    v_exp_f32 v233, v113
    v_mfma_f32_16x16x32_bf16 a[8:11], a[224:227], v[144:147], a[8:11]
    v_exp_f32 v234, v114
    v_cvt_pk_bf16_f32 v165, v230, v231
    v_cvt_pk_bf16_f32 v166, v232, v233
    v_mfma_f32_16x16x32_bf16 a[8:11], a[228:231], v[148:151], a[8:11]
    ds_read_b64_tr_b16 a[240:241], v238 offset:16960
    ds_read_b64_tr_b16 a[242:243], v238 offset:17216
    v_exp_f32 v235, v115
    v_mfma_f32_16x16x32_bf16 a[12:15], a[224:227], v[152:155], a[12:15]
    ds_read_b64_tr_b16 a[244:245], v238 offset:17472
    ds_read_b64_tr_b16 a[246:247], v238 offset:17728
    v_exp_f32 v228, v68
    v_mfma_f32_16x16x32_bf16 a[12:15], a[228:231], v[156:159], a[12:15]
    buffer_load_dwordx4 v249, s[44:47], s49 offen offset:1056 lds
    v_exp_f32 v229, v69
    v_mfma_f32_16x16x32_bf16 a[16:19], a[232:235], v[128:131], a[16:19]
    v_exp_f32 v230, v70
    v_cvt_pk_bf16_f32 v167, v234, v235
    v_cvt_pk_bf16_f32 v168, v228, v229
    v_mfma_f32_16x16x32_bf16 a[16:19], a[236:239], v[132:135], a[16:19]
    buffer_load_dwordx4 v250, s[44:47], s49 offen offset:2112 lds
    v_exp_f32 v231, v71
    v_mfma_f32_16x16x32_bf16 a[20:23], a[232:235], v[136:139], a[20:23]
    ds_read_b64_tr_b16 a[248:249], v238 offset:16992
    v_exp_f32 v232, v84
    v_cvt_pk_bf16_f32 v169, v230, v231
    v_mfma_f32_16x16x32_bf16 a[20:23], a[236:239], v[140:143], a[20:23]
    ds_read_b64_tr_b16 a[250:251], v238 offset:17248
    ds_read_b64_tr_b16 a[252:253], v238 offset:17504
    v_exp_f32 v233, v85
    v_mfma_f32_16x16x32_bf16 a[24:27], a[232:235], v[144:147], a[24:27]
    ds_read_b64_tr_b16 a[254:255], v238 offset:17760
    buffer_load_dwordx4 v251, s[44:47], s49 offen offset:3168 lds
    v_cvt_pk_bf16_f32 v170, v232, v233
    v_mfma_f32_16x16x32_bf16 a[24:27], a[236:239], v[148:151], a[24:27]
    ds_read_b64_tr_b16 a[224:225], v238 offset:17024
    s_add_u32 s49, s49, 131072
    v_exp_f32 v234, v86
    v_mfma_f32_16x16x32_bf16 a[28:31], a[232:235], v[152:155], a[28:31]
    ds_read_b64_tr_b16 a[226:227], v238 offset:17280
    ds_read_b64_tr_b16 a[228:229], v238 offset:17536
    v_exp_f32 v235, v87
    v_mfma_f32_16x16x32_bf16 a[28:31], a[236:239], v[156:159], a[28:31]
    s_add_u32 m0, s53, 118272
    v_exp_f32 v228, v100
    v_cvt_pk_bf16_f32 v171, v234, v235
    v_mfma_f32_16x16x32_bf16 v[208:211], v[244:247], v[160:163], 0
    buffer_load_dwordx4 v248, s[44:47], s49 offen offset:0 lds
    v_exp_f32 v229, v101
    v_mfma_f32_16x16x32_bf16 v[208:211], v[244:247], v[164:167], v[208:211]
    ds_read_b64_tr_b16 a[230:231], v238 offset:17792
    v_exp_f32 v230, v102
    v_cvt_pk_bf16_f32 v172, v228, v229
    s_waitcnt lgkmcnt(5)
    v_mfma_f32_16x16x32_bf16 a[32:35], a[240:243], v[128:131], a[32:35]
    ds_read_b64_tr_b16 a[232:233], v238 offset:17056
    ds_read_b64_tr_b16 a[234:235], v238 offset:17312
    v_exp_f32 v231, v103
    v_mfma_f32_16x16x32_bf16 a[32:35], a[244:247], v[132:135], a[32:35]
    ds_read_b64_tr_b16 a[236:237], v238 offset:17568
    v_exp_f32 v232, v116
    v_cvt_pk_bf16_f32 v173, v230, v231
    v_mfma_f32_16x16x32_bf16 a[36:39], a[240:243], v[136:139], a[36:39]
    ds_read_b64_tr_b16 a[238:239], v238 offset:17824
    buffer_load_dwordx4 v249, s[44:47], s49 offen offset:1056 lds
    v_mfma_f32_16x16x32_bf16 a[36:39], a[244:247], v[140:143], a[36:39]
    v_exp_f32 v233, v117
    v_mfma_f32_16x16x32_bf16 a[40:43], a[240:243], v[144:147], a[40:43]
    v_exp_f32 v234, v118
    v_cvt_pk_bf16_f32 v174, v232, v233
    v_mfma_f32_16x16x32_bf16 a[40:43], a[244:247], v[148:151], a[40:43]
    v_exp_f32 v235, v119
    v_mfma_f32_16x16x32_bf16 a[44:47], a[240:243], v[152:155], a[44:47]
    buffer_load_dwordx4 v250, s[44:47], s49 offen offset:2112 lds
    v_exp_f32 v228, v72
    v_mfma_f32_16x16x32_bf16 a[44:47], a[244:247], v[156:159], a[44:47]
    ds_read_b64_tr_b16 a[240:241], v238 offset:17088
    v_exp_f32 v229, v73
    v_cvt_pk_bf16_f32 v175, v234, v235
    v_mfma_f32_16x16x32_bf16 a[48:51], a[248:251], v[128:131], a[48:51]
    ds_read_b64_tr_b16 a[242:243], v238 offset:17344
    v_exp_f32 v230, v74
    v_cvt_pk_bf16_f32 v176, v228, v229
    s_waitcnt lgkmcnt(2)
    v_mfma_f32_16x16x32_bf16 a[48:51], a[252:255], v[132:135], a[48:51]
    ds_read_b64_tr_b16 a[244:245], v238 offset:17600
    ds_read_b64_tr_b16 a[246:247], v238 offset:17856
    v_exp_f32 v231, v75
    v_mfma_f32_16x16x32_bf16 a[52:55], a[248:251], v[136:139], a[52:55]
    buffer_load_dwordx4 v251, s[44:47], s49 offen offset:3168 lds
    s_add_u32 s49, s49, 131072
    v_cvt_pk_bf16_f32 v177, v230, v231
    v_mfma_f32_16x16x32_bf16 a[52:55], a[252:255], v[140:143], a[52:55]
    v_exp_f32 v232, v88
    v_mfma_f32_16x16x32_bf16 a[56:59], a[248:251], v[144:147], a[56:59]
    v_exp_f32 v233, v89
    v_mfma_f32_16x16x32_bf16 a[56:59], a[252:255], v[148:151], a[56:59]
    v_exp_f32 v234, v90
    v_cvt_pk_bf16_f32 v178, v232, v233
    v_mfma_f32_16x16x32_bf16 a[60:63], a[248:251], v[152:155], a[60:63]
    v_exp_f32 v235, v91
    v_mfma_f32_16x16x32_bf16 a[60:63], a[252:255], v[156:159], a[60:63]
    ds_read_b64_tr_b16 a[248:249], v238 offset:17120
    v_exp_f32 v228, v104
    v_cvt_pk_bf16_f32 v179, v234, v235
    v_mfma_f32_16x16x32_bf16 a[64:67], a[224:227], v[128:131], a[64:67]
    ds_read_b64_tr_b16 a[250:251], v238 offset:17376
    ds_read_b64_tr_b16 a[252:253], v238 offset:17632
    v_exp_f32 v229, v105
    v_mfma_f32_16x16x32_bf16 a[64:67], a[228:231], v[132:135], a[64:67]
    ds_read_b64_tr_b16 a[254:255], v238 offset:17888
    v_exp_f32 v230, v106
    v_cvt_pk_bf16_f32 v180, v228, v229
    v_mfma_f32_16x16x32_bf16 a[68:71], a[224:227], v[136:139], a[68:71]
    s_waitcnt vmcnt(10)
    v_cmp_eq_u32 vcc, 1, v254
    s_nop 0
    s_and_b32 s58, vcc_lo, -1
    s_cmp_eq_u32 s58, -1
    s_cbranch_scc0 L_gth
L_gth_ret:
    v_mfma_f32_16x16x32_bf16 a[68:71], a[228:231], v[140:143], a[68:71]
    buffer_load_dwordx4 a[128:131], v48, s[24:27], s48 offen offset:0 sc1
    v_exp_f32 v231, v107
    v_mfma_f32_16x16x32_bf16 a[72:75], a[224:227], v[144:147], a[72:75]
    buffer_load_dwordx4 a[132:135], v48, s[24:27], s48 offen offset:1024 sc1
    v_exp_f32 v232, v120
    v_mfma_f32_16x16x32_bf16 a[72:75], a[228:231], v[148:151], a[72:75]
    v_exp_f32 v233, v121
    v_cvt_pk_bf16_f32 v181, v230, v231
    v_mfma_f32_16x16x32_bf16 a[76:79], a[224:227], v[152:155], a[76:79]
    buffer_load_dwordx4 a[136:139], v48, s[24:27], s48 offen offset:2048 sc1
    v_exp_f32 v234, v122
    v_mfma_f32_16x16x32_bf16 a[76:79], a[228:231], v[156:159], a[76:79]
    v_exp_f32 v235, v123
    v_cvt_pk_bf16_f32 v182, v232, v233
    v_mfma_f32_16x16x32_bf16 v[212:215], v[244:247], v[168:171], 0
    v_exp_f32 v228, v76
    v_cvt_pk_bf16_f32 v183, v234, v235
    v_mfma_f32_16x16x32_bf16 v[212:215], v[244:247], v[172:175], v[212:215]
    v_exp_f32 v229, v77
    v_mfma_f32_16x16x32_bf16 a[80:83], a[232:235], v[128:131], a[80:83]
    buffer_load_dwordx4 a[140:143], v48, s[24:27], s48 offen offset:3072 sc1
    v_cvt_pk_bf16_f32 v184, v228, v229
    v_mfma_f32_16x16x32_bf16 a[80:83], a[236:239], v[132:135], a[80:83]
    v_exp_f32 v230, v78
    v_mfma_f32_16x16x32_bf16 a[84:87], a[232:235], v[136:139], a[84:87]
    v_exp_f32 v231, v79
    v_mfma_f32_16x16x32_bf16 a[84:87], a[236:239], v[140:143], a[84:87]
    v_exp_f32 v232, v92
    v_cvt_pk_bf16_f32 v185, v230, v231
    v_mfma_f32_16x16x32_bf16 a[88:91], a[232:235], v[144:147], a[88:91]
    buffer_load_dwordx4 a[144:147], v49, s[24:27], s48 offen offset:0 sc1
    v_exp_f32 v233, v93
    v_mfma_f32_16x16x32_bf16 a[88:91], a[236:239], v[148:151], a[88:91]
    v_exp_f32 v234, v94
    v_cvt_pk_bf16_f32 v186, v232, v233
    v_mfma_f32_16x16x32_bf16 a[92:95], a[232:235], v[152:155], a[92:95]
    v_exp_f32 v235, v95
    v_mfma_f32_16x16x32_bf16 a[92:95], a[236:239], v[156:159], a[92:95]
    s_waitcnt vmcnt(25) lgkmcnt(0)
    s_barrier
    v_exp_f32 v228, v108
    v_mfma_f32_16x16x32_bf16 a[96:99], a[240:243], v[128:131], a[96:99]
    ds_read_b64_tr_b16 a[224:225], v238 offset:50688
    buffer_load_dwordx4 a[148:151], v49, s[24:27], s48 offen offset:1024 sc1
    v_cvt_pk_bf16_f32 v187, v234, v235
    v_mfma_f32_16x16x32_bf16 a[96:99], a[244:247], v[132:135], a[96:99]
    ds_read_b64_tr_b16 a[226:227], v238 offset:50944
    ds_read_b64_tr_b16 a[228:229], v238 offset:51200
    v_exp_f32 v229, v109
    v_mfma_f32_16x16x32_bf16 a[100:103], a[240:243], v[136:139], a[100:103]
    ds_read_b64_tr_b16 a[230:231], v238 offset:51456
    v_exp_f32 v230, v110
    v_cvt_pk_bf16_f32 v188, v228, v229
    v_mfma_f32_16x16x32_bf16 a[100:103], a[244:247], v[140:143], a[100:103]
    ds_read_b64_tr_b16 a[232:233], v238 offset:50720
    ds_read_b64_tr_b16 a[234:235], v238 offset:50976
    v_exp_f32 v231, v111
    v_mfma_f32_16x16x32_bf16 a[104:107], a[240:243], v[144:147], a[104:107]
    buffer_load_dwordx4 a[152:155], v49, s[24:27], s48 offen offset:2048 sc1
    v_exp_f32 v232, v124
    v_mfma_f32_16x16x32_bf16 a[104:107], a[244:247], v[148:151], a[104:107]
    ds_read_b64_tr_b16 a[236:237], v238 offset:51232
    v_exp_f32 v233, v125
    v_cvt_pk_bf16_f32 v189, v230, v231
    v_mfma_f32_16x16x32_bf16 a[108:111], a[240:243], v[152:155], a[108:111]
    ds_read_b64_tr_b16 a[238:239], v238 offset:51488
    v_exp_f32 v234, v126
    v_cvt_pk_bf16_f32 v190, v232, v233
    v_mfma_f32_16x16x32_bf16 a[108:111], a[244:247], v[156:159], a[108:111]
    v_exp_f32 v235, v127
    v_mfma_f32_16x16x32_bf16 v[216:219], v[244:247], v[176:179], 0
    buffer_load_dwordx4 a[156:159], v49, s[24:27], s48 offen offset:3072 sc1
    v_cvt_pk_bf16_f32 v191, v234, v235
    v_mfma_f32_16x16x32_bf16 v[216:219], v[244:247], v[180:183], v[216:219]
    v_mfma_f32_16x16x32_bf16 a[112:115], a[248:251], v[128:131], a[112:115]
    v_mfma_f32_16x16x32_bf16 a[112:115], a[252:255], v[132:135], a[112:115]
    v_mfma_f32_16x16x32_bf16 a[116:119], a[248:251], v[136:139], a[116:119]
    v_mfma_f32_16x16x32_bf16 a[116:119], a[252:255], v[140:143], a[116:119]
    v_mfma_f32_16x16x32_bf16 a[120:123], a[248:251], v[144:147], a[120:123]
    v_mfma_f32_16x16x32_bf16 a[120:123], a[252:255], v[148:151], a[120:123]
    v_mfma_f32_16x16x32_bf16 a[124:127], a[248:251], v[152:155], a[124:127]
    v_mfma_f32_16x16x32_bf16 a[124:127], a[252:255], v[156:159], a[124:127]
    v_mfma_f32_16x16x32_bf16 v[220:223], v[244:247], v[184:187], 0
    v_max3_f32 v241, v208, v212, v216
    v_mfma_f32_16x16x32_bf16 v[220:223], v[244:247], v[188:191], v[220:223]
    s_nop 9
    v_max_f32 v241, v241, v220
    v_cmp_lt_f32 vcc, s61, v241
    s_cbranch_vccnz L_fb31
L_fb31_ret:
    v_add_f32 v224, v224, v208
    v_add_f32 v225, v225, v212
    v_add_f32 v226, v226, v216
    v_add_f32 v227, v227, v220
    s_waitcnt lgkmcnt(0)
    v_mfma_f32_16x16x32_bf16 a[0:3], a[224:227], v[160:163], a[0:3]
    buffer_load_dwordx4 a[160:163], v50, s[24:27], s48 offen offset:0 sc1
    v_mfma_f32_16x16x32_bf16 a[0:3], a[228:231], v[164:167], a[0:3]
    ds_read_b64_tr_b16 a[240:241], v238 offset:50752
    ds_read_b64_tr_b16 a[242:243], v238 offset:51008
    v_mfma_f32_16x16x32_bf16 a[4:7], a[224:227], v[168:171], a[4:7]
    ds_read_b64_tr_b16 a[244:245], v238 offset:51264
    ds_read_b64_tr_b16 a[246:247], v238 offset:51520
    v_mfma_f32_16x16x32_bf16 a[4:7], a[228:231], v[172:175], a[4:7]
    buffer_load_dwordx4 a[164:167], v50, s[24:27], s48 offen offset:1024 sc1
    v_mfma_f32_16x16x32_bf16 a[8:11], a[224:227], v[176:179], a[8:11]
    buffer_load_dwordx4 a[168:171], v50, s[24:27], s48 offen offset:2048 sc1
    v_mfma_f32_16x16x32_bf16 a[8:11], a[228:231], v[180:183], a[8:11]
    ds_read_b64_tr_b16 a[248:249], v238 offset:50784
    ds_read_b64_tr_b16 a[250:251], v238 offset:51040
    v_mfma_f32_16x16x32_bf16 a[12:15], a[224:227], v[184:187], a[12:15]
    ds_read_b64_tr_b16 a[252:253], v238 offset:51296
    ds_read_b64_tr_b16 a[254:255], v238 offset:51552
    v_mfma_f32_16x16x32_bf16 a[12:15], a[228:231], v[188:191], a[12:15]
    buffer_load_dwordx4 a[172:175], v50, s[24:27], s48 offen offset:3072 sc1
    v_mfma_f32_16x16x32_bf16 a[16:19], a[232:235], v[160:163], a[16:19]
    ds_read_b64_tr_b16 a[224:225], v238 offset:50816
    ds_read_b64_tr_b16 a[226:227], v238 offset:51072
    v_mfma_f32_16x16x32_bf16 a[16:19], a[236:239], v[164:167], a[16:19]
    buffer_load_dwordx4 a[176:179], v51, s[24:27], s48 offen offset:0 sc1
    v_mfma_f32_16x16x32_bf16 a[20:23], a[232:235], v[168:171], a[20:23]
    ds_read_b64_tr_b16 a[228:229], v238 offset:51328
    ds_read_b64_tr_b16 a[230:231], v238 offset:51584
    v_mfma_f32_16x16x32_bf16 a[20:23], a[236:239], v[172:175], a[20:23]
    buffer_load_dwordx4 a[180:183], v51, s[24:27], s48 offen offset:1024 sc1
    v_mfma_f32_16x16x32_bf16 a[24:27], a[232:235], v[176:179], a[24:27]
    v_mfma_f32_16x16x32_bf16 a[24:27], a[236:239], v[180:183], a[24:27]
    v_mfma_f32_16x16x32_bf16 a[28:31], a[232:235], v[184:187], a[28:31]
    buffer_load_dwordx4 a[184:187], v51, s[24:27], s48 offen offset:2048 sc1
    v_mfma_f32_16x16x32_bf16 a[28:31], a[236:239], v[188:191], a[28:31]
    ds_read_b64_tr_b16 a[232:233], v238 offset:50848
    ds_read_b64_tr_b16 a[234:235], v238 offset:51104
    s_waitcnt lgkmcnt(4)
    v_mfma_f32_16x16x32_bf16 a[32:35], a[240:243], v[160:163], a[32:35]
    buffer_load_dwordx4 a[188:191], v51, s[24:27], s48 offen offset:3072 sc1
    v_mfma_f32_16x16x32_bf16 a[32:35], a[244:247], v[164:167], a[32:35]
    s_add_u32 s48, s48, 4096
    s_add_u32 m0, s53, 0
    v_mfma_f32_16x16x32_bf16 a[36:39], a[240:243], v[168:171], a[36:39]
    buffer_load_dwordx4 v248, s[44:47], s49 offen offset:0 lds
    v_mfma_f32_16x16x32_bf16 a[36:39], a[244:247], v[172:175], a[36:39]
    ds_read_b64_tr_b16 a[236:237], v238 offset:51360
    ds_read_b64_tr_b16 a[238:239], v238 offset:51616
    v_mfma_f32_16x16x32_bf16 a[40:43], a[240:243], v[176:179], a[40:43]
    v_mfma_f32_16x16x32_bf16 a[40:43], a[244:247], v[180:183], a[40:43]
    buffer_load_dwordx4 v249, s[44:47], s49 offen offset:1056 lds
    v_mfma_f32_16x16x32_bf16 a[44:47], a[240:243], v[184:187], a[44:47]
    v_mfma_f32_16x16x32_bf16 a[44:47], a[244:247], v[188:191], a[44:47]
    buffer_load_dwordx4 v250, s[44:47], s49 offen offset:2112 lds
    v_mfma_f32_16x16x32_bf16 a[48:51], a[248:251], v[160:163], a[48:51]
    ds_read_b64_tr_b16 a[240:241], v238 offset:50880
    ds_read_b64_tr_b16 a[242:243], v238 offset:51136
    v_mfma_f32_16x16x32_bf16 a[48:51], a[252:255], v[164:167], a[48:51]
    buffer_load_dwordx4 v251, s[44:47], s49 offen offset:3168 lds
    v_mfma_f32_16x16x32_bf16 a[52:55], a[248:251], v[168:171], a[52:55]
    ds_read_b64_tr_b16 a[244:245], v238 offset:51392
    s_add_u32 s49, s49, 131072
    v_mfma_f32_16x16x32_bf16 a[52:55], a[252:255], v[172:175], a[52:55]
    ds_read_b64_tr_b16 a[246:247], v238 offset:51648
    s_add_u32 m0, s53, 16896
    v_mfma_f32_16x16x32_bf16 a[56:59], a[248:251], v[176:179], a[56:59]
    buffer_load_dwordx4 v248, s[44:47], s49 offen offset:0 lds
    v_mfma_f32_16x16x32_bf16 a[56:59], a[252:255], v[180:183], a[56:59]
    v_mfma_f32_16x16x32_bf16 a[60:63], a[248:251], v[184:187], a[60:63]
    buffer_load_dwordx4 v249, s[44:47], s49 offen offset:1056 lds
    v_mfma_f32_16x16x32_bf16 a[60:63], a[252:255], v[188:191], a[60:63]
    ds_read_b64_tr_b16 a[248:249], v238 offset:50912
    ds_read_b64_tr_b16 a[250:251], v238 offset:51168
    v_mfma_f32_16x16x32_bf16 a[64:67], a[224:227], v[160:163], a[64:67]
    buffer_load_dwordx4 v250, s[44:47], s49 offen offset:2112 lds
    s_waitcnt lgkmcnt(3)
    v_mfma_f32_16x16x32_bf16 a[64:67], a[228:231], v[164:167], a[64:67]
    ds_read_b64_tr_b16 a[252:253], v238 offset:51424
    ds_read_b64_tr_b16 a[254:255], v238 offset:51680
    v_mfma_f32_16x16x32_bf16 a[68:71], a[224:227], v[168:171], a[68:71]
    v_mfma_f32_16x16x32_bf16 a[68:71], a[228:231], v[172:175], a[68:71]
    buffer_load_dwordx4 v251, s[44:47], s49 offen offset:3168 lds
    v_mfma_f32_16x16x32_bf16 a[72:75], a[224:227], v[176:179], a[72:75]
    s_add_u32 s49, s49, 131072
    v_mfma_f32_16x16x32_bf16 a[72:75], a[228:231], v[180:183], a[72:75]
    buffer_load_dwordx4 a[192:195], v48, s[24:27], s48 offen offset:0 sc1
    v_mfma_f32_16x16x32_bf16 a[76:79], a[224:227], v[184:187], a[76:79]
    v_mfma_f32_16x16x32_bf16 a[76:79], a[228:231], v[188:191], a[76:79]
    buffer_load_dwordx4 a[196:199], v48, s[24:27], s48 offen offset:1024 sc1
    v_mfma_f32_16x16x32_bf16 a[80:83], a[232:235], v[160:163], a[80:83]
    v_mfma_f32_16x16x32_bf16 a[80:83], a[236:239], v[164:167], a[80:83]
    v_mfma_f32_16x16x32_bf16 a[84:87], a[232:235], v[168:171], a[84:87]
    buffer_load_dwordx4 a[200:203], v48, s[24:27], s48 offen offset:2048 sc1
    v_mfma_f32_16x16x32_bf16 a[84:87], a[236:239], v[172:175], a[84:87]
    v_mfma_f32_16x16x32_bf16 a[88:91], a[232:235], v[176:179], a[88:91]
    buffer_load_dwordx4 a[204:207], v48, s[24:27], s48 offen offset:3072 sc1
    v_mfma_f32_16x16x32_bf16 a[88:91], a[236:239], v[180:183], a[88:91]
    v_mfma_f32_16x16x32_bf16 a[92:95], a[232:235], v[184:187], a[92:95]
    buffer_load_dwordx4 a[208:211], v49, s[24:27], s48 offen offset:0 sc1
    v_mfma_f32_16x16x32_bf16 a[92:95], a[236:239], v[188:191], a[92:95]
    s_waitcnt vmcnt(40) lgkmcnt(0)
    s_barrier
    v_mfma_f32_16x16x32_bf16 a[96:99], a[240:243], v[160:163], a[96:99]
    ds_read_b64_tr_b16 v[64:65], v239 offset:0
    ds_read_b64_tr_b16 v[66:67], v239 offset:256
    v_mfma_f32_16x16x32_bf16 a[96:99], a[244:247], v[164:167], a[96:99]
    buffer_load_dwordx4 a[212:215], v49, s[24:27], s48 offen offset:1024 sc1
    v_mfma_f32_16x16x32_bf16 a[100:103], a[240:243], v[168:171], a[100:103]
    ds_read_b64_tr_b16 v[68:69], v239 offset:512
    ds_read_b64_tr_b16 v[70:71], v239 offset:768
    v_mfma_f32_16x16x32_bf16 a[100:103], a[244:247], v[172:175], a[100:103]
    buffer_load_dwordx4 a[216:219], v49, s[24:27], s48 offen offset:2048 sc1
    v_mfma_f32_16x16x32_bf16 a[104:107], a[240:243], v[176:179], a[104:107]
    ds_read_b64_tr_b16 v[72:73], v239 offset:16896
    ds_read_b64_tr_b16 v[74:75], v239 offset:17152
    v_mfma_f32_16x16x32_bf16 a[104:107], a[244:247], v[180:183], a[104:107]
    buffer_load_dwordx4 a[220:223], v49, s[24:27], s48 offen offset:3072 sc1
    v_mfma_f32_16x16x32_bf16 a[108:111], a[240:243], v[184:187], a[108:111]
    ds_read_b64_tr_b16 v[76:77], v239 offset:17408
    ds_read_b64_tr_b16 v[78:79], v239 offset:17664
    v_mfma_f32_16x16x32_bf16 a[108:111], a[244:247], v[188:191], a[108:111]
    ds_read_b64_tr_b16 v[80:81], v239 offset:32
    ds_read_b64_tr_b16 v[82:83], v239 offset:288
    v_mfma_f32_16x16x32_bf16 a[112:115], a[248:251], v[160:163], a[112:115]
    ds_read_b64_tr_b16 v[84:85], v239 offset:544
    ds_read_b64_tr_b16 v[86:87], v239 offset:800
    v_mfma_f32_16x16x32_bf16 a[112:115], a[252:255], v[164:167], a[112:115]
    ds_read_b64_tr_b16 v[88:89], v239 offset:16928
    ds_read_b64_tr_b16 v[90:91], v239 offset:17184
    v_mfma_f32_16x16x32_bf16 a[116:119], a[248:251], v[168:171], a[116:119]
    ds_read_b64_tr_b16 v[92:93], v239 offset:17440
    ds_read_b64_tr_b16 v[94:95], v239 offset:17696
    v_mfma_f32_16x16x32_bf16 a[116:119], a[252:255], v[172:175], a[116:119]
    v_mfma_f32_16x16x32_bf16 a[120:123], a[248:251], v[176:179], a[120:123]
    v_mfma_f32_16x16x32_bf16 a[120:123], a[252:255], v[180:183], a[120:123]
    v_mfma_f32_16x16x32_bf16 a[124:127], a[248:251], v[184:187], a[124:127]
    v_mfma_f32_16x16x32_bf16 a[124:127], a[252:255], v[188:191], a[124:127]
    buffer_load_dwordx4 a[224:227], v50, s[24:27], s48 offen offset:0 sc1
    buffer_load_dwordx4 a[228:231], v50, s[24:27], s48 offen offset:1024 sc1
    buffer_load_dwordx4 a[232:235], v50, s[24:27], s48 offen offset:2048 sc1
    buffer_load_dwordx4 a[236:239], v50, s[24:27], s48 offen offset:3072 sc1
    buffer_load_dwordx4 a[240:243], v51, s[24:27], s48 offen offset:0 sc1
    buffer_load_dwordx4 a[244:247], v51, s[24:27], s48 offen offset:1024 sc1
    buffer_load_dwordx4 a[248:251], v51, s[24:27], s48 offen offset:2048 sc1
    buffer_load_dwordx4 a[252:255], v51, s[24:27], s48 offen offset:3072 sc1
    s_add_u32 s48, s48, 4096
    s_mul_i32 s59, s99, 524288
    s_lshl_b32 s62, s55, 12
    s_add_u32 s59, s59, s62
    v_mov_b32 v255, v253
    v_add_u32 v253, s59, v243
    s_mov_b32 s62, 131072
    s_mov_b32 s63, 262144
    s_mov_b32 s64, 393216
    v_mov_b32 v228, v224
    v_mov_b32 v229, v225
    v_mov_b32 v230, v226
    v_mov_b32 v231, v227
    s_nop 0
    v_permlane16_swap_b32 v224, v228
    v_permlane16_swap_b32 v225, v229
    v_permlane16_swap_b32 v226, v230
    v_permlane16_swap_b32 v227, v231
    v_add_f32 v224, v224, v228
    v_add_f32 v225, v225, v229
    v_add_f32 v226, v226, v230
    v_add_f32 v227, v227, v231
    v_mov_b32 v228, v224
    v_mov_b32 v229, v225
    v_mov_b32 v230, v226
    v_mov_b32 v231, v227
    s_nop 0
    v_permlane32_swap_b32 v224, v228
    v_permlane32_swap_b32 v225, v229
    v_permlane32_swap_b32 v226, v230
    v_permlane32_swap_b32 v227, v231
    v_add_f32 v224, v224, v228
    v_add_f32 v225, v225, v229
    v_add_f32 v226, v226, v230
    v_add_f32 v227, v227, v231
    v_rcp_f32 v228, v224
    v_rcp_f32 v230, v225
    v_rcp_f32 v232, v226
    v_rcp_f32 v234, v227
    s_nop 2
    v_mov_b32 v229, v228
    v_mov_b32 v231, v230
    v_mov_b32 v233, v232
    v_mov_b32 v235, v234
    v_accvgpr_read_b32 v192, a0
    v_accvgpr_read_b32 v193, a1
    v_accvgpr_read_b32 v194, a2
    v_accvgpr_read_b32 v195, a3
    v_accvgpr_read_b32 v196, a16
    v_accvgpr_read_b32 v197, a17
    v_accvgpr_read_b32 v198, a18
    v_accvgpr_read_b32 v199, a19
    v_pk_mul_f32 v[192:193], v[192:193], v[228:229]
    v_pk_mul_f32 v[194:195], v[194:195], v[228:229]
    v_pk_mul_f32 v[196:197], v[196:197], v[228:229]
    v_pk_mul_f32 v[198:199], v[198:199], v[228:229]
    v_cvt_pk_bf16_f32 v128, v192, v193
    v_cvt_pk_bf16_f32 v129, v194, v195
    v_cvt_pk_bf16_f32 v130, v196, v197
    v_cvt_pk_bf16_f32 v131, v198, v199
    v_accvgpr_read_b32 v200, a32
    v_accvgpr_read_b32 v201, a33
    v_accvgpr_read_b32 v202, a34
    v_accvgpr_read_b32 v203, a35
    v_accvgpr_read_b32 v204, a48
    v_accvgpr_read_b32 v205, a49
    v_accvgpr_read_b32 v206, a50
    v_accvgpr_read_b32 v207, a51
    v_pk_mul_f32 v[200:201], v[200:201], v[228:229]
    v_pk_mul_f32 v[202:203], v[202:203], v[228:229]
    v_pk_mul_f32 v[204:205], v[204:205], v[228:229]
    v_pk_mul_f32 v[206:207], v[206:207], v[228:229]
    v_cvt_pk_bf16_f32 v132, v200, v201
    v_cvt_pk_bf16_f32 v133, v202, v203
    v_cvt_pk_bf16_f32 v134, v204, v205
    v_cvt_pk_bf16_f32 v135, v206, v207
    v_accvgpr_read_b32 v208, a64
    v_accvgpr_read_b32 v209, a65
    v_accvgpr_read_b32 v210, a66
    v_accvgpr_read_b32 v211, a67
    v_accvgpr_read_b32 v212, a80
    v_accvgpr_read_b32 v213, a81
    v_accvgpr_read_b32 v214, a82
    v_accvgpr_read_b32 v215, a83
    v_pk_mul_f32 v[208:209], v[208:209], v[228:229]
    v_pk_mul_f32 v[210:211], v[210:211], v[228:229]
    v_pk_mul_f32 v[212:213], v[212:213], v[228:229]
    v_pk_mul_f32 v[214:215], v[214:215], v[228:229]
    v_cvt_pk_bf16_f32 v136, v208, v209
    v_cvt_pk_bf16_f32 v137, v210, v211
    v_cvt_pk_bf16_f32 v138, v212, v213
    v_cvt_pk_bf16_f32 v139, v214, v215
    v_accvgpr_read_b32 v216, a96
    v_accvgpr_read_b32 v217, a97
    v_accvgpr_read_b32 v218, a98
    v_accvgpr_read_b32 v219, a99
    v_accvgpr_read_b32 v220, a112
    v_accvgpr_read_b32 v221, a113
    v_accvgpr_read_b32 v222, a114
    v_accvgpr_read_b32 v223, a115
    v_pk_mul_f32 v[216:217], v[216:217], v[228:229]
    v_pk_mul_f32 v[218:219], v[218:219], v[228:229]
    v_pk_mul_f32 v[220:221], v[220:221], v[228:229]
    v_pk_mul_f32 v[222:223], v[222:223], v[228:229]
    v_cvt_pk_bf16_f32 v140, v216, v217
    v_cvt_pk_bf16_f32 v141, v218, v219
    v_cvt_pk_bf16_f32 v142, v220, v221
    v_cvt_pk_bf16_f32 v143, v222, v223
    v_accvgpr_read_b32 v192, a4
    v_accvgpr_read_b32 v193, a5
    v_accvgpr_read_b32 v194, a6
    v_accvgpr_read_b32 v195, a7
    v_accvgpr_read_b32 v196, a20
    v_accvgpr_read_b32 v197, a21
    v_accvgpr_read_b32 v198, a22
    v_accvgpr_read_b32 v199, a23
    v_pk_mul_f32 v[192:193], v[192:193], v[230:231]
    v_pk_mul_f32 v[194:195], v[194:195], v[230:231]
    v_pk_mul_f32 v[196:197], v[196:197], v[230:231]
    v_pk_mul_f32 v[198:199], v[198:199], v[230:231]
    v_cvt_pk_bf16_f32 v144, v192, v193
    v_cvt_pk_bf16_f32 v145, v194, v195
    v_cvt_pk_bf16_f32 v146, v196, v197
    v_cvt_pk_bf16_f32 v147, v198, v199
    v_accvgpr_read_b32 v200, a36
    v_accvgpr_read_b32 v201, a37
    v_accvgpr_read_b32 v202, a38
    v_accvgpr_read_b32 v203, a39
    v_accvgpr_read_b32 v204, a52
    v_accvgpr_read_b32 v205, a53
    v_accvgpr_read_b32 v206, a54
    v_accvgpr_read_b32 v207, a55
    v_pk_mul_f32 v[200:201], v[200:201], v[230:231]
    v_pk_mul_f32 v[202:203], v[202:203], v[230:231]
    v_pk_mul_f32 v[204:205], v[204:205], v[230:231]
    v_pk_mul_f32 v[206:207], v[206:207], v[230:231]
    v_cvt_pk_bf16_f32 v148, v200, v201
    v_cvt_pk_bf16_f32 v149, v202, v203
    v_cvt_pk_bf16_f32 v150, v204, v205
    v_cvt_pk_bf16_f32 v151, v206, v207
    v_accvgpr_read_b32 v208, a68
    v_accvgpr_read_b32 v209, a69
    v_accvgpr_read_b32 v210, a70
    v_accvgpr_read_b32 v211, a71
    v_accvgpr_read_b32 v212, a84
    v_accvgpr_read_b32 v213, a85
    v_accvgpr_read_b32 v214, a86
    v_accvgpr_read_b32 v215, a87
    v_pk_mul_f32 v[208:209], v[208:209], v[230:231]
    v_pk_mul_f32 v[210:211], v[210:211], v[230:231]
    v_pk_mul_f32 v[212:213], v[212:213], v[230:231]
    v_pk_mul_f32 v[214:215], v[214:215], v[230:231]
    v_cvt_pk_bf16_f32 v152, v208, v209
    v_cvt_pk_bf16_f32 v153, v210, v211
    v_cvt_pk_bf16_f32 v154, v212, v213
    v_cvt_pk_bf16_f32 v155, v214, v215
    v_accvgpr_read_b32 v216, a100
    v_accvgpr_read_b32 v217, a101
    v_accvgpr_read_b32 v218, a102
    v_accvgpr_read_b32 v219, a103
    v_accvgpr_read_b32 v220, a116
    v_accvgpr_read_b32 v221, a117
    v_accvgpr_read_b32 v222, a118
    v_accvgpr_read_b32 v223, a119
    v_pk_mul_f32 v[216:217], v[216:217], v[230:231]
    v_pk_mul_f32 v[218:219], v[218:219], v[230:231]
    v_pk_mul_f32 v[220:221], v[220:221], v[230:231]
    v_pk_mul_f32 v[222:223], v[222:223], v[230:231]
    v_cvt_pk_bf16_f32 v156, v216, v217
    v_cvt_pk_bf16_f32 v157, v218, v219
    v_cvt_pk_bf16_f32 v158, v220, v221
    v_cvt_pk_bf16_f32 v159, v222, v223
    s_waitcnt vmcnt(40)
    v_accvgpr_read_b32 v192, a8
    v_accvgpr_read_b32 v193, a9
    v_accvgpr_read_b32 v194, a10
    v_accvgpr_read_b32 v195, a11
    v_accvgpr_read_b32 v196, a24
    v_accvgpr_read_b32 v197, a25
    v_accvgpr_read_b32 v198, a26
    v_accvgpr_read_b32 v199, a27
    v_pk_mul_f32 v[192:193], v[192:193], v[232:233]
    v_pk_mul_f32 v[194:195], v[194:195], v[232:233]
    v_pk_mul_f32 v[196:197], v[196:197], v[232:233]
    v_pk_mul_f32 v[198:199], v[198:199], v[232:233]
    v_cvt_pk_bf16_f32 v160, v192, v193
    v_cvt_pk_bf16_f32 v161, v194, v195
    v_cvt_pk_bf16_f32 v162, v196, v197
    v_cvt_pk_bf16_f32 v163, v198, v199
    v_accvgpr_read_b32 v200, a40
    v_accvgpr_read_b32 v201, a41
    v_accvgpr_read_b32 v202, a42
    v_accvgpr_read_b32 v203, a43
    v_accvgpr_read_b32 v204, a56
    v_accvgpr_read_b32 v205, a57
    v_accvgpr_read_b32 v206, a58
    v_accvgpr_read_b32 v207, a59
    v_pk_mul_f32 v[200:201], v[200:201], v[232:233]
    v_pk_mul_f32 v[202:203], v[202:203], v[232:233]
    v_pk_mul_f32 v[204:205], v[204:205], v[232:233]
    v_pk_mul_f32 v[206:207], v[206:207], v[232:233]
    v_cvt_pk_bf16_f32 v164, v200, v201
    v_cvt_pk_bf16_f32 v165, v202, v203
    v_cvt_pk_bf16_f32 v166, v204, v205
    v_cvt_pk_bf16_f32 v167, v206, v207
    v_accvgpr_read_b32 v208, a72
    v_accvgpr_read_b32 v209, a73
    v_accvgpr_read_b32 v210, a74
    v_accvgpr_read_b32 v211, a75
    v_accvgpr_read_b32 v212, a88
    v_accvgpr_read_b32 v213, a89
    v_accvgpr_read_b32 v214, a90
    v_accvgpr_read_b32 v215, a91
    v_pk_mul_f32 v[208:209], v[208:209], v[232:233]
    v_pk_mul_f32 v[210:211], v[210:211], v[232:233]
    v_pk_mul_f32 v[212:213], v[212:213], v[232:233]
    v_pk_mul_f32 v[214:215], v[214:215], v[232:233]
    v_cvt_pk_bf16_f32 v168, v208, v209
    v_cvt_pk_bf16_f32 v169, v210, v211
    v_cvt_pk_bf16_f32 v170, v212, v213
    v_cvt_pk_bf16_f32 v171, v214, v215
    v_accvgpr_read_b32 v216, a104
    v_accvgpr_read_b32 v217, a105
    v_accvgpr_read_b32 v218, a106
    v_accvgpr_read_b32 v219, a107
    v_accvgpr_read_b32 v220, a120
    v_accvgpr_read_b32 v221, a121
    v_accvgpr_read_b32 v222, a122
    v_accvgpr_read_b32 v223, a123
    v_pk_mul_f32 v[216:217], v[216:217], v[232:233]
    v_pk_mul_f32 v[218:219], v[218:219], v[232:233]
    v_pk_mul_f32 v[220:221], v[220:221], v[232:233]
    v_pk_mul_f32 v[222:223], v[222:223], v[232:233]
    v_cvt_pk_bf16_f32 v172, v216, v217
    v_cvt_pk_bf16_f32 v173, v218, v219
    v_cvt_pk_bf16_f32 v174, v220, v221
    v_cvt_pk_bf16_f32 v175, v222, v223
    v_accvgpr_read_b32 v192, a12
    v_accvgpr_read_b32 v193, a13
    v_accvgpr_read_b32 v194, a14
    v_accvgpr_read_b32 v195, a15
    v_accvgpr_read_b32 v196, a28
    v_accvgpr_read_b32 v197, a29
    v_accvgpr_read_b32 v198, a30
    v_accvgpr_read_b32 v199, a31
    v_pk_mul_f32 v[192:193], v[192:193], v[234:235]
    v_pk_mul_f32 v[194:195], v[194:195], v[234:235]
    v_pk_mul_f32 v[196:197], v[196:197], v[234:235]
    v_pk_mul_f32 v[198:199], v[198:199], v[234:235]
    v_cvt_pk_bf16_f32 v176, v192, v193
    v_cvt_pk_bf16_f32 v177, v194, v195
    v_cvt_pk_bf16_f32 v178, v196, v197
    v_cvt_pk_bf16_f32 v179, v198, v199
    v_accvgpr_read_b32 v200, a44
    v_accvgpr_read_b32 v201, a45
    v_accvgpr_read_b32 v202, a46
    v_accvgpr_read_b32 v203, a47
    v_accvgpr_read_b32 v204, a60
    v_accvgpr_read_b32 v205, a61
    v_accvgpr_read_b32 v206, a62
    v_accvgpr_read_b32 v207, a63
    v_pk_mul_f32 v[200:201], v[200:201], v[234:235]
    v_pk_mul_f32 v[202:203], v[202:203], v[234:235]
    v_pk_mul_f32 v[204:205], v[204:205], v[234:235]
    v_pk_mul_f32 v[206:207], v[206:207], v[234:235]
    v_cvt_pk_bf16_f32 v180, v200, v201
    v_cvt_pk_bf16_f32 v181, v202, v203
    v_cvt_pk_bf16_f32 v182, v204, v205
    v_cvt_pk_bf16_f32 v183, v206, v207
    v_accvgpr_read_b32 v208, a76
    v_accvgpr_read_b32 v209, a77
    v_accvgpr_read_b32 v210, a78
    v_accvgpr_read_b32 v211, a79
    v_accvgpr_read_b32 v212, a92
    v_accvgpr_read_b32 v213, a93
    v_accvgpr_read_b32 v214, a94
    v_accvgpr_read_b32 v215, a95
    v_pk_mul_f32 v[208:209], v[208:209], v[234:235]
    v_pk_mul_f32 v[210:211], v[210:211], v[234:235]
    v_pk_mul_f32 v[212:213], v[212:213], v[234:235]
    v_pk_mul_f32 v[214:215], v[214:215], v[234:235]
    v_cvt_pk_bf16_f32 v184, v208, v209
    v_cvt_pk_bf16_f32 v185, v210, v211
    v_cvt_pk_bf16_f32 v186, v212, v213
    v_cvt_pk_bf16_f32 v187, v214, v215
    v_accvgpr_read_b32 v216, a108
    v_accvgpr_read_b32 v217, a109
    v_accvgpr_read_b32 v218, a110
    v_accvgpr_read_b32 v219, a111
    v_accvgpr_read_b32 v220, a124
    v_accvgpr_read_b32 v221, a125
    v_accvgpr_read_b32 v222, a126
    v_accvgpr_read_b32 v223, a127
    v_pk_mul_f32 v[216:217], v[216:217], v[234:235]
    v_pk_mul_f32 v[218:219], v[218:219], v[234:235]
    v_pk_mul_f32 v[220:221], v[220:221], v[234:235]
    v_pk_mul_f32 v[222:223], v[222:223], v[234:235]
    v_cvt_pk_bf16_f32 v188, v216, v217
    v_cvt_pk_bf16_f32 v189, v218, v219
    v_cvt_pk_bf16_f32 v190, v220, v221
    v_cvt_pk_bf16_f32 v191, v222, v223
    s_lshl2_add_u32 s58, s99, s56
    s_lshl_b32 s58, s58, 15
    s_lshr_b32 s59, s3, 2
    s_lshl_b32 s59, s59, 8
    s_add_u32 s58, s58, s59
    v_and_b32 v224, 15, v242
    v_lshlrev_b32 v224, 11, v224
    v_add_u32 v224, s58, v224
    v_lshl_add_u32 v52, v252, 3, v224
    v_lshl_add_u32 v53, v252, 4, v224
    s_add_u32 s58, s56, 1
    s_and_b32 s58, s58, 3
    s_sub_i32 s58, s58, s56
    s_mul_i32 s58, s58, 98304
    s_add_u32 s58, s58, 16384
    v_add_u32 v54, s58, v255
    s_add_u32 s58, s56, 2
    s_and_b32 s58, s58, 3
    s_sub_i32 s58, s58, s56
    s_mul_i32 s58, s58, 98304
    s_add_u32 s58, s58, 8192
    v_add_u32 v55, s58, v255
    s_add_u32 s58, s56, 3
    s_and_b32 s58, s58, 3
    s_sub_i32 s58, s58, s56
    s_mul_i32 s58, s58, 98304
    s_add_u32 s58, s58, 0
    v_add_u32 v56, s58, v255
    s_mov_b32 s20, s100
    s_mov_b32 s21, s101
    s_mov_b32 s22, 4194304
    s_mov_b32 s23, 0x20000
    s_waitcnt vmcnt(24)
    s_waitcnt lgkmcnt(2)
    v_mfma_f32_16x16x32_bf16 a[0:3], v[64:67], a[128:131], 0
    ds_read_b64_tr_b16 v[96:97], v239 offset:64
    v_mfma_f32_16x16x32_bf16 a[0:3], v[68:71], a[132:135], a[0:3]
    buffer_store_dwordx4 v[128:131], v253, s[28:31], 0 offen offset:0 sc1
    v_mfma_f32_16x16x32_bf16 a[0:3], v[72:75], a[136:139], a[0:3]
    ds_read_b64_tr_b16 v[98:99], v239 offset:320
    ds_read_b64_tr_b16 v[100:101], v239 offset:576
    v_mfma_f32_16x16x32_bf16 a[0:3], v[76:79], a[140:143], a[0:3]
    ds_read_b64_tr_b16 v[102:103], v239 offset:832
    v_mfma_f32_16x16x32_bf16 a[4:7], v[64:67], a[144:147], 0
    ds_read_b64_tr_b16 v[104:105], v239 offset:16960
    v_mfma_f32_16x16x32_bf16 a[4:7], v[68:71], a[148:151], a[4:7]
    ds_read_b64_tr_b16 v[106:107], v239 offset:17216
    v_mfma_f32_16x16x32_bf16 a[4:7], v[72:75], a[152:155], a[4:7]
    ds_read_b64_tr_b16 v[108:109], v239 offset:17472
    v_mfma_f32_16x16x32_bf16 a[4:7], v[76:79], a[156:159], a[4:7]
    ds_read_b64_tr_b16 v[110:111], v239 offset:17728
    v_mfma_f32_16x16x32_bf16 a[8:11], v[64:67], a[160:163], 0
    buffer_store_dwordx4 v[132:135], v253, s[28:31], 0 offen offset:1024 sc1
    v_mfma_f32_16x16x32_bf16 a[8:11], v[68:71], a[164:167], a[8:11]
    v_mfma_f32_16x16x32_bf16 a[8:11], v[72:75], a[168:171], a[8:11]
    v_mfma_f32_16x16x32_bf16 a[8:11], v[76:79], a[172:175], a[8:11]
    v_mfma_f32_16x16x32_bf16 a[12:15], v[64:67], a[176:179], 0
    v_mfma_f32_16x16x32_bf16 a[12:15], v[68:71], a[180:183], a[12:15]
    v_mfma_f32_16x16x32_bf16 a[12:15], v[72:75], a[184:187], a[12:15]
    v_mfma_f32_16x16x32_bf16 a[12:15], v[76:79], a[188:191], a[12:15]
    buffer_store_dwordx4 v[136:139], v253, s[28:31], 0 offen offset:2048 sc1
    v_mfma_f32_16x16x32_bf16 a[16:19], v[80:83], a[128:131], 0
    ds_read_b64_tr_b16 v[112:113], v239 offset:96
    v_mfma_f32_16x16x32_bf16 a[16:19], v[84:87], a[132:135], a[16:19]
    ds_read_b64_tr_b16 v[114:115], v239 offset:352
    v_mfma_f32_16x16x32_bf16 a[16:19], v[88:91], a[136:139], a[16:19]
    ds_read_b64_tr_b16 v[116:117], v239 offset:608
    s_waitcnt lgkmcnt(3)
    v_mfma_f32_16x16x32_bf16 a[16:19], v[92:95], a[140:143], a[16:19]
    ds_read_b64_tr_b16 v[118:119], v239 offset:864
    v_mfma_f32_16x16x32_bf16 a[20:23], v[80:83], a[144:147], 0
    ds_read_b64_tr_b16 v[120:121], v239 offset:16992
    v_mfma_f32_16x16x32_bf16 a[20:23], v[84:87], a[148:151], a[20:23]
    ds_read_b64_tr_b16 v[122:123], v239 offset:17248
    v_mfma_f32_16x16x32_bf16 a[20:23], v[88:91], a[152:155], a[20:23]
    ds_read_b64_tr_b16 v[124:125], v239 offset:17504
    v_mfma_f32_16x16x32_bf16 a[20:23], v[92:95], a[156:159], a[20:23]
    ds_read_b64_tr_b16 v[126:127], v239 offset:17760
    v_mfma_f32_16x16x32_bf16 a[24:27], v[80:83], a[160:163], 0
    buffer_store_dwordx4 v[140:143], v253, s[28:31], 0 offen offset:3072 sc1
    v_mfma_f32_16x16x32_bf16 a[24:27], v[84:87], a[164:167], a[24:27]
    v_mfma_f32_16x16x32_bf16 a[24:27], v[88:91], a[168:171], a[24:27]
    v_mfma_f32_16x16x32_bf16 a[24:27], v[92:95], a[172:175], a[24:27]
    v_mfma_f32_16x16x32_bf16 a[28:31], v[80:83], a[176:179], 0
    v_mfma_f32_16x16x32_bf16 a[28:31], v[84:87], a[180:183], a[28:31]
    v_mfma_f32_16x16x32_bf16 a[28:31], v[88:91], a[184:187], a[28:31]
    buffer_store_dwordx4 v[144:147], v253, s[28:31], s62 offen offset:0 sc1
    v_mfma_f32_16x16x32_bf16 a[28:31], v[92:95], a[188:191], a[28:31]
    v_mfma_f32_16x16x32_bf16 a[32:35], v[96:99], a[128:131], 0
    ds_read_b64_tr_b16 v[64:65], v239 offset:128
    v_mfma_f32_16x16x32_bf16 a[32:35], v[100:103], a[132:135], a[32:35]
    ds_read_b64_tr_b16 v[66:67], v239 offset:384
    v_mfma_f32_16x16x32_bf16 a[32:35], v[104:107], a[136:139], a[32:35]
    ds_read_b64_tr_b16 v[68:69], v239 offset:640
    v_mfma_f32_16x16x32_bf16 a[32:35], v[108:111], a[140:143], a[32:35]
    ds_read_b64_tr_b16 v[70:71], v239 offset:896
    v_mfma_f32_16x16x32_bf16 a[36:39], v[96:99], a[144:147], 0
    ds_read_b64_tr_b16 v[72:73], v239 offset:17024
    v_mfma_f32_16x16x32_bf16 a[36:39], v[100:103], a[148:151], a[36:39]
    ds_read_b64_tr_b16 v[74:75], v239 offset:17280
    v_mfma_f32_16x16x32_bf16 a[36:39], v[104:107], a[152:155], a[36:39]
    ds_read_b64_tr_b16 v[76:77], v239 offset:17536
    v_mfma_f32_16x16x32_bf16 a[36:39], v[108:111], a[156:159], a[36:39]
    buffer_store_dwordx4 v[148:151], v253, s[28:31], s62 offen offset:1024 sc1
    v_mfma_f32_16x16x32_bf16 a[40:43], v[96:99], a[160:163], 0
    ds_read_b64_tr_b16 v[78:79], v239 offset:17792
    v_mfma_f32_16x16x32_bf16 a[40:43], v[100:103], a[164:167], a[40:43]
    v_mfma_f32_16x16x32_bf16 a[40:43], v[104:107], a[168:171], a[40:43]
    v_mfma_f32_16x16x32_bf16 a[40:43], v[108:111], a[172:175], a[40:43]
    v_mfma_f32_16x16x32_bf16 a[44:47], v[96:99], a[176:179], 0
    v_mfma_f32_16x16x32_bf16 a[44:47], v[100:103], a[180:183], a[44:47]
    buffer_store_dwordx4 v[152:155], v253, s[28:31], s62 offen offset:2048 sc1
    v_mfma_f32_16x16x32_bf16 a[44:47], v[104:107], a[184:187], a[44:47]
    v_mfma_f32_16x16x32_bf16 a[44:47], v[108:111], a[188:191], a[44:47]
    s_waitcnt lgkmcnt(0)
    v_mfma_f32_16x16x32_bf16 a[48:51], v[112:115], a[128:131], 0
    ds_read_b64_tr_b16 v[80:81], v239 offset:160
    v_mfma_f32_16x16x32_bf16 a[48:51], v[116:119], a[132:135], a[48:51]
    ds_read_b64_tr_b16 v[82:83], v239 offset:416
    v_mfma_f32_16x16x32_bf16 a[48:51], v[120:123], a[136:139], a[48:51]
    ds_read_b64_tr_b16 v[84:85], v239 offset:672
    v_mfma_f32_16x16x32_bf16 a[48:51], v[124:127], a[140:143], a[48:51]
    ds_read_b64_tr_b16 v[86:87], v239 offset:928
    v_mfma_f32_16x16x32_bf16 a[52:55], v[112:115], a[144:147], 0
    ds_read_b64_tr_b16 v[88:89], v239 offset:17056
    v_mfma_f32_16x16x32_bf16 a[52:55], v[116:119], a[148:151], a[52:55]
    buffer_store_dwordx4 v[156:159], v253, s[28:31], s62 offen offset:3072 sc1
    v_mfma_f32_16x16x32_bf16 a[52:55], v[120:123], a[152:155], a[52:55]
    ds_read_b64_tr_b16 v[90:91], v239 offset:17312
    ds_read_b64_tr_b16 v[92:93], v239 offset:17568
    v_mfma_f32_16x16x32_bf16 a[52:55], v[124:127], a[156:159], a[52:55]
    ds_read_b64_tr_b16 v[94:95], v239 offset:17824
    v_mfma_f32_16x16x32_bf16 a[56:59], v[112:115], a[160:163], 0
    v_mfma_f32_16x16x32_bf16 a[56:59], v[116:119], a[164:167], a[56:59]
    v_mfma_f32_16x16x32_bf16 a[56:59], v[120:123], a[168:171], a[56:59]
    v_mfma_f32_16x16x32_bf16 a[56:59], v[124:127], a[172:175], a[56:59]
    s_add_u32 m0, s53, 33792
    v_mfma_f32_16x16x32_bf16 a[60:63], v[112:115], a[176:179], 0
    buffer_load_dwordx4 v248, s[44:47], s49 offen offset:0 lds
    v_mfma_f32_16x16x32_bf16 a[60:63], v[116:119], a[180:183], a[60:63]
    v_mfma_f32_16x16x32_bf16 a[60:63], v[120:123], a[184:187], a[60:63]
    v_mfma_f32_16x16x32_bf16 a[60:63], v[124:127], a[188:191], a[60:63]
    v_mfma_f32_16x16x32_bf16 a[64:67], v[64:67], a[128:131], 0
    ds_read_b64_tr_b16 v[96:97], v239 offset:192
    v_mfma_f32_16x16x32_bf16 a[64:67], v[68:71], a[132:135], a[64:67]
    ds_read_b64_tr_b16 v[98:99], v239 offset:448
    v_mfma_f32_16x16x32_bf16 a[64:67], v[72:75], a[136:139], a[64:67]
    ds_read_b64_tr_b16 v[100:101], v239 offset:704
    v_mfma_f32_16x16x32_bf16 a[64:67], v[76:79], a[140:143], a[64:67]
    buffer_load_dwordx4 v249, s[44:47], s49 offen offset:1056 lds
    v_mfma_f32_16x16x32_bf16 a[68:71], v[64:67], a[144:147], 0
    ds_read_b64_tr_b16 v[102:103], v239 offset:960
    ds_read_b64_tr_b16 v[104:105], v239 offset:17088
    v_mfma_f32_16x16x32_bf16 a[68:71], v[68:71], a[148:151], a[68:71]
    ds_read_b64_tr_b16 v[106:107], v239 offset:17344
    v_mfma_f32_16x16x32_bf16 a[68:71], v[72:75], a[152:155], a[68:71]
    ds_read_b64_tr_b16 v[108:109], v239 offset:17600
    v_mfma_f32_16x16x32_bf16 a[68:71], v[76:79], a[156:159], a[68:71]
    ds_read_b64_tr_b16 v[110:111], v239 offset:17856
    v_mfma_f32_16x16x32_bf16 a[72:75], v[64:67], a[160:163], 0
    v_mfma_f32_16x16x32_bf16 a[72:75], v[68:71], a[164:167], a[72:75]
    v_mfma_f32_16x16x32_bf16 a[72:75], v[72:75], a[168:171], a[72:75]
    v_mfma_f32_16x16x32_bf16 a[72:75], v[76:79], a[172:175], a[72:75]
    buffer_load_dwordx4 v250, s[44:47], s49 offen offset:2112 lds
    v_mfma_f32_16x16x32_bf16 a[76:79], v[64:67], a[176:179], 0
    v_mfma_f32_16x16x32_bf16 a[76:79], v[68:71], a[180:183], a[76:79]
    v_mfma_f32_16x16x32_bf16 a[76:79], v[72:75], a[184:187], a[76:79]
    v_mfma_f32_16x16x32_bf16 a[76:79], v[76:79], a[188:191], a[76:79]
    s_waitcnt lgkmcnt(0)
    v_mfma_f32_16x16x32_bf16 a[80:83], v[80:83], a[128:131], 0
    ds_read_b64_tr_b16 v[112:113], v239 offset:224
    v_mfma_f32_16x16x32_bf16 a[80:83], v[84:87], a[132:135], a[80:83]
    ds_read_b64_tr_b16 v[114:115], v239 offset:480
    v_mfma_f32_16x16x32_bf16 a[80:83], v[88:91], a[136:139], a[80:83]
    buffer_load_dwordx4 v251, s[44:47], s49 offen offset:3168 lds
    v_mfma_f32_16x16x32_bf16 a[80:83], v[92:95], a[140:143], a[80:83]
    ds_read_b64_tr_b16 v[116:117], v239 offset:736
    s_add_u32 s49, s49, 131072
    v_mfma_f32_16x16x32_bf16 a[84:87], v[80:83], a[144:147], 0
    ds_read_b64_tr_b16 v[118:119], v239 offset:992
    ds_read_b64_tr_b16 v[120:121], v239 offset:17120
    v_mfma_f32_16x16x32_bf16 a[84:87], v[84:87], a[148:151], a[84:87]
    ds_read_b64_tr_b16 v[122:123], v239 offset:17376
    v_mfma_f32_16x16x32_bf16 a[84:87], v[88:91], a[152:155], a[84:87]
    ds_read_b64_tr_b16 v[124:125], v239 offset:17632
    v_mfma_f32_16x16x32_bf16 a[84:87], v[92:95], a[156:159], a[84:87]
    ds_read_b64_tr_b16 v[126:127], v239 offset:17888
    v_mfma_f32_16x16x32_bf16 a[88:91], v[80:83], a[160:163], 0
    v_mfma_f32_16x16x32_bf16 a[88:91], v[84:87], a[164:167], a[88:91]
    s_add_u32 m0, s53, 50688
    v_mfma_f32_16x16x32_bf16 a[88:91], v[88:91], a[168:171], a[88:91]
    buffer_load_dwordx4 v248, s[44:47], s49 offen offset:0 lds
    v_mfma_f32_16x16x32_bf16 a[88:91], v[92:95], a[172:175], a[88:91]
    v_mfma_f32_16x16x32_bf16 a[92:95], v[80:83], a[176:179], 0
    v_mfma_f32_16x16x32_bf16 a[92:95], v[84:87], a[180:183], a[92:95]
    v_mfma_f32_16x16x32_bf16 a[92:95], v[88:91], a[184:187], a[92:95]
    v_mfma_f32_16x16x32_bf16 a[92:95], v[92:95], a[188:191], a[92:95]
    v_mfma_f32_16x16x32_bf16 a[96:99], v[96:99], a[128:131], 0
    v_mfma_f32_16x16x32_bf16 a[96:99], v[100:103], a[132:135], a[96:99]
    buffer_load_dwordx4 v249, s[44:47], s49 offen offset:1056 lds
    v_mfma_f32_16x16x32_bf16 a[96:99], v[104:107], a[136:139], a[96:99]
    v_mfma_f32_16x16x32_bf16 a[96:99], v[108:111], a[140:143], a[96:99]
    v_mfma_f32_16x16x32_bf16 a[100:103], v[96:99], a[144:147], 0
    s_waitcnt vmcnt(63) lgkmcnt(0)
    s_barrier
    v_mfma_f32_16x16x32_bf16 a[100:103], v[100:103], a[148:151], a[100:103]
    ds_read_b64_tr_b16 v[64:65], v239 offset:33792
    v_mfma_f32_16x16x32_bf16 a[100:103], v[104:107], a[152:155], a[100:103]
    ds_read_b64_tr_b16 v[66:67], v239 offset:34048
    v_mfma_f32_16x16x32_bf16 a[100:103], v[108:111], a[156:159], a[100:103]
    ds_read_b64_tr_b16 v[68:69], v239 offset:34304
    v_mfma_f32_16x16x32_bf16 a[104:107], v[96:99], a[160:163], 0
    ds_read_b64_tr_b16 v[70:71], v239 offset:34560
    v_mfma_f32_16x16x32_bf16 a[104:107], v[100:103], a[164:167], a[104:107]
    buffer_load_dwordx4 v250, s[44:47], s49 offen offset:2112 lds
    v_mfma_f32_16x16x32_bf16 a[104:107], v[104:107], a[168:171], a[104:107]
    ds_read_b64_tr_b16 v[72:73], v239 offset:50688
    ds_read_b64_tr_b16 v[74:75], v239 offset:50944
    v_mfma_f32_16x16x32_bf16 a[104:107], v[108:111], a[172:175], a[104:107]
    ds_read_b64_tr_b16 v[76:77], v239 offset:51200
    v_mfma_f32_16x16x32_bf16 a[108:111], v[96:99], a[176:179], 0
    ds_read_b64_tr_b16 v[78:79], v239 offset:51456
    v_mfma_f32_16x16x32_bf16 a[108:111], v[100:103], a[180:183], a[108:111]
    v_mfma_f32_16x16x32_bf16 a[108:111], v[104:107], a[184:187], a[108:111]
    v_mfma_f32_16x16x32_bf16 a[108:111], v[108:111], a[188:191], a[108:111]
    v_mfma_f32_16x16x32_bf16 a[112:115], v[112:115], a[128:131], 0
    buffer_load_dwordx4 v251, s[44:47], s49 offen offset:3168 lds
    v_mfma_f32_16x16x32_bf16 a[112:115], v[116:119], a[132:135], a[112:115]
    ds_read_b64_tr_b16 v[80:81], v239 offset:33824
    s_add_u32 s49, s49, 131072
    v_mfma_f32_16x16x32_bf16 a[112:115], v[120:123], a[136:139], a[112:115]
    ds_read_b64_tr_b16 v[82:83], v239 offset:34080
    v_mfma_f32_16x16x32_bf16 a[112:115], v[124:127], a[140:143], a[112:115]
    ds_read_b64_tr_b16 v[84:85], v239 offset:34336
    v_mfma_f32_16x16x32_bf16 a[116:119], v[112:115], a[144:147], 0
    ds_read_b64_tr_b16 v[86:87], v239 offset:34592
    v_mfma_f32_16x16x32_bf16 a[116:119], v[116:119], a[148:151], a[116:119]
    ds_read_b64_tr_b16 v[88:89], v239 offset:50720
    v_mfma_f32_16x16x32_bf16 a[116:119], v[120:123], a[152:155], a[116:119]
    ds_read_b64_tr_b16 v[90:91], v239 offset:50976
    v_mfma_f32_16x16x32_bf16 a[116:119], v[124:127], a[156:159], a[116:119]
    ds_read_b64_tr_b16 v[92:93], v239 offset:51232
    v_mfma_f32_16x16x32_bf16 a[120:123], v[112:115], a[160:163], 0
    ds_read_b64_tr_b16 v[94:95], v239 offset:51488
    v_mfma_f32_16x16x32_bf16 a[120:123], v[116:119], a[164:167], a[120:123]
    v_mfma_f32_16x16x32_bf16 a[120:123], v[120:123], a[168:171], a[120:123]
    v_mfma_f32_16x16x32_bf16 a[120:123], v[124:127], a[172:175], a[120:123]
    v_mfma_f32_16x16x32_bf16 a[124:127], v[112:115], a[176:179], 0
    v_mfma_f32_16x16x32_bf16 a[124:127], v[116:119], a[180:183], a[124:127]
    v_mfma_f32_16x16x32_bf16 a[124:127], v[120:123], a[184:187], a[124:127]
    v_mfma_f32_16x16x32_bf16 a[124:127], v[124:127], a[188:191], a[124:127]
    s_waitcnt vmcnt(16)
    s_waitcnt lgkmcnt(0)
    v_mfma_f32_16x16x32_bf16 a[0:3], v[64:67], a[192:195], a[0:3]
    ds_read_b64_tr_b16 v[96:97], v239 offset:33856
    v_mfma_f32_16x16x32_bf16 a[0:3], v[68:71], a[196:199], a[0:3]
    buffer_load_dwordx4 a[128:131], v48, s[24:27], s48 offen offset:0 sc1
    v_mfma_f32_16x16x32_bf16 a[0:3], v[72:75], a[200:203], a[0:3]
    ds_read_b64_tr_b16 v[98:99], v239 offset:34112
    ds_read_b64_tr_b16 v[100:101], v239 offset:34368
    v_mfma_f32_16x16x32_bf16 a[0:3], v[76:79], a[204:207], a[0:3]
    ds_read_b64_tr_b16 v[102:103], v239 offset:34624
    v_mfma_f32_16x16x32_bf16 a[4:7], v[64:67], a[208:211], a[4:7]
    ds_read_b64_tr_b16 v[104:105], v239 offset:50752
    v_mfma_f32_16x16x32_bf16 a[4:7], v[68:71], a[212:215], a[4:7]
    buffer_load_dwordx4 a[132:135], v48, s[24:27], s48 offen offset:1024 sc1
    v_mfma_f32_16x16x32_bf16 a[4:7], v[72:75], a[216:219], a[4:7]
    ds_read_b64_tr_b16 v[106:107], v239 offset:51008
    ds_read_b64_tr_b16 v[108:109], v239 offset:51264
    v_mfma_f32_16x16x32_bf16 a[4:7], v[76:79], a[220:223], a[4:7]
    ds_read_b64_tr_b16 v[110:111], v239 offset:51520
    v_mfma_f32_16x16x32_bf16 a[8:11], v[64:67], a[224:227], a[8:11]
    v_mfma_f32_16x16x32_bf16 a[8:11], v[68:71], a[228:231], a[8:11]
    buffer_load_dwordx4 a[136:139], v48, s[24:27], s48 offen offset:2048 sc1
    v_mfma_f32_16x16x32_bf16 a[8:11], v[72:75], a[232:235], a[8:11]
    v_mfma_f32_16x16x32_bf16 a[8:11], v[76:79], a[236:239], a[8:11]
    v_mfma_f32_16x16x32_bf16 a[12:15], v[64:67], a[240:243], a[12:15]
    v_mfma_f32_16x16x32_bf16 a[12:15], v[68:71], a[244:247], a[12:15]
    buffer_load_dwordx4 a[140:143], v48, s[24:27], s48 offen offset:3072 sc1
    v_mfma_f32_16x16x32_bf16 a[12:15], v[72:75], a[248:251], a[12:15]
    v_mfma_f32_16x16x32_bf16 a[12:15], v[76:79], a[252:255], a[12:15]
    v_mfma_f32_16x16x32_bf16 a[16:19], v[80:83], a[192:195], a[16:19]
    ds_read_b64_tr_b16 v[112:113], v239 offset:33888
    v_mfma_f32_16x16x32_bf16 a[16:19], v[84:87], a[196:199], a[16:19]
    ds_read_b64_tr_b16 v[114:115], v239 offset:34144
    v_mfma_f32_16x16x32_bf16 a[16:19], v[88:91], a[200:203], a[16:19]
    buffer_load_dwordx4 a[144:147], v49, s[24:27], s48 offen offset:0 sc1
    v_mfma_f32_16x16x32_bf16 a[16:19], v[92:95], a[204:207], a[16:19]
    ds_read_b64_tr_b16 v[116:117], v239 offset:34400
    ds_read_b64_tr_b16 v[118:119], v239 offset:34656
    v_mfma_f32_16x16x32_bf16 a[20:23], v[80:83], a[208:211], a[20:23]
    ds_read_b64_tr_b16 v[120:121], v239 offset:50784
    v_mfma_f32_16x16x32_bf16 a[20:23], v[84:87], a[212:215], a[20:23]
    ds_read_b64_tr_b16 v[122:123], v239 offset:51040
    v_mfma_f32_16x16x32_bf16 a[20:23], v[88:91], a[216:219], a[20:23]
    ds_read_b64_tr_b16 v[124:125], v239 offset:51296
    v_mfma_f32_16x16x32_bf16 a[20:23], v[92:95], a[220:223], a[20:23]
    buffer_load_dwordx4 a[148:151], v49, s[24:27], s48 offen offset:1024 sc1
    v_mfma_f32_16x16x32_bf16 a[24:27], v[80:83], a[224:227], a[24:27]
    ds_read_b64_tr_b16 v[126:127], v239 offset:51552
    v_mfma_f32_16x16x32_bf16 a[24:27], v[84:87], a[228:231], a[24:27]
    v_mfma_f32_16x16x32_bf16 a[24:27], v[88:91], a[232:235], a[24:27]
    buffer_load_dwordx4 a[152:155], v49, s[24:27], s48 offen offset:2048 sc1
    v_mfma_f32_16x16x32_bf16 a[24:27], v[92:95], a[236:239], a[24:27]
    v_mfma_f32_16x16x32_bf16 a[28:31], v[80:83], a[240:243], a[28:31]
    v_mfma_f32_16x16x32_bf16 a[28:31], v[84:87], a[244:247], a[28:31]
    v_mfma_f32_16x16x32_bf16 a[28:31], v[88:91], a[248:251], a[28:31]
    buffer_load_dwordx4 a[156:159], v49, s[24:27], s48 offen offset:3072 sc1
    v_mfma_f32_16x16x32_bf16 a[28:31], v[92:95], a[252:255], a[28:31]
    s_waitcnt lgkmcnt(0)
    v_mfma_f32_16x16x32_bf16 a[32:35], v[96:99], a[192:195], a[32:35]
    ds_read_b64_tr_b16 v[64:65], v239 offset:33920
    v_mfma_f32_16x16x32_bf16 a[32:35], v[100:103], a[196:199], a[32:35]
    ds_read_b64_tr_b16 v[66:67], v239 offset:34176
    v_mfma_f32_16x16x32_bf16 a[32:35], v[104:107], a[200:203], a[32:35]
    ds_read_b64_tr_b16 v[68:69], v239 offset:34432
    v_mfma_f32_16x16x32_bf16 a[32:35], v[108:111], a[204:207], a[32:35]
    buffer_load_dwordx4 a[160:163], v50, s[24:27], s48 offen offset:0 sc1
    v_mfma_f32_16x16x32_bf16 a[36:39], v[96:99], a[208:211], a[36:39]
    ds_read_b64_tr_b16 v[70:71], v239 offset:34688
    ds_read_b64_tr_b16 v[72:73], v239 offset:50816
    v_mfma_f32_16x16x32_bf16 a[36:39], v[100:103], a[212:215], a[36:39]
    ds_read_b64_tr_b16 v[74:75], v239 offset:51072
    v_mfma_f32_16x16x32_bf16 a[36:39], v[104:107], a[216:219], a[36:39]
    ds_read_b64_tr_b16 v[76:77], v239 offset:51328
    v_mfma_f32_16x16x32_bf16 a[36:39], v[108:111], a[220:223], a[36:39]
    ds_read_b64_tr_b16 v[78:79], v239 offset:51584
    v_mfma_f32_16x16x32_bf16 a[40:43], v[96:99], a[224:227], a[40:43]
    buffer_load_dwordx4 a[164:167], v50, s[24:27], s48 offen offset:1024 sc1
    v_mfma_f32_16x16x32_bf16 a[40:43], v[100:103], a[228:231], a[40:43]
    v_mfma_f32_16x16x32_bf16 a[40:43], v[104:107], a[232:235], a[40:43]
    v_mfma_f32_16x16x32_bf16 a[40:43], v[108:111], a[236:239], a[40:43]
    buffer_load_dwordx4 a[168:171], v50, s[24:27], s48 offen offset:2048 sc1
    v_mfma_f32_16x16x32_bf16 a[44:47], v[96:99], a[240:243], a[44:47]
    v_mfma_f32_16x16x32_bf16 a[44:47], v[100:103], a[244:247], a[44:47]
    v_mfma_f32_16x16x32_bf16 a[44:47], v[104:107], a[248:251], a[44:47]
    v_mfma_f32_16x16x32_bf16 a[44:47], v[108:111], a[252:255], a[44:47]
    buffer_load_dwordx4 a[172:175], v50, s[24:27], s48 offen offset:3072 sc1
    v_mfma_f32_16x16x32_bf16 a[48:51], v[112:115], a[192:195], a[48:51]
    ds_read_b64_tr_b16 v[80:81], v239 offset:33952
    v_mfma_f32_16x16x32_bf16 a[48:51], v[116:119], a[196:199], a[48:51]
    ds_read_b64_tr_b16 v[82:83], v239 offset:34208
    v_mfma_f32_16x16x32_bf16 a[48:51], v[120:123], a[200:203], a[48:51]
    ds_read_b64_tr_b16 v[84:85], v239 offset:34464
    v_mfma_f32_16x16x32_bf16 a[48:51], v[124:127], a[204:207], a[48:51]
    ds_read_b64_tr_b16 v[86:87], v239 offset:34720
    v_mfma_f32_16x16x32_bf16 a[52:55], v[112:115], a[208:211], a[52:55]
    buffer_load_dwordx4 a[176:179], v51, s[24:27], s48 offen offset:0 sc1
    v_mfma_f32_16x16x32_bf16 a[52:55], v[116:119], a[212:215], a[52:55]
    ds_read_b64_tr_b16 v[88:89], v239 offset:50848
    ds_read_b64_tr_b16 v[90:91], v239 offset:51104
    v_mfma_f32_16x16x32_bf16 a[52:55], v[120:123], a[216:219], a[52:55]
    ds_read_b64_tr_b16 v[92:93], v239 offset:51360
    v_mfma_f32_16x16x32_bf16 a[52:55], v[124:127], a[220:223], a[52:55]
    ds_read_b64_tr_b16 v[94:95], v239 offset:51616
    v_mfma_f32_16x16x32_bf16 a[56:59], v[112:115], a[224:227], a[56:59]
    buffer_load_dwordx4 a[180:183], v51, s[24:27], s48 offen offset:1024 sc1
    v_mfma_f32_16x16x32_bf16 a[56:59], v[116:119], a[228:231], a[56:59]
    v_mfma_f32_16x16x32_bf16 a[56:59], v[120:123], a[232:235], a[56:59]
    v_mfma_f32_16x16x32_bf16 a[56:59], v[124:127], a[236:239], a[56:59]
    v_mfma_f32_16x16x32_bf16 a[60:63], v[112:115], a[240:243], a[60:63]
    buffer_load_dwordx4 a[184:187], v51, s[24:27], s48 offen offset:2048 sc1
    v_mfma_f32_16x16x32_bf16 a[60:63], v[116:119], a[244:247], a[60:63]
    v_mfma_f32_16x16x32_bf16 a[60:63], v[120:123], a[248:251], a[60:63]
    v_mfma_f32_16x16x32_bf16 a[60:63], v[124:127], a[252:255], a[60:63]
    s_waitcnt lgkmcnt(0)
    v_mfma_f32_16x16x32_bf16 a[64:67], v[64:67], a[192:195], a[64:67]
    buffer_load_dwordx4 a[188:191], v51, s[24:27], s48 offen offset:3072 sc1
    v_mfma_f32_16x16x32_bf16 a[64:67], v[68:71], a[196:199], a[64:67]
    ds_read_b64_tr_b16 v[96:97], v239 offset:33984
    s_add_u32 s48, s48, 4096
    v_mfma_f32_16x16x32_bf16 a[64:67], v[72:75], a[200:203], a[64:67]
    ds_read_b64_tr_b16 v[98:99], v239 offset:34240
    ds_read_b64_tr_b16 v[100:101], v239 offset:34496
    v_mfma_f32_16x16x32_bf16 a[64:67], v[76:79], a[204:207], a[64:67]
    ds_read_b64_tr_b16 v[102:103], v239 offset:34752
    v_mfma_f32_16x16x32_bf16 a[68:71], v[64:67], a[208:211], a[68:71]
    ds_read_b64_tr_b16 v[104:105], v239 offset:50880
    v_mfma_f32_16x16x32_bf16 a[68:71], v[68:71], a[212:215], a[68:71]
    buffer_store_dwordx4 v[160:163], v253, s[28:31], s63 offen offset:0 sc1
    v_mfma_f32_16x16x32_bf16 a[68:71], v[72:75], a[216:219], a[68:71]
    ds_read_b64_tr_b16 v[106:107], v239 offset:51136
    ds_read_b64_tr_b16 v[108:109], v239 offset:51392
    v_mfma_f32_16x16x32_bf16 a[68:71], v[76:79], a[220:223], a[68:71]
    ds_read_b64_tr_b16 v[110:111], v239 offset:51648
    v_mfma_f32_16x16x32_bf16 a[72:75], v[64:67], a[224:227], a[72:75]
    v_mfma_f32_16x16x32_bf16 a[72:75], v[68:71], a[228:231], a[72:75]
    buffer_store_dwordx4 v[164:167], v253, s[28:31], s63 offen offset:1024 sc1
    v_mfma_f32_16x16x32_bf16 a[72:75], v[72:75], a[232:235], a[72:75]
    v_mfma_f32_16x16x32_bf16 a[72:75], v[76:79], a[236:239], a[72:75]
    v_mfma_f32_16x16x32_bf16 a[76:79], v[64:67], a[240:243], a[76:79]
    v_mfma_f32_16x16x32_bf16 a[76:79], v[68:71], a[244:247], a[76:79]
    buffer_store_dwordx4 v[168:171], v253, s[28:31], s63 offen offset:2048 sc1
    v_mfma_f32_16x16x32_bf16 a[76:79], v[72:75], a[248:251], a[76:79]
    v_mfma_f32_16x16x32_bf16 a[76:79], v[76:79], a[252:255], a[76:79]
    v_mfma_f32_16x16x32_bf16 a[80:83], v[80:83], a[192:195], a[80:83]
    ds_read_b64_tr_b16 v[112:113], v239 offset:34016
    v_mfma_f32_16x16x32_bf16 a[80:83], v[84:87], a[196:199], a[80:83]
    buffer_store_dwordx4 v[172:175], v253, s[28:31], s63 offen offset:3072 sc1
    v_mfma_f32_16x16x32_bf16 a[80:83], v[88:91], a[200:203], a[80:83]
    ds_read_b64_tr_b16 v[114:115], v239 offset:34272
    ds_read_b64_tr_b16 v[116:117], v239 offset:34528
    v_mfma_f32_16x16x32_bf16 a[80:83], v[92:95], a[204:207], a[80:83]
    ds_read_b64_tr_b16 v[118:119], v239 offset:34784
    v_mfma_f32_16x16x32_bf16 a[84:87], v[80:83], a[208:211], a[84:87]
    ds_read_b64_tr_b16 v[120:121], v239 offset:50912
    v_mfma_f32_16x16x32_bf16 a[84:87], v[84:87], a[212:215], a[84:87]
    ds_read_b64_tr_b16 v[122:123], v239 offset:51168
    s_add_u32 m0, s53, 67584
    v_mfma_f32_16x16x32_bf16 a[84:87], v[88:91], a[216:219], a[84:87]
    ds_read_b64_tr_b16 v[124:125], v239 offset:51424
    v_mfma_f32_16x16x32_bf16 a[84:87], v[92:95], a[220:223], a[84:87]
    buffer_load_dwordx4 v248, s[44:47], s49 offen offset:0 lds
    v_mfma_f32_16x16x32_bf16 a[88:91], v[80:83], a[224:227], a[88:91]
    ds_read_b64_tr_b16 v[126:127], v239 offset:51680
    v_mfma_f32_16x16x32_bf16 a[88:91], v[84:87], a[228:231], a[88:91]
    v_mfma_f32_16x16x32_bf16 a[88:91], v[88:91], a[232:235], a[88:91]
    buffer_load_dwordx4 v249, s[44:47], s49 offen offset:1056 lds
    v_mfma_f32_16x16x32_bf16 a[88:91], v[92:95], a[236:239], a[88:91]
    v_mfma_f32_16x16x32_bf16 a[92:95], v[80:83], a[240:243], a[92:95]
    v_mfma_f32_16x16x32_bf16 a[92:95], v[84:87], a[244:247], a[92:95]
    v_mfma_f32_16x16x32_bf16 a[92:95], v[88:91], a[248:251], a[92:95]
    buffer_load_dwordx4 v250, s[44:47], s49 offen offset:2112 lds
    v_mfma_f32_16x16x32_bf16 a[92:95], v[92:95], a[252:255], a[92:95]
    s_waitcnt lgkmcnt(0)
    v_mfma_f32_16x16x32_bf16 a[96:99], v[96:99], a[192:195], a[96:99]
    v_mfma_f32_16x16x32_bf16 a[96:99], v[100:103], a[196:199], a[96:99]
    v_mfma_f32_16x16x32_bf16 a[96:99], v[104:107], a[200:203], a[96:99]
    buffer_load_dwordx4 v251, s[44:47], s49 offen offset:3168 lds
    v_mfma_f32_16x16x32_bf16 a[96:99], v[108:111], a[204:207], a[96:99]
    s_add_u32 s49, s49, 131072
    v_mfma_f32_16x16x32_bf16 a[100:103], v[96:99], a[208:211], a[100:103]
    s_waitcnt vmcnt(56) lgkmcnt(0)
    s_barrier
    v_mfma_f32_16x16x32_bf16 a[100:103], v[100:103], a[212:215], a[100:103]
    ds_read_b64_tr_b16 v[64:65], v238 offset:0
    v_mfma_f32_16x16x32_bf16 a[100:103], v[104:107], a[216:219], a[100:103]
    ds_read_b64_tr_b16 v[66:67], v238 offset:256
    s_add_u32 m0, s53, 84480
    v_mfma_f32_16x16x32_bf16 a[100:103], v[108:111], a[220:223], a[100:103]
    buffer_load_dwordx4 v248, s[44:47], s49 offen offset:0 lds
    v_mfma_f32_16x16x32_bf16 a[104:107], v[96:99], a[224:227], a[104:107]
    ds_read_b64_tr_b16 v[68:69], v238 offset:512
    ds_read_b64_tr_b16 v[70:71], v238 offset:768
    v_mfma_f32_16x16x32_bf16 a[104:107], v[100:103], a[228:231], a[104:107]
    ds_read_b64_tr_b16 v[72:73], v238 offset:16896
    v_mfma_f32_16x16x32_bf16 a[104:107], v[104:107], a[232:235], a[104:107]
    ds_read_b64_tr_b16 v[74:75], v238 offset:17152
    v_mfma_f32_16x16x32_bf16 a[104:107], v[108:111], a[236:239], a[104:107]
    ds_read_b64_tr_b16 v[76:77], v238 offset:17408
    v_mfma_f32_16x16x32_bf16 a[108:111], v[96:99], a[240:243], a[108:111]
    ds_read_b64_tr_b16 v[78:79], v238 offset:17664
    v_mfma_f32_16x16x32_bf16 a[108:111], v[100:103], a[244:247], a[108:111]
    buffer_load_dwordx4 v249, s[44:47], s49 offen offset:1056 lds
    v_mfma_f32_16x16x32_bf16 a[108:111], v[104:107], a[248:251], a[108:111]
    v_mfma_f32_16x16x32_bf16 a[108:111], v[108:111], a[252:255], a[108:111]
    buffer_load_dwordx4 v250, s[44:47], s49 offen offset:2112 lds
    v_mfma_f32_16x16x32_bf16 a[112:115], v[112:115], a[192:195], a[112:115]
    v_mfma_f32_16x16x32_bf16 a[112:115], v[116:119], a[196:199], a[112:115]
    ds_read_b64_tr_b16 v[80:81], v238 offset:32
    v_mfma_f32_16x16x32_bf16 a[112:115], v[120:123], a[200:203], a[112:115]
    ds_read_b64_tr_b16 v[82:83], v238 offset:288
    v_mfma_f32_16x16x32_bf16 a[112:115], v[124:127], a[204:207], a[112:115]
    buffer_load_dwordx4 v251, s[44:47], s49 offen offset:3168 lds
    v_mfma_f32_16x16x32_bf16 a[116:119], v[112:115], a[208:211], a[116:119]
    ds_read_b64_tr_b16 v[84:85], v238 offset:544
    s_add_u32 s49, s49, 131072
    v_mfma_f32_16x16x32_bf16 a[116:119], v[116:119], a[212:215], a[116:119]
    ds_read_b64_tr_b16 v[86:87], v238 offset:800
    ds_read_b64_tr_b16 v[88:89], v238 offset:16928
    v_mfma_f32_16x16x32_bf16 a[116:119], v[120:123], a[216:219], a[116:119]
    ds_read_b64_tr_b16 v[90:91], v238 offset:17184
    v_mfma_f32_16x16x32_bf16 a[116:119], v[124:127], a[220:223], a[116:119]
    ds_read_b64_tr_b16 v[92:93], v238 offset:17440
    v_mfma_f32_16x16x32_bf16 a[120:123], v[112:115], a[224:227], a[120:123]
    ds_read_b64_tr_b16 v[94:95], v238 offset:17696
    v_mfma_f32_16x16x32_bf16 a[120:123], v[116:119], a[228:231], a[120:123]
    v_mfma_f32_16x16x32_bf16 a[120:123], v[120:123], a[232:235], a[120:123]
    v_mfma_f32_16x16x32_bf16 a[120:123], v[124:127], a[236:239], a[120:123]
    v_mfma_f32_16x16x32_bf16 a[124:127], v[112:115], a[240:243], a[124:127]
    v_mfma_f32_16x16x32_bf16 a[124:127], v[116:119], a[244:247], a[124:127]
    v_mfma_f32_16x16x32_bf16 a[124:127], v[120:123], a[248:251], a[124:127]
    v_mfma_f32_16x16x32_bf16 a[124:127], v[124:127], a[252:255], a[124:127]
    s_waitcnt vmcnt(12)
    s_waitcnt lgkmcnt(0)
    v_mfma_f32_16x16x32_bf16 a[0:3], v[64:67], a[128:131], a[0:3]
    ds_read_b64_tr_b16 v[96:97], v238 offset:64
    v_mfma_f32_16x16x32_bf16 a[0:3], v[68:71], a[132:135], a[0:3]
    buffer_load_dwordx4 a[192:195], v48, s[24:27], s48 offen offset:0 sc1
    v_mfma_f32_16x16x32_bf16 a[0:3], v[72:75], a[136:139], a[0:3]
    ds_read_b64_tr_b16 v[98:99], v238 offset:320
    ds_read_b64_tr_b16 v[100:101], v238 offset:576
    v_mfma_f32_16x16x32_bf16 a[0:3], v[76:79], a[140:143], a[0:3]
    ds_read_b64_tr_b16 v[102:103], v238 offset:832
    v_mfma_f32_16x16x32_bf16 a[4:7], v[64:67], a[144:147], a[4:7]
    ds_read_b64_tr_b16 v[104:105], v238 offset:16960
    v_mfma_f32_16x16x32_bf16 a[4:7], v[68:71], a[148:151], a[4:7]
    buffer_load_dwordx4 a[196:199], v48, s[24:27], s48 offen offset:1024 sc1
    v_mfma_f32_16x16x32_bf16 a[4:7], v[72:75], a[152:155], a[4:7]
    ds_read_b64_tr_b16 v[106:107], v238 offset:17216
    ds_read_b64_tr_b16 v[108:109], v238 offset:17472
    v_mfma_f32_16x16x32_bf16 a[4:7], v[76:79], a[156:159], a[4:7]
    ds_read_b64_tr_b16 v[110:111], v238 offset:17728
    v_mfma_f32_16x16x32_bf16 a[8:11], v[64:67], a[160:163], a[8:11]
    v_mfma_f32_16x16x32_bf16 a[8:11], v[68:71], a[164:167], a[8:11]
    buffer_load_dwordx4 a[200:203], v48, s[24:27], s48 offen offset:2048 sc1
    v_mfma_f32_16x16x32_bf16 a[8:11], v[72:75], a[168:171], a[8:11]
    v_mfma_f32_16x16x32_bf16 a[8:11], v[76:79], a[172:175], a[8:11]
    v_mfma_f32_16x16x32_bf16 a[12:15], v[64:67], a[176:179], a[12:15]
    v_mfma_f32_16x16x32_bf16 a[12:15], v[68:71], a[180:183], a[12:15]
    buffer_load_dwordx4 a[204:207], v48, s[24:27], s48 offen offset:3072 sc1
    v_mfma_f32_16x16x32_bf16 a[12:15], v[72:75], a[184:187], a[12:15]
    v_mfma_f32_16x16x32_bf16 a[12:15], v[76:79], a[188:191], a[12:15]
    v_mfma_f32_16x16x32_bf16 a[16:19], v[80:83], a[128:131], a[16:19]
    ds_read_b64_tr_b16 v[112:113], v238 offset:96
    v_mfma_f32_16x16x32_bf16 a[16:19], v[84:87], a[132:135], a[16:19]
    ds_read_b64_tr_b16 v[114:115], v238 offset:352
    v_mfma_f32_16x16x32_bf16 a[16:19], v[88:91], a[136:139], a[16:19]
    buffer_load_dwordx4 a[208:211], v49, s[24:27], s48 offen offset:0 sc1
    v_mfma_f32_16x16x32_bf16 a[16:19], v[92:95], a[140:143], a[16:19]
    ds_read_b64_tr_b16 v[116:117], v238 offset:608
    ds_read_b64_tr_b16 v[118:119], v238 offset:864
    v_mfma_f32_16x16x32_bf16 a[20:23], v[80:83], a[144:147], a[20:23]
    ds_read_b64_tr_b16 v[120:121], v238 offset:16992
    v_mfma_f32_16x16x32_bf16 a[20:23], v[84:87], a[148:151], a[20:23]
    ds_read_b64_tr_b16 v[122:123], v238 offset:17248
    v_mfma_f32_16x16x32_bf16 a[20:23], v[88:91], a[152:155], a[20:23]
    ds_read_b64_tr_b16 v[124:125], v238 offset:17504
    v_mfma_f32_16x16x32_bf16 a[20:23], v[92:95], a[156:159], a[20:23]
    buffer_load_dwordx4 a[212:215], v49, s[24:27], s48 offen offset:1024 sc1
    v_mfma_f32_16x16x32_bf16 a[24:27], v[80:83], a[160:163], a[24:27]
    ds_read_b64_tr_b16 v[126:127], v238 offset:17760
    v_mfma_f32_16x16x32_bf16 a[24:27], v[84:87], a[164:167], a[24:27]
    v_mfma_f32_16x16x32_bf16 a[24:27], v[88:91], a[168:171], a[24:27]
    buffer_load_dwordx4 a[216:219], v49, s[24:27], s48 offen offset:2048 sc1
    v_mfma_f32_16x16x32_bf16 a[24:27], v[92:95], a[172:175], a[24:27]
    v_mfma_f32_16x16x32_bf16 a[28:31], v[80:83], a[176:179], a[28:31]
    v_mfma_f32_16x16x32_bf16 a[28:31], v[84:87], a[180:183], a[28:31]
    v_mfma_f32_16x16x32_bf16 a[28:31], v[88:91], a[184:187], a[28:31]
    buffer_load_dwordx4 a[220:223], v49, s[24:27], s48 offen offset:3072 sc1
    v_mfma_f32_16x16x32_bf16 a[28:31], v[92:95], a[188:191], a[28:31]
    s_waitcnt lgkmcnt(0)
    v_mfma_f32_16x16x32_bf16 a[32:35], v[96:99], a[128:131], a[32:35]
    ds_read_b64_tr_b16 v[64:65], v238 offset:128
    v_mfma_f32_16x16x32_bf16 a[32:35], v[100:103], a[132:135], a[32:35]
    ds_read_b64_tr_b16 v[66:67], v238 offset:384
    v_mfma_f32_16x16x32_bf16 a[32:35], v[104:107], a[136:139], a[32:35]
    ds_read_b64_tr_b16 v[68:69], v238 offset:640
    v_mfma_f32_16x16x32_bf16 a[32:35], v[108:111], a[140:143], a[32:35]
    buffer_load_dwordx4 a[224:227], v50, s[24:27], s48 offen offset:0 sc1
    v_mfma_f32_16x16x32_bf16 a[36:39], v[96:99], a[144:147], a[36:39]
    ds_read_b64_tr_b16 v[70:71], v238 offset:896
    ds_read_b64_tr_b16 v[72:73], v238 offset:17024
    v_mfma_f32_16x16x32_bf16 a[36:39], v[100:103], a[148:151], a[36:39]
    ds_read_b64_tr_b16 v[74:75], v238 offset:17280
    v_mfma_f32_16x16x32_bf16 a[36:39], v[104:107], a[152:155], a[36:39]
    ds_read_b64_tr_b16 v[76:77], v238 offset:17536
    v_mfma_f32_16x16x32_bf16 a[36:39], v[108:111], a[156:159], a[36:39]
    ds_read_b64_tr_b16 v[78:79], v238 offset:17792
    v_mfma_f32_16x16x32_bf16 a[40:43], v[96:99], a[160:163], a[40:43]
    buffer_load_dwordx4 a[228:231], v50, s[24:27], s48 offen offset:1024 sc1
    v_mfma_f32_16x16x32_bf16 a[40:43], v[100:103], a[164:167], a[40:43]
    v_mfma_f32_16x16x32_bf16 a[40:43], v[104:107], a[168:171], a[40:43]
    v_mfma_f32_16x16x32_bf16 a[40:43], v[108:111], a[172:175], a[40:43]
    buffer_load_dwordx4 a[232:235], v50, s[24:27], s48 offen offset:2048 sc1
    v_mfma_f32_16x16x32_bf16 a[44:47], v[96:99], a[176:179], a[44:47]
    v_mfma_f32_16x16x32_bf16 a[44:47], v[100:103], a[180:183], a[44:47]
    v_mfma_f32_16x16x32_bf16 a[44:47], v[104:107], a[184:187], a[44:47]
    v_mfma_f32_16x16x32_bf16 a[44:47], v[108:111], a[188:191], a[44:47]
    buffer_load_dwordx4 a[236:239], v50, s[24:27], s48 offen offset:3072 sc1
    v_mfma_f32_16x16x32_bf16 a[48:51], v[112:115], a[128:131], a[48:51]
    ds_read_b64_tr_b16 v[80:81], v238 offset:160
    v_mfma_f32_16x16x32_bf16 a[48:51], v[116:119], a[132:135], a[48:51]
    ds_read_b64_tr_b16 v[82:83], v238 offset:416
    v_mfma_f32_16x16x32_bf16 a[48:51], v[120:123], a[136:139], a[48:51]
    ds_read_b64_tr_b16 v[84:85], v238 offset:672
    v_mfma_f32_16x16x32_bf16 a[48:51], v[124:127], a[140:143], a[48:51]
    ds_read_b64_tr_b16 v[86:87], v238 offset:928
    v_mfma_f32_16x16x32_bf16 a[52:55], v[112:115], a[144:147], a[52:55]
    buffer_load_dwordx4 a[240:243], v51, s[24:27], s48 offen offset:0 sc1
    v_mfma_f32_16x16x32_bf16 a[52:55], v[116:119], a[148:151], a[52:55]
    ds_read_b64_tr_b16 v[88:89], v238 offset:17056
    ds_read_b64_tr_b16 v[90:91], v238 offset:17312
    v_mfma_f32_16x16x32_bf16 a[52:55], v[120:123], a[152:155], a[52:55]
    ds_read_b64_tr_b16 v[92:93], v238 offset:17568
    v_mfma_f32_16x16x32_bf16 a[52:55], v[124:127], a[156:159], a[52:55]
    ds_read_b64_tr_b16 v[94:95], v238 offset:17824
    v_mfma_f32_16x16x32_bf16 a[56:59], v[112:115], a[160:163], a[56:59]
    buffer_load_dwordx4 a[244:247], v51, s[24:27], s48 offen offset:1024 sc1
    v_mfma_f32_16x16x32_bf16 a[56:59], v[116:119], a[164:167], a[56:59]
    v_mfma_f32_16x16x32_bf16 a[56:59], v[120:123], a[168:171], a[56:59]
    v_mfma_f32_16x16x32_bf16 a[56:59], v[124:127], a[172:175], a[56:59]
    v_mfma_f32_16x16x32_bf16 a[60:63], v[112:115], a[176:179], a[60:63]
    buffer_load_dwordx4 a[248:251], v51, s[24:27], s48 offen offset:2048 sc1
    v_mfma_f32_16x16x32_bf16 a[60:63], v[116:119], a[180:183], a[60:63]
    v_mfma_f32_16x16x32_bf16 a[60:63], v[120:123], a[184:187], a[60:63]
    v_mfma_f32_16x16x32_bf16 a[60:63], v[124:127], a[188:191], a[60:63]
    s_waitcnt lgkmcnt(0)
    v_mfma_f32_16x16x32_bf16 a[64:67], v[64:67], a[128:131], a[64:67]
    buffer_load_dwordx4 a[252:255], v51, s[24:27], s48 offen offset:3072 sc1
    v_mfma_f32_16x16x32_bf16 a[64:67], v[68:71], a[132:135], a[64:67]
    ds_read_b64_tr_b16 v[96:97], v238 offset:192
    s_add_u32 s48, s48, 4096
    v_mfma_f32_16x16x32_bf16 a[64:67], v[72:75], a[136:139], a[64:67]
    ds_read_b64_tr_b16 v[98:99], v238 offset:448
    ds_read_b64_tr_b16 v[100:101], v238 offset:704
    v_mfma_f32_16x16x32_bf16 a[64:67], v[76:79], a[140:143], a[64:67]
    ds_read_b64_tr_b16 v[102:103], v238 offset:960
    v_mfma_f32_16x16x32_bf16 a[68:71], v[64:67], a[144:147], a[68:71]
    ds_read_b64_tr_b16 v[104:105], v238 offset:17088
    v_mfma_f32_16x16x32_bf16 a[68:71], v[68:71], a[148:151], a[68:71]
    buffer_store_dwordx4 v[176:179], v253, s[28:31], s64 offen offset:0 sc1
    v_mfma_f32_16x16x32_bf16 a[68:71], v[72:75], a[152:155], a[68:71]
    ds_read_b64_tr_b16 v[106:107], v238 offset:17344
    ds_read_b64_tr_b16 v[108:109], v238 offset:17600
    v_mfma_f32_16x16x32_bf16 a[68:71], v[76:79], a[156:159], a[68:71]
    ds_read_b64_tr_b16 v[110:111], v238 offset:17856
    v_mfma_f32_16x16x32_bf16 a[72:75], v[64:67], a[160:163], a[72:75]
    v_mfma_f32_16x16x32_bf16 a[72:75], v[68:71], a[164:167], a[72:75]
    buffer_store_dwordx4 v[180:183], v253, s[28:31], s64 offen offset:1024 sc1
    v_mfma_f32_16x16x32_bf16 a[72:75], v[72:75], a[168:171], a[72:75]
    v_mfma_f32_16x16x32_bf16 a[72:75], v[76:79], a[172:175], a[72:75]
    v_mfma_f32_16x16x32_bf16 a[76:79], v[64:67], a[176:179], a[76:79]
    v_mfma_f32_16x16x32_bf16 a[76:79], v[68:71], a[180:183], a[76:79]
    buffer_store_dwordx4 v[184:187], v253, s[28:31], s64 offen offset:2048 sc1
    v_mfma_f32_16x16x32_bf16 a[76:79], v[72:75], a[184:187], a[76:79]
    v_mfma_f32_16x16x32_bf16 a[76:79], v[76:79], a[188:191], a[76:79]
    v_mfma_f32_16x16x32_bf16 a[80:83], v[80:83], a[128:131], a[80:83]
    ds_read_b64_tr_b16 v[112:113], v238 offset:224
    v_mfma_f32_16x16x32_bf16 a[80:83], v[84:87], a[132:135], a[80:83]
    buffer_store_dwordx4 v[188:191], v253, s[28:31], s64 offen offset:3072 sc1
    v_mfma_f32_16x16x32_bf16 a[80:83], v[88:91], a[136:139], a[80:83]
    ds_read_b64_tr_b16 v[114:115], v238 offset:480
    ds_read_b64_tr_b16 v[116:117], v238 offset:736
    v_mfma_f32_16x16x32_bf16 a[80:83], v[92:95], a[140:143], a[80:83]
    ds_read_b64_tr_b16 v[118:119], v238 offset:992
    v_mfma_f32_16x16x32_bf16 a[84:87], v[80:83], a[144:147], a[84:87]
    ds_read_b64_tr_b16 v[120:121], v238 offset:17120
    v_mfma_f32_16x16x32_bf16 a[84:87], v[84:87], a[148:151], a[84:87]
    ds_read_b64_tr_b16 v[122:123], v238 offset:17376
    s_add_u32 m0, s53, 101376
    v_mfma_f32_16x16x32_bf16 a[84:87], v[88:91], a[152:155], a[84:87]
    ds_read_b64_tr_b16 v[124:125], v238 offset:17632
    v_mfma_f32_16x16x32_bf16 a[84:87], v[92:95], a[156:159], a[84:87]
    buffer_load_dwordx4 v248, s[44:47], s49 offen offset:0 lds
    v_mfma_f32_16x16x32_bf16 a[88:91], v[80:83], a[160:163], a[88:91]
    ds_read_b64_tr_b16 v[126:127], v238 offset:17888
    v_mfma_f32_16x16x32_bf16 a[88:91], v[84:87], a[164:167], a[88:91]
    v_mfma_f32_16x16x32_bf16 a[88:91], v[88:91], a[168:171], a[88:91]
    buffer_load_dwordx4 v249, s[44:47], s49 offen offset:1056 lds
    v_mfma_f32_16x16x32_bf16 a[88:91], v[92:95], a[172:175], a[88:91]
    v_mfma_f32_16x16x32_bf16 a[92:95], v[80:83], a[176:179], a[92:95]
    v_mfma_f32_16x16x32_bf16 a[92:95], v[84:87], a[180:183], a[92:95]
    v_mfma_f32_16x16x32_bf16 a[92:95], v[88:91], a[184:187], a[92:95]
    buffer_load_dwordx4 v250, s[44:47], s49 offen offset:2112 lds
    v_mfma_f32_16x16x32_bf16 a[92:95], v[92:95], a[188:191], a[92:95]
    s_waitcnt lgkmcnt(0)
    v_mfma_f32_16x16x32_bf16 a[96:99], v[96:99], a[128:131], a[96:99]
    v_mfma_f32_16x16x32_bf16 a[96:99], v[100:103], a[132:135], a[96:99]
    v_mfma_f32_16x16x32_bf16 a[96:99], v[104:107], a[136:139], a[96:99]
    buffer_load_dwordx4 v251, s[44:47], s49 offen offset:3168 lds
    v_mfma_f32_16x16x32_bf16 a[96:99], v[108:111], a[140:143], a[96:99]
    s_add_u32 s49, s49, 131072
    v_mfma_f32_16x16x32_bf16 a[100:103], v[96:99], a[144:147], a[100:103]
    s_waitcnt vmcnt(52) lgkmcnt(0)
    s_barrier
    v_mfma_f32_16x16x32_bf16 a[100:103], v[100:103], a[148:151], a[100:103]
    ds_read_b64_tr_b16 v[64:65], v238 offset:33792
    v_mfma_f32_16x16x32_bf16 a[100:103], v[104:107], a[152:155], a[100:103]
    ds_read_b64_tr_b16 v[66:67], v238 offset:34048
    s_add_u32 m0, s53, 118272
    v_mfma_f32_16x16x32_bf16 a[100:103], v[108:111], a[156:159], a[100:103]
    buffer_load_dwordx4 v248, s[44:47], s49 offen offset:0 lds
    v_mfma_f32_16x16x32_bf16 a[104:107], v[96:99], a[160:163], a[104:107]
    ds_read_b64_tr_b16 v[68:69], v238 offset:34304
    ds_read_b64_tr_b16 v[70:71], v238 offset:34560
    v_mfma_f32_16x16x32_bf16 a[104:107], v[100:103], a[164:167], a[104:107]
    ds_read_b64_tr_b16 v[72:73], v238 offset:50688
    v_mfma_f32_16x16x32_bf16 a[104:107], v[104:107], a[168:171], a[104:107]
    ds_read_b64_tr_b16 v[74:75], v238 offset:50944
    v_mfma_f32_16x16x32_bf16 a[104:107], v[108:111], a[172:175], a[104:107]
    ds_read_b64_tr_b16 v[76:77], v238 offset:51200
    v_mfma_f32_16x16x32_bf16 a[108:111], v[96:99], a[176:179], a[108:111]
    ds_read_b64_tr_b16 v[78:79], v238 offset:51456
    v_mfma_f32_16x16x32_bf16 a[108:111], v[100:103], a[180:183], a[108:111]
    buffer_load_dwordx4 v249, s[44:47], s49 offen offset:1056 lds
    v_mfma_f32_16x16x32_bf16 a[108:111], v[104:107], a[184:187], a[108:111]
    v_mfma_f32_16x16x32_bf16 a[108:111], v[108:111], a[188:191], a[108:111]
    buffer_load_dwordx4 v250, s[44:47], s49 offen offset:2112 lds
    v_mfma_f32_16x16x32_bf16 a[112:115], v[112:115], a[128:131], a[112:115]
    v_mfma_f32_16x16x32_bf16 a[112:115], v[116:119], a[132:135], a[112:115]
    ds_read_b64_tr_b16 v[80:81], v238 offset:33824
    v_mfma_f32_16x16x32_bf16 a[112:115], v[120:123], a[136:139], a[112:115]
    ds_read_b64_tr_b16 v[82:83], v238 offset:34080
    v_mfma_f32_16x16x32_bf16 a[112:115], v[124:127], a[140:143], a[112:115]
    buffer_load_dwordx4 v251, s[44:47], s49 offen offset:3168 lds
    v_mfma_f32_16x16x32_bf16 a[116:119], v[112:115], a[144:147], a[116:119]
    ds_read_b64_tr_b16 v[84:85], v238 offset:34336
    s_add_u32 s49, s49, 131072
    v_mfma_f32_16x16x32_bf16 a[116:119], v[116:119], a[148:151], a[116:119]
    ds_read_b64_tr_b16 v[86:87], v238 offset:34592
    ds_read_b64_tr_b16 v[88:89], v238 offset:50720
    v_mfma_f32_16x16x32_bf16 a[116:119], v[120:123], a[152:155], a[116:119]
    ds_read_b64_tr_b16 v[90:91], v238 offset:50976
    v_mfma_f32_16x16x32_bf16 a[116:119], v[124:127], a[156:159], a[116:119]
    ds_read_b64_tr_b16 v[92:93], v238 offset:51232
    v_mfma_f32_16x16x32_bf16 a[120:123], v[112:115], a[160:163], a[120:123]
    ds_read_b64_tr_b16 v[94:95], v238 offset:51488
    v_mfma_f32_16x16x32_bf16 a[120:123], v[116:119], a[164:167], a[120:123]
    v_mfma_f32_16x16x32_bf16 a[120:123], v[120:123], a[168:171], a[120:123]
    v_mfma_f32_16x16x32_bf16 a[120:123], v[124:127], a[172:175], a[120:123]
    v_mfma_f32_16x16x32_bf16 a[124:127], v[112:115], a[176:179], a[124:127]
    v_mfma_f32_16x16x32_bf16 a[124:127], v[116:119], a[180:183], a[124:127]
    v_mfma_f32_16x16x32_bf16 a[124:127], v[120:123], a[184:187], a[124:127]
    v_mfma_f32_16x16x32_bf16 a[124:127], v[124:127], a[188:191], a[124:127]
    s_waitcnt vmcnt(12)
    s_waitcnt lgkmcnt(0)
    v_mfma_f32_16x16x32_bf16 a[0:3], v[64:67], a[192:195], a[0:3]
    ds_read_b64_tr_b16 v[96:97], v238 offset:33856
    v_mfma_f32_16x16x32_bf16 a[0:3], v[68:71], a[196:199], a[0:3]
    buffer_load_dwordx4 a[128:131], v48, s[24:27], s48 offen offset:0 sc1
    v_mfma_f32_16x16x32_bf16 a[0:3], v[72:75], a[200:203], a[0:3]
    ds_read_b64_tr_b16 v[98:99], v238 offset:34112
    ds_read_b64_tr_b16 v[100:101], v238 offset:34368
    v_mfma_f32_16x16x32_bf16 a[0:3], v[76:79], a[204:207], a[0:3]
    ds_read_b64_tr_b16 v[102:103], v238 offset:34624
    v_mfma_f32_16x16x32_bf16 a[4:7], v[64:67], a[208:211], a[4:7]
    ds_read_b64_tr_b16 v[104:105], v238 offset:50752
    v_mfma_f32_16x16x32_bf16 a[4:7], v[68:71], a[212:215], a[4:7]
    buffer_load_dwordx4 a[132:135], v48, s[24:27], s48 offen offset:1024 sc1
    v_mfma_f32_16x16x32_bf16 a[4:7], v[72:75], a[216:219], a[4:7]
    ds_read_b64_tr_b16 v[106:107], v238 offset:51008
    ds_read_b64_tr_b16 v[108:109], v238 offset:51264
    v_mfma_f32_16x16x32_bf16 a[4:7], v[76:79], a[220:223], a[4:7]
    ds_read_b64_tr_b16 v[110:111], v238 offset:51520
    v_mfma_f32_16x16x32_bf16 a[8:11], v[64:67], a[224:227], a[8:11]
    v_mfma_f32_16x16x32_bf16 a[8:11], v[68:71], a[228:231], a[8:11]
    v_mfma_f32_16x16x32_bf16 a[8:11], v[72:75], a[232:235], a[8:11]
    buffer_load_dwordx4 a[136:139], v48, s[24:27], s48 offen offset:2048 sc1
    v_mfma_f32_16x16x32_bf16 a[8:11], v[76:79], a[236:239], a[8:11]
    v_mfma_f32_16x16x32_bf16 a[12:15], v[64:67], a[240:243], a[12:15]
    v_mfma_f32_16x16x32_bf16 a[12:15], v[68:71], a[244:247], a[12:15]
    v_mfma_f32_16x16x32_bf16 a[12:15], v[72:75], a[248:251], a[12:15]
    v_mfma_f32_16x16x32_bf16 a[12:15], v[76:79], a[252:255], a[12:15]
    buffer_load_dwordx4 a[140:143], v48, s[24:27], s48 offen offset:3072 sc1
    v_mfma_f32_16x16x32_bf16 a[16:19], v[80:83], a[192:195], a[16:19]
    ds_read_b64_tr_b16 v[112:113], v238 offset:33888
    v_mfma_f32_16x16x32_bf16 a[16:19], v[84:87], a[196:199], a[16:19]
    ds_read_b64_tr_b16 v[114:115], v238 offset:34144
    v_mfma_f32_16x16x32_bf16 a[16:19], v[88:91], a[200:203], a[16:19]
    ds_read_b64_tr_b16 v[116:117], v238 offset:34400
    v_mfma_f32_16x16x32_bf16 a[16:19], v[92:95], a[204:207], a[16:19]
    ds_read_b64_tr_b16 v[118:119], v238 offset:34656
    v_mfma_f32_16x16x32_bf16 a[20:23], v[80:83], a[208:211], a[20:23]
    buffer_load_dwordx4 a[144:147], v49, s[24:27], s48 offen offset:0 sc1
    v_mfma_f32_16x16x32_bf16 a[20:23], v[84:87], a[212:215], a[20:23]
    ds_read_b64_tr_b16 v[120:121], v238 offset:50784
    ds_read_b64_tr_b16 v[122:123], v238 offset:51040
    v_mfma_f32_16x16x32_bf16 a[20:23], v[88:91], a[216:219], a[20:23]
    ds_read_b64_tr_b16 v[124:125], v238 offset:51296
    v_mfma_f32_16x16x32_bf16 a[20:23], v[92:95], a[220:223], a[20:23]
    ds_read_b64_tr_b16 v[126:127], v238 offset:51552
    v_mfma_f32_16x16x32_bf16 a[24:27], v[80:83], a[224:227], a[24:27]
    v_mfma_f32_16x16x32_bf16 a[24:27], v[84:87], a[228:231], a[24:27]
    buffer_load_dwordx4 a[148:151], v49, s[24:27], s48 offen offset:1024 sc1
    v_mfma_f32_16x16x32_bf16 a[24:27], v[88:91], a[232:235], a[24:27]
    v_mfma_f32_16x16x32_bf16 a[24:27], v[92:95], a[236:239], a[24:27]
    v_mfma_f32_16x16x32_bf16 a[28:31], v[80:83], a[240:243], a[28:31]
    v_mfma_f32_16x16x32_bf16 a[28:31], v[84:87], a[244:247], a[28:31]
    v_mfma_f32_16x16x32_bf16 a[28:31], v[88:91], a[248:251], a[28:31]
    buffer_load_dwordx4 a[152:155], v49, s[24:27], s48 offen offset:2048 sc1
    v_mfma_f32_16x16x32_bf16 a[28:31], v[92:95], a[252:255], a[28:31]
    s_waitcnt lgkmcnt(0)
    v_mfma_f32_16x16x32_bf16 a[32:35], v[96:99], a[192:195], a[32:35]
    ds_read_b64_tr_b16 v[64:65], v238 offset:33920
    v_mfma_f32_16x16x32_bf16 a[32:35], v[100:103], a[196:199], a[32:35]
    ds_read_b64_tr_b16 v[66:67], v238 offset:34176
    v_mfma_f32_16x16x32_bf16 a[32:35], v[104:107], a[200:203], a[32:35]
    ds_read_b64_tr_b16 v[68:69], v238 offset:34432
    v_mfma_f32_16x16x32_bf16 a[32:35], v[108:111], a[204:207], a[32:35]
    buffer_load_dwordx4 a[156:159], v49, s[24:27], s48 offen offset:3072 sc1
    v_mfma_f32_16x16x32_bf16 a[36:39], v[96:99], a[208:211], a[36:39]
    ds_read_b64_tr_b16 v[70:71], v238 offset:34688
    ds_read_b64_tr_b16 v[72:73], v238 offset:50816
    v_mfma_f32_16x16x32_bf16 a[36:39], v[100:103], a[212:215], a[36:39]
    ds_read_b64_tr_b16 v[74:75], v238 offset:51072
    v_mfma_f32_16x16x32_bf16 a[36:39], v[104:107], a[216:219], a[36:39]
    ds_read_b64_tr_b16 v[76:77], v238 offset:51328
    v_mfma_f32_16x16x32_bf16 a[36:39], v[108:111], a[220:223], a[36:39]
    ds_read_b64_tr_b16 v[78:79], v238 offset:51584
    v_mfma_f32_16x16x32_bf16 a[40:43], v[96:99], a[224:227], a[40:43]
    buffer_load_dwordx4 a[160:163], v50, s[24:27], s48 offen offset:0 sc1
    v_mfma_f32_16x16x32_bf16 a[40:43], v[100:103], a[228:231], a[40:43]
    v_mfma_f32_16x16x32_bf16 a[40:43], v[104:107], a[232:235], a[40:43]
    v_mfma_f32_16x16x32_bf16 a[40:43], v[108:111], a[236:239], a[40:43]
    v_mfma_f32_16x16x32_bf16 a[44:47], v[96:99], a[240:243], a[44:47]
    v_mfma_f32_16x16x32_bf16 a[44:47], v[100:103], a[244:247], a[44:47]
    buffer_load_dwordx4 a[164:167], v50, s[24:27], s48 offen offset:1024 sc1
    v_mfma_f32_16x16x32_bf16 a[44:47], v[104:107], a[248:251], a[44:47]
    v_mfma_f32_16x16x32_bf16 a[44:47], v[108:111], a[252:255], a[44:47]
    v_mfma_f32_16x16x32_bf16 a[48:51], v[112:115], a[192:195], a[48:51]
    ds_read_b64_tr_b16 v[80:81], v238 offset:33952
    v_mfma_f32_16x16x32_bf16 a[48:51], v[116:119], a[196:199], a[48:51]
    ds_read_b64_tr_b16 v[82:83], v238 offset:34208
    v_mfma_f32_16x16x32_bf16 a[48:51], v[120:123], a[200:203], a[48:51]
    buffer_load_dwordx4 a[168:171], v50, s[24:27], s48 offen offset:2048 sc1
    v_mfma_f32_16x16x32_bf16 a[48:51], v[124:127], a[204:207], a[48:51]
    ds_read_b64_tr_b16 v[84:85], v238 offset:34464
    ds_read_b64_tr_b16 v[86:87], v238 offset:34720
    v_mfma_f32_16x16x32_bf16 a[52:55], v[112:115], a[208:211], a[52:55]
    ds_read_b64_tr_b16 v[88:89], v238 offset:50848
    v_mfma_f32_16x16x32_bf16 a[52:55], v[116:119], a[212:215], a[52:55]
    ds_read_b64_tr_b16 v[90:91], v238 offset:51104
    v_mfma_f32_16x16x32_bf16 a[52:55], v[120:123], a[216:219], a[52:55]
    ds_read_b64_tr_b16 v[92:93], v238 offset:51360
    v_mfma_f32_16x16x32_bf16 a[52:55], v[124:127], a[220:223], a[52:55]
    ds_read_b64_tr_b16 v[94:95], v238 offset:51616
    v_mfma_f32_16x16x32_bf16 a[56:59], v[112:115], a[224:227], a[56:59]
    buffer_load_dwordx4 a[172:175], v50, s[24:27], s48 offen offset:3072 sc1
    v_mfma_f32_16x16x32_bf16 a[56:59], v[116:119], a[228:231], a[56:59]
    v_mfma_f32_16x16x32_bf16 a[56:59], v[120:123], a[232:235], a[56:59]
    v_mfma_f32_16x16x32_bf16 a[56:59], v[124:127], a[236:239], a[56:59]
    v_mfma_f32_16x16x32_bf16 a[60:63], v[112:115], a[240:243], a[60:63]
    buffer_load_dwordx4 a[176:179], v51, s[24:27], s48 offen offset:0 sc1
    v_mfma_f32_16x16x32_bf16 a[60:63], v[116:119], a[244:247], a[60:63]
    v_mfma_f32_16x16x32_bf16 a[60:63], v[120:123], a[248:251], a[60:63]
    v_mfma_f32_16x16x32_bf16 a[60:63], v[124:127], a[252:255], a[60:63]
    s_waitcnt lgkmcnt(0)
    v_mfma_f32_16x16x32_bf16 a[64:67], v[64:67], a[192:195], a[64:67]
    ds_read_b64_tr_b16 v[96:97], v238 offset:33984
    v_mfma_f32_16x16x32_bf16 a[64:67], v[68:71], a[196:199], a[64:67]
    buffer_load_dwordx4 a[180:183], v51, s[24:27], s48 offen offset:1024 sc1
    v_mfma_f32_16x16x32_bf16 a[64:67], v[72:75], a[200:203], a[64:67]
    ds_read_b64_tr_b16 v[98:99], v238 offset:34240
    ds_read_b64_tr_b16 v[100:101], v238 offset:34496
    v_mfma_f32_16x16x32_bf16 a[64:67], v[76:79], a[204:207], a[64:67]
    ds_read_b64_tr_b16 v[102:103], v238 offset:34752
    v_mfma_f32_16x16x32_bf16 a[68:71], v[64:67], a[208:211], a[68:71]
    ds_read_b64_tr_b16 v[104:105], v238 offset:50880
    v_mfma_f32_16x16x32_bf16 a[68:71], v[68:71], a[212:215], a[68:71]
    ds_read_b64_tr_b16 v[106:107], v238 offset:51136
    v_mfma_f32_16x16x32_bf16 a[68:71], v[72:75], a[216:219], a[68:71]
    ds_read_b64_tr_b16 v[108:109], v238 offset:51392
    v_mfma_f32_16x16x32_bf16 a[68:71], v[76:79], a[220:223], a[68:71]
    buffer_load_dwordx4 a[184:187], v51, s[24:27], s48 offen offset:2048 sc1
    v_mfma_f32_16x16x32_bf16 a[72:75], v[64:67], a[224:227], a[72:75]
    ds_read_b64_tr_b16 v[110:111], v238 offset:51648
    v_mfma_f32_16x16x32_bf16 a[72:75], v[68:71], a[228:231], a[72:75]
    v_mfma_f32_16x16x32_bf16 a[72:75], v[72:75], a[232:235], a[72:75]
    v_mfma_f32_16x16x32_bf16 a[72:75], v[76:79], a[236:239], a[72:75]
    buffer_load_dwordx4 a[188:191], v51, s[24:27], s48 offen offset:3072 sc1
    v_mfma_f32_16x16x32_bf16 a[76:79], v[64:67], a[240:243], a[76:79]
    s_add_u32 s48, s48, 4096
    v_mfma_f32_16x16x32_bf16 a[76:79], v[68:71], a[244:247], a[76:79]
    v_mfma_f32_16x16x32_bf16 a[76:79], v[72:75], a[248:251], a[76:79]
    v_mfma_f32_16x16x32_bf16 a[76:79], v[76:79], a[252:255], a[76:79]
    s_add_u32 m0, s53, 0
    v_mfma_f32_16x16x32_bf16 a[80:83], v[80:83], a[192:195], a[80:83]
    buffer_load_dwordx4 v248, s[44:47], s49 offen offset:0 lds
    v_mfma_f32_16x16x32_bf16 a[80:83], v[84:87], a[196:199], a[80:83]
    ds_read_b64_tr_b16 v[112:113], v238 offset:34016
    ds_read_b64_tr_b16 v[114:115], v238 offset:34272
    v_mfma_f32_16x16x32_bf16 a[80:83], v[88:91], a[200:203], a[80:83]
    ds_read_b64_tr_b16 v[116:117], v238 offset:34528
    v_mfma_f32_16x16x32_bf16 a[80:83], v[92:95], a[204:207], a[80:83]
    ds_read_b64_tr_b16 v[118:119], v238 offset:34784
    v_mfma_f32_16x16x32_bf16 a[84:87], v[80:83], a[208:211], a[84:87]
    ds_read_b64_tr_b16 v[120:121], v238 offset:50912
    v_mfma_f32_16x16x32_bf16 a[84:87], v[84:87], a[212:215], a[84:87]
    buffer_load_dwordx4 v249, s[44:47], s49 offen offset:1056 lds
    v_mfma_f32_16x16x32_bf16 a[84:87], v[88:91], a[216:219], a[84:87]
    ds_read_b64_tr_b16 v[122:123], v238 offset:51168
    ds_read_b64_tr_b16 v[124:125], v238 offset:51424
    v_mfma_f32_16x16x32_bf16 a[84:87], v[92:95], a[220:223], a[84:87]
    ds_read_b64_tr_b16 v[126:127], v238 offset:51680
    v_mfma_f32_16x16x32_bf16 a[88:91], v[80:83], a[224:227], a[88:91]
    v_mfma_f32_16x16x32_bf16 a[88:91], v[84:87], a[228:231], a[88:91]
    v_mfma_f32_16x16x32_bf16 a[88:91], v[88:91], a[232:235], a[88:91]
    buffer_load_dwordx4 v250, s[44:47], s49 offen offset:2112 lds
    v_mfma_f32_16x16x32_bf16 a[88:91], v[92:95], a[236:239], a[88:91]
    v_mfma_f32_16x16x32_bf16 a[92:95], v[80:83], a[240:243], a[92:95]
    v_mfma_f32_16x16x32_bf16 a[92:95], v[84:87], a[244:247], a[92:95]
    v_mfma_f32_16x16x32_bf16 a[92:95], v[88:91], a[248:251], a[92:95]
    v_mfma_f32_16x16x32_bf16 a[92:95], v[92:95], a[252:255], a[92:95]
    buffer_load_dwordx4 v251, s[44:47], s49 offen offset:3168 lds
    s_waitcnt lgkmcnt(0)
    v_mfma_f32_16x16x32_bf16 a[96:99], v[96:99], a[192:195], a[96:99]
    s_add_u32 s49, s49, 131072
    v_mfma_f32_16x16x32_bf16 a[96:99], v[100:103], a[196:199], a[96:99]
    v_mfma_f32_16x16x32_bf16 a[96:99], v[104:107], a[200:203], a[96:99]
    v_mfma_f32_16x16x32_bf16 a[96:99], v[108:111], a[204:207], a[96:99]
    s_add_u32 m0, s53, 16896
    v_mfma_f32_16x16x32_bf16 a[100:103], v[96:99], a[208:211], a[100:103]
    s_waitcnt vmcnt(28) lgkmcnt(0)
    s_barrier
    s_lshl_b32 s59, s55, 2
    s_add_u32 s59, s59, s98
    s_add_u32 s59, s59, 128
    s_cmp_lg_u32 s54, 0
    s_cbranch_scc1 L_sgo
    v_mov_b32 v241, 1
    s_mov_b64 exec, 1
    buffer_store_dword v241, off, s[36:39], s59 sc1
    s_mov_b64 exec, -1
L_sgo:
    v_mfma_f32_16x16x32_bf16 a[100:103], v[100:103], a[212:215], a[100:103]
    buffer_load_dwordx4 v248, s[44:47], s49 offen offset:0 lds
    v_mfma_f32_16x16x32_bf16 a[100:103], v[104:107], a[216:219], a[100:103]
    ds_read_b64_tr_b16 v[64:65], v239 offset:0
    ds_read_b64_tr_b16 v[66:67], v239 offset:256
    v_mfma_f32_16x16x32_bf16 a[100:103], v[108:111], a[220:223], a[100:103]
    ds_read_b64_tr_b16 v[68:69], v239 offset:512
    v_mfma_f32_16x16x32_bf16 a[104:107], v[96:99], a[224:227], a[104:107]
    ds_read_b64_tr_b16 v[70:71], v239 offset:768
    v_mfma_f32_16x16x32_bf16 a[104:107], v[100:103], a[228:231], a[104:107]
    buffer_load_dwordx4 v249, s[44:47], s49 offen offset:1056 lds
    v_mfma_f32_16x16x32_bf16 a[104:107], v[104:107], a[232:235], a[104:107]
    ds_read_b64_tr_b16 v[72:73], v239 offset:16896
    ds_read_b64_tr_b16 v[74:75], v239 offset:17152
    v_mfma_f32_16x16x32_bf16 a[104:107], v[108:111], a[236:239], a[104:107]
    ds_read_b64_tr_b16 v[76:77], v239 offset:17408
    v_mfma_f32_16x16x32_bf16 a[108:111], v[96:99], a[240:243], a[108:111]
    ds_read_b64_tr_b16 v[78:79], v239 offset:17664
    v_mfma_f32_16x16x32_bf16 a[108:111], v[100:103], a[244:247], a[108:111]
    v_mfma_f32_16x16x32_bf16 a[108:111], v[104:107], a[248:251], a[108:111]
    buffer_load_dwordx4 v250, s[44:47], s49 offen offset:2112 lds
    v_mfma_f32_16x16x32_bf16 a[108:111], v[108:111], a[252:255], a[108:111]
    v_mfma_f32_16x16x32_bf16 a[112:115], v[112:115], a[192:195], a[112:115]
    v_mfma_f32_16x16x32_bf16 a[112:115], v[116:119], a[196:199], a[112:115]
    ds_read_b64_tr_b16 v[80:81], v239 offset:32
    v_mfma_f32_16x16x32_bf16 a[112:115], v[120:123], a[200:203], a[112:115]
    ds_read_b64_tr_b16 v[82:83], v239 offset:288
    v_mfma_f32_16x16x32_bf16 a[112:115], v[124:127], a[204:207], a[112:115]
    buffer_load_dwordx4 v251, s[44:47], s49 offen offset:3168 lds
    v_mfma_f32_16x16x32_bf16 a[116:119], v[112:115], a[208:211], a[116:119]
    ds_read_b64_tr_b16 v[84:85], v239 offset:544
    s_add_u32 s49, s49, 131072
    v_mfma_f32_16x16x32_bf16 a[116:119], v[116:119], a[212:215], a[116:119]
    ds_read_b64_tr_b16 v[86:87], v239 offset:800
    ds_read_b64_tr_b16 v[88:89], v239 offset:16928
    v_mfma_f32_16x16x32_bf16 a[116:119], v[120:123], a[216:219], a[116:119]
    ds_read_b64_tr_b16 v[90:91], v239 offset:17184
    v_mfma_f32_16x16x32_bf16 a[116:119], v[124:127], a[220:223], a[116:119]
    ds_read_b64_tr_b16 v[92:93], v239 offset:17440
    v_mfma_f32_16x16x32_bf16 a[120:123], v[112:115], a[224:227], a[120:123]
    ds_read_b64_tr_b16 v[94:95], v239 offset:17696
    v_mfma_f32_16x16x32_bf16 a[120:123], v[116:119], a[228:231], a[120:123]
    v_mfma_f32_16x16x32_bf16 a[120:123], v[120:123], a[232:235], a[120:123]
    v_mfma_f32_16x16x32_bf16 a[120:123], v[124:127], a[236:239], a[120:123]
    v_mfma_f32_16x16x32_bf16 a[124:127], v[112:115], a[240:243], a[124:127]
    v_mfma_f32_16x16x32_bf16 a[124:127], v[116:119], a[244:247], a[124:127]
    v_mfma_f32_16x16x32_bf16 a[124:127], v[120:123], a[248:251], a[124:127]
    v_mfma_f32_16x16x32_bf16 a[124:127], v[124:127], a[252:255], a[124:127]
    s_waitcnt vmcnt(8)
    s_waitcnt lgkmcnt(0)
    v_mfma_f32_16x16x32_bf16 a[0:3], v[64:67], a[128:131], a[0:3]
    ds_read_b64_tr_b16 v[96:97], v239 offset:64
    v_mfma_f32_16x16x32_bf16 a[0:3], v[68:71], a[132:135], a[0:3]
    buffer_load_dwordx4 a[192:195], v48, s[24:27], s48 offen offset:0 sc1
    v_mfma_f32_16x16x32_bf16 a[0:3], v[72:75], a[136:139], a[0:3]
    ds_read_b64_tr_b16 v[98:99], v239 offset:320
    ds_read_b64_tr_b16 v[100:101], v239 offset:576
    v_mfma_f32_16x16x32_bf16 a[0:3], v[76:79], a[140:143], a[0:3]
    ds_read_b64_tr_b16 v[102:103], v239 offset:832
    v_mfma_f32_16x16x32_bf16 a[4:7], v[64:67], a[144:147], a[4:7]
    ds_read_b64_tr_b16 v[104:105], v239 offset:16960
    v_mfma_f32_16x16x32_bf16 a[4:7], v[68:71], a[148:151], a[4:7]
    buffer_load_dwordx4 a[196:199], v48, s[24:27], s48 offen offset:1024 sc1
    v_mfma_f32_16x16x32_bf16 a[4:7], v[72:75], a[152:155], a[4:7]
    ds_read_b64_tr_b16 v[106:107], v239 offset:17216
    ds_read_b64_tr_b16 v[108:109], v239 offset:17472
    v_mfma_f32_16x16x32_bf16 a[4:7], v[76:79], a[156:159], a[4:7]
    ds_read_b64_tr_b16 v[110:111], v239 offset:17728
    v_mfma_f32_16x16x32_bf16 a[8:11], v[64:67], a[160:163], a[8:11]
    v_mfma_f32_16x16x32_bf16 a[8:11], v[68:71], a[164:167], a[8:11]
    v_mfma_f32_16x16x32_bf16 a[8:11], v[72:75], a[168:171], a[8:11]
    buffer_load_dwordx4 a[200:203], v48, s[24:27], s48 offen offset:2048 sc1
    v_mfma_f32_16x16x32_bf16 a[8:11], v[76:79], a[172:175], a[8:11]
    v_mfma_f32_16x16x32_bf16 a[12:15], v[64:67], a[176:179], a[12:15]
    v_mfma_f32_16x16x32_bf16 a[12:15], v[68:71], a[180:183], a[12:15]
    v_mfma_f32_16x16x32_bf16 a[12:15], v[72:75], a[184:187], a[12:15]
    v_mfma_f32_16x16x32_bf16 a[12:15], v[76:79], a[188:191], a[12:15]
    buffer_load_dwordx4 a[204:207], v48, s[24:27], s48 offen offset:3072 sc1
    v_mfma_f32_16x16x32_bf16 a[16:19], v[80:83], a[128:131], a[16:19]
    ds_read_b64_tr_b16 v[112:113], v239 offset:96
    v_mfma_f32_16x16x32_bf16 a[16:19], v[84:87], a[132:135], a[16:19]
    ds_read_b64_tr_b16 v[114:115], v239 offset:352
    v_mfma_f32_16x16x32_bf16 a[16:19], v[88:91], a[136:139], a[16:19]
    ds_read_b64_tr_b16 v[116:117], v239 offset:608
    v_mfma_f32_16x16x32_bf16 a[16:19], v[92:95], a[140:143], a[16:19]
    ds_read_b64_tr_b16 v[118:119], v239 offset:864
    v_mfma_f32_16x16x32_bf16 a[20:23], v[80:83], a[144:147], a[20:23]
    buffer_load_dwordx4 a[208:211], v49, s[24:27], s48 offen offset:0 sc1
    v_mfma_f32_16x16x32_bf16 a[20:23], v[84:87], a[148:151], a[20:23]
    ds_read_b64_tr_b16 v[120:121], v239 offset:16992
    ds_read_b64_tr_b16 v[122:123], v239 offset:17248
    v_mfma_f32_16x16x32_bf16 a[20:23], v[88:91], a[152:155], a[20:23]
    ds_read_b64_tr_b16 v[124:125], v239 offset:17504
    v_mfma_f32_16x16x32_bf16 a[20:23], v[92:95], a[156:159], a[20:23]
    ds_read_b64_tr_b16 v[126:127], v239 offset:17760
    v_mfma_f32_16x16x32_bf16 a[24:27], v[80:83], a[160:163], a[24:27]
    v_mfma_f32_16x16x32_bf16 a[24:27], v[84:87], a[164:167], a[24:27]
    buffer_load_dwordx4 a[212:215], v49, s[24:27], s48 offen offset:1024 sc1
    v_mfma_f32_16x16x32_bf16 a[24:27], v[88:91], a[168:171], a[24:27]
    v_mfma_f32_16x16x32_bf16 a[24:27], v[92:95], a[172:175], a[24:27]
    v_mfma_f32_16x16x32_bf16 a[28:31], v[80:83], a[176:179], a[28:31]
    v_mfma_f32_16x16x32_bf16 a[28:31], v[84:87], a[180:183], a[28:31]
    v_mfma_f32_16x16x32_bf16 a[28:31], v[88:91], a[184:187], a[28:31]
    buffer_load_dwordx4 a[216:219], v49, s[24:27], s48 offen offset:2048 sc1
    v_mfma_f32_16x16x32_bf16 a[28:31], v[92:95], a[188:191], a[28:31]
    s_waitcnt lgkmcnt(0)
    v_mfma_f32_16x16x32_bf16 a[32:35], v[96:99], a[128:131], a[32:35]
    ds_read_b64_tr_b16 v[64:65], v239 offset:128
    v_mfma_f32_16x16x32_bf16 a[32:35], v[100:103], a[132:135], a[32:35]
    ds_read_b64_tr_b16 v[66:67], v239 offset:384
    v_mfma_f32_16x16x32_bf16 a[32:35], v[104:107], a[136:139], a[32:35]
    ds_read_b64_tr_b16 v[68:69], v239 offset:640
    v_mfma_f32_16x16x32_bf16 a[32:35], v[108:111], a[140:143], a[32:35]
    buffer_load_dwordx4 a[220:223], v49, s[24:27], s48 offen offset:3072 sc1
    v_mfma_f32_16x16x32_bf16 a[36:39], v[96:99], a[144:147], a[36:39]
    ds_read_b64_tr_b16 v[70:71], v239 offset:896
    ds_read_b64_tr_b16 v[72:73], v239 offset:17024
    v_mfma_f32_16x16x32_bf16 a[36:39], v[100:103], a[148:151], a[36:39]
    ds_read_b64_tr_b16 v[74:75], v239 offset:17280
    v_mfma_f32_16x16x32_bf16 a[36:39], v[104:107], a[152:155], a[36:39]
    ds_read_b64_tr_b16 v[76:77], v239 offset:17536
    v_mfma_f32_16x16x32_bf16 a[36:39], v[108:111], a[156:159], a[36:39]
    ds_read_b64_tr_b16 v[78:79], v239 offset:17792
    v_mfma_f32_16x16x32_bf16 a[40:43], v[96:99], a[160:163], a[40:43]
    buffer_load_dwordx4 a[224:227], v50, s[24:27], s48 offen offset:0 sc1
    v_mfma_f32_16x16x32_bf16 a[40:43], v[100:103], a[164:167], a[40:43]
    v_mfma_f32_16x16x32_bf16 a[40:43], v[104:107], a[168:171], a[40:43]
    v_mfma_f32_16x16x32_bf16 a[40:43], v[108:111], a[172:175], a[40:43]
    v_mfma_f32_16x16x32_bf16 a[44:47], v[96:99], a[176:179], a[44:47]
    v_mfma_f32_16x16x32_bf16 a[44:47], v[100:103], a[180:183], a[44:47]
    buffer_load_dwordx4 a[228:231], v50, s[24:27], s48 offen offset:1024 sc1
    v_mfma_f32_16x16x32_bf16 a[44:47], v[104:107], a[184:187], a[44:47]
    v_mfma_f32_16x16x32_bf16 a[44:47], v[108:111], a[188:191], a[44:47]
    v_mfma_f32_16x16x32_bf16 a[48:51], v[112:115], a[128:131], a[48:51]
    ds_read_b64_tr_b16 v[80:81], v239 offset:160
    v_mfma_f32_16x16x32_bf16 a[48:51], v[116:119], a[132:135], a[48:51]
    ds_read_b64_tr_b16 v[82:83], v239 offset:416
    v_mfma_f32_16x16x32_bf16 a[48:51], v[120:123], a[136:139], a[48:51]
    buffer_load_dwordx4 a[232:235], v50, s[24:27], s48 offen offset:2048 sc1
    v_mfma_f32_16x16x32_bf16 a[48:51], v[124:127], a[140:143], a[48:51]
    ds_read_b64_tr_b16 v[84:85], v239 offset:672
    ds_read_b64_tr_b16 v[86:87], v239 offset:928
    v_mfma_f32_16x16x32_bf16 a[52:55], v[112:115], a[144:147], a[52:55]
    ds_read_b64_tr_b16 v[88:89], v239 offset:17056
    v_mfma_f32_16x16x32_bf16 a[52:55], v[116:119], a[148:151], a[52:55]
    ds_read_b64_tr_b16 v[90:91], v239 offset:17312
    v_mfma_f32_16x16x32_bf16 a[52:55], v[120:123], a[152:155], a[52:55]
    ds_read_b64_tr_b16 v[92:93], v239 offset:17568
    v_mfma_f32_16x16x32_bf16 a[52:55], v[124:127], a[156:159], a[52:55]
    ds_read_b64_tr_b16 v[94:95], v239 offset:17824
    v_mfma_f32_16x16x32_bf16 a[56:59], v[112:115], a[160:163], a[56:59]
    buffer_load_dwordx4 a[236:239], v50, s[24:27], s48 offen offset:3072 sc1
    v_mfma_f32_16x16x32_bf16 a[56:59], v[116:119], a[164:167], a[56:59]
    v_mfma_f32_16x16x32_bf16 a[56:59], v[120:123], a[168:171], a[56:59]
    v_mfma_f32_16x16x32_bf16 a[56:59], v[124:127], a[172:175], a[56:59]
    v_mfma_f32_16x16x32_bf16 a[60:63], v[112:115], a[176:179], a[60:63]
    buffer_load_dwordx4 a[240:243], v51, s[24:27], s48 offen offset:0 sc1
    v_mfma_f32_16x16x32_bf16 a[60:63], v[116:119], a[180:183], a[60:63]
    v_mfma_f32_16x16x32_bf16 a[60:63], v[120:123], a[184:187], a[60:63]
    v_mfma_f32_16x16x32_bf16 a[60:63], v[124:127], a[188:191], a[60:63]
    s_waitcnt lgkmcnt(0)
    v_mfma_f32_16x16x32_bf16 a[64:67], v[64:67], a[128:131], a[64:67]
    ds_read_b64_tr_b16 v[96:97], v239 offset:192
    v_mfma_f32_16x16x32_bf16 a[64:67], v[68:71], a[132:135], a[64:67]
    buffer_load_dwordx4 a[244:247], v51, s[24:27], s48 offen offset:1024 sc1
    v_mfma_f32_16x16x32_bf16 a[64:67], v[72:75], a[136:139], a[64:67]
    ds_read_b64_tr_b16 v[98:99], v239 offset:448
    ds_read_b64_tr_b16 v[100:101], v239 offset:704
    v_mfma_f32_16x16x32_bf16 a[64:67], v[76:79], a[140:143], a[64:67]
    ds_read_b64_tr_b16 v[102:103], v239 offset:960
    v_mfma_f32_16x16x32_bf16 a[68:71], v[64:67], a[144:147], a[68:71]
    ds_read_b64_tr_b16 v[104:105], v239 offset:17088
    v_mfma_f32_16x16x32_bf16 a[68:71], v[68:71], a[148:151], a[68:71]
    ds_read_b64_tr_b16 v[106:107], v239 offset:17344
    v_mfma_f32_16x16x32_bf16 a[68:71], v[72:75], a[152:155], a[68:71]
    ds_read_b64_tr_b16 v[108:109], v239 offset:17600
    v_mfma_f32_16x16x32_bf16 a[68:71], v[76:79], a[156:159], a[68:71]
    buffer_load_dwordx4 a[248:251], v51, s[24:27], s48 offen offset:2048 sc1
    v_mfma_f32_16x16x32_bf16 a[72:75], v[64:67], a[160:163], a[72:75]
    ds_read_b64_tr_b16 v[110:111], v239 offset:17856
    v_mfma_f32_16x16x32_bf16 a[72:75], v[68:71], a[164:167], a[72:75]
    v_mfma_f32_16x16x32_bf16 a[72:75], v[72:75], a[168:171], a[72:75]
    v_mfma_f32_16x16x32_bf16 a[72:75], v[76:79], a[172:175], a[72:75]
    buffer_load_dwordx4 a[252:255], v51, s[24:27], s48 offen offset:3072 sc1
    v_mfma_f32_16x16x32_bf16 a[76:79], v[64:67], a[176:179], a[76:79]
    s_add_u32 s48, s48, 4096
    v_mfma_f32_16x16x32_bf16 a[76:79], v[68:71], a[180:183], a[76:79]
    v_mfma_f32_16x16x32_bf16 a[76:79], v[72:75], a[184:187], a[76:79]
    v_mfma_f32_16x16x32_bf16 a[76:79], v[76:79], a[188:191], a[76:79]
    s_add_u32 m0, s53, 33792
    v_mfma_f32_16x16x32_bf16 a[80:83], v[80:83], a[128:131], a[80:83]
    buffer_load_dwordx4 v248, s[40:43], s66 offen offset:0 lds
    v_mfma_f32_16x16x32_bf16 a[80:83], v[84:87], a[132:135], a[80:83]
    ds_read_b64_tr_b16 v[112:113], v239 offset:224
    ds_read_b64_tr_b16 v[114:115], v239 offset:480
    v_mfma_f32_16x16x32_bf16 a[80:83], v[88:91], a[136:139], a[80:83]
    ds_read_b64_tr_b16 v[116:117], v239 offset:736
    v_mfma_f32_16x16x32_bf16 a[80:83], v[92:95], a[140:143], a[80:83]
    ds_read_b64_tr_b16 v[118:119], v239 offset:992
    v_mfma_f32_16x16x32_bf16 a[84:87], v[80:83], a[144:147], a[84:87]
    ds_read_b64_tr_b16 v[120:121], v239 offset:17120
    v_mfma_f32_16x16x32_bf16 a[84:87], v[84:87], a[148:151], a[84:87]
    buffer_load_dwordx4 v249, s[40:43], s66 offen offset:1056 lds
    v_mfma_f32_16x16x32_bf16 a[84:87], v[88:91], a[152:155], a[84:87]
    ds_read_b64_tr_b16 v[122:123], v239 offset:17376
    ds_read_b64_tr_b16 v[124:125], v239 offset:17632
    v_mfma_f32_16x16x32_bf16 a[84:87], v[92:95], a[156:159], a[84:87]
    ds_read_b64_tr_b16 v[126:127], v239 offset:17888
    v_mfma_f32_16x16x32_bf16 a[88:91], v[80:83], a[160:163], a[88:91]
    v_mfma_f32_16x16x32_bf16 a[88:91], v[84:87], a[164:167], a[88:91]
    v_mfma_f32_16x16x32_bf16 a[88:91], v[88:91], a[168:171], a[88:91]
    buffer_load_dwordx4 v250, s[40:43], s66 offen offset:2112 lds
    v_mfma_f32_16x16x32_bf16 a[88:91], v[92:95], a[172:175], a[88:91]
    v_mfma_f32_16x16x32_bf16 a[92:95], v[80:83], a[176:179], a[92:95]
    v_mfma_f32_16x16x32_bf16 a[92:95], v[84:87], a[180:183], a[92:95]
    v_mfma_f32_16x16x32_bf16 a[92:95], v[88:91], a[184:187], a[92:95]
    v_mfma_f32_16x16x32_bf16 a[92:95], v[92:95], a[188:191], a[92:95]
    buffer_load_dwordx4 v251, s[40:43], s66 offen offset:3168 lds
    s_waitcnt lgkmcnt(0)
    v_mfma_f32_16x16x32_bf16 a[96:99], v[96:99], a[128:131], a[96:99]
    s_add_u32 s66, s66, 131072
    v_mfma_f32_16x16x32_bf16 a[96:99], v[100:103], a[132:135], a[96:99]
    v_mfma_f32_16x16x32_bf16 a[96:99], v[104:107], a[136:139], a[96:99]
    v_mfma_f32_16x16x32_bf16 a[96:99], v[108:111], a[140:143], a[96:99]
    s_add_u32 m0, s53, 50688
    v_mfma_f32_16x16x32_bf16 a[100:103], v[96:99], a[144:147], a[100:103]
    s_waitcnt vmcnt(44) lgkmcnt(0)
    s_barrier
    v_mfma_f32_16x16x32_bf16 a[100:103], v[100:103], a[148:151], a[100:103]
    buffer_load_dwordx4 v248, s[40:43], s66 offen offset:0 lds
    v_mfma_f32_16x16x32_bf16 a[100:103], v[104:107], a[152:155], a[100:103]
    ds_read_b64_tr_b16 v[64:65], v239 offset:33792
    ds_read_b64_tr_b16 v[66:67], v239 offset:34048
    v_mfma_f32_16x16x32_bf16 a[100:103], v[108:111], a[156:159], a[100:103]
    ds_read_b64_tr_b16 v[68:69], v239 offset:34304
    v_mfma_f32_16x16x32_bf16 a[104:107], v[96:99], a[160:163], a[104:107]
    ds_read_b64_tr_b16 v[70:71], v239 offset:34560
    v_mfma_f32_16x16x32_bf16 a[104:107], v[100:103], a[164:167], a[104:107]
    buffer_load_dwordx4 v249, s[40:43], s66 offen offset:1056 lds
    v_mfma_f32_16x16x32_bf16 a[104:107], v[104:107], a[168:171], a[104:107]
    ds_read_b64_tr_b16 v[72:73], v239 offset:50688
    ds_read_b64_tr_b16 v[74:75], v239 offset:50944
    v_mfma_f32_16x16x32_bf16 a[104:107], v[108:111], a[172:175], a[104:107]
    ds_read_b64_tr_b16 v[76:77], v239 offset:51200
    v_mfma_f32_16x16x32_bf16 a[108:111], v[96:99], a[176:179], a[108:111]
    ds_read_b64_tr_b16 v[78:79], v239 offset:51456
    v_mfma_f32_16x16x32_bf16 a[108:111], v[100:103], a[180:183], a[108:111]
    v_mfma_f32_16x16x32_bf16 a[108:111], v[104:107], a[184:187], a[108:111]
    buffer_load_dwordx4 v250, s[40:43], s66 offen offset:2112 lds
    v_mfma_f32_16x16x32_bf16 a[108:111], v[108:111], a[188:191], a[108:111]
    v_mfma_f32_16x16x32_bf16 a[112:115], v[112:115], a[128:131], a[112:115]
    v_mfma_f32_16x16x32_bf16 a[112:115], v[116:119], a[132:135], a[112:115]
    ds_read_b64_tr_b16 v[80:81], v239 offset:33824
    v_mfma_f32_16x16x32_bf16 a[112:115], v[120:123], a[136:139], a[112:115]
    ds_read_b64_tr_b16 v[82:83], v239 offset:34080
    v_mfma_f32_16x16x32_bf16 a[112:115], v[124:127], a[140:143], a[112:115]
    buffer_load_dwordx4 v251, s[40:43], s66 offen offset:3168 lds
    v_mfma_f32_16x16x32_bf16 a[116:119], v[112:115], a[144:147], a[116:119]
    ds_read_b64_tr_b16 v[84:85], v239 offset:34336
    s_add_u32 s66, s66, 131072
    v_mfma_f32_16x16x32_bf16 a[116:119], v[116:119], a[148:151], a[116:119]
    ds_read_b64_tr_b16 v[86:87], v239 offset:34592
    ds_read_b64_tr_b16 v[88:89], v239 offset:50720
    v_mfma_f32_16x16x32_bf16 a[116:119], v[120:123], a[152:155], a[116:119]
    ds_read_b64_tr_b16 v[90:91], v239 offset:50976
    v_mfma_f32_16x16x32_bf16 a[116:119], v[124:127], a[156:159], a[116:119]
    ds_read_b64_tr_b16 v[92:93], v239 offset:51232
    v_mfma_f32_16x16x32_bf16 a[120:123], v[112:115], a[160:163], a[120:123]
    ds_read_b64_tr_b16 v[94:95], v239 offset:51488
    v_mfma_f32_16x16x32_bf16 a[120:123], v[116:119], a[164:167], a[120:123]
    v_mfma_f32_16x16x32_bf16 a[120:123], v[120:123], a[168:171], a[120:123]
    v_mfma_f32_16x16x32_bf16 a[120:123], v[124:127], a[172:175], a[120:123]
    v_mfma_f32_16x16x32_bf16 a[124:127], v[112:115], a[176:179], a[124:127]
    v_mfma_f32_16x16x32_bf16 a[124:127], v[116:119], a[180:183], a[124:127]
    v_mfma_f32_16x16x32_bf16 a[124:127], v[120:123], a[184:187], a[124:127]
    v_mfma_f32_16x16x32_bf16 a[124:127], v[124:127], a[188:191], a[124:127]
    s_waitcnt vmcnt(8)
    s_waitcnt lgkmcnt(0)
    v_mfma_f32_16x16x32_bf16 a[0:3], v[64:67], a[192:195], a[0:3]
    ds_read_b64_tr_b16 v[96:97], v239 offset:33856
    v_mfma_f32_16x16x32_bf16 a[0:3], v[68:71], a[196:199], a[0:3]
    buffer_load_dwordx4 a[128:131], v48, s[24:27], s48 offen offset:0 sc1
    v_mfma_f32_16x16x32_bf16 a[0:3], v[72:75], a[200:203], a[0:3]
    ds_read_b64_tr_b16 v[98:99], v239 offset:34112
    ds_read_b64_tr_b16 v[100:101], v239 offset:34368
    v_mfma_f32_16x16x32_bf16 a[0:3], v[76:79], a[204:207], a[0:3]
    ds_read_b64_tr_b16 v[102:103], v239 offset:34624
    v_mfma_f32_16x16x32_bf16 a[4:7], v[64:67], a[208:211], a[4:7]
    ds_read_b64_tr_b16 v[104:105], v239 offset:50752
    v_mfma_f32_16x16x32_bf16 a[4:7], v[68:71], a[212:215], a[4:7]
    buffer_load_dwordx4 a[132:135], v48, s[24:27], s48 offen offset:1024 sc1
    v_mfma_f32_16x16x32_bf16 a[4:7], v[72:75], a[216:219], a[4:7]
    ds_read_b64_tr_b16 v[106:107], v239 offset:51008
    ds_read_b64_tr_b16 v[108:109], v239 offset:51264
    v_mfma_f32_16x16x32_bf16 a[4:7], v[76:79], a[220:223], a[4:7]
    ds_read_b64_tr_b16 v[110:111], v239 offset:51520
    v_mfma_f32_16x16x32_bf16 a[8:11], v[64:67], a[224:227], a[8:11]
    v_mfma_f32_16x16x32_bf16 a[8:11], v[68:71], a[228:231], a[8:11]
    v_mfma_f32_16x16x32_bf16 a[8:11], v[72:75], a[232:235], a[8:11]
    buffer_load_dwordx4 a[136:139], v48, s[24:27], s48 offen offset:2048 sc1
    v_mfma_f32_16x16x32_bf16 a[8:11], v[76:79], a[236:239], a[8:11]
    v_mfma_f32_16x16x32_bf16 a[12:15], v[64:67], a[240:243], a[12:15]
    v_mfma_f32_16x16x32_bf16 a[12:15], v[68:71], a[244:247], a[12:15]
    v_mfma_f32_16x16x32_bf16 a[12:15], v[72:75], a[248:251], a[12:15]
    v_mfma_f32_16x16x32_bf16 a[12:15], v[76:79], a[252:255], a[12:15]
    buffer_load_dwordx4 a[140:143], v48, s[24:27], s48 offen offset:3072 sc1
    v_mfma_f32_16x16x32_bf16 a[16:19], v[80:83], a[192:195], a[16:19]
    ds_read_b64_tr_b16 v[112:113], v239 offset:33888
    v_mfma_f32_16x16x32_bf16 a[16:19], v[84:87], a[196:199], a[16:19]
    ds_read_b64_tr_b16 v[114:115], v239 offset:34144
    v_mfma_f32_16x16x32_bf16 a[16:19], v[88:91], a[200:203], a[16:19]
    ds_read_b64_tr_b16 v[116:117], v239 offset:34400
    v_mfma_f32_16x16x32_bf16 a[16:19], v[92:95], a[204:207], a[16:19]
    ds_read_b64_tr_b16 v[118:119], v239 offset:34656
    v_mfma_f32_16x16x32_bf16 a[20:23], v[80:83], a[208:211], a[20:23]
    buffer_load_dwordx4 a[144:147], v49, s[24:27], s48 offen offset:0 sc1
    v_mfma_f32_16x16x32_bf16 a[20:23], v[84:87], a[212:215], a[20:23]
    ds_read_b64_tr_b16 v[120:121], v239 offset:50784
    ds_read_b64_tr_b16 v[122:123], v239 offset:51040
    v_mfma_f32_16x16x32_bf16 a[20:23], v[88:91], a[216:219], a[20:23]
    ds_read_b64_tr_b16 v[124:125], v239 offset:51296
    v_mfma_f32_16x16x32_bf16 a[20:23], v[92:95], a[220:223], a[20:23]
    ds_read_b64_tr_b16 v[126:127], v239 offset:51552
    v_mfma_f32_16x16x32_bf16 a[24:27], v[80:83], a[224:227], a[24:27]
    buffer_load_dwordx4 a[148:151], v49, s[24:27], s48 offen offset:1024 sc1
    v_mfma_f32_16x16x32_bf16 a[24:27], v[84:87], a[228:231], a[24:27]
    v_mfma_f32_16x16x32_bf16 a[24:27], v[88:91], a[232:235], a[24:27]
    v_mfma_f32_16x16x32_bf16 a[24:27], v[92:95], a[236:239], a[24:27]
    v_mfma_f32_16x16x32_bf16 a[28:31], v[80:83], a[240:243], a[28:31]
    v_mfma_f32_16x16x32_bf16 a[28:31], v[84:87], a[244:247], a[28:31]
    buffer_load_dwordx4 a[152:155], v49, s[24:27], s48 offen offset:2048 sc1
    v_mfma_f32_16x16x32_bf16 a[28:31], v[88:91], a[248:251], a[28:31]
    v_mfma_f32_16x16x32_bf16 a[28:31], v[92:95], a[252:255], a[28:31]
    s_waitcnt lgkmcnt(0)
    v_mfma_f32_16x16x32_bf16 a[32:35], v[96:99], a[192:195], a[32:35]
    ds_read_b64_tr_b16 v[64:65], v239 offset:33920
    v_mfma_f32_16x16x32_bf16 a[32:35], v[100:103], a[196:199], a[32:35]
    ds_read_b64_tr_b16 v[66:67], v239 offset:34176
    v_mfma_f32_16x16x32_bf16 a[32:35], v[104:107], a[200:203], a[32:35]
    buffer_load_dwordx4 a[156:159], v49, s[24:27], s48 offen offset:3072 sc1
    v_mfma_f32_16x16x32_bf16 a[32:35], v[108:111], a[204:207], a[32:35]
    ds_read_b64_tr_b16 v[68:69], v239 offset:34432
    ds_read_b64_tr_b16 v[70:71], v239 offset:34688
    v_mfma_f32_16x16x32_bf16 a[36:39], v[96:99], a[208:211], a[36:39]
    ds_read_b64_tr_b16 v[72:73], v239 offset:50816
    v_mfma_f32_16x16x32_bf16 a[36:39], v[100:103], a[212:215], a[36:39]
    ds_read_b64_tr_b16 v[74:75], v239 offset:51072
    v_mfma_f32_16x16x32_bf16 a[36:39], v[104:107], a[216:219], a[36:39]
    ds_read_b64_tr_b16 v[76:77], v239 offset:51328
    v_mfma_f32_16x16x32_bf16 a[36:39], v[108:111], a[220:223], a[36:39]
    ds_read_b64_tr_b16 v[78:79], v239 offset:51584
    v_mfma_f32_16x16x32_bf16 a[40:43], v[96:99], a[224:227], a[40:43]
    buffer_load_dwordx4 a[160:163], v50, s[24:27], s48 offen offset:0 sc1
    v_mfma_f32_16x16x32_bf16 a[40:43], v[100:103], a[228:231], a[40:43]
    v_mfma_f32_16x16x32_bf16 a[40:43], v[104:107], a[232:235], a[40:43]
    v_mfma_f32_16x16x32_bf16 a[40:43], v[108:111], a[236:239], a[40:43]
    buffer_load_dwordx4 a[164:167], v50, s[24:27], s48 offen offset:1024 sc1
    v_mfma_f32_16x16x32_bf16 a[44:47], v[96:99], a[240:243], a[44:47]
    v_mfma_f32_16x16x32_bf16 a[44:47], v[100:103], a[244:247], a[44:47]
    v_mfma_f32_16x16x32_bf16 a[44:47], v[104:107], a[248:251], a[44:47]
    v_mfma_f32_16x16x32_bf16 a[44:47], v[108:111], a[252:255], a[44:47]
    v_mfma_f32_16x16x32_bf16 a[48:51], v[112:115], a[192:195], a[48:51]
    buffer_load_dwordx4 a[168:171], v50, s[24:27], s48 offen offset:2048 sc1
    v_mfma_f32_16x16x32_bf16 a[48:51], v[116:119], a[196:199], a[48:51]
    ds_read_b64_tr_b16 v[80:81], v239 offset:33952
    ds_read_b64_tr_b16 v[82:83], v239 offset:34208
    v_mfma_f32_16x16x32_bf16 a[48:51], v[120:123], a[200:203], a[48:51]
    ds_read_b64_tr_b16 v[84:85], v239 offset:34464
    v_mfma_f32_16x16x32_bf16 a[48:51], v[124:127], a[204:207], a[48:51]
    ds_read_b64_tr_b16 v[86:87], v239 offset:34720
    v_mfma_f32_16x16x32_bf16 a[52:55], v[112:115], a[208:211], a[52:55]
    ds_read_b64_tr_b16 v[88:89], v239 offset:50848
    v_mfma_f32_16x16x32_bf16 a[52:55], v[116:119], a[212:215], a[52:55]
    buffer_load_dwordx4 a[172:175], v50, s[24:27], s48 offen offset:3072 sc1
    v_mfma_f32_16x16x32_bf16 a[52:55], v[120:123], a[216:219], a[52:55]
    ds_read_b64_tr_b16 v[90:91], v239 offset:51104
    ds_read_b64_tr_b16 v[92:93], v239 offset:51360
    v_mfma_f32_16x16x32_bf16 a[52:55], v[124:127], a[220:223], a[52:55]
    ds_read_b64_tr_b16 v[94:95], v239 offset:51616
    v_mfma_f32_16x16x32_bf16 a[56:59], v[112:115], a[224:227], a[56:59]
    v_mfma_f32_16x16x32_bf16 a[56:59], v[116:119], a[228:231], a[56:59]
    v_mfma_f32_16x16x32_bf16 a[56:59], v[120:123], a[232:235], a[56:59]
    buffer_load_dwordx4 a[176:179], v51, s[24:27], s48 offen offset:0 sc1
    v_mfma_f32_16x16x32_bf16 a[56:59], v[124:127], a[236:239], a[56:59]
    v_mfma_f32_16x16x32_bf16 a[60:63], v[112:115], a[240:243], a[60:63]
    v_mfma_f32_16x16x32_bf16 a[60:63], v[116:119], a[244:247], a[60:63]
    v_mfma_f32_16x16x32_bf16 a[60:63], v[120:123], a[248:251], a[60:63]
    buffer_load_dwordx4 a[180:183], v51, s[24:27], s48 offen offset:1024 sc1
    v_mfma_f32_16x16x32_bf16 a[60:63], v[124:127], a[252:255], a[60:63]
    s_waitcnt lgkmcnt(0)
    v_mfma_f32_16x16x32_bf16 a[64:67], v[64:67], a[192:195], a[64:67]
    ds_read_b64_tr_b16 v[96:97], v239 offset:33984
    v_mfma_f32_16x16x32_bf16 a[64:67], v[68:71], a[196:199], a[64:67]
    ds_read_b64_tr_b16 v[98:99], v239 offset:34240
    v_mfma_f32_16x16x32_bf16 a[64:67], v[72:75], a[200:203], a[64:67]
    ds_read_b64_tr_b16 v[100:101], v239 offset:34496
    v_mfma_f32_16x16x32_bf16 a[64:67], v[76:79], a[204:207], a[64:67]
    buffer_load_dwordx4 a[184:187], v51, s[24:27], s48 offen offset:2048 sc1
    v_mfma_f32_16x16x32_bf16 a[68:71], v[64:67], a[208:211], a[68:71]
    ds_read_b64_tr_b16 v[102:103], v239 offset:34752
    ds_read_b64_tr_b16 v[104:105], v239 offset:50880
    v_mfma_f32_16x16x32_bf16 a[68:71], v[68:71], a[212:215], a[68:71]
    ds_read_b64_tr_b16 v[106:107], v239 offset:51136
    v_mfma_f32_16x16x32_bf16 a[68:71], v[72:75], a[216:219], a[68:71]
    ds_read_b64_tr_b16 v[108:109], v239 offset:51392
    v_mfma_f32_16x16x32_bf16 a[68:71], v[76:79], a[220:223], a[68:71]
    ds_read_b64_tr_b16 v[110:111], v239 offset:51648
    v_mfma_f32_16x16x32_bf16 a[72:75], v[64:67], a[224:227], a[72:75]
    buffer_load_dwordx4 a[188:191], v51, s[24:27], s48 offen offset:3072 sc1
    v_mfma_f32_16x16x32_bf16 a[72:75], v[68:71], a[228:231], a[72:75]
    s_add_u32 s48, s48, 4096
    v_mfma_f32_16x16x32_bf16 a[72:75], v[72:75], a[232:235], a[72:75]
    v_mfma_f32_16x16x32_bf16 a[72:75], v[76:79], a[236:239], a[72:75]
    v_mfma_f32_16x16x32_bf16 a[76:79], v[64:67], a[240:243], a[76:79]
    v_mfma_f32_16x16x32_bf16 a[76:79], v[68:71], a[244:247], a[76:79]
    buffer_load_dword v254, v240, s[36:39], s98 offen offset:128 sc1
    v_mfma_f32_16x16x32_bf16 a[76:79], v[72:75], a[248:251], a[76:79]
    v_mfma_f32_16x16x32_bf16 a[76:79], v[76:79], a[252:255], a[76:79]
    v_mfma_f32_16x16x32_bf16 a[80:83], v[80:83], a[192:195], a[80:83]
    ds_read_b64_tr_b16 v[112:113], v239 offset:34016
    s_add_u32 m0, s53, 67584
    v_mfma_f32_16x16x32_bf16 a[80:83], v[84:87], a[196:199], a[80:83]
    buffer_load_dwordx4 v248, s[40:43], s66 offen offset:0 lds
    v_mfma_f32_16x16x32_bf16 a[80:83], v[88:91], a[200:203], a[80:83]
    ds_read_b64_tr_b16 v[114:115], v239 offset:34272
    ds_read_b64_tr_b16 v[116:117], v239 offset:34528
    v_mfma_f32_16x16x32_bf16 a[80:83], v[92:95], a[204:207], a[80:83]
    ds_read_b64_tr_b16 v[118:119], v239 offset:34784
    v_mfma_f32_16x16x32_bf16 a[84:87], v[80:83], a[208:211], a[84:87]
    ds_read_b64_tr_b16 v[120:121], v239 offset:50912
    v_mfma_f32_16x16x32_bf16 a[84:87], v[84:87], a[212:215], a[84:87]
    ds_read_b64_tr_b16 v[122:123], v239 offset:51168
    v_mfma_f32_16x16x32_bf16 a[84:87], v[88:91], a[216:219], a[84:87]
    ds_read_b64_tr_b16 v[124:125], v239 offset:51424
    v_mfma_f32_16x16x32_bf16 a[84:87], v[92:95], a[220:223], a[84:87]
    buffer_load_dwordx4 v249, s[40:43], s66 offen offset:1056 lds
    v_mfma_f32_16x16x32_bf16 a[88:91], v[80:83], a[224:227], a[88:91]
    ds_read_b64_tr_b16 v[126:127], v239 offset:51680
    v_mfma_f32_16x16x32_bf16 a[88:91], v[84:87], a[228:231], a[88:91]
    v_mfma_f32_16x16x32_bf16 a[88:91], v[88:91], a[232:235], a[88:91]
    v_mfma_f32_16x16x32_bf16 a[88:91], v[92:95], a[236:239], a[88:91]
    buffer_load_dwordx4 v250, s[40:43], s66 offen offset:2112 lds
    v_mfma_f32_16x16x32_bf16 a[92:95], v[80:83], a[240:243], a[92:95]
    v_mfma_f32_16x16x32_bf16 a[92:95], v[84:87], a[244:247], a[92:95]
    v_mfma_f32_16x16x32_bf16 a[92:95], v[88:91], a[248:251], a[92:95]
    v_mfma_f32_16x16x32_bf16 a[92:95], v[92:95], a[252:255], a[92:95]
    s_waitcnt lgkmcnt(0)
    v_mfma_f32_16x16x32_bf16 a[96:99], v[96:99], a[192:195], a[96:99]
    buffer_load_dwordx4 v251, s[40:43], s66 offen offset:3168 lds
    v_mfma_f32_16x16x32_bf16 a[96:99], v[100:103], a[196:199], a[96:99]
    s_add_u32 s66, s66, 131072
    v_mfma_f32_16x16x32_bf16 a[96:99], v[104:107], a[200:203], a[96:99]
    v_mfma_f32_16x16x32_bf16 a[96:99], v[108:111], a[204:207], a[96:99]
    s_add_u32 m0, s53, 84480
    v_mfma_f32_16x16x32_bf16 a[100:103], v[96:99], a[208:211], a[100:103]
    s_waitcnt vmcnt(45) lgkmcnt(0)
    s_barrier
    v_mfma_f32_16x16x32_bf16 a[100:103], v[100:103], a[212:215], a[100:103]
    buffer_load_dwordx4 v248, s[40:43], s66 offen offset:0 lds
    v_mfma_f32_16x16x32_bf16 a[100:103], v[104:107], a[216:219], a[100:103]
    ds_read_b64_tr_b16 v[64:65], v238 offset:0
    ds_read_b64_tr_b16 v[66:67], v238 offset:256
    v_mfma_f32_16x16x32_bf16 a[100:103], v[108:111], a[220:223], a[100:103]
    ds_read_b64_tr_b16 v[68:69], v238 offset:512
    v_mfma_f32_16x16x32_bf16 a[104:107], v[96:99], a[224:227], a[104:107]
    ds_read_b64_tr_b16 v[70:71], v238 offset:768
    v_mfma_f32_16x16x32_bf16 a[104:107], v[100:103], a[228:231], a[104:107]
    buffer_load_dwordx4 v249, s[40:43], s66 offen offset:1056 lds
    v_mfma_f32_16x16x32_bf16 a[104:107], v[104:107], a[232:235], a[104:107]
    ds_read_b64_tr_b16 v[72:73], v238 offset:16896
    ds_read_b64_tr_b16 v[74:75], v238 offset:17152
    v_mfma_f32_16x16x32_bf16 a[104:107], v[108:111], a[236:239], a[104:107]
    ds_read_b64_tr_b16 v[76:77], v238 offset:17408
    v_mfma_f32_16x16x32_bf16 a[108:111], v[96:99], a[240:243], a[108:111]
    ds_read_b64_tr_b16 v[78:79], v238 offset:17664
    v_mfma_f32_16x16x32_bf16 a[108:111], v[100:103], a[244:247], a[108:111]
    v_mfma_f32_16x16x32_bf16 a[108:111], v[104:107], a[248:251], a[108:111]
    buffer_load_dwordx4 v250, s[40:43], s66 offen offset:2112 lds
    v_mfma_f32_16x16x32_bf16 a[108:111], v[108:111], a[252:255], a[108:111]
    v_mfma_f32_16x16x32_bf16 a[112:115], v[112:115], a[192:195], a[112:115]
    v_mfma_f32_16x16x32_bf16 a[112:115], v[116:119], a[196:199], a[112:115]
    ds_read_b64_tr_b16 v[80:81], v238 offset:32
    v_mfma_f32_16x16x32_bf16 a[112:115], v[120:123], a[200:203], a[112:115]
    ds_read_b64_tr_b16 v[82:83], v238 offset:288
    v_mfma_f32_16x16x32_bf16 a[112:115], v[124:127], a[204:207], a[112:115]
    buffer_load_dwordx4 v251, s[40:43], s66 offen offset:3168 lds
    v_mfma_f32_16x16x32_bf16 a[116:119], v[112:115], a[208:211], a[116:119]
    ds_read_b64_tr_b16 v[84:85], v238 offset:544
    s_add_u32 s66, s66, 131072
    v_mfma_f32_16x16x32_bf16 a[116:119], v[116:119], a[212:215], a[116:119]
    ds_read_b64_tr_b16 v[86:87], v238 offset:800
    ds_read_b64_tr_b16 v[88:89], v238 offset:16928
    v_mfma_f32_16x16x32_bf16 a[116:119], v[120:123], a[216:219], a[116:119]
    ds_read_b64_tr_b16 v[90:91], v238 offset:17184
    v_mfma_f32_16x16x32_bf16 a[116:119], v[124:127], a[220:223], a[116:119]
    ds_read_b64_tr_b16 v[92:93], v238 offset:17440
    v_mfma_f32_16x16x32_bf16 a[120:123], v[112:115], a[224:227], a[120:123]
    ds_read_b64_tr_b16 v[94:95], v238 offset:17696
    v_mfma_f32_16x16x32_bf16 a[120:123], v[116:119], a[228:231], a[120:123]
    v_mfma_f32_16x16x32_bf16 a[120:123], v[120:123], a[232:235], a[120:123]
    v_mfma_f32_16x16x32_bf16 a[120:123], v[124:127], a[236:239], a[120:123]
    v_mfma_f32_16x16x32_bf16 a[124:127], v[112:115], a[240:243], a[124:127]
    v_mfma_f32_16x16x32_bf16 a[124:127], v[116:119], a[244:247], a[124:127]
    v_mfma_f32_16x16x32_bf16 a[124:127], v[120:123], a[248:251], a[124:127]
    v_mfma_f32_16x16x32_bf16 a[124:127], v[124:127], a[252:255], a[124:127]
    s_waitcnt vmcnt(9)
    s_waitcnt lgkmcnt(0)
    v_mfma_f32_16x16x32_bf16 a[0:3], v[64:67], a[128:131], a[0:3]
    ds_read_b64_tr_b16 v[96:97], v238 offset:64
    v_mfma_f32_16x16x32_bf16 a[0:3], v[68:71], a[132:135], a[0:3]
    ds_read_b64_tr_b16 v[98:99], v238 offset:320
    v_mfma_f32_16x16x32_bf16 a[0:3], v[72:75], a[136:139], a[0:3]
    ds_read_b64_tr_b16 v[100:101], v238 offset:576
    v_mfma_f32_16x16x32_bf16 a[0:3], v[76:79], a[140:143], a[0:3]
    ds_read_b64_tr_b16 v[102:103], v238 offset:832
    v_mfma_f32_16x16x32_bf16 a[4:7], v[64:67], a[144:147], a[4:7]
    ds_read_b64_tr_b16 v[104:105], v238 offset:16960
    v_mfma_f32_16x16x32_bf16 a[4:7], v[68:71], a[148:151], a[4:7]
    s_waitcnt vmcnt(8)
    v_cmp_eq_u32 vcc, 1, v254
    s_nop 0
    s_and_b32 s58, vcc_lo, -1
    s_cmp_eq_u32 s58, -1
    s_cbranch_scc0 L_gto
L_gto_ret:
    s_add_u32 s58, s56, 1
    s_and_b32 s58, s58, 3
    s_lshl2_add_u32 s58, s99, s58
    s_mul_i32 s58, s58, 131072
    v_add_u32 v48, s58, v243
    s_add_u32 s58, s56, 2
    s_and_b32 s58, s58, 3
    s_lshl2_add_u32 s58, s99, s58
    s_mul_i32 s58, s58, 131072
    v_add_u32 v49, s58, v243
    s_add_u32 s58, s56, 3
    s_and_b32 s58, s58, 3
    s_lshl2_add_u32 s58, s99, s58
    s_mul_i32 s58, s58, 131072
    v_add_u32 v50, s58, v243
    s_add_u32 s58, s56, 4
    s_and_b32 s58, s58, 3
    s_lshl2_add_u32 s58, s99, s58
    s_mul_i32 s58, s58, 131072
    v_add_u32 v51, s58, v243
    v_mfma_f32_16x16x32_bf16 a[4:7], v[72:75], a[152:155], a[4:7]
    buffer_load_dwordx4 a[192:195], v48, s[28:31], s50 offen offset:0 sc1
    v_mfma_f32_16x16x32_bf16 a[4:7], v[76:79], a[156:159], a[4:7]
    buffer_load_dwordx4 a[196:199], v48, s[28:31], s50 offen offset:1024 sc1
    v_mfma_f32_16x16x32_bf16 a[8:11], v[64:67], a[160:163], a[8:11]
    ds_read_b64_tr_b16 v[106:107], v238 offset:17216
    ds_read_b64_tr_b16 v[108:109], v238 offset:17472
    v_mfma_f32_16x16x32_bf16 a[8:11], v[68:71], a[164:167], a[8:11]
    ds_read_b64_tr_b16 v[110:111], v238 offset:17728
    v_mfma_f32_16x16x32_bf16 a[8:11], v[72:75], a[168:171], a[8:11]
    buffer_load_dwordx4 a[200:203], v48, s[28:31], s50 offen offset:2048 sc1
    v_mfma_f32_16x16x32_bf16 a[8:11], v[76:79], a[172:175], a[8:11]
    v_mfma_f32_16x16x32_bf16 a[12:15], v[64:67], a[176:179], a[12:15]
    v_mfma_f32_16x16x32_bf16 a[12:15], v[68:71], a[180:183], a[12:15]
    v_mfma_f32_16x16x32_bf16 a[12:15], v[72:75], a[184:187], a[12:15]
    v_mfma_f32_16x16x32_bf16 a[12:15], v[76:79], a[188:191], a[12:15]
    buffer_load_dwordx4 a[204:207], v48, s[28:31], s50 offen offset:3072 sc1
    v_mfma_f32_16x16x32_bf16 a[16:19], v[80:83], a[128:131], a[16:19]
    ds_read_b64_tr_b16 v[112:113], v238 offset:96
    v_mfma_f32_16x16x32_bf16 a[16:19], v[84:87], a[132:135], a[16:19]
    ds_read_b64_tr_b16 v[114:115], v238 offset:352
    v_mfma_f32_16x16x32_bf16 a[16:19], v[88:91], a[136:139], a[16:19]
    ds_read_b64_tr_b16 v[116:117], v238 offset:608
    v_mfma_f32_16x16x32_bf16 a[16:19], v[92:95], a[140:143], a[16:19]
    ds_read_b64_tr_b16 v[118:119], v238 offset:864
    v_mfma_f32_16x16x32_bf16 a[20:23], v[80:83], a[144:147], a[20:23]
    buffer_load_dwordx4 a[208:211], v49, s[28:31], s50 offen offset:0 sc1
    v_mfma_f32_16x16x32_bf16 a[20:23], v[84:87], a[148:151], a[20:23]
    ds_read_b64_tr_b16 v[120:121], v238 offset:16992
    ds_read_b64_tr_b16 v[122:123], v238 offset:17248
    v_mfma_f32_16x16x32_bf16 a[20:23], v[88:91], a[152:155], a[20:23]
    ds_read_b64_tr_b16 v[124:125], v238 offset:17504
    v_mfma_f32_16x16x32_bf16 a[20:23], v[92:95], a[156:159], a[20:23]
    ds_read_b64_tr_b16 v[126:127], v238 offset:17760
    v_mfma_f32_16x16x32_bf16 a[24:27], v[80:83], a[160:163], a[24:27]
    v_accvgpr_read_b32 v224, a0
    v_accvgpr_read_b32 v225, a1
    v_mfma_f32_16x16x32_bf16 a[24:27], v[84:87], a[164:167], a[24:27]
    v_cvt_pk_bf16_f32 v0, v224, v225
    v_mfma_f32_16x16x32_bf16 a[24:27], v[88:91], a[168:171], a[24:27]
    buffer_load_dwordx4 a[212:215], v49, s[28:31], s50 offen offset:1024 sc1
    v_mfma_f32_16x16x32_bf16 a[24:27], v[92:95], a[172:175], a[24:27]
    v_mfma_f32_16x16x32_bf16 a[28:31], v[80:83], a[176:179], a[28:31]
    v_mfma_f32_16x16x32_bf16 a[28:31], v[84:87], a[180:183], a[28:31]
    v_mfma_f32_16x16x32_bf16 a[28:31], v[88:91], a[184:187], a[28:31]
    buffer_load_dwordx4 a[216:219], v49, s[28:31], s50 offen offset:2048 sc1
    v_mfma_f32_16x16x32_bf16 a[28:31], v[92:95], a[188:191], a[28:31]
    s_waitcnt lgkmcnt(0)
    v_mfma_f32_16x16x32_bf16 a[32:35], v[96:99], a[128:131], a[32:35]
    ds_read_b64_tr_b16 v[64:65], v238 offset:128
    v_mfma_f32_16x16x32_bf16 a[32:35], v[100:103], a[132:135], a[32:35]
    v_accvgpr_read_b32 v226, a2
    v_accvgpr_read_b32 v227, a3
    v_mfma_f32_16x16x32_bf16 a[32:35], v[104:107], a[136:139], a[32:35]
    ds_read_b64_tr_b16 v[66:67], v238 offset:384
    v_cvt_pk_bf16_f32 v1, v226, v227
    v_mfma_f32_16x16x32_bf16 a[32:35], v[108:111], a[140:143], a[32:35]
    buffer_load_dwordx4 a[220:223], v49, s[28:31], s50 offen offset:3072 sc1
    v_mfma_f32_16x16x32_bf16 a[36:39], v[96:99], a[144:147], a[36:39]
    ds_read_b64_tr_b16 v[68:69], v238 offset:640
    ds_read_b64_tr_b16 v[70:71], v238 offset:896
    v_mfma_f32_16x16x32_bf16 a[36:39], v[100:103], a[148:151], a[36:39]
    ds_read_b64_tr_b16 v[72:73], v238 offset:17024
    ds_read_b64_tr_b16 v[74:75], v238 offset:17280
    v_mfma_f32_16x16x32_bf16 a[36:39], v[104:107], a[152:155], a[36:39]
    ds_read_b64_tr_b16 v[76:77], v238 offset:17536
    v_mfma_f32_16x16x32_bf16 a[36:39], v[108:111], a[156:159], a[36:39]
    ds_read_b64_tr_b16 v[78:79], v238 offset:17792
    v_mfma_f32_16x16x32_bf16 a[40:43], v[96:99], a[160:163], a[40:43]
    buffer_load_dwordx4 a[224:227], v50, s[28:31], s50 offen offset:0 sc1
    v_mfma_f32_16x16x32_bf16 a[40:43], v[100:103], a[164:167], a[40:43]
    v_mfma_f32_16x16x32_bf16 a[40:43], v[104:107], a[168:171], a[40:43]
    v_mfma_f32_16x16x32_bf16 a[40:43], v[108:111], a[172:175], a[40:43]
    v_accvgpr_read_b32 v228, a4
    v_accvgpr_read_b32 v229, a5
    v_mfma_f32_16x16x32_bf16 a[44:47], v[96:99], a[176:179], a[44:47]
    v_cvt_pk_bf16_f32 v16, v228, v229
    v_accvgpr_read_b32 v228, a16
    v_accvgpr_read_b32 v229, a17
    v_mfma_f32_16x16x32_bf16 a[44:47], v[100:103], a[180:183], a[44:47]
    v_cvt_pk_bf16_f32 v2, v228, v229
    v_mfma_f32_16x16x32_bf16 a[44:47], v[104:107], a[184:187], a[44:47]
    buffer_load_dwordx4 a[228:231], v50, s[28:31], s50 offen offset:1024 sc1
    v_mfma_f32_16x16x32_bf16 a[44:47], v[108:111], a[188:191], a[44:47]
    v_mfma_f32_16x16x32_bf16 a[48:51], v[112:115], a[128:131], a[48:51]
    ds_read_b64_tr_b16 v[80:81], v238 offset:160
    v_mfma_f32_16x16x32_bf16 a[48:51], v[116:119], a[132:135], a[48:51]
    ds_read_b64_tr_b16 v[82:83], v238 offset:416
    v_mfma_f32_16x16x32_bf16 a[48:51], v[120:123], a[136:139], a[48:51]
    buffer_load_dwordx4 a[232:235], v50, s[28:31], s50 offen offset:2048 sc1
    v_mfma_f32_16x16x32_bf16 a[48:51], v[124:127], a[140:143], a[48:51]
    ds_read_b64_tr_b16 v[84:85], v238 offset:672
    ds_read_b64_tr_b16 v[86:87], v238 offset:928
    v_mfma_f32_16x16x32_bf16 a[52:55], v[112:115], a[144:147], a[52:55]
    ds_read_b64_tr_b16 v[88:89], v238 offset:17056
    v_mfma_f32_16x16x32_bf16 a[52:55], v[116:119], a[148:151], a[52:55]
    v_accvgpr_read_b32 v230, a6
    v_accvgpr_read_b32 v231, a7
    v_mfma_f32_16x16x32_bf16 a[52:55], v[120:123], a[152:155], a[52:55]
    v_cvt_pk_bf16_f32 v17, v230, v231
    v_accvgpr_read_b32 v230, a18
    v_accvgpr_read_b32 v231, a19
    v_mfma_f32_16x16x32_bf16 a[52:55], v[124:127], a[156:159], a[52:55]
    ds_read_b64_tr_b16 v[90:91], v238 offset:17312
    v_cvt_pk_bf16_f32 v3, v230, v231
    v_mfma_f32_16x16x32_bf16 a[56:59], v[112:115], a[160:163], a[56:59]
    ds_read_b64_tr_b16 v[92:93], v238 offset:17568
    ds_read_b64_tr_b16 v[94:95], v238 offset:17824
    v_mfma_f32_16x16x32_bf16 a[56:59], v[116:119], a[164:167], a[56:59]
    buffer_load_dwordx4 a[236:239], v50, s[28:31], s50 offen offset:3072 sc1
    v_mfma_f32_16x16x32_bf16 a[56:59], v[120:123], a[168:171], a[56:59]
    v_mfma_f32_16x16x32_bf16 a[56:59], v[124:127], a[172:175], a[56:59]
    v_mfma_f32_16x16x32_bf16 a[60:63], v[112:115], a[176:179], a[60:63]
    buffer_load_dwordx4 a[240:243], v51, s[28:31], s50 offen offset:0 sc1
    v_mfma_f32_16x16x32_bf16 a[60:63], v[116:119], a[180:183], a[60:63]
    v_mfma_f32_16x16x32_bf16 a[60:63], v[120:123], a[184:187], a[60:63]
    v_mfma_f32_16x16x32_bf16 a[60:63], v[124:127], a[188:191], a[60:63]
    v_accvgpr_read_b32 v224, a8
    v_accvgpr_read_b32 v225, a9
    s_waitcnt lgkmcnt(0)
    v_mfma_f32_16x16x32_bf16 a[64:67], v[64:67], a[128:131], a[64:67]
    v_cvt_pk_bf16_f32 v32, v224, v225
    v_accvgpr_read_b32 v224, a20
    v_accvgpr_read_b32 v225, a21
    v_mfma_f32_16x16x32_bf16 a[64:67], v[68:71], a[132:135], a[64:67]
    v_cvt_pk_bf16_f32 v18, v224, v225
    v_accvgpr_read_b32 v224, a32
    v_accvgpr_read_b32 v225, a33
    v_mfma_f32_16x16x32_bf16 a[64:67], v[72:75], a[136:139], a[64:67]
    ds_read_b64_tr_b16 v[96:97], v238 offset:192
    v_cvt_pk_bf16_f32 v4, v224, v225
    v_mfma_f32_16x16x32_bf16 a[64:67], v[76:79], a[140:143], a[64:67]
    buffer_load_dwordx4 a[244:247], v51, s[28:31], s50 offen offset:1024 sc1
    v_mfma_f32_16x16x32_bf16 a[68:71], v[64:67], a[144:147], a[68:71]
    ds_read_b64_tr_b16 v[98:99], v238 offset:448
    ds_read_b64_tr_b16 v[100:101], v238 offset:704
    v_mfma_f32_16x16x32_bf16 a[68:71], v[68:71], a[148:151], a[68:71]
    ds_read_b64_tr_b16 v[102:103], v238 offset:960
    ds_read_b64_tr_b16 v[104:105], v238 offset:17088
    v_mfma_f32_16x16x32_bf16 a[68:71], v[72:75], a[152:155], a[68:71]
    ds_read_b64_tr_b16 v[106:107], v238 offset:17344
    ds_read_b64_tr_b16 v[108:109], v238 offset:17600
    v_mfma_f32_16x16x32_bf16 a[68:71], v[76:79], a[156:159], a[68:71]
    buffer_load_dwordx4 a[248:251], v51, s[28:31], s50 offen offset:2048 sc1
    v_mfma_f32_16x16x32_bf16 a[72:75], v[64:67], a[160:163], a[72:75]
    ds_read_b64_tr_b16 v[110:111], v238 offset:17856
    v_mfma_f32_16x16x32_bf16 a[72:75], v[68:71], a[164:167], a[72:75]
    v_accvgpr_read_b32 v226, a10
    v_accvgpr_read_b32 v227, a11
    v_mfma_f32_16x16x32_bf16 a[72:75], v[72:75], a[168:171], a[72:75]
    v_cvt_pk_bf16_f32 v33, v226, v227
    v_accvgpr_read_b32 v226, a22
    v_accvgpr_read_b32 v227, a23
    v_mfma_f32_16x16x32_bf16 a[72:75], v[76:79], a[172:175], a[72:75]
    v_cvt_pk_bf16_f32 v19, v226, v227
    v_accvgpr_read_b32 v226, a34
    v_accvgpr_read_b32 v227, a35
    v_mfma_f32_16x16x32_bf16 a[76:79], v[64:67], a[176:179], a[76:79]
    v_cvt_pk_bf16_f32 v5, v226, v227
    v_mfma_f32_16x16x32_bf16 a[76:79], v[68:71], a[180:183], a[76:79]
    buffer_load_dwordx4 a[252:255], v51, s[28:31], s50 offen offset:3072 sc1
    v_mfma_f32_16x16x32_bf16 a[76:79], v[72:75], a[184:187], a[76:79]
    s_add_u32 s50, s50, 4096
    v_mfma_f32_16x16x32_bf16 a[76:79], v[76:79], a[188:191], a[76:79]
    v_accvgpr_read_b32 v228, a24
    v_accvgpr_read_b32 v229, a25
    v_mfma_f32_16x16x32_bf16 a[80:83], v[80:83], a[128:131], a[80:83]
    s_add_u32 m0, s53, 101376
    v_cvt_pk_bf16_f32 v34, v228, v229
    v_accvgpr_read_b32 v228, a36
    v_accvgpr_read_b32 v229, a37
    v_mfma_f32_16x16x32_bf16 a[80:83], v[84:87], a[132:135], a[80:83]
    v_cvt_pk_bf16_f32 v20, v228, v229
    v_accvgpr_read_b32 v228, a48
    v_accvgpr_read_b32 v229, a49
    v_mfma_f32_16x16x32_bf16 a[80:83], v[88:91], a[136:139], a[80:83]
    ds_read_b64_tr_b16 v[112:113], v238 offset:224
    v_cvt_pk_bf16_f32 v6, v228, v229
    v_mfma_f32_16x16x32_bf16 a[80:83], v[92:95], a[140:143], a[80:83]
    buffer_load_dwordx4 v248, s[40:43], s66 offen offset:0 lds
    v_mfma_f32_16x16x32_bf16 a[84:87], v[80:83], a[144:147], a[84:87]
    ds_read_b64_tr_b16 v[114:115], v238 offset:480
    v_accvgpr_read_b32 v128, a12
    v_mfma_f32_16x16x32_bf16 a[84:87], v[84:87], a[148:151], a[84:87]
    buffer_load_dwordx4 v249, s[40:43], s66 offen offset:1056 lds
    v_mfma_f32_16x16x32_bf16 a[84:87], v[88:91], a[152:155], a[84:87]
    ds_read_b64_tr_b16 v[116:117], v238 offset:736
    ds_read_b64_tr_b16 v[118:119], v238 offset:992
    v_mfma_f32_16x16x32_bf16 a[84:87], v[92:95], a[156:159], a[84:87]
    ds_read_b64_tr_b16 v[120:121], v238 offset:17120
    ds_read_b64_tr_b16 v[122:123], v238 offset:17376
    v_mfma_f32_16x16x32_bf16 a[88:91], v[80:83], a[160:163], a[88:91]
    ds_read_b64_tr_b16 v[124:125], v238 offset:17632
    ds_read_b64_tr_b16 v[126:127], v238 offset:17888
    v_mfma_f32_16x16x32_bf16 a[88:91], v[84:87], a[164:167], a[88:91]
    v_accvgpr_read_b32 v230, a26
    v_accvgpr_read_b32 v231, a27
    v_mfma_f32_16x16x32_bf16 a[88:91], v[88:91], a[168:171], a[88:91]
    v_cvt_pk_bf16_f32 v35, v230, v231
    v_accvgpr_read_b32 v230, a38
    v_accvgpr_read_b32 v231, a39
    v_mfma_f32_16x16x32_bf16 a[88:91], v[92:95], a[172:175], a[88:91]
    v_cvt_pk_bf16_f32 v21, v230, v231
    v_accvgpr_read_b32 v230, a50
    v_accvgpr_read_b32 v231, a51
    v_mfma_f32_16x16x32_bf16 a[92:95], v[80:83], a[176:179], a[92:95]
    v_cvt_pk_bf16_f32 v7, v230, v231
    v_mfma_f32_16x16x32_bf16 a[92:95], v[84:87], a[180:183], a[92:95]
    buffer_load_dwordx4 v250, s[40:43], s66 offen offset:2112 lds
    v_mfma_f32_16x16x32_bf16 a[92:95], v[88:91], a[184:187], a[92:95]
    v_accvgpr_read_b32 v129, a13
    v_mfma_f32_16x16x32_bf16 a[92:95], v[92:95], a[188:191], a[92:95]
    v_accvgpr_read_b32 v224, a40
    v_accvgpr_read_b32 v225, a41
    s_waitcnt lgkmcnt(0)
    v_mfma_f32_16x16x32_bf16 a[96:99], v[96:99], a[128:131], a[96:99]
    buffer_load_dwordx4 v251, s[40:43], s66 offen offset:3168 lds
    v_mfma_f32_16x16x32_bf16 a[96:99], v[100:103], a[132:135], a[96:99]
    v_cvt_pk_bf16_f32 v36, v224, v225
    v_accvgpr_read_b32 v224, a52
    v_accvgpr_read_b32 v225, a53
    v_mfma_f32_16x16x32_bf16 a[96:99], v[104:107], a[136:139], a[96:99]
    v_cvt_pk_bf16_f32 v22, v224, v225
    v_accvgpr_read_b32 v224, a64
    v_accvgpr_read_b32 v225, a65
    v_mfma_f32_16x16x32_bf16 a[96:99], v[108:111], a[140:143], a[96:99]
    s_add_u32 s66, s66, 131072
    v_cvt_pk_bf16_f32 v8, v224, v225
    v_mfma_f32_16x16x32_bf16 a[100:103], v[96:99], a[144:147], a[100:103]
    s_waitcnt vmcnt(45) lgkmcnt(0)
    s_barrier
    v_mfma_f32_16x16x32_bf16 a[100:103], v[100:103], a[148:151], a[100:103]
    s_add_u32 m0, s53, 118272
    v_accvgpr_read_b32 v132, a28
    v_mfma_f32_16x16x32_bf16 a[100:103], v[104:107], a[152:155], a[100:103]
    buffer_load_dwordx4 v248, s[40:43], s66 offen offset:0 lds
    v_mfma_f32_16x16x32_bf16 a[100:103], v[108:111], a[156:159], a[100:103]
    ds_read_b64_tr_b16 v[64:65], v238 offset:33792
    v_accvgpr_read_b32 v130, a14
    v_mfma_f32_16x16x32_bf16 a[104:107], v[96:99], a[160:163], a[104:107]
    ds_read_b64_tr_b16 v[66:67], v238 offset:34048
    ds_read_b64_tr_b16 v[68:69], v238 offset:34304
    v_mfma_f32_16x16x32_bf16 a[104:107], v[100:103], a[164:167], a[104:107]
    v_accvgpr_read_b32 v226, a42
    v_accvgpr_read_b32 v227, a43
    v_mfma_f32_16x16x32_bf16 a[104:107], v[104:107], a[168:171], a[104:107]
    buffer_load_dwordx4 v249, s[40:43], s66 offen offset:1056 lds
    v_mfma_f32_16x16x32_bf16 a[104:107], v[108:111], a[172:175], a[104:107]
    v_cvt_pk_bf16_f32 v37, v226, v227
    v_accvgpr_read_b32 v226, a54
    v_accvgpr_read_b32 v227, a55
    v_mfma_f32_16x16x32_bf16 a[108:111], v[96:99], a[176:179], a[108:111]
    v_cvt_pk_bf16_f32 v23, v226, v227
    v_accvgpr_read_b32 v226, a66
    v_accvgpr_read_b32 v227, a67
    v_mfma_f32_16x16x32_bf16 a[108:111], v[100:103], a[180:183], a[108:111]
    ds_read_b64_tr_b16 v[70:71], v238 offset:34560
    v_cvt_pk_bf16_f32 v9, v226, v227
    v_mfma_f32_16x16x32_bf16 a[108:111], v[104:107], a[184:187], a[108:111]
    ds_read_b64_tr_b16 v[72:73], v238 offset:50688
    ds_read_b64_tr_b16 v[74:75], v238 offset:50944
    v_mfma_f32_16x16x32_bf16 a[108:111], v[108:111], a[188:191], a[108:111]
    ds_read_b64_tr_b16 v[76:77], v238 offset:51200
    ds_read_b64_tr_b16 v[78:79], v238 offset:51456
    v_mfma_f32_16x16x32_bf16 a[112:115], v[112:115], a[128:131], a[112:115]
    v_accvgpr_read_b32 v133, a29
    v_accvgpr_read_b32 v228, a56
    v_mfma_f32_16x16x32_bf16 a[112:115], v[116:119], a[132:135], a[112:115]
    v_accvgpr_read_b32 v229, a57
    v_accvgpr_read_b32 v131, a15
    v_mfma_f32_16x16x32_bf16 a[112:115], v[120:123], a[136:139], a[112:115]
    buffer_load_dwordx4 v250, s[40:43], s66 offen offset:2112 lds
    v_mfma_f32_16x16x32_bf16 a[112:115], v[124:127], a[140:143], a[112:115]
    v_cvt_pk_bf16_f32 v38, v228, v229
    v_accvgpr_read_b32 v228, a68
    v_accvgpr_read_b32 v229, a69
    v_mfma_f32_16x16x32_bf16 a[116:119], v[112:115], a[144:147], a[116:119]
    v_cvt_pk_bf16_f32 v24, v228, v229
    v_accvgpr_read_b32 v228, a80
    v_accvgpr_read_b32 v229, a81
    v_mfma_f32_16x16x32_bf16 a[116:119], v[116:119], a[148:151], a[116:119]
    v_cvt_pk_bf16_f32 v10, v228, v229
    v_accvgpr_read_b32 v136, a44
    v_mfma_f32_16x16x32_bf16 a[116:119], v[120:123], a[152:155], a[116:119]
    buffer_load_dwordx4 v251, s[40:43], s66 offen offset:3168 lds
    v_mfma_f32_16x16x32_bf16 a[116:119], v[124:127], a[156:159], a[116:119]
    s_add_u32 s66, s66, 131072
    v_accvgpr_read_b32 v134, a30
    v_mfma_f32_16x16x32_bf16 a[120:123], v[112:115], a[160:163], a[120:123]
    ds_read_b64_tr_b16 v[80:81], v238 offset:33824
    ds_read_b64_tr_b16 v[82:83], v238 offset:34080
    v_mfma_f32_16x16x32_bf16 a[120:123], v[116:119], a[164:167], a[120:123]
    ds_read_b64_tr_b16 v[84:85], v238 offset:34336
    ds_read_b64_tr_b16 v[86:87], v238 offset:34592
    v_mfma_f32_16x16x32_bf16 a[120:123], v[120:123], a[168:171], a[120:123]
    ds_read_b64_tr_b16 v[88:89], v238 offset:50720
    ds_read_b64_tr_b16 v[90:91], v238 offset:50976
    v_mfma_f32_16x16x32_bf16 a[120:123], v[124:127], a[172:175], a[120:123]
    ds_read_b64_tr_b16 v[92:93], v238 offset:51232
    ds_read_b64_tr_b16 v[94:95], v238 offset:51488
    v_mfma_f32_16x16x32_bf16 a[124:127], v[112:115], a[176:179], a[124:127]
    v_accvgpr_read_b32 v230, a58
    v_accvgpr_read_b32 v231, a59
    v_mfma_f32_16x16x32_bf16 a[124:127], v[116:119], a[180:183], a[124:127]
    v_cvt_pk_bf16_f32 v39, v230, v231
    v_accvgpr_read_b32 v230, a70
    v_accvgpr_read_b32 v231, a71
    v_mfma_f32_16x16x32_bf16 a[124:127], v[120:123], a[184:187], a[124:127]
    v_cvt_pk_bf16_f32 v25, v230, v231
    v_accvgpr_read_b32 v230, a82
    v_accvgpr_read_b32 v231, a83
    v_mfma_f32_16x16x32_bf16 a[124:127], v[124:127], a[188:191], a[124:127]
    s_waitcnt vmcnt(8)
    v_cvt_pk_bf16_f32 v11, v230, v231
    s_waitcnt lgkmcnt(4)
    v_mfma_f32_16x16x32_bf16 a[0:3], v[64:67], a[192:195], 0
    v_accvgpr_read_b32 v137, a45
    v_accvgpr_read_b32 v224, a72
    v_mfma_f32_16x16x32_bf16 a[0:3], v[68:71], a[196:199], a[0:3]
    v_accvgpr_read_b32 v225, a73
    v_accvgpr_read_b32 v135, a31
    v_mfma_f32_16x16x32_bf16 a[0:3], v[72:75], a[200:203], a[0:3]
    v_cvt_pk_bf16_f32 v40, v224, v225
    v_accvgpr_read_b32 v224, a84
    v_accvgpr_read_b32 v225, a85
    v_mfma_f32_16x16x32_bf16 a[0:3], v[76:79], a[204:207], a[0:3]
    v_cvt_pk_bf16_f32 v26, v224, v225
    v_accvgpr_read_b32 v224, a96
    v_accvgpr_read_b32 v225, a97
    v_mfma_f32_16x16x32_bf16 a[4:7], v[64:67], a[208:211], 0
    v_cvt_pk_bf16_f32 v12, v224, v225
    v_accvgpr_read_b32 v140, a60
    v_mfma_f32_16x16x32_bf16 a[4:7], v[68:71], a[212:215], a[4:7]
    buffer_load_dwordx4 a[128:131], v48, s[28:31], s50 offen offset:0 sc1
    v_mfma_f32_16x16x32_bf16 a[4:7], v[72:75], a[216:219], a[4:7]
    buffer_load_dwordx4 a[132:135], v48, s[28:31], s50 offen offset:1024 sc1
    v_mfma_f32_16x16x32_bf16 a[4:7], v[76:79], a[220:223], a[4:7]
    ds_read_b64_tr_b16 v[96:97], v238 offset:33856
    v_accvgpr_read_b32 v138, a46
    v_mfma_f32_16x16x32_bf16 a[8:11], v[64:67], a[224:227], 0
    ds_read_b64_tr_b16 v[98:99], v238 offset:34112
    ds_read_b64_tr_b16 v[100:101], v238 offset:34368
    v_mfma_f32_16x16x32_bf16 a[8:11], v[68:71], a[228:231], a[8:11]
    ds_read_b64_tr_b16 v[102:103], v238 offset:34624
    ds_read_b64_tr_b16 v[104:105], v238 offset:50752
    v_mfma_f32_16x16x32_bf16 a[8:11], v[72:75], a[232:235], a[8:11]
    ds_read_b64_tr_b16 v[106:107], v238 offset:51008
    ds_read_b64_tr_b16 v[108:109], v238 offset:51264
    v_mfma_f32_16x16x32_bf16 a[8:11], v[76:79], a[236:239], a[8:11]
    ds_read_b64_tr_b16 v[110:111], v238 offset:51520
    v_accvgpr_read_b32 v226, a74
    v_mfma_f32_16x16x32_bf16 a[12:15], v[64:67], a[240:243], 0
    v_accvgpr_read_b32 v227, a75
    v_mfma_f32_16x16x32_bf16 a[12:15], v[68:71], a[244:247], a[12:15]
    v_cvt_pk_bf16_f32 v41, v226, v227
    v_accvgpr_read_b32 v226, a86
    v_accvgpr_read_b32 v227, a87
    v_mfma_f32_16x16x32_bf16 a[12:15], v[72:75], a[248:251], a[12:15]
    v_cvt_pk_bf16_f32 v27, v226, v227
    v_accvgpr_read_b32 v226, a98
    v_accvgpr_read_b32 v227, a99
    v_mfma_f32_16x16x32_bf16 a[12:15], v[76:79], a[252:255], a[12:15]
    v_cvt_pk_bf16_f32 v13, v226, v227
    v_accvgpr_read_b32 v141, a61
    v_mfma_f32_16x16x32_bf16 a[16:19], v[80:83], a[192:195], 0
    buffer_load_dwordx4 a[136:139], v48, s[28:31], s50 offen offset:2048 sc1
    v_mfma_f32_16x16x32_bf16 a[16:19], v[84:87], a[196:199], a[16:19]
    v_accvgpr_read_b32 v228, a88
    v_accvgpr_read_b32 v229, a89
    s_waitcnt lgkmcnt(0)
    v_mfma_f32_16x16x32_bf16 a[16:19], v[88:91], a[200:203], a[16:19]
    buffer_load_dwordx4 a[140:143], v48, s[28:31], s50 offen offset:3072 sc1
    v_mfma_f32_16x16x32_bf16 a[16:19], v[92:95], a[204:207], a[16:19]
    v_cvt_pk_bf16_f32 v42, v228, v229
    v_accvgpr_read_b32 v228, a100
    v_accvgpr_read_b32 v229, a101
    v_mfma_f32_16x16x32_bf16 a[20:23], v[80:83], a[208:211], 0
    v_cvt_pk_bf16_f32 v28, v228, v229
    v_accvgpr_read_b32 v228, a112
    v_accvgpr_read_b32 v229, a113
    v_mfma_f32_16x16x32_bf16 a[20:23], v[84:87], a[212:215], a[20:23]
    v_cvt_pk_bf16_f32 v14, v228, v229
    v_accvgpr_read_b32 v139, a47
    v_mfma_f32_16x16x32_bf16 a[20:23], v[88:91], a[216:219], a[20:23]
    ds_read_b64_tr_b16 v[112:113], v238 offset:33888
    v_accvgpr_read_b32 v144, a76
    v_mfma_f32_16x16x32_bf16 a[20:23], v[92:95], a[220:223], a[20:23]
    buffer_load_dwordx4 a[144:147], v49, s[28:31], s50 offen offset:0 sc1
    v_mfma_f32_16x16x32_bf16 a[24:27], v[80:83], a[224:227], 0
    ds_read_b64_tr_b16 v[114:115], v238 offset:34144
    v_accvgpr_read_b32 v142, a62
    v_mfma_f32_16x16x32_bf16 a[24:27], v[84:87], a[228:231], a[24:27]
    ds_read_b64_tr_b16 v[116:117], v238 offset:34400
    ds_read_b64_tr_b16 v[118:119], v238 offset:34656
    v_mfma_f32_16x16x32_bf16 a[24:27], v[88:91], a[232:235], a[24:27]
    ds_read_b64_tr_b16 v[120:121], v238 offset:50784
    ds_read_b64_tr_b16 v[122:123], v238 offset:51040
    v_mfma_f32_16x16x32_bf16 a[24:27], v[92:95], a[236:239], a[24:27]
    ds_read_b64_tr_b16 v[124:125], v238 offset:51296
    ds_read_b64_tr_b16 v[126:127], v238 offset:51552
    v_mfma_f32_16x16x32_bf16 a[28:31], v[80:83], a[240:243], 0
    v_accvgpr_read_b32 v230, a90
    v_accvgpr_read_b32 v231, a91
    v_mfma_f32_16x16x32_bf16 a[28:31], v[84:87], a[244:247], a[28:31]
    buffer_load_dwordx4 a[148:151], v49, s[28:31], s50 offen offset:1024 sc1
    v_mfma_f32_16x16x32_bf16 a[28:31], v[88:91], a[248:251], a[28:31]
    v_cvt_pk_bf16_f32 v43, v230, v231
    v_accvgpr_read_b32 v230, a102
    v_accvgpr_read_b32 v231, a103
    v_mfma_f32_16x16x32_bf16 a[28:31], v[92:95], a[252:255], a[28:31]
    v_cvt_pk_bf16_f32 v29, v230, v231
    v_accvgpr_read_b32 v230, a114
    v_accvgpr_read_b32 v231, a115
    v_mfma_f32_16x16x32_bf16 a[32:35], v[96:99], a[192:195], 0
    v_cvt_pk_bf16_f32 v15, v230, v231
    v_accvgpr_read_b32 v145, a77
    v_mfma_f32_16x16x32_bf16 a[32:35], v[100:103], a[196:199], a[32:35]
    v_accvgpr_read_b32 v224, a104
    v_accvgpr_read_b32 v225, a105
    v_mfma_f32_16x16x32_bf16 a[32:35], v[104:107], a[200:203], a[32:35]
    buffer_load_dwordx4 a[152:155], v49, s[28:31], s50 offen offset:2048 sc1
    v_mfma_f32_16x16x32_bf16 a[32:35], v[108:111], a[204:207], a[32:35]
    v_cvt_pk_bf16_f32 v44, v224, v225
    v_accvgpr_read_b32 v224, a116
    v_accvgpr_read_b32 v225, a117
    v_mfma_f32_16x16x32_bf16 a[36:39], v[96:99], a[208:211], 0
    v_cvt_pk_bf16_f32 v30, v224, v225
    v_accvgpr_read_b32 v143, a63
    v_mfma_f32_16x16x32_bf16 a[36:39], v[100:103], a[212:215], a[36:39]
    ds_read_b64_tr_b16 v[64:65], v238 offset:33920
    v_accvgpr_read_b32 v148, a92
    v_mfma_f32_16x16x32_bf16 a[36:39], v[104:107], a[216:219], a[36:39]
    buffer_load_dwordx4 a[156:159], v49, s[28:31], s50 offen offset:3072 sc1
    v_mfma_f32_16x16x32_bf16 a[36:39], v[108:111], a[220:223], a[36:39]
    ds_read_b64_tr_b16 v[66:67], v238 offset:34176
    v_accvgpr_read_b32 v146, a78
    v_mfma_f32_16x16x32_bf16 a[40:43], v[96:99], a[224:227], 0
    ds_read_b64_tr_b16 v[68:69], v238 offset:34432
    ds_read_b64_tr_b16 v[70:71], v238 offset:34688
    v_mfma_f32_16x16x32_bf16 a[40:43], v[100:103], a[228:231], a[40:43]
    ds_read_b64_tr_b16 v[72:73], v238 offset:50816
    ds_read_b64_tr_b16 v[74:75], v238 offset:51072
    v_mfma_f32_16x16x32_bf16 a[40:43], v[104:107], a[232:235], a[40:43]
    ds_read_b64_tr_b16 v[76:77], v238 offset:51328
    ds_read_b64_tr_b16 v[78:79], v238 offset:51584
    v_mfma_f32_16x16x32_bf16 a[40:43], v[108:111], a[236:239], a[40:43]
    v_accvgpr_read_b32 v226, a106
    v_accvgpr_read_b32 v227, a107
    v_mfma_f32_16x16x32_bf16 a[44:47], v[96:99], a[240:243], 0
    buffer_load_dwordx4 a[160:163], v50, s[28:31], s50 offen offset:0 sc1
    v_mfma_f32_16x16x32_bf16 a[44:47], v[100:103], a[244:247], a[44:47]
    v_cvt_pk_bf16_f32 v45, v226, v227
    v_accvgpr_read_b32 v226, a118
    v_accvgpr_read_b32 v227, a119
    v_mfma_f32_16x16x32_bf16 a[44:47], v[104:107], a[248:251], a[44:47]
    v_cvt_pk_bf16_f32 v31, v226, v227
    v_accvgpr_read_b32 v149, a93
    v_mfma_f32_16x16x32_bf16 a[44:47], v[108:111], a[252:255], a[44:47]
    buffer_load_dwordx4 a[164:167], v50, s[28:31], s50 offen offset:1024 sc1
    s_waitcnt lgkmcnt(2)
    v_mfma_f32_16x16x32_bf16 a[48:51], v[112:115], a[192:195], 0
    v_accvgpr_read_b32 v228, a120
    v_accvgpr_read_b32 v229, a121
    v_mfma_f32_16x16x32_bf16 a[48:51], v[116:119], a[196:199], a[48:51]
    v_cvt_pk_bf16_f32 v46, v228, v229
    v_accvgpr_read_b32 v147, a79
    v_mfma_f32_16x16x32_bf16 a[48:51], v[120:123], a[200:203], a[48:51]
    buffer_load_dwordx4 a[168:171], v50, s[28:31], s50 offen offset:2048 sc1
    v_mfma_f32_16x16x32_bf16 a[48:51], v[124:127], a[204:207], a[48:51]
    ds_read_b64_tr_b16 v[80:81], v238 offset:33952
    v_accvgpr_read_b32 v152, a108
    v_mfma_f32_16x16x32_bf16 a[52:55], v[112:115], a[208:211], 0
    ds_read_b64_tr_b16 v[82:83], v238 offset:34208
    ds_read_b64_tr_b16 v[84:85], v238 offset:34464
    v_mfma_f32_16x16x32_bf16 a[52:55], v[116:119], a[212:215], a[52:55]
    ds_read_b64_tr_b16 v[86:87], v238 offset:34720
    ds_read_b64_tr_b16 v[88:89], v238 offset:50848
    v_mfma_f32_16x16x32_bf16 a[52:55], v[120:123], a[216:219], a[52:55]
    ds_read_b64_tr_b16 v[90:91], v238 offset:51104
    ds_read_b64_tr_b16 v[92:93], v238 offset:51360
    v_mfma_f32_16x16x32_bf16 a[52:55], v[124:127], a[220:223], a[52:55]
    ds_read_b64_tr_b16 v[94:95], v238 offset:51616
    v_accvgpr_read_b32 v150, a94
    v_mfma_f32_16x16x32_bf16 a[56:59], v[112:115], a[224:227], 0
    buffer_load_dwordx4 a[172:175], v50, s[28:31], s50 offen offset:3072 sc1
    v_mfma_f32_16x16x32_bf16 a[56:59], v[116:119], a[228:231], a[56:59]
    v_accvgpr_read_b32 v230, a122
    v_accvgpr_read_b32 v231, a123
    v_mfma_f32_16x16x32_bf16 a[56:59], v[120:123], a[232:235], a[56:59]
    v_cvt_pk_bf16_f32 v47, v230, v231
    v_mfma_f32_16x16x32_bf16 a[56:59], v[124:127], a[236:239], a[56:59]
    v_mfma_f32_16x16x32_bf16 a[60:63], v[112:115], a[240:243], 0
    buffer_load_dwordx4 a[176:179], v51, s[28:31], s50 offen offset:0 sc1
    v_mfma_f32_16x16x32_bf16 a[60:63], v[116:119], a[244:247], a[60:63]
    v_accvgpr_read_b32 v153, a109
    v_mfma_f32_16x16x32_bf16 a[60:63], v[120:123], a[248:251], a[60:63]
    v_mfma_f32_16x16x32_bf16 a[60:63], v[124:127], a[252:255], a[60:63]
    v_mfma_f32_16x16x32_bf16 a[64:67], v[64:67], a[192:195], 0
    ds_read_b64_tr_b16 v[96:97], v238 offset:33984
    v_mfma_f32_16x16x32_bf16 a[64:67], v[68:71], a[196:199], a[64:67]
    ds_read_b64_tr_b16 v[98:99], v238 offset:34240
    v_accvgpr_read_b32 v151, a95
    v_mfma_f32_16x16x32_bf16 a[64:67], v[72:75], a[200:203], a[64:67]
    buffer_load_dwordx4 a[180:183], v51, s[28:31], s50 offen offset:1024 sc1
    s_waitcnt lgkmcnt(2)
    v_mfma_f32_16x16x32_bf16 a[64:67], v[76:79], a[204:207], a[64:67]
    ds_read_b64_tr_b16 v[100:101], v238 offset:34496
    v_accvgpr_read_b32 v156, a124
    v_mfma_f32_16x16x32_bf16 a[68:71], v[64:67], a[208:211], 0
    ds_read_b64_tr_b16 v[102:103], v238 offset:34752
    ds_read_b64_tr_b16 v[104:105], v238 offset:50880
    v_mfma_f32_16x16x32_bf16 a[68:71], v[68:71], a[212:215], a[68:71]
    ds_read_b64_tr_b16 v[106:107], v238 offset:51136
    v_mfma_f32_16x16x32_bf16 a[68:71], v[72:75], a[216:219], a[68:71]
    ds_read_b64_tr_b16 v[108:109], v238 offset:51392
    v_mfma_f32_16x16x32_bf16 a[68:71], v[76:79], a[220:223], a[68:71]
    ds_read_b64_tr_b16 v[110:111], v238 offset:51648
    v_accvgpr_read_b32 v154, a110
    v_mfma_f32_16x16x32_bf16 a[72:75], v[64:67], a[224:227], 0
    buffer_load_dwordx4 a[184:187], v51, s[28:31], s50 offen offset:2048 sc1
    v_mfma_f32_16x16x32_bf16 a[72:75], v[68:71], a[228:231], a[72:75]
    v_mfma_f32_16x16x32_bf16 a[72:75], v[72:75], a[232:235], a[72:75]
    v_mfma_f32_16x16x32_bf16 a[72:75], v[76:79], a[236:239], a[72:75]
    buffer_load_dwordx4 a[188:191], v51, s[28:31], s50 offen offset:3072 sc1
    v_mfma_f32_16x16x32_bf16 a[76:79], v[64:67], a[240:243], 0
    s_add_u32 s50, s50, 4096
    v_mfma_f32_16x16x32_bf16 a[76:79], v[68:71], a[244:247], a[76:79]
    v_accvgpr_read_b32 v157, a125
    v_mfma_f32_16x16x32_bf16 a[76:79], v[72:75], a[248:251], a[76:79]
    v_mfma_f32_16x16x32_bf16 a[76:79], v[76:79], a[252:255], a[76:79]
    s_add_u32 m0, s53, 0
    v_mfma_f32_16x16x32_bf16 a[80:83], v[80:83], a[192:195], 0
    buffer_load_dwordx4 v248, s[40:43], s66 offen offset:0 lds
    v_mfma_f32_16x16x32_bf16 a[80:83], v[84:87], a[196:199], a[80:83]
    ds_read_b64_tr_b16 v[112:113], v238 offset:34016
    v_accvgpr_read_b32 v155, a111
    v_mfma_f32_16x16x32_bf16 a[80:83], v[88:91], a[200:203], a[80:83]
    ds_read_b64_tr_b16 v[114:115], v238 offset:34272
    ds_read_b64_tr_b16 v[116:117], v238 offset:34528
    v_mfma_f32_16x16x32_bf16 a[80:83], v[92:95], a[204:207], a[80:83]
    ds_read_b64_tr_b16 v[118:119], v238 offset:34784
    v_mfma_f32_16x16x32_bf16 a[84:87], v[80:83], a[208:211], 0
    ds_read_b64_tr_b16 v[120:121], v238 offset:50912
    v_mfma_f32_16x16x32_bf16 a[84:87], v[84:87], a[212:215], a[84:87]
    buffer_load_dwordx4 v249, s[40:43], s66 offen offset:1056 lds
    v_mfma_f32_16x16x32_bf16 a[84:87], v[88:91], a[216:219], a[84:87]
    ds_read_b64_tr_b16 v[122:123], v238 offset:51168
    ds_read_b64_tr_b16 v[124:125], v238 offset:51424
    v_mfma_f32_16x16x32_bf16 a[84:87], v[92:95], a[220:223], a[84:87]
    ds_read_b64_tr_b16 v[126:127], v238 offset:51680
    v_accvgpr_read_b32 v158, a126
    v_mfma_f32_16x16x32_bf16 a[88:91], v[80:83], a[224:227], 0
    v_mfma_f32_16x16x32_bf16 a[88:91], v[84:87], a[228:231], a[88:91]
    v_mfma_f32_16x16x32_bf16 a[88:91], v[88:91], a[232:235], a[88:91]
    buffer_load_dwordx4 v250, s[40:43], s66 offen offset:2112 lds
    v_mfma_f32_16x16x32_bf16 a[88:91], v[92:95], a[236:239], a[88:91]
    v_mfma_f32_16x16x32_bf16 a[92:95], v[80:83], a[240:243], 0
    v_mfma_f32_16x16x32_bf16 a[92:95], v[84:87], a[244:247], a[92:95]
    v_mfma_f32_16x16x32_bf16 a[92:95], v[88:91], a[248:251], a[92:95]
    v_mfma_f32_16x16x32_bf16 a[92:95], v[92:95], a[252:255], a[92:95]
    buffer_load_dwordx4 v251, s[40:43], s66 offen offset:3168 lds
    s_waitcnt lgkmcnt(0)
    v_mfma_f32_16x16x32_bf16 a[96:99], v[96:99], a[192:195], 0
    s_add_u32 s66, s66, 131072
    v_mfma_f32_16x16x32_bf16 a[96:99], v[100:103], a[196:199], a[96:99]
    v_accvgpr_read_b32 v159, a127
    v_mfma_f32_16x16x32_bf16 a[96:99], v[104:107], a[200:203], a[96:99]
    v_mfma_f32_16x16x32_bf16 a[96:99], v[108:111], a[204:207], a[96:99]
    s_add_u32 m0, s53, 16896
    v_mfma_f32_16x16x32_bf16 a[100:103], v[96:99], a[208:211], 0
    s_waitcnt vmcnt(44) lgkmcnt(0)
    s_barrier
    v_mfma_f32_16x16x32_bf16 a[100:103], v[100:103], a[212:215], a[100:103]
    buffer_load_dwordx4 v248, s[40:43], s66 offen offset:0 lds
    v_mfma_f32_16x16x32_bf16 a[100:103], v[104:107], a[216:219], a[100:103]
    ds_read_b64_tr_b16 v[64:65], v239 offset:0
    ds_read_b64_tr_b16 v[66:67], v239 offset:256
    v_mfma_f32_16x16x32_bf16 a[100:103], v[108:111], a[220:223], a[100:103]
    ds_read_b64_tr_b16 v[68:69], v239 offset:512
    v_mfma_f32_16x16x32_bf16 a[104:107], v[96:99], a[224:227], 0
    ds_read_b64_tr_b16 v[70:71], v239 offset:768
    v_mfma_f32_16x16x32_bf16 a[104:107], v[100:103], a[228:231], a[104:107]
    buffer_load_dwordx4 v249, s[40:43], s66 offen offset:1056 lds
    v_mfma_f32_16x16x32_bf16 a[104:107], v[104:107], a[232:235], a[104:107]
    ds_read_b64_tr_b16 v[72:73], v239 offset:16896
    ds_read_b64_tr_b16 v[74:75], v239 offset:17152
    v_mfma_f32_16x16x32_bf16 a[104:107], v[108:111], a[236:239], a[104:107]
    ds_read_b64_tr_b16 v[76:77], v239 offset:17408
    v_mfma_f32_16x16x32_bf16 a[108:111], v[96:99], a[240:243], 0
    ds_read_b64_tr_b16 v[78:79], v239 offset:17664
    v_mfma_f32_16x16x32_bf16 a[108:111], v[100:103], a[244:247], a[108:111]
    v_mfma_f32_16x16x32_bf16 a[108:111], v[104:107], a[248:251], a[108:111]
    buffer_load_dwordx4 v250, s[40:43], s66 offen offset:2112 lds
    v_mfma_f32_16x16x32_bf16 a[108:111], v[108:111], a[252:255], a[108:111]
    v_mfma_f32_16x16x32_bf16 a[112:115], v[112:115], a[192:195], 0
    v_mfma_f32_16x16x32_bf16 a[112:115], v[116:119], a[196:199], a[112:115]
    ds_read_b64_tr_b16 v[80:81], v239 offset:32
    v_mfma_f32_16x16x32_bf16 a[112:115], v[120:123], a[200:203], a[112:115]
    ds_read_b64_tr_b16 v[82:83], v239 offset:288
    v_mfma_f32_16x16x32_bf16 a[112:115], v[124:127], a[204:207], a[112:115]
    buffer_load_dwordx4 v251, s[40:43], s66 offen offset:3168 lds
    v_mfma_f32_16x16x32_bf16 a[116:119], v[112:115], a[208:211], 0
    ds_read_b64_tr_b16 v[84:85], v239 offset:544
    s_add_u32 s66, s66, 131072
    v_mfma_f32_16x16x32_bf16 a[116:119], v[116:119], a[212:215], a[116:119]
    ds_read_b64_tr_b16 v[86:87], v239 offset:800
    ds_read_b64_tr_b16 v[88:89], v239 offset:16928
    v_mfma_f32_16x16x32_bf16 a[116:119], v[120:123], a[216:219], a[116:119]
    ds_read_b64_tr_b16 v[90:91], v239 offset:17184
    v_mfma_f32_16x16x32_bf16 a[116:119], v[124:127], a[220:223], a[116:119]
    ds_read_b64_tr_b16 v[92:93], v239 offset:17440
    v_mfma_f32_16x16x32_bf16 a[120:123], v[112:115], a[224:227], 0
    ds_read_b64_tr_b16 v[94:95], v239 offset:17696
    v_mfma_f32_16x16x32_bf16 a[120:123], v[116:119], a[228:231], a[120:123]
    v_mfma_f32_16x16x32_bf16 a[120:123], v[120:123], a[232:235], a[120:123]
    v_mfma_f32_16x16x32_bf16 a[120:123], v[124:127], a[236:239], a[120:123]
    v_mfma_f32_16x16x32_bf16 a[124:127], v[112:115], a[240:243], 0
    v_mfma_f32_16x16x32_bf16 a[124:127], v[116:119], a[244:247], a[124:127]
    v_mfma_f32_16x16x32_bf16 a[124:127], v[120:123], a[248:251], a[124:127]
    v_mfma_f32_16x16x32_bf16 a[124:127], v[124:127], a[252:255], a[124:127]
    s_waitcnt vmcnt(8)
    s_waitcnt lgkmcnt(0)
    v_mfma_f32_16x16x32_bf16 a[0:3], v[64:67], a[128:131], a[0:3]
    ds_read_b64_tr_b16 v[96:97], v239 offset:64
    v_mfma_f32_16x16x32_bf16 a[0:3], v[68:71], a[132:135], a[0:3]
    buffer_load_dwordx4 a[192:195], v48, s[28:31], s50 offen offset:0 sc1
    v_mfma_f32_16x16x32_bf16 a[0:3], v[72:75], a[136:139], a[0:3]
    ds_read_b64_tr_b16 v[98:99], v239 offset:320
    ds_read_b64_tr_b16 v[100:101], v239 offset:576
    v_mfma_f32_16x16x32_bf16 a[0:3], v[76:79], a[140:143], a[0:3]
    ds_read_b64_tr_b16 v[102:103], v239 offset:832
    v_mfma_f32_16x16x32_bf16 a[4:7], v[64:67], a[144:147], a[4:7]
    ds_read_b64_tr_b16 v[104:105], v239 offset:16960
    v_mfma_f32_16x16x32_bf16 a[4:7], v[68:71], a[148:151], a[4:7]
    buffer_load_dwordx4 a[196:199], v48, s[28:31], s50 offen offset:1024 sc1
    v_mfma_f32_16x16x32_bf16 a[4:7], v[72:75], a[152:155], a[4:7]
    ds_read_b64_tr_b16 v[106:107], v239 offset:17216
    ds_read_b64_tr_b16 v[108:109], v239 offset:17472
    v_mfma_f32_16x16x32_bf16 a[4:7], v[76:79], a[156:159], a[4:7]
    ds_read_b64_tr_b16 v[110:111], v239 offset:17728
    v_mfma_f32_16x16x32_bf16 a[8:11], v[64:67], a[160:163], a[8:11]
    v_mfma_f32_16x16x32_bf16 a[8:11], v[68:71], a[164:167], a[8:11]
    buffer_load_dwordx4 a[200:203], v48, s[28:31], s50 offen offset:2048 sc1
    v_mfma_f32_16x16x32_bf16 a[8:11], v[72:75], a[168:171], a[8:11]
    v_mfma_f32_16x16x32_bf16 a[8:11], v[76:79], a[172:175], a[8:11]
    v_mfma_f32_16x16x32_bf16 a[12:15], v[64:67], a[176:179], a[12:15]
    v_mfma_f32_16x16x32_bf16 a[12:15], v[68:71], a[180:183], a[12:15]
    v_mfma_f32_16x16x32_bf16 a[12:15], v[72:75], a[184:187], a[12:15]
    buffer_load_dwordx4 a[204:207], v48, s[28:31], s50 offen offset:3072 sc1
    v_mfma_f32_16x16x32_bf16 a[12:15], v[76:79], a[188:191], a[12:15]
    v_mfma_f32_16x16x32_bf16 a[16:19], v[80:83], a[128:131], a[16:19]
    ds_read_b64_tr_b16 v[112:113], v239 offset:96
    v_mfma_f32_16x16x32_bf16 a[16:19], v[84:87], a[132:135], a[16:19]
    ds_read_b64_tr_b16 v[114:115], v239 offset:352
    v_mfma_f32_16x16x32_bf16 a[16:19], v[88:91], a[136:139], a[16:19]
    buffer_load_dwordx4 a[208:211], v49, s[28:31], s50 offen offset:0 sc1
    v_mfma_f32_16x16x32_bf16 a[16:19], v[92:95], a[140:143], a[16:19]
    ds_read_b64_tr_b16 v[116:117], v239 offset:608
    ds_read_b64_tr_b16 v[118:119], v239 offset:864
    v_mfma_f32_16x16x32_bf16 a[20:23], v[80:83], a[144:147], a[20:23]
    ds_read_b64_tr_b16 v[120:121], v239 offset:16992
    v_mfma_f32_16x16x32_bf16 a[20:23], v[84:87], a[148:151], a[20:23]
    ds_read_b64_tr_b16 v[122:123], v239 offset:17248
    v_mfma_f32_16x16x32_bf16 a[20:23], v[88:91], a[152:155], a[20:23]
    ds_read_b64_tr_b16 v[124:125], v239 offset:17504
    v_mfma_f32_16x16x32_bf16 a[20:23], v[92:95], a[156:159], a[20:23]
    ds_read_b64_tr_b16 v[126:127], v239 offset:17760
    v_mfma_f32_16x16x32_bf16 a[24:27], v[80:83], a[160:163], a[24:27]
    buffer_load_dwordx4 a[212:215], v49, s[28:31], s50 offen offset:1024 sc1
    v_mfma_f32_16x16x32_bf16 a[24:27], v[84:87], a[164:167], a[24:27]
    v_mfma_f32_16x16x32_bf16 a[24:27], v[88:91], a[168:171], a[24:27]
    v_mfma_f32_16x16x32_bf16 a[24:27], v[92:95], a[172:175], a[24:27]
    buffer_load_dwordx4 a[216:219], v49, s[28:31], s50 offen offset:2048 sc1
    v_mfma_f32_16x16x32_bf16 a[28:31], v[80:83], a[176:179], a[28:31]
    v_mfma_f32_16x16x32_bf16 a[28:31], v[84:87], a[180:183], a[28:31]
    v_mfma_f32_16x16x32_bf16 a[28:31], v[88:91], a[184:187], a[28:31]
    v_mfma_f32_16x16x32_bf16 a[28:31], v[92:95], a[188:191], a[28:31]
    buffer_load_dwordx4 a[220:223], v49, s[28:31], s50 offen offset:3072 sc1
    s_waitcnt lgkmcnt(0)
    v_mfma_f32_16x16x32_bf16 a[32:35], v[96:99], a[128:131], a[32:35]
    ds_read_b64_tr_b16 v[64:65], v239 offset:128
    v_mfma_f32_16x16x32_bf16 a[32:35], v[100:103], a[132:135], a[32:35]
    ds_read_b64_tr_b16 v[66:67], v239 offset:384
    v_mfma_f32_16x16x32_bf16 a[32:35], v[104:107], a[136:139], a[32:35]
    ds_read_b64_tr_b16 v[68:69], v239 offset:640
    v_mfma_f32_16x16x32_bf16 a[32:35], v[108:111], a[140:143], a[32:35]
    ds_read_b64_tr_b16 v[70:71], v239 offset:896
    v_mfma_f32_16x16x32_bf16 a[36:39], v[96:99], a[144:147], a[36:39]
    buffer_load_dwordx4 a[224:227], v50, s[28:31], s50 offen offset:0 sc1
    v_mfma_f32_16x16x32_bf16 a[36:39], v[100:103], a[148:151], a[36:39]
    ds_read_b64_tr_b16 v[72:73], v239 offset:17024
    ds_read_b64_tr_b16 v[74:75], v239 offset:17280
    v_mfma_f32_16x16x32_bf16 a[36:39], v[104:107], a[152:155], a[36:39]
    ds_read_b64_tr_b16 v[76:77], v239 offset:17536
    v_mfma_f32_16x16x32_bf16 a[36:39], v[108:111], a[156:159], a[36:39]
    ds_read_b64_tr_b16 v[78:79], v239 offset:17792
    v_mfma_f32_16x16x32_bf16 a[40:43], v[96:99], a[160:163], a[40:43]
    buffer_load_dwordx4 a[228:231], v50, s[28:31], s50 offen offset:1024 sc1
    v_mfma_f32_16x16x32_bf16 a[40:43], v[100:103], a[164:167], a[40:43]
    v_mfma_f32_16x16x32_bf16 a[40:43], v[104:107], a[168:171], a[40:43]
    v_mfma_f32_16x16x32_bf16 a[40:43], v[108:111], a[172:175], a[40:43]
    v_mfma_f32_16x16x32_bf16 a[44:47], v[96:99], a[176:179], a[44:47]
    v_mfma_f32_16x16x32_bf16 a[44:47], v[100:103], a[180:183], a[44:47]
    buffer_load_dwordx4 a[232:235], v50, s[28:31], s50 offen offset:2048 sc1
    v_mfma_f32_16x16x32_bf16 a[44:47], v[104:107], a[184:187], a[44:47]
    v_mfma_f32_16x16x32_bf16 a[44:47], v[108:111], a[188:191], a[44:47]
    v_mfma_f32_16x16x32_bf16 a[48:51], v[112:115], a[128:131], a[48:51]
    ds_read_b64_tr_b16 v[80:81], v239 offset:160
    v_mfma_f32_16x16x32_bf16 a[48:51], v[116:119], a[132:135], a[48:51]
    buffer_load_dwordx4 a[236:239], v50, s[28:31], s50 offen offset:3072 sc1
    v_mfma_f32_16x16x32_bf16 a[48:51], v[120:123], a[136:139], a[48:51]
    ds_read_b64_tr_b16 v[82:83], v239 offset:416
    ds_read_b64_tr_b16 v[84:85], v239 offset:672
    v_mfma_f32_16x16x32_bf16 a[48:51], v[124:127], a[140:143], a[48:51]
    ds_read_b64_tr_b16 v[86:87], v239 offset:928
    v_mfma_f32_16x16x32_bf16 a[52:55], v[112:115], a[144:147], a[52:55]
    ds_read_b64_tr_b16 v[88:89], v239 offset:17056
    v_mfma_f32_16x16x32_bf16 a[52:55], v[116:119], a[148:151], a[52:55]
    buffer_load_dwordx4 a[240:243], v51, s[28:31], s50 offen offset:0 sc1
    v_mfma_f32_16x16x32_bf16 a[52:55], v[120:123], a[152:155], a[52:55]
    ds_read_b64_tr_b16 v[90:91], v239 offset:17312
    ds_read_b64_tr_b16 v[92:93], v239 offset:17568
    v_mfma_f32_16x16x32_bf16 a[52:55], v[124:127], a[156:159], a[52:55]
    ds_read_b64_tr_b16 v[94:95], v239 offset:17824
    v_mfma_f32_16x16x32_bf16 a[56:59], v[112:115], a[160:163], a[56:59]
    v_mfma_f32_16x16x32_bf16 a[56:59], v[116:119], a[164:167], a[56:59]
    v_mfma_f32_16x16x32_bf16 a[56:59], v[120:123], a[168:171], a[56:59]
    buffer_load_dwordx4 a[244:247], v51, s[28:31], s50 offen offset:1024 sc1
    v_mfma_f32_16x16x32_bf16 a[56:59], v[124:127], a[172:175], a[56:59]
    v_mfma_f32_16x16x32_bf16 a[60:63], v[112:115], a[176:179], a[60:63]
    v_mfma_f32_16x16x32_bf16 a[60:63], v[116:119], a[180:183], a[60:63]
    v_mfma_f32_16x16x32_bf16 a[60:63], v[120:123], a[184:187], a[60:63]
    buffer_load_dwordx4 a[248:251], v51, s[28:31], s50 offen offset:2048 sc1
    v_mfma_f32_16x16x32_bf16 a[60:63], v[124:127], a[188:191], a[60:63]
    s_waitcnt lgkmcnt(0)
    v_mfma_f32_16x16x32_bf16 a[64:67], v[64:67], a[128:131], a[64:67]
    ds_read_b64_tr_b16 v[96:97], v239 offset:192
    v_mfma_f32_16x16x32_bf16 a[64:67], v[68:71], a[132:135], a[64:67]
    ds_read_b64_tr_b16 v[98:99], v239 offset:448
    v_mfma_f32_16x16x32_bf16 a[64:67], v[72:75], a[136:139], a[64:67]
    ds_read_b64_tr_b16 v[100:101], v239 offset:704
    v_mfma_f32_16x16x32_bf16 a[64:67], v[76:79], a[140:143], a[64:67]
    buffer_load_dwordx4 a[252:255], v51, s[28:31], s50 offen offset:3072 sc1
    v_mfma_f32_16x16x32_bf16 a[68:71], v[64:67], a[144:147], a[68:71]
    ds_read_b64_tr_b16 v[102:103], v239 offset:960
    s_add_u32 s50, s50, 4096
    v_mfma_f32_16x16x32_bf16 a[68:71], v[68:71], a[148:151], a[68:71]
    ds_read_b64_tr_b16 v[104:105], v239 offset:17088
    ds_read_b64_tr_b16 v[106:107], v239 offset:17344
    v_mfma_f32_16x16x32_bf16 a[68:71], v[72:75], a[152:155], a[68:71]
    ds_read_b64_tr_b16 v[108:109], v239 offset:17600
    s_mov_b32 s61, 0
    v_mfma_f32_16x16x32_bf16 a[68:71], v[76:79], a[156:159], a[68:71]
    ds_read_b64_tr_b16 v[110:111], v239 offset:17856
    v_mfma_f32_16x16x32_bf16 a[72:75], v[64:67], a[160:163], a[72:75]
    buffer_store_dwordx4 v[0:3], v255, s[4:7], s61 offen offset:0 sc1
    v_mfma_f32_16x16x32_bf16 a[72:75], v[68:71], a[164:167], a[72:75]
    v_mfma_f32_16x16x32_bf16 a[72:75], v[72:75], a[168:171], a[72:75]
    s_mov_b32 s61, 0
    v_mfma_f32_16x16x32_bf16 a[72:75], v[76:79], a[172:175], a[72:75]
    buffer_store_dwordx4 v[4:7], v255, s[4:7], s61 offen offset:1024 sc1
    v_mfma_f32_16x16x32_bf16 a[76:79], v[64:67], a[176:179], a[76:79]
    v_mfma_f32_16x16x32_bf16 a[76:79], v[68:71], a[180:183], a[76:79]
    v_mfma_f32_16x16x32_bf16 a[76:79], v[72:75], a[184:187], a[76:79]
    v_mfma_f32_16x16x32_bf16 a[76:79], v[76:79], a[188:191], a[76:79]
    s_mov_b32 s61, 0
    v_mfma_f32_16x16x32_bf16 a[80:83], v[80:83], a[128:131], a[80:83]
    buffer_store_dwordx4 v[8:11], v255, s[4:7], s61 offen offset:2048 sc1
    v_mfma_f32_16x16x32_bf16 a[80:83], v[84:87], a[132:135], a[80:83]
    ds_read_b64_tr_b16 v[112:113], v239 offset:224
    ds_read_b64_tr_b16 v[114:115], v239 offset:480
    v_mfma_f32_16x16x32_bf16 a[80:83], v[88:91], a[136:139], a[80:83]
    ds_read_b64_tr_b16 v[116:117], v239 offset:736
    v_mfma_f32_16x16x32_bf16 a[80:83], v[92:95], a[140:143], a[80:83]
    ds_read_b64_tr_b16 v[118:119], v239 offset:992
    s_add_u32 m0, s53, 33792
    v_mfma_f32_16x16x32_bf16 a[84:87], v[80:83], a[144:147], a[84:87]
    buffer_load_dwordx4 v248, s[40:43], s66 offen offset:0 lds
    v_mfma_f32_16x16x32_bf16 a[84:87], v[84:87], a[148:151], a[84:87]
    ds_read_b64_tr_b16 v[120:121], v239 offset:17120
    ds_read_b64_tr_b16 v[122:123], v239 offset:17376
    v_mfma_f32_16x16x32_bf16 a[84:87], v[88:91], a[152:155], a[84:87]
    ds_read_b64_tr_b16 v[124:125], v239 offset:17632
    v_mfma_f32_16x16x32_bf16 a[84:87], v[92:95], a[156:159], a[84:87]
    ds_read_b64_tr_b16 v[126:127], v239 offset:17888
    v_mfma_f32_16x16x32_bf16 a[88:91], v[80:83], a[160:163], a[88:91]
    v_mfma_f32_16x16x32_bf16 a[88:91], v[84:87], a[164:167], a[88:91]
    buffer_load_dwordx4 v249, s[40:43], s66 offen offset:1056 lds
    v_mfma_f32_16x16x32_bf16 a[88:91], v[88:91], a[168:171], a[88:91]
    v_mfma_f32_16x16x32_bf16 a[88:91], v[92:95], a[172:175], a[88:91]
    v_mfma_f32_16x16x32_bf16 a[92:95], v[80:83], a[176:179], a[92:95]
    v_mfma_f32_16x16x32_bf16 a[92:95], v[84:87], a[180:183], a[92:95]
    buffer_load_dwordx4 v250, s[40:43], s66 offen offset:2112 lds
    v_mfma_f32_16x16x32_bf16 a[92:95], v[88:91], a[184:187], a[92:95]
    v_mfma_f32_16x16x32_bf16 a[92:95], v[92:95], a[188:191], a[92:95]
    s_waitcnt lgkmcnt(0)
    v_mfma_f32_16x16x32_bf16 a[96:99], v[96:99], a[128:131], a[96:99]
    v_mfma_f32_16x16x32_bf16 a[96:99], v[100:103], a[132:135], a[96:99]
    buffer_load_dwordx4 v251, s[40:43], s66 offen offset:3168 lds
    v_mfma_f32_16x16x32_bf16 a[96:99], v[104:107], a[136:139], a[96:99]
    s_add_u32 s66, s66, 131072
    v_mfma_f32_16x16x32_bf16 a[96:99], v[108:111], a[140:143], a[96:99]
    v_mfma_f32_16x16x32_bf16 a[100:103], v[96:99], a[144:147], a[100:103]
    s_waitcnt vmcnt(47) lgkmcnt(0)
    s_barrier
    v_mfma_f32_16x16x32_bf16 a[100:103], v[100:103], a[148:151], a[100:103]
    ds_read_b64_tr_b16 v[64:65], v239 offset:33792
    s_add_u32 m0, s53, 50688
    v_mfma_f32_16x16x32_bf16 a[100:103], v[104:107], a[152:155], a[100:103]
    buffer_load_dwordx4 v248, s[40:43], s66 offen offset:0 lds
    v_mfma_f32_16x16x32_bf16 a[100:103], v[108:111], a[156:159], a[100:103]
    ds_read_b64_tr_b16 v[66:67], v239 offset:34048
    ds_read_b64_tr_b16 v[68:69], v239 offset:34304
    v_mfma_f32_16x16x32_bf16 a[104:107], v[96:99], a[160:163], a[104:107]
    ds_read_b64_tr_b16 v[70:71], v239 offset:34560
    v_mfma_f32_16x16x32_bf16 a[104:107], v[100:103], a[164:167], a[104:107]
    ds_read_b64_tr_b16 v[72:73], v239 offset:50688
    v_mfma_f32_16x16x32_bf16 a[104:107], v[104:107], a[168:171], a[104:107]
    buffer_load_dwordx4 v249, s[40:43], s66 offen offset:1056 lds
    v_mfma_f32_16x16x32_bf16 a[104:107], v[108:111], a[172:175], a[104:107]
    ds_read_b64_tr_b16 v[74:75], v239 offset:50944
    ds_read_b64_tr_b16 v[76:77], v239 offset:51200
    v_mfma_f32_16x16x32_bf16 a[108:111], v[96:99], a[176:179], a[108:111]
    ds_read_b64_tr_b16 v[78:79], v239 offset:51456
    v_mfma_f32_16x16x32_bf16 a[108:111], v[100:103], a[180:183], a[108:111]
    v_mfma_f32_16x16x32_bf16 a[108:111], v[104:107], a[184:187], a[108:111]
    v_mfma_f32_16x16x32_bf16 a[108:111], v[108:111], a[188:191], a[108:111]
    buffer_load_dwordx4 v250, s[40:43], s66 offen offset:2112 lds
    v_mfma_f32_16x16x32_bf16 a[112:115], v[112:115], a[128:131], a[112:115]
    v_mfma_f32_16x16x32_bf16 a[112:115], v[116:119], a[132:135], a[112:115]
    ds_read_b64_tr_b16 v[80:81], v239 offset:33824
    v_mfma_f32_16x16x32_bf16 a[112:115], v[120:123], a[136:139], a[112:115]
    ds_read_b64_tr_b16 v[82:83], v239 offset:34080
    v_mfma_f32_16x16x32_bf16 a[112:115], v[124:127], a[140:143], a[112:115]
    buffer_load_dwordx4 v251, s[40:43], s66 offen offset:3168 lds
    v_mfma_f32_16x16x32_bf16 a[116:119], v[112:115], a[144:147], a[116:119]
    ds_read_b64_tr_b16 v[84:85], v239 offset:34336
    s_add_u32 s66, s66, 131072
    v_mfma_f32_16x16x32_bf16 a[116:119], v[116:119], a[148:151], a[116:119]
    ds_read_b64_tr_b16 v[86:87], v239 offset:34592
    ds_read_b64_tr_b16 v[88:89], v239 offset:50720
    v_mfma_f32_16x16x32_bf16 a[116:119], v[120:123], a[152:155], a[116:119]
    ds_read_b64_tr_b16 v[90:91], v239 offset:50976
    v_mfma_f32_16x16x32_bf16 a[116:119], v[124:127], a[156:159], a[116:119]
    ds_read_b64_tr_b16 v[92:93], v239 offset:51232
    v_mfma_f32_16x16x32_bf16 a[120:123], v[112:115], a[160:163], a[120:123]
    ds_read_b64_tr_b16 v[94:95], v239 offset:51488
    v_mfma_f32_16x16x32_bf16 a[120:123], v[116:119], a[164:167], a[120:123]
    v_mfma_f32_16x16x32_bf16 a[120:123], v[120:123], a[168:171], a[120:123]
    v_mfma_f32_16x16x32_bf16 a[120:123], v[124:127], a[172:175], a[120:123]
    v_mfma_f32_16x16x32_bf16 a[124:127], v[112:115], a[176:179], a[124:127]
    v_mfma_f32_16x16x32_bf16 a[124:127], v[116:119], a[180:183], a[124:127]
    v_mfma_f32_16x16x32_bf16 a[124:127], v[120:123], a[184:187], a[124:127]
    v_mfma_f32_16x16x32_bf16 a[124:127], v[124:127], a[188:191], a[124:127]
    s_waitcnt vmcnt(11)
    s_waitcnt lgkmcnt(0)
    v_mfma_f32_16x16x32_bf16 a[0:3], v[64:67], a[192:195], a[0:3]
    ds_read_b64_tr_b16 v[96:97], v239 offset:33856
    v_mfma_f32_16x16x32_bf16 a[0:3], v[68:71], a[196:199], a[0:3]
    buffer_load_dwordx4 a[128:131], v48, s[28:31], s50 offen offset:0 sc1
    v_mfma_f32_16x16x32_bf16 a[0:3], v[72:75], a[200:203], a[0:3]
    ds_read_b64_tr_b16 v[98:99], v239 offset:34112
    ds_read_b64_tr_b16 v[100:101], v239 offset:34368
    v_mfma_f32_16x16x32_bf16 a[0:3], v[76:79], a[204:207], a[0:3]
    ds_read_b64_tr_b16 v[102:103], v239 offset:34624
    v_mfma_f32_16x16x32_bf16 a[4:7], v[64:67], a[208:211], a[4:7]
    ds_read_b64_tr_b16 v[104:105], v239 offset:50752
    v_mfma_f32_16x16x32_bf16 a[4:7], v[68:71], a[212:215], a[4:7]
    buffer_load_dwordx4 a[132:135], v48, s[28:31], s50 offen offset:1024 sc1
    v_mfma_f32_16x16x32_bf16 a[4:7], v[72:75], a[216:219], a[4:7]
    ds_read_b64_tr_b16 v[106:107], v239 offset:51008
    ds_read_b64_tr_b16 v[108:109], v239 offset:51264
    v_mfma_f32_16x16x32_bf16 a[4:7], v[76:79], a[220:223], a[4:7]
    ds_read_b64_tr_b16 v[110:111], v239 offset:51520
    v_mfma_f32_16x16x32_bf16 a[8:11], v[64:67], a[224:227], a[8:11]
    v_mfma_f32_16x16x32_bf16 a[8:11], v[68:71], a[228:231], a[8:11]
    buffer_load_dwordx4 a[136:139], v48, s[28:31], s50 offen offset:2048 sc1
    v_mfma_f32_16x16x32_bf16 a[8:11], v[72:75], a[232:235], a[8:11]
    v_mfma_f32_16x16x32_bf16 a[8:11], v[76:79], a[236:239], a[8:11]
    v_mfma_f32_16x16x32_bf16 a[12:15], v[64:67], a[240:243], a[12:15]
    v_mfma_f32_16x16x32_bf16 a[12:15], v[68:71], a[244:247], a[12:15]
    v_mfma_f32_16x16x32_bf16 a[12:15], v[72:75], a[248:251], a[12:15]
    buffer_load_dwordx4 a[140:143], v48, s[28:31], s50 offen offset:3072 sc1
    v_mfma_f32_16x16x32_bf16 a[12:15], v[76:79], a[252:255], a[12:15]
    v_mfma_f32_16x16x32_bf16 a[16:19], v[80:83], a[192:195], a[16:19]
    ds_read_b64_tr_b16 v[112:113], v239 offset:33888
    v_mfma_f32_16x16x32_bf16 a[16:19], v[84:87], a[196:199], a[16:19]
    ds_read_b64_tr_b16 v[114:115], v239 offset:34144
    v_mfma_f32_16x16x32_bf16 a[16:19], v[88:91], a[200:203], a[16:19]
    buffer_load_dwordx4 a[144:147], v49, s[28:31], s50 offen offset:0 sc1
    v_mfma_f32_16x16x32_bf16 a[16:19], v[92:95], a[204:207], a[16:19]
    ds_read_b64_tr_b16 v[116:117], v239 offset:34400
    ds_read_b64_tr_b16 v[118:119], v239 offset:34656
    v_mfma_f32_16x16x32_bf16 a[20:23], v[80:83], a[208:211], a[20:23]
    ds_read_b64_tr_b16 v[120:121], v239 offset:50784
    v_mfma_f32_16x16x32_bf16 a[20:23], v[84:87], a[212:215], a[20:23]
    ds_read_b64_tr_b16 v[122:123], v239 offset:51040
    v_mfma_f32_16x16x32_bf16 a[20:23], v[88:91], a[216:219], a[20:23]
    ds_read_b64_tr_b16 v[124:125], v239 offset:51296
    v_mfma_f32_16x16x32_bf16 a[20:23], v[92:95], a[220:223], a[20:23]
    ds_read_b64_tr_b16 v[126:127], v239 offset:51552
    v_mfma_f32_16x16x32_bf16 a[24:27], v[80:83], a[224:227], a[24:27]
    buffer_load_dwordx4 a[148:151], v49, s[28:31], s50 offen offset:1024 sc1
    v_mfma_f32_16x16x32_bf16 a[24:27], v[84:87], a[228:231], a[24:27]
    v_mfma_f32_16x16x32_bf16 a[24:27], v[88:91], a[232:235], a[24:27]
    v_mfma_f32_16x16x32_bf16 a[24:27], v[92:95], a[236:239], a[24:27]
    buffer_load_dwordx4 a[152:155], v49, s[28:31], s50 offen offset:2048 sc1
    v_mfma_f32_16x16x32_bf16 a[28:31], v[80:83], a[240:243], a[28:31]
    v_mfma_f32_16x16x32_bf16 a[28:31], v[84:87], a[244:247], a[28:31]
    v_mfma_f32_16x16x32_bf16 a[28:31], v[88:91], a[248:251], a[28:31]
    v_mfma_f32_16x16x32_bf16 a[28:31], v[92:95], a[252:255], a[28:31]
    buffer_load_dwordx4 a[156:159], v49, s[28:31], s50 offen offset:3072 sc1
    s_waitcnt lgkmcnt(0)
    v_mfma_f32_16x16x32_bf16 a[32:35], v[96:99], a[192:195], a[32:35]
    ds_read_b64_tr_b16 v[64:65], v239 offset:33920
    v_mfma_f32_16x16x32_bf16 a[32:35], v[100:103], a[196:199], a[32:35]
    ds_read_b64_tr_b16 v[66:67], v239 offset:34176
    v_mfma_f32_16x16x32_bf16 a[32:35], v[104:107], a[200:203], a[32:35]
    ds_read_b64_tr_b16 v[68:69], v239 offset:34432
    v_mfma_f32_16x16x32_bf16 a[32:35], v[108:111], a[204:207], a[32:35]
    ds_read_b64_tr_b16 v[70:71], v239 offset:34688
    v_mfma_f32_16x16x32_bf16 a[36:39], v[96:99], a[208:211], a[36:39]
    buffer_load_dwordx4 a[160:163], v50, s[28:31], s50 offen offset:0 sc1
    v_mfma_f32_16x16x32_bf16 a[36:39], v[100:103], a[212:215], a[36:39]
    ds_read_b64_tr_b16 v[72:73], v239 offset:50816
    ds_read_b64_tr_b16 v[74:75], v239 offset:51072
    v_mfma_f32_16x16x32_bf16 a[36:39], v[104:107], a[216:219], a[36:39]
    ds_read_b64_tr_b16 v[76:77], v239 offset:51328
    v_mfma_f32_16x16x32_bf16 a[36:39], v[108:111], a[220:223], a[36:39]
    ds_read_b64_tr_b16 v[78:79], v239 offset:51584
    v_mfma_f32_16x16x32_bf16 a[40:43], v[96:99], a[224:227], a[40:43]
    buffer_load_dwordx4 a[164:167], v50, s[28:31], s50 offen offset:1024 sc1
    v_mfma_f32_16x16x32_bf16 a[40:43], v[100:103], a[228:231], a[40:43]
    v_mfma_f32_16x16x32_bf16 a[40:43], v[104:107], a[232:235], a[40:43]
    v_mfma_f32_16x16x32_bf16 a[40:43], v[108:111], a[236:239], a[40:43]
    v_mfma_f32_16x16x32_bf16 a[44:47], v[96:99], a[240:243], a[44:47]
    v_mfma_f32_16x16x32_bf16 a[44:47], v[100:103], a[244:247], a[44:47]
    buffer_load_dwordx4 a[168:171], v50, s[28:31], s50 offen offset:2048 sc1
    v_mfma_f32_16x16x32_bf16 a[44:47], v[104:107], a[248:251], a[44:47]
    v_mfma_f32_16x16x32_bf16 a[44:47], v[108:111], a[252:255], a[44:47]
    v_mfma_f32_16x16x32_bf16 a[48:51], v[112:115], a[192:195], a[48:51]
    ds_read_b64_tr_b16 v[80:81], v239 offset:33952
    v_mfma_f32_16x16x32_bf16 a[48:51], v[116:119], a[196:199], a[48:51]
    buffer_load_dwordx4 a[172:175], v50, s[28:31], s50 offen offset:3072 sc1
    v_mfma_f32_16x16x32_bf16 a[48:51], v[120:123], a[200:203], a[48:51]
    ds_read_b64_tr_b16 v[82:83], v239 offset:34208
    ds_read_b64_tr_b16 v[84:85], v239 offset:34464
    v_mfma_f32_16x16x32_bf16 a[48:51], v[124:127], a[204:207], a[48:51]
    ds_read_b64_tr_b16 v[86:87], v239 offset:34720
    v_mfma_f32_16x16x32_bf16 a[52:55], v[112:115], a[208:211], a[52:55]
    ds_read_b64_tr_b16 v[88:89], v239 offset:50848
    v_mfma_f32_16x16x32_bf16 a[52:55], v[116:119], a[212:215], a[52:55]
    buffer_load_dwordx4 a[176:179], v51, s[28:31], s50 offen offset:0 sc1
    v_mfma_f32_16x16x32_bf16 a[52:55], v[120:123], a[216:219], a[52:55]
    ds_read_b64_tr_b16 v[90:91], v239 offset:51104
    ds_read_b64_tr_b16 v[92:93], v239 offset:51360
    v_mfma_f32_16x16x32_bf16 a[52:55], v[124:127], a[220:223], a[52:55]
    ds_read_b64_tr_b16 v[94:95], v239 offset:51616
    v_mfma_f32_16x16x32_bf16 a[56:59], v[112:115], a[224:227], a[56:59]
    v_mfma_f32_16x16x32_bf16 a[56:59], v[116:119], a[228:231], a[56:59]
    v_mfma_f32_16x16x32_bf16 a[56:59], v[120:123], a[232:235], a[56:59]
    buffer_load_dwordx4 a[180:183], v51, s[28:31], s50 offen offset:1024 sc1
    v_mfma_f32_16x16x32_bf16 a[56:59], v[124:127], a[236:239], a[56:59]
    v_mfma_f32_16x16x32_bf16 a[60:63], v[112:115], a[240:243], a[60:63]
    v_mfma_f32_16x16x32_bf16 a[60:63], v[116:119], a[244:247], a[60:63]
    v_mfma_f32_16x16x32_bf16 a[60:63], v[120:123], a[248:251], a[60:63]
    buffer_load_dwordx4 a[184:187], v51, s[28:31], s50 offen offset:2048 sc1
    v_mfma_f32_16x16x32_bf16 a[60:63], v[124:127], a[252:255], a[60:63]
    s_waitcnt lgkmcnt(0)
    v_mfma_f32_16x16x32_bf16 a[64:67], v[64:67], a[192:195], a[64:67]
    ds_read_b64_tr_b16 v[96:97], v239 offset:33984
    v_mfma_f32_16x16x32_bf16 a[64:67], v[68:71], a[196:199], a[64:67]
    ds_read_b64_tr_b16 v[98:99], v239 offset:34240
    v_mfma_f32_16x16x32_bf16 a[64:67], v[72:75], a[200:203], a[64:67]
    ds_read_b64_tr_b16 v[100:101], v239 offset:34496
    v_mfma_f32_16x16x32_bf16 a[64:67], v[76:79], a[204:207], a[64:67]
    buffer_load_dwordx4 a[188:191], v51, s[28:31], s50 offen offset:3072 sc1
    v_mfma_f32_16x16x32_bf16 a[68:71], v[64:67], a[208:211], a[68:71]
    ds_read_b64_tr_b16 v[102:103], v239 offset:34752
    s_add_u32 s50, s50, 4096
    v_mfma_f32_16x16x32_bf16 a[68:71], v[68:71], a[212:215], a[68:71]
    ds_read_b64_tr_b16 v[104:105], v239 offset:50880
    ds_read_b64_tr_b16 v[106:107], v239 offset:51136
    v_mfma_f32_16x16x32_bf16 a[68:71], v[72:75], a[216:219], a[68:71]
    ds_read_b64_tr_b16 v[108:109], v239 offset:51392
    s_mov_b32 s61, 0
    v_mfma_f32_16x16x32_bf16 a[68:71], v[76:79], a[220:223], a[68:71]
    ds_read_b64_tr_b16 v[110:111], v239 offset:51648
    v_mfma_f32_16x16x32_bf16 a[72:75], v[64:67], a[224:227], a[72:75]
    buffer_store_dwordx4 v[12:15], v255, s[4:7], s61 offen offset:3072 sc1
    v_mfma_f32_16x16x32_bf16 a[72:75], v[68:71], a[228:231], a[72:75]
    v_mfma_f32_16x16x32_bf16 a[72:75], v[72:75], a[232:235], a[72:75]
    s_mov_b32 s61, 8192
    v_mfma_f32_16x16x32_bf16 a[72:75], v[76:79], a[236:239], a[72:75]
    buffer_store_dwordx4 v[16:19], v255, s[4:7], s61 offen offset:0 sc1
    v_mfma_f32_16x16x32_bf16 a[76:79], v[64:67], a[240:243], a[76:79]
    v_mfma_f32_16x16x32_bf16 a[76:79], v[68:71], a[244:247], a[76:79]
    v_mfma_f32_16x16x32_bf16 a[76:79], v[72:75], a[248:251], a[76:79]
    v_mfma_f32_16x16x32_bf16 a[76:79], v[76:79], a[252:255], a[76:79]
    s_mov_b32 s61, 8192
    v_mfma_f32_16x16x32_bf16 a[80:83], v[80:83], a[192:195], a[80:83]
    buffer_store_dwordx4 v[20:23], v255, s[4:7], s61 offen offset:1024 sc1
    v_mfma_f32_16x16x32_bf16 a[80:83], v[84:87], a[196:199], a[80:83]
    ds_read_b64_tr_b16 v[112:113], v239 offset:34016
    ds_read_b64_tr_b16 v[114:115], v239 offset:34272
    v_mfma_f32_16x16x32_bf16 a[80:83], v[88:91], a[200:203], a[80:83]
    ds_read_b64_tr_b16 v[116:117], v239 offset:34528
    v_mfma_f32_16x16x32_bf16 a[80:83], v[92:95], a[204:207], a[80:83]
    ds_read_b64_tr_b16 v[118:119], v239 offset:34784
    s_add_u32 m0, s53, 67584
    v_mfma_f32_16x16x32_bf16 a[84:87], v[80:83], a[208:211], a[84:87]
    buffer_load_dwordx4 v248, s[40:43], s66 offen offset:0 lds
    v_mfma_f32_16x16x32_bf16 a[84:87], v[84:87], a[212:215], a[84:87]
    ds_read_b64_tr_b16 v[120:121], v239 offset:50912
    ds_read_b64_tr_b16 v[122:123], v239 offset:51168
    v_mfma_f32_16x16x32_bf16 a[84:87], v[88:91], a[216:219], a[84:87]
    ds_read_b64_tr_b16 v[124:125], v239 offset:51424
    v_mfma_f32_16x16x32_bf16 a[84:87], v[92:95], a[220:223], a[84:87]
    ds_read_b64_tr_b16 v[126:127], v239 offset:51680
    v_mfma_f32_16x16x32_bf16 a[88:91], v[80:83], a[224:227], a[88:91]
    v_mfma_f32_16x16x32_bf16 a[88:91], v[84:87], a[228:231], a[88:91]
    buffer_load_dwordx4 v249, s[40:43], s66 offen offset:1056 lds
    v_mfma_f32_16x16x32_bf16 a[88:91], v[88:91], a[232:235], a[88:91]
    v_mfma_f32_16x16x32_bf16 a[88:91], v[92:95], a[236:239], a[88:91]
    v_mfma_f32_16x16x32_bf16 a[92:95], v[80:83], a[240:243], a[92:95]
    v_mfma_f32_16x16x32_bf16 a[92:95], v[84:87], a[244:247], a[92:95]
    buffer_load_dwordx4 v250, s[40:43], s66 offen offset:2112 lds
    v_mfma_f32_16x16x32_bf16 a[92:95], v[88:91], a[248:251], a[92:95]
    v_mfma_f32_16x16x32_bf16 a[92:95], v[92:95], a[252:255], a[92:95]
    s_waitcnt lgkmcnt(0)
    v_mfma_f32_16x16x32_bf16 a[96:99], v[96:99], a[192:195], a[96:99]
    v_mfma_f32_16x16x32_bf16 a[96:99], v[100:103], a[196:199], a[96:99]
    buffer_load_dwordx4 v251, s[40:43], s66 offen offset:3168 lds
    v_mfma_f32_16x16x32_bf16 a[96:99], v[104:107], a[200:203], a[96:99]
    s_add_u32 s66, s66, 131072
    v_mfma_f32_16x16x32_bf16 a[96:99], v[108:111], a[204:207], a[96:99]
    v_mfma_f32_16x16x32_bf16 a[100:103], v[96:99], a[208:211], a[100:103]
    s_waitcnt vmcnt(50) lgkmcnt(0)
    s_barrier
    v_mfma_f32_16x16x32_bf16 a[100:103], v[100:103], a[212:215], a[100:103]
    ds_read_b64_tr_b16 v[64:65], v238 offset:0
    s_add_u32 m0, s53, 84480
    v_mfma_f32_16x16x32_bf16 a[100:103], v[104:107], a[216:219], a[100:103]
    buffer_load_dwordx4 v248, s[40:43], s66 offen offset:0 lds
    v_mfma_f32_16x16x32_bf16 a[100:103], v[108:111], a[220:223], a[100:103]
    ds_read_b64_tr_b16 v[66:67], v238 offset:256
    ds_read_b64_tr_b16 v[68:69], v238 offset:512
    v_mfma_f32_16x16x32_bf16 a[104:107], v[96:99], a[224:227], a[104:107]
    ds_read_b64_tr_b16 v[70:71], v238 offset:768
    v_mfma_f32_16x16x32_bf16 a[104:107], v[100:103], a[228:231], a[104:107]
    ds_read_b64_tr_b16 v[72:73], v238 offset:16896
    v_mfma_f32_16x16x32_bf16 a[104:107], v[104:107], a[232:235], a[104:107]
    buffer_load_dwordx4 v249, s[40:43], s66 offen offset:1056 lds
    v_mfma_f32_16x16x32_bf16 a[104:107], v[108:111], a[236:239], a[104:107]
    ds_read_b64_tr_b16 v[74:75], v238 offset:17152
    ds_read_b64_tr_b16 v[76:77], v238 offset:17408
    v_mfma_f32_16x16x32_bf16 a[108:111], v[96:99], a[240:243], a[108:111]
    ds_read_b64_tr_b16 v[78:79], v238 offset:17664
    v_mfma_f32_16x16x32_bf16 a[108:111], v[100:103], a[244:247], a[108:111]
    v_mfma_f32_16x16x32_bf16 a[108:111], v[104:107], a[248:251], a[108:111]
    v_mfma_f32_16x16x32_bf16 a[108:111], v[108:111], a[252:255], a[108:111]
    buffer_load_dwordx4 v250, s[40:43], s66 offen offset:2112 lds
    v_mfma_f32_16x16x32_bf16 a[112:115], v[112:115], a[192:195], a[112:115]
    v_mfma_f32_16x16x32_bf16 a[112:115], v[116:119], a[196:199], a[112:115]
    ds_read_b64_tr_b16 v[80:81], v238 offset:32
    v_mfma_f32_16x16x32_bf16 a[112:115], v[120:123], a[200:203], a[112:115]
    ds_read_b64_tr_b16 v[82:83], v238 offset:288
    v_mfma_f32_16x16x32_bf16 a[112:115], v[124:127], a[204:207], a[112:115]
    buffer_load_dwordx4 v251, s[40:43], s66 offen offset:3168 lds
    v_mfma_f32_16x16x32_bf16 a[116:119], v[112:115], a[208:211], a[116:119]
    ds_read_b64_tr_b16 v[84:85], v238 offset:544
    s_add_u32 s66, s66, 131072
    v_mfma_f32_16x16x32_bf16 a[116:119], v[116:119], a[212:215], a[116:119]
    ds_read_b64_tr_b16 v[86:87], v238 offset:800
    ds_read_b64_tr_b16 v[88:89], v238 offset:16928
    v_mfma_f32_16x16x32_bf16 a[116:119], v[120:123], a[216:219], a[116:119]
    ds_read_b64_tr_b16 v[90:91], v238 offset:17184
    v_mfma_f32_16x16x32_bf16 a[116:119], v[124:127], a[220:223], a[116:119]
    ds_read_b64_tr_b16 v[92:93], v238 offset:17440
    v_mfma_f32_16x16x32_bf16 a[120:123], v[112:115], a[224:227], a[120:123]
    ds_read_b64_tr_b16 v[94:95], v238 offset:17696
    v_mfma_f32_16x16x32_bf16 a[120:123], v[116:119], a[228:231], a[120:123]
    v_mfma_f32_16x16x32_bf16 a[120:123], v[120:123], a[232:235], a[120:123]
    v_mfma_f32_16x16x32_bf16 a[120:123], v[124:127], a[236:239], a[120:123]
    v_mfma_f32_16x16x32_bf16 a[124:127], v[112:115], a[240:243], a[124:127]
    v_mfma_f32_16x16x32_bf16 a[124:127], v[116:119], a[244:247], a[124:127]
    v_mfma_f32_16x16x32_bf16 a[124:127], v[120:123], a[248:251], a[124:127]
    v_mfma_f32_16x16x32_bf16 a[124:127], v[124:127], a[252:255], a[124:127]
    s_waitcnt vmcnt(11)
    s_waitcnt lgkmcnt(0)
    v_mfma_f32_16x16x32_bf16 a[0:3], v[64:67], a[128:131], a[0:3]
    ds_read_b64_tr_b16 v[96:97], v238 offset:64
    v_mfma_f32_16x16x32_bf16 a[0:3], v[68:71], a[132:135], a[0:3]
    buffer_load_dwordx4 a[192:195], v48, s[28:31], s50 offen offset:0 sc1
    v_mfma_f32_16x16x32_bf16 a[0:3], v[72:75], a[136:139], a[0:3]
    ds_read_b64_tr_b16 v[98:99], v238 offset:320
    ds_read_b64_tr_b16 v[100:101], v238 offset:576
    v_mfma_f32_16x16x32_bf16 a[0:3], v[76:79], a[140:143], a[0:3]
    ds_read_b64_tr_b16 v[102:103], v238 offset:832
    v_mfma_f32_16x16x32_bf16 a[4:7], v[64:67], a[144:147], a[4:7]
    ds_read_b64_tr_b16 v[104:105], v238 offset:16960
    v_mfma_f32_16x16x32_bf16 a[4:7], v[68:71], a[148:151], a[4:7]
    buffer_load_dwordx4 a[196:199], v48, s[28:31], s50 offen offset:1024 sc1
    v_mfma_f32_16x16x32_bf16 a[4:7], v[72:75], a[152:155], a[4:7]
    ds_read_b64_tr_b16 v[106:107], v238 offset:17216
    ds_read_b64_tr_b16 v[108:109], v238 offset:17472
    v_mfma_f32_16x16x32_bf16 a[4:7], v[76:79], a[156:159], a[4:7]
    ds_read_b64_tr_b16 v[110:111], v238 offset:17728
    v_mfma_f32_16x16x32_bf16 a[8:11], v[64:67], a[160:163], a[8:11]
    v_mfma_f32_16x16x32_bf16 a[8:11], v[68:71], a[164:167], a[8:11]
    buffer_load_dwordx4 a[200:203], v48, s[28:31], s50 offen offset:2048 sc1
    v_mfma_f32_16x16x32_bf16 a[8:11], v[72:75], a[168:171], a[8:11]
    v_mfma_f32_16x16x32_bf16 a[8:11], v[76:79], a[172:175], a[8:11]
    v_mfma_f32_16x16x32_bf16 a[12:15], v[64:67], a[176:179], a[12:15]
    v_mfma_f32_16x16x32_bf16 a[12:15], v[68:71], a[180:183], a[12:15]
    v_mfma_f32_16x16x32_bf16 a[12:15], v[72:75], a[184:187], a[12:15]
    buffer_load_dwordx4 a[204:207], v48, s[28:31], s50 offen offset:3072 sc1
    v_mfma_f32_16x16x32_bf16 a[12:15], v[76:79], a[188:191], a[12:15]
    v_mfma_f32_16x16x32_bf16 a[16:19], v[80:83], a[128:131], a[16:19]
    ds_read_b64_tr_b16 v[112:113], v238 offset:96
    v_mfma_f32_16x16x32_bf16 a[16:19], v[84:87], a[132:135], a[16:19]
    ds_read_b64_tr_b16 v[114:115], v238 offset:352
    v_mfma_f32_16x16x32_bf16 a[16:19], v[88:91], a[136:139], a[16:19]
    buffer_load_dwordx4 a[208:211], v49, s[28:31], s50 offen offset:0 sc1
    v_mfma_f32_16x16x32_bf16 a[16:19], v[92:95], a[140:143], a[16:19]
    ds_read_b64_tr_b16 v[116:117], v238 offset:608
    ds_read_b64_tr_b16 v[118:119], v238 offset:864
    v_mfma_f32_16x16x32_bf16 a[20:23], v[80:83], a[144:147], a[20:23]
    ds_read_b64_tr_b16 v[120:121], v238 offset:16992
    v_mfma_f32_16x16x32_bf16 a[20:23], v[84:87], a[148:151], a[20:23]
    ds_read_b64_tr_b16 v[122:123], v238 offset:17248
    v_mfma_f32_16x16x32_bf16 a[20:23], v[88:91], a[152:155], a[20:23]
    ds_read_b64_tr_b16 v[124:125], v238 offset:17504
    v_mfma_f32_16x16x32_bf16 a[20:23], v[92:95], a[156:159], a[20:23]
    ds_read_b64_tr_b16 v[126:127], v238 offset:17760
    v_mfma_f32_16x16x32_bf16 a[24:27], v[80:83], a[160:163], a[24:27]
    buffer_load_dwordx4 a[212:215], v49, s[28:31], s50 offen offset:1024 sc1
    v_mfma_f32_16x16x32_bf16 a[24:27], v[84:87], a[164:167], a[24:27]
    v_mfma_f32_16x16x32_bf16 a[24:27], v[88:91], a[168:171], a[24:27]
    v_mfma_f32_16x16x32_bf16 a[24:27], v[92:95], a[172:175], a[24:27]
    buffer_load_dwordx4 a[216:219], v49, s[28:31], s50 offen offset:2048 sc1
    v_mfma_f32_16x16x32_bf16 a[28:31], v[80:83], a[176:179], a[28:31]
    v_mfma_f32_16x16x32_bf16 a[28:31], v[84:87], a[180:183], a[28:31]
    v_mfma_f32_16x16x32_bf16 a[28:31], v[88:91], a[184:187], a[28:31]
    v_mfma_f32_16x16x32_bf16 a[28:31], v[92:95], a[188:191], a[28:31]
    buffer_load_dwordx4 a[220:223], v49, s[28:31], s50 offen offset:3072 sc1
    s_waitcnt lgkmcnt(0)
    v_mfma_f32_16x16x32_bf16 a[32:35], v[96:99], a[128:131], a[32:35]
    ds_read_b64_tr_b16 v[64:65], v238 offset:128
    v_mfma_f32_16x16x32_bf16 a[32:35], v[100:103], a[132:135], a[32:35]
    ds_read_b64_tr_b16 v[66:67], v238 offset:384
    v_mfma_f32_16x16x32_bf16 a[32:35], v[104:107], a[136:139], a[32:35]
    ds_read_b64_tr_b16 v[68:69], v238 offset:640
    v_mfma_f32_16x16x32_bf16 a[32:35], v[108:111], a[140:143], a[32:35]
    ds_read_b64_tr_b16 v[70:71], v238 offset:896
    v_mfma_f32_16x16x32_bf16 a[36:39], v[96:99], a[144:147], a[36:39]
    buffer_load_dwordx4 a[224:227], v50, s[28:31], s50 offen offset:0 sc1
    v_mfma_f32_16x16x32_bf16 a[36:39], v[100:103], a[148:151], a[36:39]
    ds_read_b64_tr_b16 v[72:73], v238 offset:17024
    ds_read_b64_tr_b16 v[74:75], v238 offset:17280
    v_mfma_f32_16x16x32_bf16 a[36:39], v[104:107], a[152:155], a[36:39]
    ds_read_b64_tr_b16 v[76:77], v238 offset:17536
    v_mfma_f32_16x16x32_bf16 a[36:39], v[108:111], a[156:159], a[36:39]
    ds_read_b64_tr_b16 v[78:79], v238 offset:17792
    v_mfma_f32_16x16x32_bf16 a[40:43], v[96:99], a[160:163], a[40:43]
    buffer_load_dwordx4 a[228:231], v50, s[28:31], s50 offen offset:1024 sc1
    v_mfma_f32_16x16x32_bf16 a[40:43], v[100:103], a[164:167], a[40:43]
    v_mfma_f32_16x16x32_bf16 a[40:43], v[104:107], a[168:171], a[40:43]
    v_mfma_f32_16x16x32_bf16 a[40:43], v[108:111], a[172:175], a[40:43]
    v_mfma_f32_16x16x32_bf16 a[44:47], v[96:99], a[176:179], a[44:47]
    v_mfma_f32_16x16x32_bf16 a[44:47], v[100:103], a[180:183], a[44:47]
    buffer_load_dwordx4 a[232:235], v50, s[28:31], s50 offen offset:2048 sc1
    v_mfma_f32_16x16x32_bf16 a[44:47], v[104:107], a[184:187], a[44:47]
    v_mfma_f32_16x16x32_bf16 a[44:47], v[108:111], a[188:191], a[44:47]
    v_mfma_f32_16x16x32_bf16 a[48:51], v[112:115], a[128:131], a[48:51]
    ds_read_b64_tr_b16 v[80:81], v238 offset:160
    v_mfma_f32_16x16x32_bf16 a[48:51], v[116:119], a[132:135], a[48:51]
    buffer_load_dwordx4 a[236:239], v50, s[28:31], s50 offen offset:3072 sc1
    v_mfma_f32_16x16x32_bf16 a[48:51], v[120:123], a[136:139], a[48:51]
    ds_read_b64_tr_b16 v[82:83], v238 offset:416
    ds_read_b64_tr_b16 v[84:85], v238 offset:672
    v_mfma_f32_16x16x32_bf16 a[48:51], v[124:127], a[140:143], a[48:51]
    ds_read_b64_tr_b16 v[86:87], v238 offset:928
    v_mfma_f32_16x16x32_bf16 a[52:55], v[112:115], a[144:147], a[52:55]
    ds_read_b64_tr_b16 v[88:89], v238 offset:17056
    v_mfma_f32_16x16x32_bf16 a[52:55], v[116:119], a[148:151], a[52:55]
    buffer_load_dwordx4 a[240:243], v51, s[28:31], s50 offen offset:0 sc1
    v_mfma_f32_16x16x32_bf16 a[52:55], v[120:123], a[152:155], a[52:55]
    ds_read_b64_tr_b16 v[90:91], v238 offset:17312
    ds_read_b64_tr_b16 v[92:93], v238 offset:17568
    v_mfma_f32_16x16x32_bf16 a[52:55], v[124:127], a[156:159], a[52:55]
    ds_read_b64_tr_b16 v[94:95], v238 offset:17824
    v_mfma_f32_16x16x32_bf16 a[56:59], v[112:115], a[160:163], a[56:59]
    v_mfma_f32_16x16x32_bf16 a[56:59], v[116:119], a[164:167], a[56:59]
    v_mfma_f32_16x16x32_bf16 a[56:59], v[120:123], a[168:171], a[56:59]
    buffer_load_dwordx4 a[244:247], v51, s[28:31], s50 offen offset:1024 sc1
    v_mfma_f32_16x16x32_bf16 a[56:59], v[124:127], a[172:175], a[56:59]
    v_mfma_f32_16x16x32_bf16 a[60:63], v[112:115], a[176:179], a[60:63]
    v_mfma_f32_16x16x32_bf16 a[60:63], v[116:119], a[180:183], a[60:63]
    v_mfma_f32_16x16x32_bf16 a[60:63], v[120:123], a[184:187], a[60:63]
    buffer_load_dwordx4 a[248:251], v51, s[28:31], s50 offen offset:2048 sc1
    v_mfma_f32_16x16x32_bf16 a[60:63], v[124:127], a[188:191], a[60:63]
    s_waitcnt lgkmcnt(0)
    v_mfma_f32_16x16x32_bf16 a[64:67], v[64:67], a[128:131], a[64:67]
    ds_read_b64_tr_b16 v[96:97], v238 offset:192
    v_mfma_f32_16x16x32_bf16 a[64:67], v[68:71], a[132:135], a[64:67]
    ds_read_b64_tr_b16 v[98:99], v238 offset:448
    v_mfma_f32_16x16x32_bf16 a[64:67], v[72:75], a[136:139], a[64:67]
    ds_read_b64_tr_b16 v[100:101], v238 offset:704
    v_mfma_f32_16x16x32_bf16 a[64:67], v[76:79], a[140:143], a[64:67]
    buffer_load_dwordx4 a[252:255], v51, s[28:31], s50 offen offset:3072 sc1
    v_mfma_f32_16x16x32_bf16 a[68:71], v[64:67], a[144:147], a[68:71]
    ds_read_b64_tr_b16 v[102:103], v238 offset:960
    s_add_u32 s50, s50, 4096
    v_mfma_f32_16x16x32_bf16 a[68:71], v[68:71], a[148:151], a[68:71]
    ds_read_b64_tr_b16 v[104:105], v238 offset:17088
    ds_read_b64_tr_b16 v[106:107], v238 offset:17344
    v_mfma_f32_16x16x32_bf16 a[68:71], v[72:75], a[152:155], a[68:71]
    ds_read_b64_tr_b16 v[108:109], v238 offset:17600
    s_mov_b32 s61, 8192
    v_mfma_f32_16x16x32_bf16 a[68:71], v[76:79], a[156:159], a[68:71]
    ds_read_b64_tr_b16 v[110:111], v238 offset:17856
    v_mfma_f32_16x16x32_bf16 a[72:75], v[64:67], a[160:163], a[72:75]
    buffer_store_dwordx4 v[24:27], v255, s[4:7], s61 offen offset:2048 sc1
    v_mfma_f32_16x16x32_bf16 a[72:75], v[68:71], a[164:167], a[72:75]
    v_mfma_f32_16x16x32_bf16 a[72:75], v[72:75], a[168:171], a[72:75]
    s_mov_b32 s61, 8192
    v_mfma_f32_16x16x32_bf16 a[72:75], v[76:79], a[172:175], a[72:75]
    buffer_store_dwordx4 v[28:31], v255, s[4:7], s61 offen offset:3072 sc1
    v_mfma_f32_16x16x32_bf16 a[76:79], v[64:67], a[176:179], a[76:79]
    v_mfma_f32_16x16x32_bf16 a[76:79], v[68:71], a[180:183], a[76:79]
    v_mfma_f32_16x16x32_bf16 a[76:79], v[72:75], a[184:187], a[76:79]
    v_mfma_f32_16x16x32_bf16 a[76:79], v[76:79], a[188:191], a[76:79]
    s_mov_b32 s61, 16384
    v_mfma_f32_16x16x32_bf16 a[80:83], v[80:83], a[128:131], a[80:83]
    buffer_store_dwordx4 v[32:35], v255, s[4:7], s61 offen offset:0 sc1
    v_mfma_f32_16x16x32_bf16 a[80:83], v[84:87], a[132:135], a[80:83]
    ds_read_b64_tr_b16 v[112:113], v238 offset:224
    ds_read_b64_tr_b16 v[114:115], v238 offset:480
    v_mfma_f32_16x16x32_bf16 a[80:83], v[88:91], a[136:139], a[80:83]
    ds_read_b64_tr_b16 v[116:117], v238 offset:736
    v_mfma_f32_16x16x32_bf16 a[80:83], v[92:95], a[140:143], a[80:83]
    ds_read_b64_tr_b16 v[118:119], v238 offset:992
    s_add_u32 m0, s53, 101376
    v_mfma_f32_16x16x32_bf16 a[84:87], v[80:83], a[144:147], a[84:87]
    buffer_load_dwordx4 v248, s[40:43], s66 offen offset:0 lds
    v_mfma_f32_16x16x32_bf16 a[84:87], v[84:87], a[148:151], a[84:87]
    ds_read_b64_tr_b16 v[120:121], v238 offset:17120
    ds_read_b64_tr_b16 v[122:123], v238 offset:17376
    v_mfma_f32_16x16x32_bf16 a[84:87], v[88:91], a[152:155], a[84:87]
    ds_read_b64_tr_b16 v[124:125], v238 offset:17632
    v_mfma_f32_16x16x32_bf16 a[84:87], v[92:95], a[156:159], a[84:87]
    ds_read_b64_tr_b16 v[126:127], v238 offset:17888
    v_mfma_f32_16x16x32_bf16 a[88:91], v[80:83], a[160:163], a[88:91]
    v_mfma_f32_16x16x32_bf16 a[88:91], v[84:87], a[164:167], a[88:91]
    buffer_load_dwordx4 v249, s[40:43], s66 offen offset:1056 lds
    v_mfma_f32_16x16x32_bf16 a[88:91], v[88:91], a[168:171], a[88:91]
    v_mfma_f32_16x16x32_bf16 a[88:91], v[92:95], a[172:175], a[88:91]
    v_mfma_f32_16x16x32_bf16 a[92:95], v[80:83], a[176:179], a[92:95]
    v_mfma_f32_16x16x32_bf16 a[92:95], v[84:87], a[180:183], a[92:95]
    buffer_load_dwordx4 v250, s[40:43], s66 offen offset:2112 lds
    v_mfma_f32_16x16x32_bf16 a[92:95], v[88:91], a[184:187], a[92:95]
    v_mfma_f32_16x16x32_bf16 a[92:95], v[92:95], a[188:191], a[92:95]
    s_waitcnt lgkmcnt(0)
    v_mfma_f32_16x16x32_bf16 a[96:99], v[96:99], a[128:131], a[96:99]
    v_mfma_f32_16x16x32_bf16 a[96:99], v[100:103], a[132:135], a[96:99]
    buffer_load_dwordx4 v251, s[40:43], s66 offen offset:3168 lds
    v_mfma_f32_16x16x32_bf16 a[96:99], v[104:107], a[136:139], a[96:99]
    s_add_u32 s66, s66, 131072
    v_mfma_f32_16x16x32_bf16 a[96:99], v[108:111], a[140:143], a[96:99]
    v_mfma_f32_16x16x32_bf16 a[100:103], v[96:99], a[144:147], a[100:103]
    s_waitcnt vmcnt(50) lgkmcnt(0)
    s_barrier
    v_mfma_f32_16x16x32_bf16 a[100:103], v[100:103], a[148:151], a[100:103]
    ds_read_b64_tr_b16 v[64:65], v238 offset:33792
    s_add_u32 m0, s53, 118272
    v_mfma_f32_16x16x32_bf16 a[100:103], v[104:107], a[152:155], a[100:103]
    buffer_load_dwordx4 v248, s[40:43], s66 offen offset:0 lds
    v_mfma_f32_16x16x32_bf16 a[100:103], v[108:111], a[156:159], a[100:103]
    ds_read_b64_tr_b16 v[66:67], v238 offset:34048
    ds_read_b64_tr_b16 v[68:69], v238 offset:34304
    v_mfma_f32_16x16x32_bf16 a[104:107], v[96:99], a[160:163], a[104:107]
    ds_read_b64_tr_b16 v[70:71], v238 offset:34560
    v_mfma_f32_16x16x32_bf16 a[104:107], v[100:103], a[164:167], a[104:107]
    ds_read_b64_tr_b16 v[72:73], v238 offset:50688
    v_mfma_f32_16x16x32_bf16 a[104:107], v[104:107], a[168:171], a[104:107]
    buffer_load_dwordx4 v249, s[40:43], s66 offen offset:1056 lds
    v_mfma_f32_16x16x32_bf16 a[104:107], v[108:111], a[172:175], a[104:107]
    ds_read_b64_tr_b16 v[74:75], v238 offset:50944
    ds_read_b64_tr_b16 v[76:77], v238 offset:51200
    v_mfma_f32_16x16x32_bf16 a[108:111], v[96:99], a[176:179], a[108:111]
    ds_read_b64_tr_b16 v[78:79], v238 offset:51456
    v_mfma_f32_16x16x32_bf16 a[108:111], v[100:103], a[180:183], a[108:111]
    v_mfma_f32_16x16x32_bf16 a[108:111], v[104:107], a[184:187], a[108:111]
    v_mfma_f32_16x16x32_bf16 a[108:111], v[108:111], a[188:191], a[108:111]
    buffer_load_dwordx4 v250, s[40:43], s66 offen offset:2112 lds
    v_mfma_f32_16x16x32_bf16 a[112:115], v[112:115], a[128:131], a[112:115]
    v_mfma_f32_16x16x32_bf16 a[112:115], v[116:119], a[132:135], a[112:115]
    ds_read_b64_tr_b16 v[80:81], v238 offset:33824
    v_mfma_f32_16x16x32_bf16 a[112:115], v[120:123], a[136:139], a[112:115]
    ds_read_b64_tr_b16 v[82:83], v238 offset:34080
    v_mfma_f32_16x16x32_bf16 a[112:115], v[124:127], a[140:143], a[112:115]
    buffer_load_dwordx4 v251, s[40:43], s66 offen offset:3168 lds
    v_mfma_f32_16x16x32_bf16 a[116:119], v[112:115], a[144:147], a[116:119]
    ds_read_b64_tr_b16 v[84:85], v238 offset:34336
    s_add_u32 s66, s66, 131072
    v_mfma_f32_16x16x32_bf16 a[116:119], v[116:119], a[148:151], a[116:119]
    ds_read_b64_tr_b16 v[86:87], v238 offset:34592
    ds_read_b64_tr_b16 v[88:89], v238 offset:50720
    v_mfma_f32_16x16x32_bf16 a[116:119], v[120:123], a[152:155], a[116:119]
    ds_read_b64_tr_b16 v[90:91], v238 offset:50976
    v_mfma_f32_16x16x32_bf16 a[116:119], v[124:127], a[156:159], a[116:119]
    ds_read_b64_tr_b16 v[92:93], v238 offset:51232
    v_mfma_f32_16x16x32_bf16 a[120:123], v[112:115], a[160:163], a[120:123]
    ds_read_b64_tr_b16 v[94:95], v238 offset:51488
    v_mfma_f32_16x16x32_bf16 a[120:123], v[116:119], a[164:167], a[120:123]
    v_mfma_f32_16x16x32_bf16 a[120:123], v[120:123], a[168:171], a[120:123]
    v_mfma_f32_16x16x32_bf16 a[120:123], v[124:127], a[172:175], a[120:123]
    v_mfma_f32_16x16x32_bf16 a[124:127], v[112:115], a[176:179], a[124:127]
    v_mfma_f32_16x16x32_bf16 a[124:127], v[116:119], a[180:183], a[124:127]
    v_mfma_f32_16x16x32_bf16 a[124:127], v[120:123], a[184:187], a[124:127]
    v_mfma_f32_16x16x32_bf16 a[124:127], v[124:127], a[188:191], a[124:127]
    s_waitcnt vmcnt(11)
    s_waitcnt lgkmcnt(0)
    v_mfma_f32_16x16x32_bf16 a[0:3], v[64:67], a[192:195], a[0:3]
    ds_read_b64_tr_b16 v[96:97], v238 offset:33856
    v_mfma_f32_16x16x32_bf16 a[0:3], v[68:71], a[196:199], a[0:3]
    buffer_load_dwordx4 a[128:131], v48, s[28:31], s50 offen offset:0 sc1
    v_mfma_f32_16x16x32_bf16 a[0:3], v[72:75], a[200:203], a[0:3]
    ds_read_b64_tr_b16 v[98:99], v238 offset:34112
    ds_read_b64_tr_b16 v[100:101], v238 offset:34368
    v_mfma_f32_16x16x32_bf16 a[0:3], v[76:79], a[204:207], a[0:3]
    ds_read_b64_tr_b16 v[102:103], v238 offset:34624
    v_mfma_f32_16x16x32_bf16 a[4:7], v[64:67], a[208:211], a[4:7]
    ds_read_b64_tr_b16 v[104:105], v238 offset:50752
    v_mfma_f32_16x16x32_bf16 a[4:7], v[68:71], a[212:215], a[4:7]
    buffer_load_dwordx4 a[132:135], v48, s[28:31], s50 offen offset:1024 sc1
    v_mfma_f32_16x16x32_bf16 a[4:7], v[72:75], a[216:219], a[4:7]
    ds_read_b64_tr_b16 v[106:107], v238 offset:51008
    ds_read_b64_tr_b16 v[108:109], v238 offset:51264
    v_mfma_f32_16x16x32_bf16 a[4:7], v[76:79], a[220:223], a[4:7]
    ds_read_b64_tr_b16 v[110:111], v238 offset:51520
    v_mfma_f32_16x16x32_bf16 a[8:11], v[64:67], a[224:227], a[8:11]
    v_mfma_f32_16x16x32_bf16 a[8:11], v[68:71], a[228:231], a[8:11]
    buffer_load_dwordx4 a[136:139], v48, s[28:31], s50 offen offset:2048 sc1
    v_mfma_f32_16x16x32_bf16 a[8:11], v[72:75], a[232:235], a[8:11]
    v_mfma_f32_16x16x32_bf16 a[8:11], v[76:79], a[236:239], a[8:11]
    v_mfma_f32_16x16x32_bf16 a[12:15], v[64:67], a[240:243], a[12:15]
    v_mfma_f32_16x16x32_bf16 a[12:15], v[68:71], a[244:247], a[12:15]
    v_mfma_f32_16x16x32_bf16 a[12:15], v[72:75], a[248:251], a[12:15]
    buffer_load_dwordx4 a[140:143], v48, s[28:31], s50 offen offset:3072 sc1
    v_mfma_f32_16x16x32_bf16 a[12:15], v[76:79], a[252:255], a[12:15]
    v_mfma_f32_16x16x32_bf16 a[16:19], v[80:83], a[192:195], a[16:19]
    ds_read_b64_tr_b16 v[112:113], v238 offset:33888
    v_mfma_f32_16x16x32_bf16 a[16:19], v[84:87], a[196:199], a[16:19]
    ds_read_b64_tr_b16 v[114:115], v238 offset:34144
    v_mfma_f32_16x16x32_bf16 a[16:19], v[88:91], a[200:203], a[16:19]
    buffer_load_dwordx4 a[144:147], v49, s[28:31], s50 offen offset:0 sc1
    v_mfma_f32_16x16x32_bf16 a[16:19], v[92:95], a[204:207], a[16:19]
    ds_read_b64_tr_b16 v[116:117], v238 offset:34400
    ds_read_b64_tr_b16 v[118:119], v238 offset:34656
    v_mfma_f32_16x16x32_bf16 a[20:23], v[80:83], a[208:211], a[20:23]
    ds_read_b64_tr_b16 v[120:121], v238 offset:50784
    v_mfma_f32_16x16x32_bf16 a[20:23], v[84:87], a[212:215], a[20:23]
    ds_read_b64_tr_b16 v[122:123], v238 offset:51040
    v_mfma_f32_16x16x32_bf16 a[20:23], v[88:91], a[216:219], a[20:23]
    ds_read_b64_tr_b16 v[124:125], v238 offset:51296
    v_mfma_f32_16x16x32_bf16 a[20:23], v[92:95], a[220:223], a[20:23]
    ds_read_b64_tr_b16 v[126:127], v238 offset:51552
    v_mfma_f32_16x16x32_bf16 a[24:27], v[80:83], a[224:227], a[24:27]
    buffer_load_dwordx4 a[148:151], v49, s[28:31], s50 offen offset:1024 sc1
    v_mfma_f32_16x16x32_bf16 a[24:27], v[84:87], a[228:231], a[24:27]
    v_mfma_f32_16x16x32_bf16 a[24:27], v[88:91], a[232:235], a[24:27]
    v_mfma_f32_16x16x32_bf16 a[24:27], v[92:95], a[236:239], a[24:27]
    buffer_load_dwordx4 a[152:155], v49, s[28:31], s50 offen offset:2048 sc1
    v_mfma_f32_16x16x32_bf16 a[28:31], v[80:83], a[240:243], a[28:31]
    v_mfma_f32_16x16x32_bf16 a[28:31], v[84:87], a[244:247], a[28:31]
    v_mfma_f32_16x16x32_bf16 a[28:31], v[88:91], a[248:251], a[28:31]
    v_mfma_f32_16x16x32_bf16 a[28:31], v[92:95], a[252:255], a[28:31]
    buffer_load_dwordx4 a[156:159], v49, s[28:31], s50 offen offset:3072 sc1
    s_waitcnt lgkmcnt(0)
    v_mfma_f32_16x16x32_bf16 a[32:35], v[96:99], a[192:195], a[32:35]
    ds_read_b64_tr_b16 v[64:65], v238 offset:33920
    v_mfma_f32_16x16x32_bf16 a[32:35], v[100:103], a[196:199], a[32:35]
    ds_read_b64_tr_b16 v[66:67], v238 offset:34176
    v_mfma_f32_16x16x32_bf16 a[32:35], v[104:107], a[200:203], a[32:35]
    ds_read_b64_tr_b16 v[68:69], v238 offset:34432
    v_mfma_f32_16x16x32_bf16 a[32:35], v[108:111], a[204:207], a[32:35]
    ds_read_b64_tr_b16 v[70:71], v238 offset:34688
    v_mfma_f32_16x16x32_bf16 a[36:39], v[96:99], a[208:211], a[36:39]
    buffer_load_dwordx4 a[160:163], v50, s[28:31], s50 offen offset:0 sc1
    v_mfma_f32_16x16x32_bf16 a[36:39], v[100:103], a[212:215], a[36:39]
    ds_read_b64_tr_b16 v[72:73], v238 offset:50816
    ds_read_b64_tr_b16 v[74:75], v238 offset:51072
    v_mfma_f32_16x16x32_bf16 a[36:39], v[104:107], a[216:219], a[36:39]
    ds_read_b64_tr_b16 v[76:77], v238 offset:51328
    v_mfma_f32_16x16x32_bf16 a[36:39], v[108:111], a[220:223], a[36:39]
    ds_read_b64_tr_b16 v[78:79], v238 offset:51584
    v_mfma_f32_16x16x32_bf16 a[40:43], v[96:99], a[224:227], a[40:43]
    buffer_load_dwordx4 a[164:167], v50, s[28:31], s50 offen offset:1024 sc1
    v_mfma_f32_16x16x32_bf16 a[40:43], v[100:103], a[228:231], a[40:43]
    v_mfma_f32_16x16x32_bf16 a[40:43], v[104:107], a[232:235], a[40:43]
    v_mfma_f32_16x16x32_bf16 a[40:43], v[108:111], a[236:239], a[40:43]
    v_mfma_f32_16x16x32_bf16 a[44:47], v[96:99], a[240:243], a[44:47]
    v_mfma_f32_16x16x32_bf16 a[44:47], v[100:103], a[244:247], a[44:47]
    buffer_load_dwordx4 a[168:171], v50, s[28:31], s50 offen offset:2048 sc1
    v_mfma_f32_16x16x32_bf16 a[44:47], v[104:107], a[248:251], a[44:47]
    v_mfma_f32_16x16x32_bf16 a[44:47], v[108:111], a[252:255], a[44:47]
    v_mfma_f32_16x16x32_bf16 a[48:51], v[112:115], a[192:195], a[48:51]
    ds_read_b64_tr_b16 v[80:81], v238 offset:33952
    v_mfma_f32_16x16x32_bf16 a[48:51], v[116:119], a[196:199], a[48:51]
    buffer_load_dwordx4 a[172:175], v50, s[28:31], s50 offen offset:3072 sc1
    v_mfma_f32_16x16x32_bf16 a[48:51], v[120:123], a[200:203], a[48:51]
    ds_read_b64_tr_b16 v[82:83], v238 offset:34208
    ds_read_b64_tr_b16 v[84:85], v238 offset:34464
    v_mfma_f32_16x16x32_bf16 a[48:51], v[124:127], a[204:207], a[48:51]
    ds_read_b64_tr_b16 v[86:87], v238 offset:34720
    v_mfma_f32_16x16x32_bf16 a[52:55], v[112:115], a[208:211], a[52:55]
    ds_read_b64_tr_b16 v[88:89], v238 offset:50848
    v_mfma_f32_16x16x32_bf16 a[52:55], v[116:119], a[212:215], a[52:55]
    buffer_load_dwordx4 a[176:179], v51, s[28:31], s50 offen offset:0 sc1
    v_mfma_f32_16x16x32_bf16 a[52:55], v[120:123], a[216:219], a[52:55]
    ds_read_b64_tr_b16 v[90:91], v238 offset:51104
    ds_read_b64_tr_b16 v[92:93], v238 offset:51360
    v_mfma_f32_16x16x32_bf16 a[52:55], v[124:127], a[220:223], a[52:55]
    ds_read_b64_tr_b16 v[94:95], v238 offset:51616
    v_mfma_f32_16x16x32_bf16 a[56:59], v[112:115], a[224:227], a[56:59]
    v_mfma_f32_16x16x32_bf16 a[56:59], v[116:119], a[228:231], a[56:59]
    v_mfma_f32_16x16x32_bf16 a[56:59], v[120:123], a[232:235], a[56:59]
    buffer_load_dwordx4 a[180:183], v51, s[28:31], s50 offen offset:1024 sc1
    v_mfma_f32_16x16x32_bf16 a[56:59], v[124:127], a[236:239], a[56:59]
    v_mfma_f32_16x16x32_bf16 a[60:63], v[112:115], a[240:243], a[60:63]
    v_mfma_f32_16x16x32_bf16 a[60:63], v[116:119], a[244:247], a[60:63]
    v_mfma_f32_16x16x32_bf16 a[60:63], v[120:123], a[248:251], a[60:63]
    buffer_load_dwordx4 a[184:187], v51, s[28:31], s50 offen offset:2048 sc1
    v_mfma_f32_16x16x32_bf16 a[60:63], v[124:127], a[252:255], a[60:63]
    s_waitcnt lgkmcnt(0)
    v_mfma_f32_16x16x32_bf16 a[64:67], v[64:67], a[192:195], a[64:67]
    ds_read_b64_tr_b16 v[96:97], v238 offset:33984
    v_mfma_f32_16x16x32_bf16 a[64:67], v[68:71], a[196:199], a[64:67]
    ds_read_b64_tr_b16 v[98:99], v238 offset:34240
    v_mfma_f32_16x16x32_bf16 a[64:67], v[72:75], a[200:203], a[64:67]
    ds_read_b64_tr_b16 v[100:101], v238 offset:34496
    v_mfma_f32_16x16x32_bf16 a[64:67], v[76:79], a[204:207], a[64:67]
    buffer_load_dwordx4 a[188:191], v51, s[28:31], s50 offen offset:3072 sc1
    v_mfma_f32_16x16x32_bf16 a[68:71], v[64:67], a[208:211], a[68:71]
    ds_read_b64_tr_b16 v[102:103], v238 offset:34752
    s_add_u32 s50, s50, 4096
    v_mfma_f32_16x16x32_bf16 a[68:71], v[68:71], a[212:215], a[68:71]
    ds_read_b64_tr_b16 v[104:105], v238 offset:50880
    ds_read_b64_tr_b16 v[106:107], v238 offset:51136
    v_mfma_f32_16x16x32_bf16 a[68:71], v[72:75], a[216:219], a[68:71]
    ds_read_b64_tr_b16 v[108:109], v238 offset:51392
    s_mov_b32 s61, 16384
    v_mfma_f32_16x16x32_bf16 a[68:71], v[76:79], a[220:223], a[68:71]
    ds_read_b64_tr_b16 v[110:111], v238 offset:51648
    v_mfma_f32_16x16x32_bf16 a[72:75], v[64:67], a[224:227], a[72:75]
    buffer_store_dwordx4 v[36:39], v255, s[4:7], s61 offen offset:1024 sc1
    v_mfma_f32_16x16x32_bf16 a[72:75], v[68:71], a[228:231], a[72:75]
    v_mfma_f32_16x16x32_bf16 a[72:75], v[72:75], a[232:235], a[72:75]
    s_mov_b32 s61, 16384
    v_mfma_f32_16x16x32_bf16 a[72:75], v[76:79], a[236:239], a[72:75]
    buffer_store_dwordx4 v[40:43], v255, s[4:7], s61 offen offset:2048 sc1
    v_mfma_f32_16x16x32_bf16 a[76:79], v[64:67], a[240:243], a[76:79]
    v_mfma_f32_16x16x32_bf16 a[76:79], v[68:71], a[244:247], a[76:79]
    v_mfma_f32_16x16x32_bf16 a[76:79], v[72:75], a[248:251], a[76:79]
    v_mfma_f32_16x16x32_bf16 a[76:79], v[76:79], a[252:255], a[76:79]
    s_mov_b32 s61, 16384
    v_mfma_f32_16x16x32_bf16 a[80:83], v[80:83], a[192:195], a[80:83]
    buffer_store_dwordx4 v[44:47], v255, s[4:7], s61 offen offset:3072 sc1
    v_mfma_f32_16x16x32_bf16 a[80:83], v[84:87], a[196:199], a[80:83]
    ds_read_b64_tr_b16 v[112:113], v238 offset:34016
    ds_read_b64_tr_b16 v[114:115], v238 offset:34272
    v_mfma_f32_16x16x32_bf16 a[80:83], v[88:91], a[200:203], a[80:83]
    ds_read_b64_tr_b16 v[116:117], v238 offset:34528
    v_mfma_f32_16x16x32_bf16 a[80:83], v[92:95], a[204:207], a[80:83]
    ds_read_b64_tr_b16 v[118:119], v238 offset:34784
    s_add_u32 m0, s53, 0
    v_mfma_f32_16x16x32_bf16 a[84:87], v[80:83], a[208:211], a[84:87]
    buffer_load_dwordx4 v248, s[40:43], s66 offen offset:0 lds
    v_mfma_f32_16x16x32_bf16 a[84:87], v[84:87], a[212:215], a[84:87]
    ds_read_b64_tr_b16 v[120:121], v238 offset:50912
    ds_read_b64_tr_b16 v[122:123], v238 offset:51168
    v_mfma_f32_16x16x32_bf16 a[84:87], v[88:91], a[216:219], a[84:87]
    ds_read_b64_tr_b16 v[124:125], v238 offset:51424
    v_mfma_f32_16x16x32_bf16 a[84:87], v[92:95], a[220:223], a[84:87]
    ds_read_b64_tr_b16 v[126:127], v238 offset:51680
    v_mfma_f32_16x16x32_bf16 a[88:91], v[80:83], a[224:227], a[88:91]
    v_mfma_f32_16x16x32_bf16 a[88:91], v[84:87], a[228:231], a[88:91]
    buffer_load_dwordx4 v249, s[40:43], s66 offen offset:1056 lds
    v_mfma_f32_16x16x32_bf16 a[88:91], v[88:91], a[232:235], a[88:91]
    v_mfma_f32_16x16x32_bf16 a[88:91], v[92:95], a[236:239], a[88:91]
    v_mfma_f32_16x16x32_bf16 a[92:95], v[80:83], a[240:243], a[92:95]
    v_mfma_f32_16x16x32_bf16 a[92:95], v[84:87], a[244:247], a[92:95]
    buffer_load_dwordx4 v250, s[40:43], s66 offen offset:2112 lds
    v_mfma_f32_16x16x32_bf16 a[92:95], v[88:91], a[248:251], a[92:95]
    v_mfma_f32_16x16x32_bf16 a[92:95], v[92:95], a[252:255], a[92:95]
    s_waitcnt lgkmcnt(0)
    v_mfma_f32_16x16x32_bf16 a[96:99], v[96:99], a[192:195], a[96:99]
    v_mfma_f32_16x16x32_bf16 a[96:99], v[100:103], a[196:199], a[96:99]
    buffer_load_dwordx4 v251, s[40:43], s66 offen offset:3168 lds
    v_mfma_f32_16x16x32_bf16 a[96:99], v[104:107], a[200:203], a[96:99]
    s_add_u32 s66, s66, 131072
    v_mfma_f32_16x16x32_bf16 a[96:99], v[108:111], a[204:207], a[96:99]
    v_mfma_f32_16x16x32_bf16 a[100:103], v[96:99], a[208:211], a[100:103]
    s_waitcnt vmcnt(50) lgkmcnt(0)
    s_barrier
    v_mfma_f32_16x16x32_bf16 a[100:103], v[100:103], a[212:215], a[100:103]
    ds_read_b64_tr_b16 v[64:65], v239 offset:0
    s_add_u32 m0, s53, 16896
    v_mfma_f32_16x16x32_bf16 a[100:103], v[104:107], a[216:219], a[100:103]
    buffer_load_dwordx4 v248, s[40:43], s66 offen offset:0 lds
    v_mfma_f32_16x16x32_bf16 a[100:103], v[108:111], a[220:223], a[100:103]
    ds_read_b64_tr_b16 v[66:67], v239 offset:256
    ds_read_b64_tr_b16 v[68:69], v239 offset:512
    v_mfma_f32_16x16x32_bf16 a[104:107], v[96:99], a[224:227], a[104:107]
    ds_read_b64_tr_b16 v[70:71], v239 offset:768
    v_mfma_f32_16x16x32_bf16 a[104:107], v[100:103], a[228:231], a[104:107]
    ds_read_b64_tr_b16 v[72:73], v239 offset:16896
    v_mfma_f32_16x16x32_bf16 a[104:107], v[104:107], a[232:235], a[104:107]
    buffer_load_dwordx4 v249, s[40:43], s66 offen offset:1056 lds
    v_mfma_f32_16x16x32_bf16 a[104:107], v[108:111], a[236:239], a[104:107]
    ds_read_b64_tr_b16 v[74:75], v239 offset:17152
    ds_read_b64_tr_b16 v[76:77], v239 offset:17408
    v_mfma_f32_16x16x32_bf16 a[108:111], v[96:99], a[240:243], a[108:111]
    ds_read_b64_tr_b16 v[78:79], v239 offset:17664
    v_mfma_f32_16x16x32_bf16 a[108:111], v[100:103], a[244:247], a[108:111]
    v_mfma_f32_16x16x32_bf16 a[108:111], v[104:107], a[248:251], a[108:111]
    v_mfma_f32_16x16x32_bf16 a[108:111], v[108:111], a[252:255], a[108:111]
    buffer_load_dwordx4 v250, s[40:43], s66 offen offset:2112 lds
    v_mfma_f32_16x16x32_bf16 a[112:115], v[112:115], a[192:195], a[112:115]
    v_mfma_f32_16x16x32_bf16 a[112:115], v[116:119], a[196:199], a[112:115]
    ds_read_b64_tr_b16 v[80:81], v239 offset:32
    v_mfma_f32_16x16x32_bf16 a[112:115], v[120:123], a[200:203], a[112:115]
    ds_read_b64_tr_b16 v[82:83], v239 offset:288
    v_mfma_f32_16x16x32_bf16 a[112:115], v[124:127], a[204:207], a[112:115]
    buffer_load_dwordx4 v251, s[40:43], s66 offen offset:3168 lds
    v_mfma_f32_16x16x32_bf16 a[116:119], v[112:115], a[208:211], a[116:119]
    ds_read_b64_tr_b16 v[84:85], v239 offset:544
    s_add_u32 s66, s66, 131072
    v_mfma_f32_16x16x32_bf16 a[116:119], v[116:119], a[212:215], a[116:119]
    ds_read_b64_tr_b16 v[86:87], v239 offset:800
    ds_read_b64_tr_b16 v[88:89], v239 offset:16928
    v_mfma_f32_16x16x32_bf16 a[116:119], v[120:123], a[216:219], a[116:119]
    ds_read_b64_tr_b16 v[90:91], v239 offset:17184
    v_mfma_f32_16x16x32_bf16 a[116:119], v[124:127], a[220:223], a[116:119]
    ds_read_b64_tr_b16 v[92:93], v239 offset:17440
    v_mfma_f32_16x16x32_bf16 a[120:123], v[112:115], a[224:227], a[120:123]
    ds_read_b64_tr_b16 v[94:95], v239 offset:17696
    v_mfma_f32_16x16x32_bf16 a[120:123], v[116:119], a[228:231], a[120:123]
    v_mfma_f32_16x16x32_bf16 a[120:123], v[120:123], a[232:235], a[120:123]
    v_mfma_f32_16x16x32_bf16 a[120:123], v[124:127], a[236:239], a[120:123]
    v_mfma_f32_16x16x32_bf16 a[124:127], v[112:115], a[240:243], a[124:127]
    v_mfma_f32_16x16x32_bf16 a[124:127], v[116:119], a[244:247], a[124:127]
    v_mfma_f32_16x16x32_bf16 a[124:127], v[120:123], a[248:251], a[124:127]
    v_mfma_f32_16x16x32_bf16 a[124:127], v[124:127], a[252:255], a[124:127]
    s_waitcnt vmcnt(11)
    s_waitcnt lgkmcnt(0)
    v_mfma_f32_16x16x32_bf16 a[0:3], v[64:67], a[128:131], a[0:3]
    ds_read_b64_tr_b16 v[96:97], v239 offset:64
    v_mfma_f32_16x16x32_bf16 a[0:3], v[68:71], a[132:135], a[0:3]
    buffer_load_dwordx4 a[192:195], v48, s[28:31], s50 offen offset:0 sc1
    v_mfma_f32_16x16x32_bf16 a[0:3], v[72:75], a[136:139], a[0:3]
    ds_read_b64_tr_b16 v[98:99], v239 offset:320
    ds_read_b64_tr_b16 v[100:101], v239 offset:576
    v_mfma_f32_16x16x32_bf16 a[0:3], v[76:79], a[140:143], a[0:3]
    ds_read_b64_tr_b16 v[102:103], v239 offset:832
    v_mfma_f32_16x16x32_bf16 a[4:7], v[64:67], a[144:147], a[4:7]
    ds_read_b64_tr_b16 v[104:105], v239 offset:16960
    v_mfma_f32_16x16x32_bf16 a[4:7], v[68:71], a[148:151], a[4:7]
    ds_read_b64_tr_b16 v[106:107], v239 offset:17216
    v_mfma_f32_16x16x32_bf16 a[4:7], v[72:75], a[152:155], a[4:7]
    ds_read_b64_tr_b16 v[108:109], v239 offset:17472
    v_mfma_f32_16x16x32_bf16 a[4:7], v[76:79], a[156:159], a[4:7]
    ds_read_b64_tr_b16 v[110:111], v239 offset:17728
    v_mfma_f32_16x16x32_bf16 a[8:11], v[64:67], a[160:163], a[8:11]
    buffer_load_dwordx4 a[196:199], v48, s[28:31], s50 offen offset:1024 sc1
    v_mfma_f32_16x16x32_bf16 a[8:11], v[68:71], a[164:167], a[8:11]
    v_mfma_f32_16x16x32_bf16 a[8:11], v[72:75], a[168:171], a[8:11]
    v_mfma_f32_16x16x32_bf16 a[8:11], v[76:79], a[172:175], a[8:11]
    v_mfma_f32_16x16x32_bf16 a[12:15], v[64:67], a[176:179], a[12:15]
    v_mfma_f32_16x16x32_bf16 a[12:15], v[68:71], a[180:183], a[12:15]
    v_mfma_f32_16x16x32_bf16 a[12:15], v[72:75], a[184:187], a[12:15]
    v_mfma_f32_16x16x32_bf16 a[12:15], v[76:79], a[188:191], a[12:15]
    buffer_load_dwordx4 a[200:203], v48, s[28:31], s50 offen offset:2048 sc1
    v_mfma_f32_16x16x32_bf16 a[16:19], v[80:83], a[128:131], a[16:19]
    ds_read_b64_tr_b16 v[112:113], v239 offset:96
    v_mfma_f32_16x16x32_bf16 a[16:19], v[84:87], a[132:135], a[16:19]
    ds_read_b64_tr_b16 v[114:115], v239 offset:352
    v_mfma_f32_16x16x32_bf16 a[16:19], v[88:91], a[136:139], a[16:19]
    ds_read_b64_tr_b16 v[116:117], v239 offset:608
    v_mfma_f32_16x16x32_bf16 a[16:19], v[92:95], a[140:143], a[16:19]
    ds_read_b64_tr_b16 v[118:119], v239 offset:864
    v_mfma_f32_16x16x32_bf16 a[20:23], v[80:83], a[144:147], a[20:23]
    ds_read_b64_tr_b16 v[120:121], v239 offset:16992
    v_mfma_f32_16x16x32_bf16 a[20:23], v[84:87], a[148:151], a[20:23]
    ds_read_b64_tr_b16 v[122:123], v239 offset:17248
    v_mfma_f32_16x16x32_bf16 a[20:23], v[88:91], a[152:155], a[20:23]
    ds_read_b64_tr_b16 v[124:125], v239 offset:17504
    v_mfma_f32_16x16x32_bf16 a[20:23], v[92:95], a[156:159], a[20:23]
    ds_read_b64_tr_b16 v[126:127], v239 offset:17760
    v_mfma_f32_16x16x32_bf16 a[24:27], v[80:83], a[160:163], a[24:27]
    buffer_load_dwordx4 a[204:207], v48, s[28:31], s50 offen offset:3072 sc1
    v_mfma_f32_16x16x32_bf16 a[24:27], v[84:87], a[164:167], a[24:27]
    v_mfma_f32_16x16x32_bf16 a[24:27], v[88:91], a[168:171], a[24:27]
    v_mfma_f32_16x16x32_bf16 a[24:27], v[92:95], a[172:175], a[24:27]
    v_mfma_f32_16x16x32_bf16 a[28:31], v[80:83], a[176:179], a[28:31]
    v_mfma_f32_16x16x32_bf16 a[28:31], v[84:87], a[180:183], a[28:31]
    v_mfma_f32_16x16x32_bf16 a[28:31], v[88:91], a[184:187], a[28:31]
    buffer_load_dwordx4 a[208:211], v49, s[28:31], s50 offen offset:0 sc1
    v_mfma_f32_16x16x32_bf16 a[28:31], v[92:95], a[188:191], a[28:31]
    s_waitcnt lgkmcnt(0)
    v_mfma_f32_16x16x32_bf16 a[32:35], v[96:99], a[128:131], a[32:35]
    ds_read_b64_tr_b16 v[64:65], v239 offset:128
    v_mfma_f32_16x16x32_bf16 a[32:35], v[100:103], a[132:135], a[32:35]
    ds_read_b64_tr_b16 v[66:67], v239 offset:384
    v_mfma_f32_16x16x32_bf16 a[32:35], v[104:107], a[136:139], a[32:35]
    ds_read_b64_tr_b16 v[68:69], v239 offset:640
    v_mfma_f32_16x16x32_bf16 a[32:35], v[108:111], a[140:143], a[32:35]
    ds_read_b64_tr_b16 v[70:71], v239 offset:896
    v_mfma_f32_16x16x32_bf16 a[36:39], v[96:99], a[144:147], a[36:39]
    ds_read_b64_tr_b16 v[72:73], v239 offset:17024
    v_mfma_f32_16x16x32_bf16 a[36:39], v[100:103], a[148:151], a[36:39]
    ds_read_b64_tr_b16 v[74:75], v239 offset:17280
    v_mfma_f32_16x16x32_bf16 a[36:39], v[104:107], a[152:155], a[36:39]
    ds_read_b64_tr_b16 v[76:77], v239 offset:17536
    v_mfma_f32_16x16x32_bf16 a[36:39], v[108:111], a[156:159], a[36:39]
    buffer_load_dwordx4 a[212:215], v49, s[28:31], s50 offen offset:1024 sc1
    v_mfma_f32_16x16x32_bf16 a[40:43], v[96:99], a[160:163], a[40:43]
    ds_read_b64_tr_b16 v[78:79], v239 offset:17792
    v_mfma_f32_16x16x32_bf16 a[40:43], v[100:103], a[164:167], a[40:43]
    v_mfma_f32_16x16x32_bf16 a[40:43], v[104:107], a[168:171], a[40:43]
    v_mfma_f32_16x16x32_bf16 a[40:43], v[108:111], a[172:175], a[40:43]
    v_mfma_f32_16x16x32_bf16 a[44:47], v[96:99], a[176:179], a[44:47]
    v_mfma_f32_16x16x32_bf16 a[44:47], v[100:103], a[180:183], a[44:47]
    buffer_load_dwordx4 a[216:219], v49, s[28:31], s50 offen offset:2048 sc1
    v_mfma_f32_16x16x32_bf16 a[44:47], v[104:107], a[184:187], a[44:47]
    v_mfma_f32_16x16x32_bf16 a[44:47], v[108:111], a[188:191], a[44:47]
    v_mfma_f32_16x16x32_bf16 a[48:51], v[112:115], a[128:131], a[48:51]
    ds_read_b64_tr_b16 v[80:81], v239 offset:160
    v_mfma_f32_16x16x32_bf16 a[48:51], v[116:119], a[132:135], a[48:51]
    ds_read_b64_tr_b16 v[82:83], v239 offset:416
    v_mfma_f32_16x16x32_bf16 a[48:51], v[120:123], a[136:139], a[48:51]
    ds_read_b64_tr_b16 v[84:85], v239 offset:672
    v_mfma_f32_16x16x32_bf16 a[48:51], v[124:127], a[140:143], a[48:51]
    ds_read_b64_tr_b16 v[86:87], v239 offset:928
    v_mfma_f32_16x16x32_bf16 a[52:55], v[112:115], a[144:147], a[52:55]
    ds_read_b64_tr_b16 v[88:89], v239 offset:17056
    v_mfma_f32_16x16x32_bf16 a[52:55], v[116:119], a[148:151], a[52:55]
    buffer_load_dwordx4 a[220:223], v49, s[28:31], s50 offen offset:3072 sc1
    v_mfma_f32_16x16x32_bf16 a[52:55], v[120:123], a[152:155], a[52:55]
    ds_read_b64_tr_b16 v[90:91], v239 offset:17312
    ds_read_b64_tr_b16 v[92:93], v239 offset:17568
    v_mfma_f32_16x16x32_bf16 a[52:55], v[124:127], a[156:159], a[52:55]
    ds_read_b64_tr_b16 v[94:95], v239 offset:17824
    v_mfma_f32_16x16x32_bf16 a[56:59], v[112:115], a[160:163], a[56:59]
    v_mfma_f32_16x16x32_bf16 a[56:59], v[116:119], a[164:167], a[56:59]
    v_mfma_f32_16x16x32_bf16 a[56:59], v[120:123], a[168:171], a[56:59]
    v_mfma_f32_16x16x32_bf16 a[56:59], v[124:127], a[172:175], a[56:59]
    v_mfma_f32_16x16x32_bf16 a[60:63], v[112:115], a[176:179], a[60:63]
    buffer_load_dwordx4 a[224:227], v50, s[28:31], s50 offen offset:0 sc1
    v_mfma_f32_16x16x32_bf16 a[60:63], v[116:119], a[180:183], a[60:63]
    v_mfma_f32_16x16x32_bf16 a[60:63], v[120:123], a[184:187], a[60:63]
    v_mfma_f32_16x16x32_bf16 a[60:63], v[124:127], a[188:191], a[60:63]
    s_waitcnt lgkmcnt(0)
    v_mfma_f32_16x16x32_bf16 a[64:67], v[64:67], a[128:131], a[64:67]
    ds_read_b64_tr_b16 v[96:97], v239 offset:192
    v_mfma_f32_16x16x32_bf16 a[64:67], v[68:71], a[132:135], a[64:67]
    ds_read_b64_tr_b16 v[98:99], v239 offset:448
    v_mfma_f32_16x16x32_bf16 a[64:67], v[72:75], a[136:139], a[64:67]
    ds_read_b64_tr_b16 v[100:101], v239 offset:704
    v_mfma_f32_16x16x32_bf16 a[64:67], v[76:79], a[140:143], a[64:67]
    buffer_load_dwordx4 a[228:231], v50, s[28:31], s50 offen offset:1024 sc1
    v_mfma_f32_16x16x32_bf16 a[68:71], v[64:67], a[144:147], a[68:71]
    ds_read_b64_tr_b16 v[102:103], v239 offset:960
    ds_read_b64_tr_b16 v[104:105], v239 offset:17088
    v_mfma_f32_16x16x32_bf16 a[68:71], v[68:71], a[148:151], a[68:71]
    ds_read_b64_tr_b16 v[106:107], v239 offset:17344
    v_mfma_f32_16x16x32_bf16 a[68:71], v[72:75], a[152:155], a[68:71]
    ds_read_b64_tr_b16 v[108:109], v239 offset:17600
    v_mfma_f32_16x16x32_bf16 a[68:71], v[76:79], a[156:159], a[68:71]
    ds_read_b64_tr_b16 v[110:111], v239 offset:17856
    v_mfma_f32_16x16x32_bf16 a[72:75], v[64:67], a[160:163], a[72:75]
    v_mfma_f32_16x16x32_bf16 a[72:75], v[68:71], a[164:167], a[72:75]
    v_mfma_f32_16x16x32_bf16 a[72:75], v[72:75], a[168:171], a[72:75]
    v_mfma_f32_16x16x32_bf16 a[72:75], v[76:79], a[172:175], a[72:75]
    buffer_load_dwordx4 a[232:235], v50, s[28:31], s50 offen offset:2048 sc1
    v_mfma_f32_16x16x32_bf16 a[76:79], v[64:67], a[176:179], a[76:79]
    v_mfma_f32_16x16x32_bf16 a[76:79], v[68:71], a[180:183], a[76:79]
    v_mfma_f32_16x16x32_bf16 a[76:79], v[72:75], a[184:187], a[76:79]
    v_mfma_f32_16x16x32_bf16 a[76:79], v[76:79], a[188:191], a[76:79]
    v_mfma_f32_16x16x32_bf16 a[80:83], v[80:83], a[128:131], a[80:83]
    ds_read_b64_tr_b16 v[112:113], v239 offset:224
    v_mfma_f32_16x16x32_bf16 a[80:83], v[84:87], a[132:135], a[80:83]
    ds_read_b64_tr_b16 v[114:115], v239 offset:480
    v_mfma_f32_16x16x32_bf16 a[80:83], v[88:91], a[136:139], a[80:83]
    buffer_load_dwordx4 a[236:239], v50, s[28:31], s50 offen offset:3072 sc1
    v_mfma_f32_16x16x32_bf16 a[80:83], v[92:95], a[140:143], a[80:83]
    ds_read_b64_tr_b16 v[116:117], v239 offset:736
    ds_read_b64_tr_b16 v[118:119], v239 offset:992
    v_mfma_f32_16x16x32_bf16 a[84:87], v[80:83], a[144:147], a[84:87]
    ds_read_b64_tr_b16 v[120:121], v239 offset:17120
    v_mfma_f32_16x16x32_bf16 a[84:87], v[84:87], a[148:151], a[84:87]
    ds_read_b64_tr_b16 v[122:123], v239 offset:17376
    v_mfma_f32_16x16x32_bf16 a[84:87], v[88:91], a[152:155], a[84:87]
    ds_read_b64_tr_b16 v[124:125], v239 offset:17632
    v_mfma_f32_16x16x32_bf16 a[84:87], v[92:95], a[156:159], a[84:87]
    ds_read_b64_tr_b16 v[126:127], v239 offset:17888
    v_mfma_f32_16x16x32_bf16 a[88:91], v[80:83], a[160:163], a[88:91]
    v_mfma_f32_16x16x32_bf16 a[88:91], v[84:87], a[164:167], a[88:91]
    v_mfma_f32_16x16x32_bf16 a[88:91], v[88:91], a[168:171], a[88:91]
    buffer_load_dwordx4 a[240:243], v51, s[28:31], s50 offen offset:0 sc1
    v_mfma_f32_16x16x32_bf16 a[88:91], v[92:95], a[172:175], a[88:91]
    v_mfma_f32_16x16x32_bf16 a[92:95], v[80:83], a[176:179], a[92:95]
    v_mfma_f32_16x16x32_bf16 a[92:95], v[84:87], a[180:183], a[92:95]
    v_mfma_f32_16x16x32_bf16 a[92:95], v[88:91], a[184:187], a[92:95]
    v_mfma_f32_16x16x32_bf16 a[92:95], v[92:95], a[188:191], a[92:95]
    s_waitcnt lgkmcnt(0)
    v_mfma_f32_16x16x32_bf16 a[96:99], v[96:99], a[128:131], a[96:99]
    v_mfma_f32_16x16x32_bf16 a[96:99], v[100:103], a[132:135], a[96:99]
    buffer_load_dwordx4 a[244:247], v51, s[28:31], s50 offen offset:1024 sc1
    v_mfma_f32_16x16x32_bf16 a[96:99], v[104:107], a[136:139], a[96:99]
    v_mfma_f32_16x16x32_bf16 a[96:99], v[108:111], a[140:143], a[96:99]
    v_mfma_f32_16x16x32_bf16 a[100:103], v[96:99], a[144:147], a[100:103]
    s_waitcnt vmcnt(41) lgkmcnt(0)
    s_barrier
    v_mfma_f32_16x16x32_bf16 a[100:103], v[100:103], a[148:151], a[100:103]
    ds_read_b64_tr_b16 v[64:65], v239 offset:33792
    v_mfma_f32_16x16x32_bf16 a[100:103], v[104:107], a[152:155], a[100:103]
    ds_read_b64_tr_b16 v[66:67], v239 offset:34048
    v_mfma_f32_16x16x32_bf16 a[100:103], v[108:111], a[156:159], a[100:103]
    ds_read_b64_tr_b16 v[68:69], v239 offset:34304
    v_mfma_f32_16x16x32_bf16 a[104:107], v[96:99], a[160:163], a[104:107]
    ds_read_b64_tr_b16 v[70:71], v239 offset:34560
    v_mfma_f32_16x16x32_bf16 a[104:107], v[100:103], a[164:167], a[104:107]
    buffer_load_dwordx4 a[248:251], v51, s[28:31], s50 offen offset:2048 sc1
    v_mfma_f32_16x16x32_bf16 a[104:107], v[104:107], a[168:171], a[104:107]
    ds_read_b64_tr_b16 v[72:73], v239 offset:50688
    ds_read_b64_tr_b16 v[74:75], v239 offset:50944
    v_mfma_f32_16x16x32_bf16 a[104:107], v[108:111], a[172:175], a[104:107]
    ds_read_b64_tr_b16 v[76:77], v239 offset:51200
    v_mfma_f32_16x16x32_bf16 a[108:111], v[96:99], a[176:179], a[108:111]
    ds_read_b64_tr_b16 v[78:79], v239 offset:51456
    v_mfma_f32_16x16x32_bf16 a[108:111], v[100:103], a[180:183], a[108:111]
    v_mfma_f32_16x16x32_bf16 a[108:111], v[104:107], a[184:187], a[108:111]
    v_mfma_f32_16x16x32_bf16 a[108:111], v[108:111], a[188:191], a[108:111]
    v_mfma_f32_16x16x32_bf16 a[112:115], v[112:115], a[128:131], a[112:115]
    buffer_load_dwordx4 a[252:255], v51, s[28:31], s50 offen offset:3072 sc1
    v_mfma_f32_16x16x32_bf16 a[112:115], v[116:119], a[132:135], a[112:115]
    ds_read_b64_tr_b16 v[80:81], v239 offset:33824
    s_add_u32 s50, s50, 4096
    v_mfma_f32_16x16x32_bf16 a[112:115], v[120:123], a[136:139], a[112:115]
    ds_read_b64_tr_b16 v[82:83], v239 offset:34080
    v_mfma_f32_16x16x32_bf16 a[112:115], v[124:127], a[140:143], a[112:115]
    ds_read_b64_tr_b16 v[84:85], v239 offset:34336
    v_mfma_f32_16x16x32_bf16 a[116:119], v[112:115], a[144:147], a[116:119]
    ds_read_b64_tr_b16 v[86:87], v239 offset:34592
    v_mfma_f32_16x16x32_bf16 a[116:119], v[116:119], a[148:151], a[116:119]
    ds_read_b64_tr_b16 v[88:89], v239 offset:50720
    v_mfma_f32_16x16x32_bf16 a[116:119], v[120:123], a[152:155], a[116:119]
    ds_read_b64_tr_b16 v[90:91], v239 offset:50976
    v_mfma_f32_16x16x32_bf16 a[116:119], v[124:127], a[156:159], a[116:119]
    ds_read_b64_tr_b16 v[92:93], v239 offset:51232
    v_mfma_f32_16x16x32_bf16 a[120:123], v[112:115], a[160:163], a[120:123]
    ds_read_b64_tr_b16 v[94:95], v239 offset:51488
    v_mfma_f32_16x16x32_bf16 a[120:123], v[116:119], a[164:167], a[120:123]
    v_mfma_f32_16x16x32_bf16 a[120:123], v[120:123], a[168:171], a[120:123]
    v_mfma_f32_16x16x32_bf16 a[120:123], v[124:127], a[172:175], a[120:123]
    v_mfma_f32_16x16x32_bf16 a[124:127], v[112:115], a[176:179], a[124:127]
    v_mfma_f32_16x16x32_bf16 a[124:127], v[116:119], a[180:183], a[124:127]
    v_mfma_f32_16x16x32_bf16 a[124:127], v[120:123], a[184:187], a[124:127]
    v_mfma_f32_16x16x32_bf16 a[124:127], v[124:127], a[188:191], a[124:127]
    s_waitcnt vmcnt(0)
    s_waitcnt lgkmcnt(0)
    v_mfma_f32_16x16x32_bf16 a[0:3], v[64:67], a[192:195], a[0:3]
    ds_read_b64_tr_b16 v[96:97], v239 offset:33856
    v_mfma_f32_16x16x32_bf16 a[0:3], v[68:71], a[196:199], a[0:3]
    buffer_load_dwordx4 a[128:131], v48, s[28:31], s50 offen offset:0 sc1
    v_mfma_f32_16x16x32_bf16 a[0:3], v[72:75], a[200:203], a[0:3]
    ds_read_b64_tr_b16 v[98:99], v239 offset:34112
    ds_read_b64_tr_b16 v[100:101], v239 offset:34368
    v_mfma_f32_16x16x32_bf16 a[0:3], v[76:79], a[204:207], a[0:3]
    ds_read_b64_tr_b16 v[102:103], v239 offset:34624
    v_mfma_f32_16x16x32_bf16 a[4:7], v[64:67], a[208:211], a[4:7]
    buffer_load_dwordx4 a[132:135], v48, s[28:31], s50 offen offset:1024 sc1
    v_mfma_f32_16x16x32_bf16 a[4:7], v[68:71], a[212:215], a[4:7]
    ds_read_b64_tr_b16 v[104:105], v239 offset:50752
    ds_read_b64_tr_b16 v[106:107], v239 offset:51008
    v_mfma_f32_16x16x32_bf16 a[4:7], v[72:75], a[216:219], a[4:7]
    ds_read_b64_tr_b16 v[108:109], v239 offset:51264
    v_mfma_f32_16x16x32_bf16 a[4:7], v[76:79], a[220:223], a[4:7]
    ds_read_b64_tr_b16 v[110:111], v239 offset:51520
    v_mfma_f32_16x16x32_bf16 a[8:11], v[64:67], a[224:227], a[8:11]
    buffer_load_dwordx4 a[136:139], v48, s[28:31], s50 offen offset:2048 sc1
    v_mfma_f32_16x16x32_bf16 a[8:11], v[68:71], a[228:231], a[8:11]
    v_mfma_f32_16x16x32_bf16 a[8:11], v[72:75], a[232:235], a[8:11]
    buffer_load_dwordx4 a[140:143], v48, s[28:31], s50 offen offset:3072 sc1
    v_mfma_f32_16x16x32_bf16 a[8:11], v[76:79], a[236:239], a[8:11]
    v_mfma_f32_16x16x32_bf16 a[12:15], v[64:67], a[240:243], a[12:15]
    v_mfma_f32_16x16x32_bf16 a[12:15], v[68:71], a[244:247], a[12:15]
    v_mfma_f32_16x16x32_bf16 a[12:15], v[72:75], a[248:251], a[12:15]
    buffer_load_dwordx4 a[144:147], v49, s[28:31], s50 offen offset:0 sc1
    v_mfma_f32_16x16x32_bf16 a[12:15], v[76:79], a[252:255], a[12:15]
    v_mfma_f32_16x16x32_bf16 a[16:19], v[80:83], a[192:195], a[16:19]
    ds_read_b64_tr_b16 v[112:113], v239 offset:33888
    v_mfma_f32_16x16x32_bf16 a[16:19], v[84:87], a[196:199], a[16:19]
    buffer_load_dwordx4 a[148:151], v49, s[28:31], s50 offen offset:1024 sc1
    v_mfma_f32_16x16x32_bf16 a[16:19], v[88:91], a[200:203], a[16:19]
    ds_read_b64_tr_b16 v[114:115], v239 offset:34144
    ds_read_b64_tr_b16 v[116:117], v239 offset:34400
    v_mfma_f32_16x16x32_bf16 a[16:19], v[92:95], a[204:207], a[16:19]
    ds_read_b64_tr_b16 v[118:119], v239 offset:34656
    v_mfma_f32_16x16x32_bf16 a[20:23], v[80:83], a[208:211], a[20:23]
    buffer_load_dwordx4 a[152:155], v49, s[28:31], s50 offen offset:2048 sc1
    v_mfma_f32_16x16x32_bf16 a[20:23], v[84:87], a[212:215], a[20:23]
    ds_read_b64_tr_b16 v[120:121], v239 offset:50784
    ds_read_b64_tr_b16 v[122:123], v239 offset:51040
    v_mfma_f32_16x16x32_bf16 a[20:23], v[88:91], a[216:219], a[20:23]
    ds_read_b64_tr_b16 v[124:125], v239 offset:51296
    v_mfma_f32_16x16x32_bf16 a[20:23], v[92:95], a[220:223], a[20:23]
    ds_read_b64_tr_b16 v[126:127], v239 offset:51552
    v_mfma_f32_16x16x32_bf16 a[24:27], v[80:83], a[224:227], a[24:27]
    buffer_load_dwordx4 a[156:159], v49, s[28:31], s50 offen offset:3072 sc1
    v_mfma_f32_16x16x32_bf16 a[24:27], v[84:87], a[228:231], a[24:27]
    v_mfma_f32_16x16x32_bf16 a[24:27], v[88:91], a[232:235], a[24:27]
    v_mfma_f32_16x16x32_bf16 a[24:27], v[92:95], a[236:239], a[24:27]
    buffer_load_dwordx4 a[160:163], v50, s[28:31], s50 offen offset:0 sc1
    v_mfma_f32_16x16x32_bf16 a[28:31], v[80:83], a[240:243], a[28:31]
    v_mfma_f32_16x16x32_bf16 a[28:31], v[84:87], a[244:247], a[28:31]
    v_mfma_f32_16x16x32_bf16 a[28:31], v[88:91], a[248:251], a[28:31]
    buffer_load_dwordx4 a[164:167], v50, s[28:31], s50 offen offset:1024 sc1
    v_mfma_f32_16x16x32_bf16 a[28:31], v[92:95], a[252:255], a[28:31]
    s_waitcnt lgkmcnt(0)
    v_mfma_f32_16x16x32_bf16 a[32:35], v[96:99], a[192:195], a[32:35]
    ds_read_b64_tr_b16 v[64:65], v239 offset:33920
    v_mfma_f32_16x16x32_bf16 a[32:35], v[100:103], a[196:199], a[32:35]
    ds_read_b64_tr_b16 v[66:67], v239 offset:34176
    v_mfma_f32_16x16x32_bf16 a[32:35], v[104:107], a[200:203], a[32:35]
    buffer_load_dwordx4 a[168:171], v50, s[28:31], s50 offen offset:2048 sc1
    v_mfma_f32_16x16x32_bf16 a[32:35], v[108:111], a[204:207], a[32:35]
    ds_read_b64_tr_b16 v[68:69], v239 offset:34432
    ds_read_b64_tr_b16 v[70:71], v239 offset:34688
    v_mfma_f32_16x16x32_bf16 a[36:39], v[96:99], a[208:211], a[36:39]
    ds_read_b64_tr_b16 v[72:73], v239 offset:50816
    v_mfma_f32_16x16x32_bf16 a[36:39], v[100:103], a[212:215], a[36:39]
    buffer_load_dwordx4 a[172:175], v50, s[28:31], s50 offen offset:3072 sc1
    v_mfma_f32_16x16x32_bf16 a[36:39], v[104:107], a[216:219], a[36:39]
    ds_read_b64_tr_b16 v[74:75], v239 offset:51072
    ds_read_b64_tr_b16 v[76:77], v239 offset:51328
    v_mfma_f32_16x16x32_bf16 a[36:39], v[108:111], a[220:223], a[36:39]
    ds_read_b64_tr_b16 v[78:79], v239 offset:51584
    v_mfma_f32_16x16x32_bf16 a[40:43], v[96:99], a[224:227], a[40:43]
    buffer_load_dwordx4 a[176:179], v51, s[28:31], s50 offen offset:0 sc1
    v_mfma_f32_16x16x32_bf16 a[40:43], v[100:103], a[228:231], a[40:43]
    v_mfma_f32_16x16x32_bf16 a[40:43], v[104:107], a[232:235], a[40:43]
    v_mfma_f32_16x16x32_bf16 a[40:43], v[108:111], a[236:239], a[40:43]
    buffer_load_dwordx4 a[180:183], v51, s[28:31], s50 offen offset:1024 sc1
    v_mfma_f32_16x16x32_bf16 a[44:47], v[96:99], a[240:243], a[44:47]
    v_mfma_f32_16x16x32_bf16 a[44:47], v[100:103], a[244:247], a[44:47]
    v_mfma_f32_16x16x32_bf16 a[44:47], v[104:107], a[248:251], a[44:47]
    v_mfma_f32_16x16x32_bf16 a[44:47], v[108:111], a[252:255], a[44:47]
    buffer_load_dwordx4 a[184:187], v51, s[28:31], s50 offen offset:2048 sc1
    v_mfma_f32_16x16x32_bf16 a[48:51], v[112:115], a[192:195], a[48:51]
    ds_read_b64_tr_b16 v[80:81], v239 offset:33952
    v_mfma_f32_16x16x32_bf16 a[48:51], v[116:119], a[196:199], a[48:51]
    ds_read_b64_tr_b16 v[82:83], v239 offset:34208
    v_mfma_f32_16x16x32_bf16 a[48:51], v[120:123], a[200:203], a[48:51]
    buffer_load_dwordx4 a[188:191], v51, s[28:31], s50 offen offset:3072 sc1
    v_mfma_f32_16x16x32_bf16 a[48:51], v[124:127], a[204:207], a[48:51]
    ds_read_b64_tr_b16 v[84:85], v239 offset:34464
    s_add_u32 s50, s50, 4096
    v_mfma_f32_16x16x32_bf16 a[52:55], v[112:115], a[208:211], a[52:55]
    ds_read_b64_tr_b16 v[86:87], v239 offset:34720
    s_mov_b32 s61, 0
    v_mfma_f32_16x16x32_bf16 a[52:55], v[116:119], a[212:215], a[52:55]
    buffer_load_dwordx4 v[176:179], v54, s[4:7], s61 offen offset:0 sc1
    v_mfma_f32_16x16x32_bf16 a[52:55], v[120:123], a[216:219], a[52:55]
    ds_read_b64_tr_b16 v[88:89], v239 offset:50848
    ds_read_b64_tr_b16 v[90:91], v239 offset:51104
    v_mfma_f32_16x16x32_bf16 a[52:55], v[124:127], a[220:223], a[52:55]
    ds_read_b64_tr_b16 v[92:93], v239 offset:51360
    ds_read_b64_tr_b16 v[94:95], v239 offset:51616
    v_mfma_f32_16x16x32_bf16 a[56:59], v[112:115], a[224:227], a[56:59]
    v_mfma_f32_16x16x32_bf16 a[56:59], v[116:119], a[228:231], a[56:59]
    buffer_load_dwordx4 v[180:183], v54, s[4:7], s61 offen offset:1024 sc1
    v_mfma_f32_16x16x32_bf16 a[56:59], v[120:123], a[232:235], a[56:59]
    v_mfma_f32_16x16x32_bf16 a[56:59], v[124:127], a[236:239], a[56:59]
    v_mfma_f32_16x16x32_bf16 a[60:63], v[112:115], a[240:243], a[60:63]
    buffer_load_dwordx4 v[184:187], v54, s[4:7], s61 offen offset:2048 sc1
    v_mfma_f32_16x16x32_bf16 a[60:63], v[116:119], a[244:247], a[60:63]
    v_mfma_f32_16x16x32_bf16 a[60:63], v[120:123], a[248:251], a[60:63]
    v_mfma_f32_16x16x32_bf16 a[60:63], v[124:127], a[252:255], a[60:63]
    buffer_load_dwordx4 v[188:191], v54, s[4:7], s61 offen offset:3072 sc1
    s_waitcnt lgkmcnt(0)
    v_mfma_f32_16x16x32_bf16 a[64:67], v[64:67], a[192:195], a[64:67]
    ds_read_b64_tr_b16 v[96:97], v239 offset:33984
    v_mfma_f32_16x16x32_bf16 a[64:67], v[68:71], a[196:199], a[64:67]
    ds_read_b64_tr_b16 v[98:99], v239 offset:34240
    v_mfma_f32_16x16x32_bf16 a[64:67], v[72:75], a[200:203], a[64:67]
    ds_read_b64_tr_b16 v[100:101], v239 offset:34496
    v_mfma_f32_16x16x32_bf16 a[64:67], v[76:79], a[204:207], a[64:67]
    buffer_load_dwordx4 v[192:195], v55, s[4:7], s61 offen offset:0 sc1
    v_mfma_f32_16x16x32_bf16 a[68:71], v[64:67], a[208:211], a[68:71]
    ds_read_b64_tr_b16 v[102:103], v239 offset:34752
    ds_read_b64_tr_b16 v[104:105], v239 offset:50880
    v_mfma_f32_16x16x32_bf16 a[68:71], v[68:71], a[212:215], a[68:71]
    ds_read_b64_tr_b16 v[106:107], v239 offset:51136
    v_mfma_f32_16x16x32_bf16 a[68:71], v[72:75], a[216:219], a[68:71]
    ds_read_b64_tr_b16 v[108:109], v239 offset:51392
    v_mfma_f32_16x16x32_bf16 a[68:71], v[76:79], a[220:223], a[68:71]
    buffer_load_dwordx4 v[196:199], v55, s[4:7], s61 offen offset:1024 sc1
    v_mfma_f32_16x16x32_bf16 a[72:75], v[64:67], a[224:227], a[72:75]
    ds_read_b64_tr_b16 v[110:111], v239 offset:51648
    v_mfma_f32_16x16x32_bf16 a[72:75], v[68:71], a[228:231], a[72:75]
    buffer_load_dwordx4 v[200:203], v55, s[4:7], s61 offen offset:2048 sc1
    v_mfma_f32_16x16x32_bf16 a[72:75], v[72:75], a[232:235], a[72:75]
    v_mfma_f32_16x16x32_bf16 a[72:75], v[76:79], a[236:239], a[72:75]
    v_mfma_f32_16x16x32_bf16 a[76:79], v[64:67], a[240:243], a[76:79]
    v_mfma_f32_16x16x32_bf16 a[76:79], v[68:71], a[244:247], a[76:79]
    buffer_load_dwordx4 v[204:207], v55, s[4:7], s61 offen offset:3072 sc1
    v_mfma_f32_16x16x32_bf16 a[76:79], v[72:75], a[248:251], a[76:79]
    v_mfma_f32_16x16x32_bf16 a[76:79], v[76:79], a[252:255], a[76:79]
    v_mfma_f32_16x16x32_bf16 a[80:83], v[80:83], a[192:195], a[80:83]
    buffer_load_dwordx4 v[208:211], v56, s[4:7], s61 offen offset:0 sc1
    v_mfma_f32_16x16x32_bf16 a[80:83], v[84:87], a[196:199], a[80:83]
    ds_read_b64_tr_b16 v[112:113], v239 offset:34016
    ds_read_b64_tr_b16 v[114:115], v239 offset:34272
    v_mfma_f32_16x16x32_bf16 a[80:83], v[88:91], a[200:203], a[80:83]
    ds_read_b64_tr_b16 v[116:117], v239 offset:34528
    v_mfma_f32_16x16x32_bf16 a[80:83], v[92:95], a[204:207], a[80:83]
    buffer_load_dwordx4 v[212:215], v56, s[4:7], s61 offen offset:1024 sc1
    v_mfma_f32_16x16x32_bf16 a[84:87], v[80:83], a[208:211], a[84:87]
    ds_read_b64_tr_b16 v[118:119], v239 offset:34784
    ds_read_b64_tr_b16 v[120:121], v239 offset:50912
    v_mfma_f32_16x16x32_bf16 a[84:87], v[84:87], a[212:215], a[84:87]
    ds_read_b64_tr_b16 v[122:123], v239 offset:51168
    v_mfma_f32_16x16x32_bf16 a[84:87], v[88:91], a[216:219], a[84:87]
    ds_read_b64_tr_b16 v[124:125], v239 offset:51424
    v_mfma_f32_16x16x32_bf16 a[84:87], v[92:95], a[220:223], a[84:87]
    buffer_load_dwordx4 v[216:219], v56, s[4:7], s61 offen offset:2048 sc1
    v_mfma_f32_16x16x32_bf16 a[88:91], v[80:83], a[224:227], a[88:91]
    ds_read_b64_tr_b16 v[126:127], v239 offset:51680
    v_mfma_f32_16x16x32_bf16 a[88:91], v[84:87], a[228:231], a[88:91]
    v_mfma_f32_16x16x32_bf16 a[88:91], v[88:91], a[232:235], a[88:91]
    buffer_load_dwordx4 v[220:223], v56, s[4:7], s61 offen offset:3072 sc1
    v_mfma_f32_16x16x32_bf16 a[88:91], v[92:95], a[236:239], a[88:91]
    v_mfma_f32_16x16x32_bf16 a[92:95], v[80:83], a[240:243], a[92:95]
    v_mfma_f32_16x16x32_bf16 a[92:95], v[84:87], a[244:247], a[92:95]
    buffer_load_dwordx2 v[160:161], v52, s[32:35], 0 offen offset:0
    v_mfma_f32_16x16x32_bf16 a[92:95], v[88:91], a[248:251], a[92:95]
    v_mfma_f32_16x16x32_bf16 a[92:95], v[92:95], a[252:255], a[92:95]
    s_waitcnt lgkmcnt(0)
    v_mfma_f32_16x16x32_bf16 a[96:99], v[96:99], a[192:195], a[96:99]
    buffer_load_dwordx2 v[162:163], v52, s[32:35], 0 offen offset:32
    v_mfma_f32_16x16x32_bf16 a[96:99], v[100:103], a[196:199], a[96:99]
    v_mfma_f32_16x16x32_bf16 a[96:99], v[104:107], a[200:203], a[96:99]
    v_mfma_f32_16x16x32_bf16 a[96:99], v[108:111], a[204:207], a[96:99]
    v_mfma_f32_16x16x32_bf16 a[100:103], v[96:99], a[208:211], a[100:103]
    s_waitcnt vmcnt(46) lgkmcnt(0)
    s_barrier
    v_mfma_f32_16x16x32_bf16 a[100:103], v[100:103], a[212:215], a[100:103]
    buffer_load_dwordx2 v[164:165], v52, s[32:35], 0 offen offset:64
    v_mfma_f32_16x16x32_bf16 a[100:103], v[104:107], a[216:219], a[100:103]
    ds_read_b64_tr_b16 v[64:65], v238 offset:0
    ds_read_b64_tr_b16 v[66:67], v238 offset:256
    v_mfma_f32_16x16x32_bf16 a[100:103], v[108:111], a[220:223], a[100:103]
    buffer_load_dwordx2 v[166:167], v52, s[32:35], 0 offen offset:96
    v_mfma_f32_16x16x32_bf16 a[104:107], v[96:99], a[224:227], a[104:107]
    ds_read_b64_tr_b16 v[68:69], v238 offset:512
    ds_read_b64_tr_b16 v[70:71], v238 offset:768
    v_mfma_f32_16x16x32_bf16 a[104:107], v[100:103], a[228:231], a[104:107]
    ds_read_b64_tr_b16 v[72:73], v238 offset:16896
    v_mfma_f32_16x16x32_bf16 a[104:107], v[104:107], a[232:235], a[104:107]
    buffer_load_dwordx2 v[168:169], v52, s[32:35], 0 offen offset:128
    v_mfma_f32_16x16x32_bf16 a[104:107], v[108:111], a[236:239], a[104:107]
    ds_read_b64_tr_b16 v[74:75], v238 offset:17152
    ds_read_b64_tr_b16 v[76:77], v238 offset:17408
    v_mfma_f32_16x16x32_bf16 a[108:111], v[96:99], a[240:243], a[108:111]
    ds_read_b64_tr_b16 v[78:79], v238 offset:17664
    v_mfma_f32_16x16x32_bf16 a[108:111], v[100:103], a[244:247], a[108:111]
    v_mfma_f32_16x16x32_bf16 a[108:111], v[104:107], a[248:251], a[108:111]
    buffer_load_dwordx2 v[170:171], v52, s[32:35], 0 offen offset:160
    v_mfma_f32_16x16x32_bf16 a[108:111], v[108:111], a[252:255], a[108:111]
    v_mfma_f32_16x16x32_bf16 a[112:115], v[112:115], a[192:195], a[112:115]
    v_mfma_f32_16x16x32_bf16 a[112:115], v[116:119], a[196:199], a[112:115]
    buffer_load_dwordx2 v[172:173], v52, s[32:35], 0 offen offset:192
    v_mfma_f32_16x16x32_bf16 a[112:115], v[120:123], a[200:203], a[112:115]
    ds_read_b64_tr_b16 v[80:81], v238 offset:32
    ds_read_b64_tr_b16 v[82:83], v238 offset:288
    v_mfma_f32_16x16x32_bf16 a[112:115], v[124:127], a[204:207], a[112:115]
    ds_read_b64_tr_b16 v[84:85], v238 offset:544
    v_mfma_f32_16x16x32_bf16 a[116:119], v[112:115], a[208:211], a[116:119]
    buffer_load_dwordx2 v[174:175], v52, s[32:35], 0 offen offset:224
    v_mfma_f32_16x16x32_bf16 a[116:119], v[116:119], a[212:215], a[116:119]
    ds_read_b64_tr_b16 v[86:87], v238 offset:800
    ds_read_b64_tr_b16 v[88:89], v238 offset:16928
    v_mfma_f32_16x16x32_bf16 a[116:119], v[120:123], a[216:219], a[116:119]
    ds_read_b64_tr_b16 v[90:91], v238 offset:17184
    v_mfma_f32_16x16x32_bf16 a[116:119], v[124:127], a[220:223], a[116:119]
    ds_read_b64_tr_b16 v[92:93], v238 offset:17440
    v_mfma_f32_16x16x32_bf16 a[120:123], v[112:115], a[224:227], a[120:123]
    ds_read_b64_tr_b16 v[94:95], v238 offset:17696
    v_mfma_f32_16x16x32_bf16 a[120:123], v[116:119], a[228:231], a[120:123]
    v_mfma_f32_16x16x32_bf16 a[120:123], v[120:123], a[232:235], a[120:123]
    v_mfma_f32_16x16x32_bf16 a[120:123], v[124:127], a[236:239], a[120:123]
    v_mfma_f32_16x16x32_bf16 a[124:127], v[112:115], a[240:243], a[124:127]
    v_mfma_f32_16x16x32_bf16 a[124:127], v[116:119], a[244:247], a[124:127]
    v_mfma_f32_16x16x32_bf16 a[124:127], v[120:123], a[248:251], a[124:127]
    v_mfma_f32_16x16x32_bf16 a[124:127], v[124:127], a[252:255], a[124:127]
    s_waitcnt vmcnt(20)
    s_waitcnt lgkmcnt(0)
    v_mfma_f32_16x16x32_bf16 a[0:3], v[64:67], a[128:131], a[0:3]
    ds_read_b64_tr_b16 v[96:97], v238 offset:64
    v_mfma_f32_16x16x32_bf16 a[0:3], v[68:71], a[132:135], a[0:3]
    ds_read_b64_tr_b16 v[98:99], v238 offset:320
    v_mfma_f32_16x16x32_bf16 a[0:3], v[72:75], a[136:139], a[0:3]
    ds_read_b64_tr_b16 v[100:101], v238 offset:576
    v_mfma_f32_16x16x32_bf16 a[0:3], v[76:79], a[140:143], a[0:3]
    ds_read_b64_tr_b16 v[102:103], v238 offset:832
    v_mfma_f32_16x16x32_bf16 a[4:7], v[64:67], a[144:147], a[4:7]
    ds_read_b64_tr_b16 v[104:105], v238 offset:16960
    v_mfma_f32_16x16x32_bf16 a[4:7], v[68:71], a[148:151], a[4:7]
    ds_read_b64_tr_b16 v[106:107], v238 offset:17216
    v_mfma_f32_16x16x32_bf16 a[4:7], v[72:75], a[152:155], a[4:7]
    ds_read_b64_tr_b16 v[108:109], v238 offset:17472
    v_mfma_f32_16x16x32_bf16 a[4:7], v[76:79], a[156:159], a[4:7]
    ds_read_b64_tr_b16 v[110:111], v238 offset:17728
    v_mfma_f32_16x16x32_bf16 a[8:11], v[64:67], a[160:163], a[8:11]
    v_mfma_f32_16x16x32_bf16 a[8:11], v[68:71], a[164:167], a[8:11]
    v_mfma_f32_16x16x32_bf16 a[8:11], v[72:75], a[168:171], a[8:11]
    v_mfma_f32_16x16x32_bf16 a[8:11], v[76:79], a[172:175], a[8:11]
    v_mfma_f32_16x16x32_bf16 a[12:15], v[64:67], a[176:179], a[12:15]
    v_mfma_f32_16x16x32_bf16 a[12:15], v[68:71], a[180:183], a[12:15]
    v_mfma_f32_16x16x32_bf16 a[12:15], v[72:75], a[184:187], a[12:15]
    v_mfma_f32_16x16x32_bf16 a[12:15], v[76:79], a[188:191], a[12:15]
    v_mfma_f32_16x16x32_bf16 a[16:19], v[80:83], a[128:131], a[16:19]
    ds_read_b64_tr_b16 v[112:113], v238 offset:96
    v_mfma_f32_16x16x32_bf16 a[16:19], v[84:87], a[132:135], a[16:19]
    ds_read_b64_tr_b16 v[114:115], v238 offset:352
    v_mfma_f32_16x16x32_bf16 a[16:19], v[88:91], a[136:139], a[16:19]
    ds_read_b64_tr_b16 v[116:117], v238 offset:608
    v_mfma_f32_16x16x32_bf16 a[16:19], v[92:95], a[140:143], a[16:19]
    ds_read_b64_tr_b16 v[118:119], v238 offset:864
    v_mfma_f32_16x16x32_bf16 a[20:23], v[80:83], a[144:147], a[20:23]
    ds_read_b64_tr_b16 v[120:121], v238 offset:16992
    v_mfma_f32_16x16x32_bf16 a[20:23], v[84:87], a[148:151], a[20:23]
    ds_read_b64_tr_b16 v[122:123], v238 offset:17248
    v_mfma_f32_16x16x32_bf16 a[20:23], v[88:91], a[152:155], a[20:23]
    ds_read_b64_tr_b16 v[124:125], v238 offset:17504
    v_mfma_f32_16x16x32_bf16 a[20:23], v[92:95], a[156:159], a[20:23]
    ds_read_b64_tr_b16 v[126:127], v238 offset:17760
    v_mfma_f32_16x16x32_bf16 a[24:27], v[80:83], a[160:163], a[24:27]
    v_accvgpr_read_b32 v224, a0
    v_accvgpr_read_b32 v225, a1
    v_mfma_f32_16x16x32_bf16 a[24:27], v[84:87], a[164:167], a[24:27]
    v_accvgpr_read_b32 v226, a2
    v_accvgpr_read_b32 v227, a3
    v_mfma_f32_16x16x32_bf16 a[24:27], v[88:91], a[168:171], a[24:27]
    v_cvt_pk_bf16_f32 v0, v224, v225
    v_cvt_pk_bf16_f32 v1, v226, v227
    v_mfma_f32_16x16x32_bf16 a[24:27], v[92:95], a[172:175], a[24:27]
    v_accvgpr_read_b32 v228, a4
    v_accvgpr_read_b32 v229, a5
    v_mfma_f32_16x16x32_bf16 a[28:31], v[80:83], a[176:179], a[28:31]
    v_cvt_pk_bf16_f32 v16, v228, v229
    v_mfma_f32_16x16x32_bf16 a[28:31], v[84:87], a[180:183], a[28:31]
    v_accvgpr_read_b32 v230, a6
    v_accvgpr_read_b32 v231, a7
    v_mfma_f32_16x16x32_bf16 a[28:31], v[88:91], a[184:187], a[28:31]
    v_cvt_pk_bf16_f32 v17, v230, v231
    v_mfma_f32_16x16x32_bf16 a[28:31], v[92:95], a[188:191], a[28:31]
    v_accvgpr_read_b32 v224, a8
    v_accvgpr_read_b32 v225, a9
    s_waitcnt lgkmcnt(0)
    v_mfma_f32_16x16x32_bf16 a[32:35], v[96:99], a[128:131], a[32:35]
    ds_read_b64_tr_b16 v[64:65], v238 offset:128
    v_cvt_pk_bf16_f32 v32, v224, v225
    v_mfma_f32_16x16x32_bf16 a[32:35], v[100:103], a[132:135], a[32:35]
    v_accvgpr_read_b32 v226, a10
    v_accvgpr_read_b32 v227, a11
    v_mfma_f32_16x16x32_bf16 a[32:35], v[104:107], a[136:139], a[32:35]
    ds_read_b64_tr_b16 v[66:67], v238 offset:384
    v_cvt_pk_bf16_f32 v33, v226, v227
    v_mfma_f32_16x16x32_bf16 a[32:35], v[108:111], a[140:143], a[32:35]
    ds_read_b64_tr_b16 v[68:69], v238 offset:640
    ds_read_b64_tr_b16 v[70:71], v238 offset:896
    v_mfma_f32_16x16x32_bf16 a[36:39], v[96:99], a[144:147], a[36:39]
    ds_read_b64_tr_b16 v[72:73], v238 offset:17024
    v_mfma_f32_16x16x32_bf16 a[36:39], v[100:103], a[148:151], a[36:39]
    ds_read_b64_tr_b16 v[74:75], v238 offset:17280
    v_mfma_f32_16x16x32_bf16 a[36:39], v[104:107], a[152:155], a[36:39]
    ds_read_b64_tr_b16 v[76:77], v238 offset:17536
    v_mfma_f32_16x16x32_bf16 a[36:39], v[108:111], a[156:159], a[36:39]
    ds_read_b64_tr_b16 v[78:79], v238 offset:17792
    v_mfma_f32_16x16x32_bf16 a[40:43], v[96:99], a[160:163], a[40:43]
    v_accvgpr_read_b32 v228, a16
    v_accvgpr_read_b32 v229, a17
    v_mfma_f32_16x16x32_bf16 a[40:43], v[100:103], a[164:167], a[40:43]
    v_accvgpr_read_b32 v230, a18
    v_accvgpr_read_b32 v231, a19
    v_mfma_f32_16x16x32_bf16 a[40:43], v[104:107], a[168:171], a[40:43]
    v_cvt_pk_bf16_f32 v2, v228, v229
    v_cvt_pk_bf16_f32 v3, v230, v231
    v_mfma_f32_16x16x32_bf16 a[40:43], v[108:111], a[172:175], a[40:43]
    v_accvgpr_read_b32 v224, a20
    v_accvgpr_read_b32 v225, a21
    v_mfma_f32_16x16x32_bf16 a[44:47], v[96:99], a[176:179], a[44:47]
    v_cvt_pk_bf16_f32 v18, v224, v225
    v_mfma_f32_16x16x32_bf16 a[44:47], v[100:103], a[180:183], a[44:47]
    v_accvgpr_read_b32 v226, a22
    v_accvgpr_read_b32 v227, a23
    v_mfma_f32_16x16x32_bf16 a[44:47], v[104:107], a[184:187], a[44:47]
    v_cvt_pk_bf16_f32 v19, v226, v227
    v_mfma_f32_16x16x32_bf16 a[44:47], v[108:111], a[188:191], a[44:47]
    v_accvgpr_read_b32 v228, a24
    v_accvgpr_read_b32 v229, a25
    v_mfma_f32_16x16x32_bf16 a[48:51], v[112:115], a[128:131], a[48:51]
    ds_read_b64_tr_b16 v[80:81], v238 offset:160
    v_cvt_pk_bf16_f32 v34, v228, v229
    v_mfma_f32_16x16x32_bf16 a[48:51], v[116:119], a[132:135], a[48:51]
    v_accvgpr_read_b32 v230, a26
    v_accvgpr_read_b32 v231, a27
    v_mfma_f32_16x16x32_bf16 a[48:51], v[120:123], a[136:139], a[48:51]
    ds_read_b64_tr_b16 v[82:83], v238 offset:416
    v_cvt_pk_bf16_f32 v35, v230, v231
    v_mfma_f32_16x16x32_bf16 a[48:51], v[124:127], a[140:143], a[48:51]
    ds_read_b64_tr_b16 v[84:85], v238 offset:672
    ds_read_b64_tr_b16 v[86:87], v238 offset:928
    v_mfma_f32_16x16x32_bf16 a[52:55], v[112:115], a[144:147], a[52:55]
    ds_read_b64_tr_b16 v[88:89], v238 offset:17056
    v_mfma_f32_16x16x32_bf16 a[52:55], v[116:119], a[148:151], a[52:55]
    ds_read_b64_tr_b16 v[90:91], v238 offset:17312
    v_mfma_f32_16x16x32_bf16 a[52:55], v[120:123], a[152:155], a[52:55]
    ds_read_b64_tr_b16 v[92:93], v238 offset:17568
    v_mfma_f32_16x16x32_bf16 a[52:55], v[124:127], a[156:159], a[52:55]
    ds_read_b64_tr_b16 v[94:95], v238 offset:17824
    v_mfma_f32_16x16x32_bf16 a[56:59], v[112:115], a[160:163], a[56:59]
    s_mov_b32 s61, 4096
    buffer_store_dwordx4 v[0:3], v255, s[4:7], s61 offen offset:0 sc1
    v_mfma_f32_16x16x32_bf16 a[56:59], v[116:119], a[164:167], a[56:59]
    s_mov_b32 s61, 12288
    buffer_store_dwordx4 v[16:19], v255, s[4:7], s61 offen offset:0 sc1
    v_mfma_f32_16x16x32_bf16 a[56:59], v[120:123], a[168:171], a[56:59]
    s_mov_b32 s61, 20480
    buffer_store_dwordx4 v[32:35], v255, s[4:7], s61 offen offset:0 sc1
    v_mfma_f32_16x16x32_bf16 a[56:59], v[124:127], a[172:175], a[56:59]
    v_accvgpr_read_b32 v224, a32
    v_accvgpr_read_b32 v225, a33
    v_mfma_f32_16x16x32_bf16 a[60:63], v[112:115], a[176:179], a[60:63]
    v_accvgpr_read_b32 v226, a34
    v_accvgpr_read_b32 v227, a35
    v_mfma_f32_16x16x32_bf16 a[60:63], v[116:119], a[180:183], a[60:63]
    v_cvt_pk_bf16_f32 v4, v224, v225
    v_cvt_pk_bf16_f32 v5, v226, v227
    v_mfma_f32_16x16x32_bf16 a[60:63], v[120:123], a[184:187], a[60:63]
    v_accvgpr_read_b32 v228, a36
    v_accvgpr_read_b32 v229, a37
    v_mfma_f32_16x16x32_bf16 a[60:63], v[124:127], a[188:191], a[60:63]
    v_cvt_pk_bf16_f32 v20, v228, v229
    v_accvgpr_read_b32 v230, a38
    s_waitcnt lgkmcnt(0)
    v_mfma_f32_16x16x32_bf16 a[64:67], v[64:67], a[128:131], a[64:67]
    v_accvgpr_read_b32 v231, a39
    v_accvgpr_read_b32 v224, a40
    v_mfma_f32_16x16x32_bf16 a[64:67], v[68:71], a[132:135], a[64:67]
    v_cvt_pk_bf16_f32 v21, v230, v231
    v_accvgpr_read_b32 v225, a41
    v_mfma_f32_16x16x32_bf16 a[64:67], v[72:75], a[136:139], a[64:67]
    v_accvgpr_read_b32 v226, a42
    v_accvgpr_read_b32 v227, a43
    v_mfma_f32_16x16x32_bf16 a[64:67], v[76:79], a[140:143], a[64:67]
    v_cvt_pk_bf16_f32 v36, v224, v225
    v_cvt_pk_bf16_f32 v37, v226, v227
    v_mfma_f32_16x16x32_bf16 a[68:71], v[64:67], a[144:147], a[68:71]
    ds_read_b64_tr_b16 v[96:97], v238 offset:192
    ds_read_b64_tr_b16 v[98:99], v238 offset:448
    v_mfma_f32_16x16x32_bf16 a[68:71], v[68:71], a[148:151], a[68:71]
    ds_read_b64_tr_b16 v[100:101], v238 offset:704
    ds_read_b64_tr_b16 v[102:103], v238 offset:960
    v_mfma_f32_16x16x32_bf16 a[68:71], v[72:75], a[152:155], a[68:71]
    ds_read_b64_tr_b16 v[104:105], v238 offset:17088
    ds_read_b64_tr_b16 v[106:107], v238 offset:17344
    v_mfma_f32_16x16x32_bf16 a[68:71], v[76:79], a[156:159], a[68:71]
    ds_read_b64_tr_b16 v[108:109], v238 offset:17600
    ds_read_b64_tr_b16 v[110:111], v238 offset:17856
    v_mfma_f32_16x16x32_bf16 a[72:75], v[64:67], a[160:163], a[72:75]
    v_accvgpr_read_b32 v228, a48
    v_accvgpr_read_b32 v229, a49
    v_mfma_f32_16x16x32_bf16 a[72:75], v[68:71], a[164:167], a[72:75]
    v_accvgpr_read_b32 v230, a50
    v_accvgpr_read_b32 v231, a51
    v_mfma_f32_16x16x32_bf16 a[72:75], v[72:75], a[168:171], a[72:75]
    v_cvt_pk_bf16_f32 v6, v228, v229
    v_cvt_pk_bf16_f32 v7, v230, v231
    v_mfma_f32_16x16x32_bf16 a[72:75], v[76:79], a[172:175], a[72:75]
    v_accvgpr_read_b32 v224, a52
    v_accvgpr_read_b32 v225, a53
    v_mfma_f32_16x16x32_bf16 a[76:79], v[64:67], a[176:179], a[76:79]
    v_cvt_pk_bf16_f32 v22, v224, v225
    v_mfma_f32_16x16x32_bf16 a[76:79], v[68:71], a[180:183], a[76:79]
    v_accvgpr_read_b32 v226, a54
    v_accvgpr_read_b32 v227, a55
    v_mfma_f32_16x16x32_bf16 a[76:79], v[72:75], a[184:187], a[76:79]
    v_cvt_pk_bf16_f32 v23, v226, v227
    v_mfma_f32_16x16x32_bf16 a[76:79], v[76:79], a[188:191], a[76:79]
    v_accvgpr_read_b32 v228, a56
    v_accvgpr_read_b32 v229, a57
    v_mfma_f32_16x16x32_bf16 a[80:83], v[80:83], a[128:131], a[80:83]
    ds_read_b64_tr_b16 v[112:113], v238 offset:224
    v_cvt_pk_bf16_f32 v38, v228, v229
    v_mfma_f32_16x16x32_bf16 a[80:83], v[84:87], a[132:135], a[80:83]
    v_accvgpr_read_b32 v230, a58
    v_accvgpr_read_b32 v231, a59
    v_mfma_f32_16x16x32_bf16 a[80:83], v[88:91], a[136:139], a[80:83]
    ds_read_b64_tr_b16 v[114:115], v238 offset:480
    v_cvt_pk_bf16_f32 v39, v230, v231
    v_mfma_f32_16x16x32_bf16 a[80:83], v[92:95], a[140:143], a[80:83]
    ds_read_b64_tr_b16 v[116:117], v238 offset:736
    ds_read_b64_tr_b16 v[118:119], v238 offset:992
    v_mfma_f32_16x16x32_bf16 a[84:87], v[80:83], a[144:147], a[84:87]
    ds_read_b64_tr_b16 v[120:121], v238 offset:17120
    v_mfma_f32_16x16x32_bf16 a[84:87], v[84:87], a[148:151], a[84:87]
    ds_read_b64_tr_b16 v[122:123], v238 offset:17376
    v_mfma_f32_16x16x32_bf16 a[84:87], v[88:91], a[152:155], a[84:87]
    ds_read_b64_tr_b16 v[124:125], v238 offset:17632
    v_mfma_f32_16x16x32_bf16 a[84:87], v[92:95], a[156:159], a[84:87]
    ds_read_b64_tr_b16 v[126:127], v238 offset:17888
    v_mfma_f32_16x16x32_bf16 a[88:91], v[80:83], a[160:163], a[88:91]
    s_mov_b32 s61, 4096
    buffer_store_dwordx4 v[4:7], v255, s[4:7], s61 offen offset:1024 sc1
    v_mfma_f32_16x16x32_bf16 a[88:91], v[84:87], a[164:167], a[88:91]
    s_mov_b32 s61, 12288
    buffer_store_dwordx4 v[20:23], v255, s[4:7], s61 offen offset:1024 sc1
    v_mfma_f32_16x16x32_bf16 a[88:91], v[88:91], a[168:171], a[88:91]
    s_mov_b32 s61, 20480
    buffer_store_dwordx4 v[36:39], v255, s[4:7], s61 offen offset:1024 sc1
    v_mfma_f32_16x16x32_bf16 a[88:91], v[92:95], a[172:175], a[88:91]
    v_accvgpr_read_b32 v224, a64
    v_accvgpr_read_b32 v225, a65
    v_mfma_f32_16x16x32_bf16 a[92:95], v[80:83], a[176:179], a[92:95]
    v_accvgpr_read_b32 v226, a66
    v_accvgpr_read_b32 v227, a67
    v_mfma_f32_16x16x32_bf16 a[92:95], v[84:87], a[180:183], a[92:95]
    v_cvt_pk_bf16_f32 v8, v224, v225
    v_cvt_pk_bf16_f32 v9, v226, v227
    v_mfma_f32_16x16x32_bf16 a[92:95], v[88:91], a[184:187], a[92:95]
    v_accvgpr_read_b32 v228, a68
    v_accvgpr_read_b32 v229, a69
    v_mfma_f32_16x16x32_bf16 a[92:95], v[92:95], a[188:191], a[92:95]
    v_cvt_pk_bf16_f32 v24, v228, v229
    v_accvgpr_read_b32 v230, a70
    s_waitcnt lgkmcnt(0)
    v_mfma_f32_16x16x32_bf16 a[96:99], v[96:99], a[128:131], a[96:99]
    v_accvgpr_read_b32 v231, a71
    v_accvgpr_read_b32 v224, a72
    v_mfma_f32_16x16x32_bf16 a[96:99], v[100:103], a[132:135], a[96:99]
    v_cvt_pk_bf16_f32 v25, v230, v231
    v_accvgpr_read_b32 v225, a73
    v_mfma_f32_16x16x32_bf16 a[96:99], v[104:107], a[136:139], a[96:99]
    v_accvgpr_read_b32 v226, a74
    v_accvgpr_read_b32 v227, a75
    v_mfma_f32_16x16x32_bf16 a[96:99], v[108:111], a[140:143], a[96:99]
    v_cvt_pk_bf16_f32 v40, v224, v225
    v_cvt_pk_bf16_f32 v41, v226, v227
    v_mfma_f32_16x16x32_bf16 a[100:103], v[96:99], a[144:147], a[100:103]
    v_mfma_f32_16x16x32_bf16 a[100:103], v[100:103], a[148:151], a[100:103]
    v_mfma_f32_16x16x32_bf16 a[100:103], v[104:107], a[152:155], a[100:103]
    v_mfma_f32_16x16x32_bf16 a[100:103], v[108:111], a[156:159], a[100:103]
    v_mfma_f32_16x16x32_bf16 a[104:107], v[96:99], a[160:163], a[104:107]
    v_accvgpr_read_b32 v228, a80
    v_accvgpr_read_b32 v229, a81
    v_mfma_f32_16x16x32_bf16 a[104:107], v[100:103], a[164:167], a[104:107]
    v_accvgpr_read_b32 v230, a82
    v_accvgpr_read_b32 v231, a83
    v_mfma_f32_16x16x32_bf16 a[104:107], v[104:107], a[168:171], a[104:107]
    v_cvt_pk_bf16_f32 v10, v228, v229
    v_cvt_pk_bf16_f32 v11, v230, v231
    v_mfma_f32_16x16x32_bf16 a[104:107], v[108:111], a[172:175], a[104:107]
    v_accvgpr_read_b32 v224, a84
    v_accvgpr_read_b32 v225, a85
    v_mfma_f32_16x16x32_bf16 a[108:111], v[96:99], a[176:179], a[108:111]
    v_cvt_pk_bf16_f32 v26, v224, v225
    v_mfma_f32_16x16x32_bf16 a[108:111], v[100:103], a[180:183], a[108:111]
    v_accvgpr_read_b32 v226, a86
    v_accvgpr_read_b32 v227, a87
    v_mfma_f32_16x16x32_bf16 a[108:111], v[104:107], a[184:187], a[108:111]
    v_cvt_pk_bf16_f32 v27, v226, v227
    v_mfma_f32_16x16x32_bf16 a[108:111], v[108:111], a[188:191], a[108:111]
    v_accvgpr_read_b32 v228, a88
    v_accvgpr_read_b32 v229, a89
    v_mfma_f32_16x16x32_bf16 a[112:115], v[112:115], a[128:131], a[112:115]
    v_cvt_pk_bf16_f32 v42, v228, v229
    v_mfma_f32_16x16x32_bf16 a[112:115], v[116:119], a[132:135], a[112:115]
    v_accvgpr_read_b32 v230, a90
    v_accvgpr_read_b32 v231, a91
    v_mfma_f32_16x16x32_bf16 a[112:115], v[120:123], a[136:139], a[112:115]
    v_cvt_pk_bf16_f32 v43, v230, v231
    v_mfma_f32_16x16x32_bf16 a[112:115], v[124:127], a[140:143], a[112:115]
    v_mfma_f32_16x16x32_bf16 a[116:119], v[112:115], a[144:147], a[116:119]
    v_mfma_f32_16x16x32_bf16 a[116:119], v[116:119], a[148:151], a[116:119]
    v_mfma_f32_16x16x32_bf16 a[116:119], v[120:123], a[152:155], a[116:119]
    v_mfma_f32_16x16x32_bf16 a[116:119], v[124:127], a[156:159], a[116:119]
    v_mfma_f32_16x16x32_bf16 a[120:123], v[112:115], a[160:163], a[120:123]
    s_mov_b32 s61, 4096
    buffer_store_dwordx4 v[8:11], v255, s[4:7], s61 offen offset:2048 sc1
    v_mfma_f32_16x16x32_bf16 a[120:123], v[116:119], a[164:167], a[120:123]
    s_mov_b32 s61, 12288
    buffer_store_dwordx4 v[24:27], v255, s[4:7], s61 offen offset:2048 sc1
    v_mfma_f32_16x16x32_bf16 a[120:123], v[120:123], a[168:171], a[120:123]
    s_mov_b32 s61, 20480
    buffer_store_dwordx4 v[40:43], v255, s[4:7], s61 offen offset:2048 sc1
    v_mfma_f32_16x16x32_bf16 a[120:123], v[124:127], a[172:175], a[120:123]
    v_mfma_f32_16x16x32_bf16 a[124:127], v[112:115], a[176:179], a[124:127]
    v_mfma_f32_16x16x32_bf16 a[124:127], v[116:119], a[180:183], a[124:127]
    v_mfma_f32_16x16x32_bf16 a[124:127], v[120:123], a[184:187], a[124:127]
    v_mfma_f32_16x16x32_bf16 a[124:127], v[124:127], a[188:191], a[124:127]
    s_nop 6
    v_accvgpr_read_b32 v224, a96
    v_accvgpr_read_b32 v225, a97
    v_cvt_pk_bf16_f32 v12, v224, v225
    v_accvgpr_read_b32 v226, a98
    v_accvgpr_read_b32 v227, a99
    v_cvt_pk_bf16_f32 v13, v226, v227
    v_accvgpr_read_b32 v228, a100
    v_accvgpr_read_b32 v229, a101
    v_cvt_pk_bf16_f32 v28, v228, v229
    v_accvgpr_read_b32 v230, a102
    v_accvgpr_read_b32 v231, a103
    v_cvt_pk_bf16_f32 v29, v230, v231
    v_accvgpr_read_b32 v224, a104
    v_accvgpr_read_b32 v225, a105
    v_cvt_pk_bf16_f32 v44, v224, v225
    v_accvgpr_read_b32 v226, a106
    v_accvgpr_read_b32 v227, a107
    v_cvt_pk_bf16_f32 v45, v226, v227
    v_accvgpr_read_b32 v224, a112
    v_accvgpr_read_b32 v225, a113
    v_cvt_pk_bf16_f32 v14, v224, v225
    v_accvgpr_read_b32 v226, a114
    v_accvgpr_read_b32 v227, a115
    v_cvt_pk_bf16_f32 v15, v226, v227
    s_mov_b32 s61, 4096
    buffer_store_dwordx4 v[12:15], v255, s[4:7], s61 offen offset:3072 sc1
    v_accvgpr_read_b32 v228, a116
    v_accvgpr_read_b32 v229, a117
    v_cvt_pk_bf16_f32 v30, v228, v229
    v_accvgpr_read_b32 v230, a118
    v_accvgpr_read_b32 v231, a119
    v_cvt_pk_bf16_f32 v31, v230, v231
    s_mov_b32 s61, 12288
    buffer_store_dwordx4 v[28:31], v255, s[4:7], s61 offen offset:3072 sc1
    v_accvgpr_read_b32 v224, a120
    v_accvgpr_read_b32 v225, a121
    v_cvt_pk_bf16_f32 v46, v224, v225
    v_accvgpr_read_b32 v226, a122
    v_accvgpr_read_b32 v227, a123
    v_cvt_pk_bf16_f32 v47, v226, v227
    s_mov_b32 s61, 20480
    buffer_store_dwordx4 v[44:47], v255, s[4:7], s61 offen offset:3072 sc1
    s_waitcnt vmcnt(12)
    s_mov_b32 s59, 0x40000
L_vaf:
    v_max3_u32 v232, v176, v177, v178
    v_max3_u32 v232, v232, v179, v180
    v_max3_u32 v232, v232, v181, v182
    v_max3_u32 v232, v232, v183, v184
    v_max3_u32 v232, v232, v185, v186
    v_max3_u32 v232, v232, v187, v188
    v_max3_u32 v232, v232, v189, v190
    v_max3_u32 v232, v232, v191, v192
    v_max3_u32 v232, v232, v193, v194
    v_max3_u32 v232, v232, v195, v196
    v_max3_u32 v232, v232, v197, v198
    v_max3_u32 v232, v232, v199, v200
    v_max3_u32 v232, v232, v201, v202
    v_max3_u32 v232, v232, v203, v204
    v_max3_u32 v232, v232, v205, v206
    v_max3_u32 v232, v232, v207, v208
    v_max3_u32 v232, v232, v209, v210
    v_max3_u32 v232, v232, v211, v212
    v_max3_u32 v232, v232, v213, v214
    v_max3_u32 v232, v232, v215, v216
    v_max3_u32 v232, v232, v217, v218
    v_max3_u32 v232, v232, v219, v220
    v_max3_u32 v232, v232, v221, v222
    v_max_u32 v232, v232, v223
    v_cmp_eq_u32 vcc, -1, v232
    s_cbranch_vccnz L_vrf
L_vof:
    s_nop 1
    v_lshlrev_b32 v0, 16, v176
    v_and_b32 v1, 0xffff0000, v176
    v_lshlrev_b32 v2, 16, v177
    v_and_b32 v3, 0xffff0000, v177
    v_lshlrev_b32 v4, 16, v178
    v_and_b32 v5, 0xffff0000, v178
    v_lshlrev_b32 v6, 16, v179
    v_and_b32 v7, 0xffff0000, v179
    v_lshlrev_b32 v8, 16, v180
    v_and_b32 v9, 0xffff0000, v180
    v_lshlrev_b32 v10, 16, v181
    v_and_b32 v11, 0xffff0000, v181
    v_lshlrev_b32 v12, 16, v182
    v_and_b32 v13, 0xffff0000, v182
    v_lshlrev_b32 v14, 16, v183
    v_and_b32 v15, 0xffff0000, v183
    v_lshlrev_b32 v16, 16, v184
    v_and_b32 v17, 0xffff0000, v184
    v_lshlrev_b32 v18, 16, v185
    v_and_b32 v19, 0xffff0000, v185
    v_lshlrev_b32 v20, 16, v186
    v_and_b32 v21, 0xffff0000, v186
    v_lshlrev_b32 v22, 16, v187
    v_and_b32 v23, 0xffff0000, v187
    v_lshlrev_b32 v24, 16, v188
    v_and_b32 v25, 0xffff0000, v188
    v_lshlrev_b32 v26, 16, v189
    v_and_b32 v27, 0xffff0000, v189
    v_lshlrev_b32 v28, 16, v190
    v_and_b32 v29, 0xffff0000, v190
    v_lshlrev_b32 v30, 16, v191
    v_and_b32 v31, 0xffff0000, v191
    v_pk_add_f32 v[128:129], v[128:129], v[0:1]
    v_pk_add_f32 v[130:131], v[130:131], v[2:3]
    v_pk_add_f32 v[132:133], v[132:133], v[4:5]
    v_pk_add_f32 v[134:135], v[134:135], v[6:7]
    v_pk_add_f32 v[136:137], v[136:137], v[8:9]
    v_pk_add_f32 v[138:139], v[138:139], v[10:11]
    v_pk_add_f32 v[140:141], v[140:141], v[12:13]
    v_pk_add_f32 v[142:143], v[142:143], v[14:15]
    v_pk_add_f32 v[144:145], v[144:145], v[16:17]
    v_pk_add_f32 v[146:147], v[146:147], v[18:19]
    v_pk_add_f32 v[148:149], v[148:149], v[20:21]
    v_pk_add_f32 v[150:151], v[150:151], v[22:23]
    v_pk_add_f32 v[152:153], v[152:153], v[24:25]
    v_pk_add_f32 v[154:155], v[154:155], v[26:27]
    v_pk_add_f32 v[156:157], v[156:157], v[28:29]
    v_pk_add_f32 v[158:159], v[158:159], v[30:31]
    v_lshlrev_b32 v0, 16, v192
    v_and_b32 v1, 0xffff0000, v192
    v_lshlrev_b32 v2, 16, v193
    v_and_b32 v3, 0xffff0000, v193
    v_lshlrev_b32 v4, 16, v194
    v_and_b32 v5, 0xffff0000, v194
    v_lshlrev_b32 v6, 16, v195
    v_and_b32 v7, 0xffff0000, v195
    v_lshlrev_b32 v8, 16, v196
    v_and_b32 v9, 0xffff0000, v196
    v_lshlrev_b32 v10, 16, v197
    v_and_b32 v11, 0xffff0000, v197
    v_lshlrev_b32 v12, 16, v198
    v_and_b32 v13, 0xffff0000, v198
    v_lshlrev_b32 v14, 16, v199
    v_and_b32 v15, 0xffff0000, v199
    v_lshlrev_b32 v16, 16, v200
    v_and_b32 v17, 0xffff0000, v200
    v_lshlrev_b32 v18, 16, v201
    v_and_b32 v19, 0xffff0000, v201
    v_lshlrev_b32 v20, 16, v202
    v_and_b32 v21, 0xffff0000, v202
    v_lshlrev_b32 v22, 16, v203
    v_and_b32 v23, 0xffff0000, v203
    v_lshlrev_b32 v24, 16, v204
    v_and_b32 v25, 0xffff0000, v204
    v_lshlrev_b32 v26, 16, v205
    v_and_b32 v27, 0xffff0000, v205
    v_lshlrev_b32 v28, 16, v206
    v_and_b32 v29, 0xffff0000, v206
    v_lshlrev_b32 v30, 16, v207
    v_and_b32 v31, 0xffff0000, v207
    v_pk_add_f32 v[128:129], v[128:129], v[0:1]
    v_pk_add_f32 v[130:131], v[130:131], v[2:3]
    v_pk_add_f32 v[132:133], v[132:133], v[4:5]
    v_pk_add_f32 v[134:135], v[134:135], v[6:7]
    v_pk_add_f32 v[136:137], v[136:137], v[8:9]
    v_pk_add_f32 v[138:139], v[138:139], v[10:11]
    v_pk_add_f32 v[140:141], v[140:141], v[12:13]
    v_pk_add_f32 v[142:143], v[142:143], v[14:15]
    v_pk_add_f32 v[144:145], v[144:145], v[16:17]
    v_pk_add_f32 v[146:147], v[146:147], v[18:19]
    v_pk_add_f32 v[148:149], v[148:149], v[20:21]
    v_pk_add_f32 v[150:151], v[150:151], v[22:23]
    v_pk_add_f32 v[152:153], v[152:153], v[24:25]
    v_pk_add_f32 v[154:155], v[154:155], v[26:27]
    v_pk_add_f32 v[156:157], v[156:157], v[28:29]
    v_pk_add_f32 v[158:159], v[158:159], v[30:31]
    v_lshlrev_b32 v0, 16, v208
    v_and_b32 v1, 0xffff0000, v208
    v_lshlrev_b32 v2, 16, v209
    v_and_b32 v3, 0xffff0000, v209
    v_lshlrev_b32 v4, 16, v210
    v_and_b32 v5, 0xffff0000, v210
    v_lshlrev_b32 v6, 16, v211
    v_and_b32 v7, 0xffff0000, v211
    v_lshlrev_b32 v8, 16, v212
    v_and_b32 v9, 0xffff0000, v212
    v_lshlrev_b32 v10, 16, v213
    v_and_b32 v11, 0xffff0000, v213
    v_lshlrev_b32 v12, 16, v214
    v_and_b32 v13, 0xffff0000, v214
    v_lshlrev_b32 v14, 16, v215
    v_and_b32 v15, 0xffff0000, v215
    v_lshlrev_b32 v16, 16, v216
    v_and_b32 v17, 0xffff0000, v216
    v_lshlrev_b32 v18, 16, v217
    v_and_b32 v19, 0xffff0000, v217
    v_lshlrev_b32 v20, 16, v218
    v_and_b32 v21, 0xffff0000, v218
    v_lshlrev_b32 v22, 16, v219
    v_and_b32 v23, 0xffff0000, v219
    v_lshlrev_b32 v24, 16, v220
    v_and_b32 v25, 0xffff0000, v220
    v_lshlrev_b32 v26, 16, v221
    v_and_b32 v27, 0xffff0000, v221
    v_lshlrev_b32 v28, 16, v222
    v_and_b32 v29, 0xffff0000, v222
    v_lshlrev_b32 v30, 16, v223
    v_and_b32 v31, 0xffff0000, v223
    v_pk_add_f32 v[128:129], v[128:129], v[0:1]
    v_pk_add_f32 v[130:131], v[130:131], v[2:3]
    v_pk_add_f32 v[132:133], v[132:133], v[4:5]
    v_pk_add_f32 v[134:135], v[134:135], v[6:7]
    v_pk_add_f32 v[136:137], v[136:137], v[8:9]
    v_pk_add_f32 v[138:139], v[138:139], v[10:11]
    v_pk_add_f32 v[140:141], v[140:141], v[12:13]
    v_pk_add_f32 v[142:143], v[142:143], v[14:15]
    v_pk_add_f32 v[144:145], v[144:145], v[16:17]
    v_pk_add_f32 v[146:147], v[146:147], v[18:19]
    v_pk_add_f32 v[148:149], v[148:149], v[20:21]
    v_pk_add_f32 v[150:151], v[150:151], v[22:23]
    v_pk_add_f32 v[152:153], v[152:153], v[24:25]
    v_pk_add_f32 v[154:155], v[154:155], v[26:27]
    v_pk_add_f32 v[156:157], v[156:157], v[28:29]
    v_pk_add_f32 v[158:159], v[158:159], v[30:31]
    s_mov_b32 s61, 4096
    buffer_load_dwordx4 v[64:67], v54, s[4:7], s61 offen offset:0 sc1
    buffer_load_dwordx4 v[68:71], v54, s[4:7], s61 offen offset:1024 sc1
    buffer_load_dwordx4 v[72:75], v54, s[4:7], s61 offen offset:2048 sc1
    buffer_load_dwordx4 v[76:79], v54, s[4:7], s61 offen offset:3072 sc1
    buffer_load_dwordx4 v[80:83], v55, s[4:7], s61 offen offset:0 sc1
    buffer_load_dwordx4 v[84:87], v55, s[4:7], s61 offen offset:1024 sc1
    buffer_load_dwordx4 v[88:91], v55, s[4:7], s61 offen offset:2048 sc1
    buffer_load_dwordx4 v[92:95], v55, s[4:7], s61 offen offset:3072 sc1
    buffer_load_dwordx4 v[96:99], v56, s[4:7], s61 offen offset:0 sc1
    buffer_load_dwordx4 v[100:103], v56, s[4:7], s61 offen offset:1024 sc1
    buffer_load_dwordx4 v[104:107], v56, s[4:7], s61 offen offset:2048 sc1
    buffer_load_dwordx4 v[108:111], v56, s[4:7], s61 offen offset:3072 sc1
    v_pk_mul_f32 v[0:1], v[128:129], s[70:71]
    v_pk_mul_f32 v[2:3], v[130:131], s[70:71]
    v_pk_mul_f32 v[4:5], v[132:133], s[70:71]
    v_pk_mul_f32 v[6:7], v[134:135], s[70:71]
    v_pk_mul_f32 v[8:9], v[136:137], s[70:71]
    v_pk_mul_f32 v[10:11], v[138:139], s[70:71]
    v_pk_mul_f32 v[12:13], v[140:141], s[70:71]
    v_pk_mul_f32 v[14:15], v[142:143], s[70:71]
    v_pk_mul_f32 v[16:17], v[144:145], s[70:71]
    v_pk_mul_f32 v[18:19], v[146:147], s[70:71]
    v_pk_mul_f32 v[20:21], v[148:149], s[70:71]
    v_pk_mul_f32 v[22:23], v[150:151], s[70:71]
    v_pk_mul_f32 v[24:25], v[152:153], s[70:71]
    v_pk_mul_f32 v[26:27], v[154:155], s[70:71]
    v_pk_mul_f32 v[28:29], v[156:157], s[70:71]
    v_pk_mul_f32 v[30:31], v[158:159], s[70:71]
    v_exp_f32 v0, v0
    v_exp_f32 v1, v1
    v_exp_f32 v2, v2
    v_exp_f32 v3, v3
    v_exp_f32 v4, v4
    v_exp_f32 v5, v5
    v_exp_f32 v6, v6
    v_exp_f32 v7, v7
    v_exp_f32 v8, v8
    v_exp_f32 v9, v9
    v_exp_f32 v10, v10
    v_exp_f32 v11, v11
    v_exp_f32 v12, v12
    v_exp_f32 v13, v13
    v_exp_f32 v14, v14
    v_exp_f32 v15, v15
    v_exp_f32 v16, v16
    v_exp_f32 v17, v17
    v_exp_f32 v18, v18
    v_exp_f32 v19, v19
    v_exp_f32 v20, v20
    v_exp_f32 v21, v21
    v_exp_f32 v22, v22
    v_exp_f32 v23, v23
    v_exp_f32 v24, v24
    v_exp_f32 v25, v25
    v_exp_f32 v26, v26
    v_exp_f32 v27, v27
    v_exp_f32 v28, v28
    v_exp_f32 v29, v29
    v_exp_f32 v30, v30
    v_exp_f32 v31, v31
    v_pk_add_f32 v[0:1], v[0:1], 1.0 op_sel_hi:[1,0]
    v_pk_add_f32 v[2:3], v[2:3], 1.0 op_sel_hi:[1,0]
    v_pk_add_f32 v[4:5], v[4:5], 1.0 op_sel_hi:[1,0]
    v_pk_add_f32 v[6:7], v[6:7], 1.0 op_sel_hi:[1,0]
    v_pk_add_f32 v[8:9], v[8:9], 1.0 op_sel_hi:[1,0]
    v_pk_add_f32 v[10:11], v[10:11], 1.0 op_sel_hi:[1,0]
    v_pk_add_f32 v[12:13], v[12:13], 1.0 op_sel_hi:[1,0]
    v_pk_add_f32 v[14:15], v[14:15], 1.0 op_sel_hi:[1,0]
    v_pk_add_f32 v[16:17], v[16:17], 1.0 op_sel_hi:[1,0]
    v_pk_add_f32 v[18:19], v[18:19], 1.0 op_sel_hi:[1,0]
    v_pk_add_f32 v[20:21], v[20:21], 1.0 op_sel_hi:[1,0]
    v_pk_add_f32 v[22:23], v[22:23], 1.0 op_sel_hi:[1,0]
    v_pk_add_f32 v[24:25], v[24:25], 1.0 op_sel_hi:[1,0]
    v_pk_add_f32 v[26:27], v[26:27], 1.0 op_sel_hi:[1,0]
    v_pk_add_f32 v[28:29], v[28:29], 1.0 op_sel_hi:[1,0]
    v_pk_add_f32 v[30:31], v[30:31], 1.0 op_sel_hi:[1,0]
    v_rcp_f32 v0, v0
    v_rcp_f32 v1, v1
    v_rcp_f32 v2, v2
    v_rcp_f32 v3, v3
    v_rcp_f32 v4, v4
    v_rcp_f32 v5, v5
    v_rcp_f32 v6, v6
    v_rcp_f32 v7, v7
    v_rcp_f32 v8, v8
    v_rcp_f32 v9, v9
    v_rcp_f32 v10, v10
    v_rcp_f32 v11, v11
    v_rcp_f32 v12, v12
    v_rcp_f32 v13, v13
    v_rcp_f32 v14, v14
    v_rcp_f32 v15, v15
    v_rcp_f32 v16, v16
    v_rcp_f32 v17, v17
    v_rcp_f32 v18, v18
    v_rcp_f32 v19, v19
    v_rcp_f32 v20, v20
    v_rcp_f32 v21, v21
    v_rcp_f32 v22, v22
    v_rcp_f32 v23, v23
    v_rcp_f32 v24, v24
    v_rcp_f32 v25, v25
    v_rcp_f32 v26, v26
    v_rcp_f32 v27, v27
    v_rcp_f32 v28, v28
    v_rcp_f32 v29, v29
    v_rcp_f32 v30, v30
    v_rcp_f32 v31, v31
    v_pk_mul_f32 v[128:129], v[128:129], v[0:1]
    v_pk_mul_f32 v[130:131], v[130:131], v[2:3]
    v_pk_mul_f32 v[132:133], v[132:133], v[4:5]
    v_pk_mul_f32 v[134:135], v[134:135], v[6:7]
    v_pk_mul_f32 v[136:137], v[136:137], v[8:9]
    v_pk_mul_f32 v[138:139], v[138:139], v[10:11]
    v_pk_mul_f32 v[140:141], v[140:141], v[12:13]
    v_pk_mul_f32 v[142:143], v[142:143], v[14:15]
    v_pk_mul_f32 v[144:145], v[144:145], v[16:17]
    v_pk_mul_f32 v[146:147], v[146:147], v[18:19]
    v_pk_mul_f32 v[148:149], v[148:149], v[20:21]
    v_pk_mul_f32 v[150:151], v[150:151], v[22:23]
    v_pk_mul_f32 v[152:153], v[152:153], v[24:25]
    v_pk_mul_f32 v[154:155], v[154:155], v[26:27]
    v_pk_mul_f32 v[156:157], v[156:157], v[28:29]
    v_pk_mul_f32 v[158:159], v[158:159], v[30:31]
    v_accvgpr_read_b32 v176, a12
    v_accvgpr_read_b32 v177, a13
    v_accvgpr_read_b32 v178, a14
    v_accvgpr_read_b32 v179, a15
    v_accvgpr_read_b32 v180, a28
    v_accvgpr_read_b32 v181, a29
    v_accvgpr_read_b32 v182, a30
    v_accvgpr_read_b32 v183, a31
    v_accvgpr_read_b32 v184, a44
    v_accvgpr_read_b32 v185, a45
    v_accvgpr_read_b32 v186, a46
    v_accvgpr_read_b32 v187, a47
    v_accvgpr_read_b32 v188, a60
    v_accvgpr_read_b32 v189, a61
    v_accvgpr_read_b32 v190, a62
    v_accvgpr_read_b32 v191, a63
    v_accvgpr_read_b32 v192, a76
    v_accvgpr_read_b32 v193, a77
    v_accvgpr_read_b32 v194, a78
    v_accvgpr_read_b32 v195, a79
    v_accvgpr_read_b32 v196, a92
    v_accvgpr_read_b32 v197, a93
    v_accvgpr_read_b32 v198, a94
    v_accvgpr_read_b32 v199, a95
    v_accvgpr_read_b32 v200, a108
    v_accvgpr_read_b32 v201, a109
    v_accvgpr_read_b32 v202, a110
    v_accvgpr_read_b32 v203, a111
    v_accvgpr_read_b32 v204, a124
    v_accvgpr_read_b32 v205, a125
    v_accvgpr_read_b32 v206, a126
    v_accvgpr_read_b32 v207, a127
    s_waitcnt vmcnt(0)
    s_mov_b32 s59, 0x40000
L_vas:
    v_max3_u32 v232, v64, v65, v66
    v_max3_u32 v232, v232, v67, v68
    v_max3_u32 v232, v232, v69, v70
    v_max3_u32 v232, v232, v71, v72
    v_max3_u32 v232, v232, v73, v74
    v_max3_u32 v232, v232, v75, v76
    v_max3_u32 v232, v232, v77, v78
    v_max3_u32 v232, v232, v79, v80
    v_max3_u32 v232, v232, v81, v82
    v_max3_u32 v232, v232, v83, v84
    v_max3_u32 v232, v232, v85, v86
    v_max3_u32 v232, v232, v87, v88
    v_max3_u32 v232, v232, v89, v90
    v_max3_u32 v232, v232, v91, v92
    v_max3_u32 v232, v232, v93, v94
    v_max3_u32 v232, v232, v95, v96
    v_max3_u32 v232, v232, v97, v98
    v_max3_u32 v232, v232, v99, v100
    v_max3_u32 v232, v232, v101, v102
    v_max3_u32 v232, v232, v103, v104
    v_max3_u32 v232, v232, v105, v106
    v_max3_u32 v232, v232, v107, v108
    v_max3_u32 v232, v232, v109, v110
    v_max_u32 v232, v232, v111
    v_cmp_eq_u32 vcc, -1, v232
    s_cbranch_vccnz L_vrs
L_vos:
    v_lshlrev_b32 v0, 16, v64
    v_and_b32 v1, 0xffff0000, v64
    v_lshlrev_b32 v2, 16, v65
    v_and_b32 v3, 0xffff0000, v65
    v_lshlrev_b32 v4, 16, v66
    v_and_b32 v5, 0xffff0000, v66
    v_lshlrev_b32 v6, 16, v67
    v_and_b32 v7, 0xffff0000, v67
    v_lshlrev_b32 v8, 16, v68
    v_and_b32 v9, 0xffff0000, v68
    v_lshlrev_b32 v10, 16, v69
    v_and_b32 v11, 0xffff0000, v69
    v_lshlrev_b32 v12, 16, v70
    v_and_b32 v13, 0xffff0000, v70
    v_lshlrev_b32 v14, 16, v71
    v_and_b32 v15, 0xffff0000, v71
    v_lshlrev_b32 v16, 16, v72
    v_and_b32 v17, 0xffff0000, v72
    v_lshlrev_b32 v18, 16, v73
    v_and_b32 v19, 0xffff0000, v73
    v_lshlrev_b32 v20, 16, v74
    v_and_b32 v21, 0xffff0000, v74
    v_lshlrev_b32 v22, 16, v75
    v_and_b32 v23, 0xffff0000, v75
    v_lshlrev_b32 v24, 16, v76
    v_and_b32 v25, 0xffff0000, v76
    v_lshlrev_b32 v26, 16, v77
    v_and_b32 v27, 0xffff0000, v77
    v_lshlrev_b32 v28, 16, v78
    v_and_b32 v29, 0xffff0000, v78
    v_lshlrev_b32 v30, 16, v79
    v_and_b32 v31, 0xffff0000, v79
    v_pk_add_f32 v[176:177], v[176:177], v[0:1]
    v_pk_add_f32 v[178:179], v[178:179], v[2:3]
    v_pk_add_f32 v[180:181], v[180:181], v[4:5]
    v_pk_add_f32 v[182:183], v[182:183], v[6:7]
    v_pk_add_f32 v[184:185], v[184:185], v[8:9]
    v_pk_add_f32 v[186:187], v[186:187], v[10:11]
    v_pk_add_f32 v[188:189], v[188:189], v[12:13]
    v_pk_add_f32 v[190:191], v[190:191], v[14:15]
    v_pk_add_f32 v[192:193], v[192:193], v[16:17]
    v_pk_add_f32 v[194:195], v[194:195], v[18:19]
    v_pk_add_f32 v[196:197], v[196:197], v[20:21]
    v_pk_add_f32 v[198:199], v[198:199], v[22:23]
    v_pk_add_f32 v[200:201], v[200:201], v[24:25]
    v_pk_add_f32 v[202:203], v[202:203], v[26:27]
    v_pk_add_f32 v[204:205], v[204:205], v[28:29]
    v_pk_add_f32 v[206:207], v[206:207], v[30:31]
    v_lshlrev_b32 v0, 16, v80
    v_and_b32 v1, 0xffff0000, v80
    v_lshlrev_b32 v2, 16, v81
    v_and_b32 v3, 0xffff0000, v81
    v_lshlrev_b32 v4, 16, v82
    v_and_b32 v5, 0xffff0000, v82
    v_lshlrev_b32 v6, 16, v83
    v_and_b32 v7, 0xffff0000, v83
    v_lshlrev_b32 v8, 16, v84
    v_and_b32 v9, 0xffff0000, v84
    v_lshlrev_b32 v10, 16, v85
    v_and_b32 v11, 0xffff0000, v85
    v_lshlrev_b32 v12, 16, v86
    v_and_b32 v13, 0xffff0000, v86
    v_lshlrev_b32 v14, 16, v87
    v_and_b32 v15, 0xffff0000, v87
    v_lshlrev_b32 v16, 16, v88
    v_and_b32 v17, 0xffff0000, v88
    v_lshlrev_b32 v18, 16, v89
    v_and_b32 v19, 0xffff0000, v89
    v_lshlrev_b32 v20, 16, v90
    v_and_b32 v21, 0xffff0000, v90
    v_lshlrev_b32 v22, 16, v91
    v_and_b32 v23, 0xffff0000, v91
    v_lshlrev_b32 v24, 16, v92
    v_and_b32 v25, 0xffff0000, v92
    v_lshlrev_b32 v26, 16, v93
    v_and_b32 v27, 0xffff0000, v93
    v_lshlrev_b32 v28, 16, v94
    v_and_b32 v29, 0xffff0000, v94
    v_lshlrev_b32 v30, 16, v95
    v_and_b32 v31, 0xffff0000, v95
    v_pk_add_f32 v[176:177], v[176:177], v[0:1]
    v_pk_add_f32 v[178:179], v[178:179], v[2:3]
    v_pk_add_f32 v[180:181], v[180:181], v[4:5]
    v_pk_add_f32 v[182:183], v[182:183], v[6:7]
    v_pk_add_f32 v[184:185], v[184:185], v[8:9]
    v_pk_add_f32 v[186:187], v[186:187], v[10:11]
    v_pk_add_f32 v[188:189], v[188:189], v[12:13]
    v_pk_add_f32 v[190:191], v[190:191], v[14:15]
    v_pk_add_f32 v[192:193], v[192:193], v[16:17]
    v_pk_add_f32 v[194:195], v[194:195], v[18:19]
    v_pk_add_f32 v[196:197], v[196:197], v[20:21]
    v_pk_add_f32 v[198:199], v[198:199], v[22:23]
    v_pk_add_f32 v[200:201], v[200:201], v[24:25]
    v_pk_add_f32 v[202:203], v[202:203], v[26:27]
    v_pk_add_f32 v[204:205], v[204:205], v[28:29]
    v_pk_add_f32 v[206:207], v[206:207], v[30:31]
    v_lshlrev_b32 v0, 16, v96
    v_and_b32 v1, 0xffff0000, v96
    v_lshlrev_b32 v2, 16, v97
    v_and_b32 v3, 0xffff0000, v97
    v_lshlrev_b32 v4, 16, v98
    v_and_b32 v5, 0xffff0000, v98
    v_lshlrev_b32 v6, 16, v99
    v_and_b32 v7, 0xffff0000, v99
    v_lshlrev_b32 v8, 16, v100
    v_and_b32 v9, 0xffff0000, v100
    v_lshlrev_b32 v10, 16, v101
    v_and_b32 v11, 0xffff0000, v101
    v_lshlrev_b32 v12, 16, v102
    v_and_b32 v13, 0xffff0000, v102
    v_lshlrev_b32 v14, 16, v103
    v_and_b32 v15, 0xffff0000, v103
    v_lshlrev_b32 v16, 16, v104
    v_and_b32 v17, 0xffff0000, v104
    v_lshlrev_b32 v18, 16, v105
    v_and_b32 v19, 0xffff0000, v105
    v_lshlrev_b32 v20, 16, v106
    v_and_b32 v21, 0xffff0000, v106
    v_lshlrev_b32 v22, 16, v107
    v_and_b32 v23, 0xffff0000, v107
    v_lshlrev_b32 v24, 16, v108
    v_and_b32 v25, 0xffff0000, v108
    v_lshlrev_b32 v26, 16, v109
    v_and_b32 v27, 0xffff0000, v109
    v_lshlrev_b32 v28, 16, v110
    v_and_b32 v29, 0xffff0000, v110
    v_lshlrev_b32 v30, 16, v111
    v_and_b32 v31, 0xffff0000, v111
    v_pk_add_f32 v[176:177], v[176:177], v[0:1]
    v_pk_add_f32 v[178:179], v[178:179], v[2:3]
    v_pk_add_f32 v[180:181], v[180:181], v[4:5]
    v_pk_add_f32 v[182:183], v[182:183], v[6:7]
    v_pk_add_f32 v[184:185], v[184:185], v[8:9]
    v_pk_add_f32 v[186:187], v[186:187], v[10:11]
    v_pk_add_f32 v[188:189], v[188:189], v[12:13]
    v_pk_add_f32 v[190:191], v[190:191], v[14:15]
    v_pk_add_f32 v[192:193], v[192:193], v[16:17]
    v_pk_add_f32 v[194:195], v[194:195], v[18:19]
    v_pk_add_f32 v[196:197], v[196:197], v[20:21]
    v_pk_add_f32 v[198:199], v[198:199], v[22:23]
    v_pk_add_f32 v[200:201], v[200:201], v[24:25]
    v_pk_add_f32 v[202:203], v[202:203], v[26:27]
    v_pk_add_f32 v[204:205], v[204:205], v[28:29]
    v_pk_add_f32 v[206:207], v[206:207], v[30:31]
    v_lshlrev_b32 v0, 16, v160
    v_and_b32 v1, 0xffff0000, v160
    v_lshlrev_b32 v2, 16, v161
    v_and_b32 v3, 0xffff0000, v161
    v_lshlrev_b32 v4, 16, v162
    v_and_b32 v5, 0xffff0000, v162
    v_lshlrev_b32 v6, 16, v163
    v_and_b32 v7, 0xffff0000, v163
    v_pk_fma_f32 v[176:177], v[176:177], v[128:129], v[0:1]
    v_pk_fma_f32 v[178:179], v[178:179], v[130:131], v[2:3]
    v_pk_fma_f32 v[180:181], v[180:181], v[132:133], v[4:5]
    v_pk_fma_f32 v[182:183], v[182:183], v[134:135], v[6:7]
    v_cvt_pk_bf16_f32 v160, v176, v177
    v_cvt_pk_bf16_f32 v161, v178, v179
    v_cvt_pk_bf16_f32 v162, v180, v181
    v_cvt_pk_bf16_f32 v163, v182, v183
    s_nop 0
    v_permlane32_swap_b32 v160, v162
    v_permlane32_swap_b32 v161, v163
    s_nop 0
    v_permlane16_swap_b32 v160, v162
    v_permlane16_swap_b32 v161, v163
    buffer_store_dwordx4 v[160:163], v53, s[20:23], 0 offen offset:0 sc1
    v_lshlrev_b32 v0, 16, v164
    v_and_b32 v1, 0xffff0000, v164
    v_lshlrev_b32 v2, 16, v165
    v_and_b32 v3, 0xffff0000, v165
    v_lshlrev_b32 v4, 16, v166
    v_and_b32 v5, 0xffff0000, v166
    v_lshlrev_b32 v6, 16, v167
    v_and_b32 v7, 0xffff0000, v167
    v_pk_fma_f32 v[184:185], v[184:185], v[136:137], v[0:1]
    v_pk_fma_f32 v[186:187], v[186:187], v[138:139], v[2:3]
    v_pk_fma_f32 v[188:189], v[188:189], v[140:141], v[4:5]
    v_pk_fma_f32 v[190:191], v[190:191], v[142:143], v[6:7]
    v_cvt_pk_bf16_f32 v164, v184, v185
    v_cvt_pk_bf16_f32 v165, v186, v187
    v_cvt_pk_bf16_f32 v166, v188, v189
    v_cvt_pk_bf16_f32 v167, v190, v191
    s_nop 0
    v_permlane32_swap_b32 v164, v166
    v_permlane32_swap_b32 v165, v167
    s_nop 0
    v_permlane16_swap_b32 v164, v166
    v_permlane16_swap_b32 v165, v167
    buffer_store_dwordx4 v[164:167], v53, s[20:23], 0 offen offset:64 sc1
    v_lshlrev_b32 v0, 16, v168
    v_and_b32 v1, 0xffff0000, v168
    v_lshlrev_b32 v2, 16, v169
    v_and_b32 v3, 0xffff0000, v169
    v_lshlrev_b32 v4, 16, v170
    v_and_b32 v5, 0xffff0000, v170
    v_lshlrev_b32 v6, 16, v171
    v_and_b32 v7, 0xffff0000, v171
    v_pk_fma_f32 v[192:193], v[192:193], v[144:145], v[0:1]
    v_pk_fma_f32 v[194:195], v[194:195], v[146:147], v[2:3]
    v_pk_fma_f32 v[196:197], v[196:197], v[148:149], v[4:5]
    v_pk_fma_f32 v[198:199], v[198:199], v[150:151], v[6:7]
    v_cvt_pk_bf16_f32 v168, v192, v193
    v_cvt_pk_bf16_f32 v169, v194, v195
    v_cvt_pk_bf16_f32 v170, v196, v197
    v_cvt_pk_bf16_f32 v171, v198, v199
    s_nop 0
    v_permlane32_swap_b32 v168, v170
    v_permlane32_swap_b32 v169, v171
    s_nop 0
    v_permlane16_swap_b32 v168, v170
    v_permlane16_swap_b32 v169, v171
    buffer_store_dwordx4 v[168:171], v53, s[20:23], 0 offen offset:128 sc1
    v_lshlrev_b32 v0, 16, v172
    v_and_b32 v1, 0xffff0000, v172
    v_lshlrev_b32 v2, 16, v173
    v_and_b32 v3, 0xffff0000, v173
    v_lshlrev_b32 v4, 16, v174
    v_and_b32 v5, 0xffff0000, v174
    v_lshlrev_b32 v6, 16, v175
    v_and_b32 v7, 0xffff0000, v175
    v_pk_fma_f32 v[200:201], v[200:201], v[152:153], v[0:1]
    v_pk_fma_f32 v[202:203], v[202:203], v[154:155], v[2:3]
    v_pk_fma_f32 v[204:205], v[204:205], v[156:157], v[4:5]
    v_pk_fma_f32 v[206:207], v[206:207], v[158:159], v[6:7]
    v_cvt_pk_bf16_f32 v172, v200, v201
    v_cvt_pk_bf16_f32 v173, v202, v203
    v_cvt_pk_bf16_f32 v174, v204, v205
    v_cvt_pk_bf16_f32 v175, v206, v207
    s_nop 0
    v_permlane32_swap_b32 v172, v174
    v_permlane32_swap_b32 v173, v175
    s_nop 0
    v_permlane16_swap_b32 v172, v174
    v_permlane16_swap_b32 v173, v175
    buffer_store_dwordx4 v[172:175], v53, s[20:23], 0 offen offset:192 sc1
L_fin:
L_end:
    s_endpgm
L_fb0:
    s_mov_b32 s58, 1
    s_call_b64 s[68:69], L_fix0
    s_branch L_fb0_ret
L_fb1:
    s_mov_b32 s58, 0
    s_call_b64 s[68:69], L_fix1
    s_branch L_fb1_ret
L_fbL0:
    s_mov_b32 s58, 0
    s_call_b64 s[68:69], L_fix0
    s_branch L_fbL0_ret
L_fbL1:
    s_mov_b32 s58, 0
    s_call_b64 s[68:69], L_fix1
    s_branch L_fbL1_ret
L_fbL2:
    s_mov_b32 s58, 0
    s_call_b64 s[68:69], L_fix0
    s_branch L_fbL2_ret
L_fbL3:
    s_mov_b32 s58, 0
    s_call_b64 s[68:69], L_fix1
    s_branch L_fbL3_ret
L_fb30:
    s_mov_b32 s58, 0
    s_call_b64 s[68:69], L_fix0
    s_branch L_fb30_ret
L_fb31:
    s_mov_b32 s58, 0
    s_call_b64 s[68:69], L_fix1
    s_branch L_fb31_ret
L_gth:
    s_mov_b32 s65, 0
    s_mov_b32 s60, -1
    s_call_b64 s[68:69], L_gslow
    s_branch L_gth_ret
L_gto:
    s_mov_b32 s65, 128
    s_mov_b32 s60, -1
    s_call_b64 s[68:69], L_gslow
    s_branch L_gto_ret
L_vrf:
    s_sub_u32 s59, s59, 1
    s_cmp_eq_u32 s59, 0
    s_cbranch_scc1 L_vof
    s_mov_b32 s61, 0
    buffer_load_dwordx4 v[176:179], v54, s[4:7], s61 offen offset:0 sc1
    buffer_load_dwordx4 v[180:183], v54, s[4:7], s61 offen offset:1024 sc1
    buffer_load_dwordx4 v[184:187], v54, s[4:7], s61 offen offset:2048 sc1
    buffer_load_dwordx4 v[188:191], v54, s[4:7], s61 offen offset:3072 sc1
    buffer_load_dwordx4 v[192:195], v55, s[4:7], s61 offen offset:0 sc1
    buffer_load_dwordx4 v[196:199], v55, s[4:7], s61 offen offset:1024 sc1
    buffer_load_dwordx4 v[200:203], v55, s[4:7], s61 offen offset:2048 sc1
    buffer_load_dwordx4 v[204:207], v55, s[4:7], s61 offen offset:3072 sc1
    buffer_load_dwordx4 v[208:211], v56, s[4:7], s61 offen offset:0 sc1
    buffer_load_dwordx4 v[212:215], v56, s[4:7], s61 offen offset:1024 sc1
    buffer_load_dwordx4 v[216:219], v56, s[4:7], s61 offen offset:2048 sc1
    buffer_load_dwordx4 v[220:223], v56, s[4:7], s61 offen offset:3072 sc1
    s_waitcnt vmcnt(0)
    s_branch L_vaf
L_vrs:
    s_sub_u32 s59, s59, 1
    s_cmp_eq_u32 s59, 0
    s_cbranch_scc1 L_vos
    s_mov_b32 s61, 4096
    buffer_load_dwordx4 v[64:67], v54, s[4:7], s61 offen offset:0 sc1
    buffer_load_dwordx4 v[68:71], v54, s[4:7], s61 offen offset:1024 sc1
    buffer_load_dwordx4 v[72:75], v54, s[4:7], s61 offen offset:2048 sc1
    buffer_load_dwordx4 v[76:79], v54, s[4:7], s61 offen offset:3072 sc1
    buffer_load_dwordx4 v[80:83], v55, s[4:7], s61 offen offset:0 sc1
    buffer_load_dwordx4 v[84:87], v55, s[4:7], s61 offen offset:1024 sc1
    buffer_load_dwordx4 v[88:91], v55, s[4:7], s61 offen offset:2048 sc1
    buffer_load_dwordx4 v[92:95], v55, s[4:7], s61 offen offset:3072 sc1
    buffer_load_dwordx4 v[96:99], v56, s[4:7], s61 offen offset:0 sc1
    buffer_load_dwordx4 v[100:103], v56, s[4:7], s61 offen offset:1024 sc1
    buffer_load_dwordx4 v[104:107], v56, s[4:7], s61 offen offset:2048 sc1
    buffer_load_dwordx4 v[108:111], v56, s[4:7], s61 offen offset:3072 sc1
    s_waitcnt vmcnt(0)
    s_branch L_vas
L_gslow:
    s_mov_b32 s59, 0x40000
    s_add_u32 s65, s65, s98
L_gs1:
    buffer_load_dword v254, v240, s[36:39], s65 offen sc1
    s_waitcnt vmcnt(0)
    v_cmp_eq_u32 vcc, 1, v254
    s_nop 0
    s_and_b32 s58, vcc_lo, s60
    s_cmp_eq_u32 s58, s60
    s_cbranch_scc1 L_gs3
    s_sleep 2
    s_sub_u32 s59, s59, 1
    s_cmp_lg_u32 s59, 0
    s_cbranch_scc1 L_gs1
L_gs3:
    s_setpc_b64 s[68:69]
L_fix0:
    s_nop 7
    v_max3_f32 v228, v0, v1, v2
    v_max3_f32 v228, v228, v3, v16
    v_max3_f32 v228, v228, v17, v18
    v_max3_f32 v228, v228, v19, v32
    v_max3_f32 v228, v228, v33, v34
    v_max3_f32 v228, v228, v35, v48
    v_max3_f32 v228, v228, v49, v50
    v_max_f32 v228, v228, v51
    v_max3_f32 v229, v4, v5, v6
    v_max3_f32 v229, v229, v7, v20
    v_max3_f32 v229, v229, v21, v22
    v_max3_f32 v229, v229, v23, v36
    v_max3_f32 v229, v229, v37, v38
    v_max3_f32 v229, v229, v39, v52
    v_max3_f32 v229, v229, v53, v54
    v_max_f32 v229, v229, v55
    v_max3_f32 v230, v8, v9, v10
    v_max3_f32 v230, v230, v11, v24
    v_max3_f32 v230, v230, v25, v26
    v_max3_f32 v230, v230, v27, v40
    v_max3_f32 v230, v230, v41, v42
    v_max3_f32 v230, v230, v43, v56
    v_max3_f32 v230, v230, v57, v58
    v_max_f32 v230, v230, v59
    v_max3_f32 v231, v12, v13, v14
    v_max3_f32 v231, v231, v15, v28
    v_max3_f32 v231, v231, v29, v30
    v_max3_f32 v231, v231, v31, v44
    v_max3_f32 v231, v231, v45, v46
    v_max3_f32 v231, v231, v47, v60
    v_max3_f32 v231, v231, v61, v62
    v_max_f32 v231, v231, v63
    v_mov_b32 v232, v228
    v_mov_b32 v233, v229
    v_mov_b32 v234, v230
    v_mov_b32 v235, v231
    s_nop 1
    v_permlane16_swap_b32 v228, v232
    v_permlane16_swap_b32 v229, v233
    v_permlane16_swap_b32 v230, v234
    v_permlane16_swap_b32 v231, v235
    v_max_f32 v228, v228, v232
    v_max_f32 v229, v229, v233
    v_max_f32 v230, v230, v234
    v_max_f32 v231, v231, v235
    v_mov_b32 v232, v228
    v_mov_b32 v233, v229
    v_mov_b32 v234, v230
    v_mov_b32 v235, v231
    s_nop 1
    v_permlane32_swap_b32 v228, v232
    v_permlane32_swap_b32 v229, v233
    v_permlane32_swap_b32 v230, v234
    v_permlane32_swap_b32 v231, v235
    v_max_f32 v228, v228, v232
    v_max_f32 v229, v229, v233
    v_max_f32 v230, v230, v234
    v_max_f32 v231, v231, v235
    v_add_f32 v228, 0x42c40000, v228
    v_add_f32 v229, 0x42c40000, v229
    v_add_f32 v230, 0x42c40000, v230
    v_add_f32 v231, 0x42c40000, v231
    v_max_f32 v228, 0, v228
    v_max_f32 v229, 0, v229
    v_max_f32 v230, 0, v230
    v_max_f32 v231, 0, v231
    v_sub_f32 v192, v192, v228
    v_sub_f32 v193, v193, v228
    v_sub_f32 v194, v194, v228
    v_sub_f32 v195, v195, v228
    v_sub_f32 v196, v196, v229
    v_sub_f32 v197, v197, v229
    v_sub_f32 v198, v198, v229
    v_sub_f32 v199, v199, v229
    v_sub_f32 v200, v200, v230
    v_sub_f32 v201, v201, v230
    v_sub_f32 v202, v202, v230
    v_sub_f32 v203, v203, v230
    v_sub_f32 v204, v204, v231
    v_sub_f32 v205, v205, v231
    v_sub_f32 v206, v206, v231
    v_sub_f32 v207, v207, v231
    v_sub_f32 v0, v0, v228
    v_sub_f32 v1, v1, v228
    v_sub_f32 v2, v2, v228
    v_sub_f32 v3, v3, v228
    v_sub_f32 v4, v4, v229
    v_sub_f32 v5, v5, v229
    v_sub_f32 v6, v6, v229
    v_sub_f32 v7, v7, v229
    v_sub_f32 v8, v8, v230
    v_sub_f32 v9, v9, v230
    v_sub_f32 v10, v10, v230
    v_sub_f32 v11, v11, v230
    v_sub_f32 v12, v12, v231
    v_sub_f32 v13, v13, v231
    v_sub_f32 v14, v14, v231
    v_sub_f32 v15, v15, v231
    v_sub_f32 v16, v16, v228
    v_sub_f32 v17, v17, v228
    v_sub_f32 v18, v18, v228
    v_sub_f32 v19, v19, v228
    v_sub_f32 v20, v20, v229
    v_sub_f32 v21, v21, v229
    v_sub_f32 v22, v22, v229
    v_sub_f32 v23, v23, v229
    v_sub_f32 v24, v24, v230
    v_sub_f32 v25, v25, v230
    v_sub_f32 v26, v26, v230
    v_sub_f32 v27, v27, v230
    v_sub_f32 v28, v28, v231
    v_sub_f32 v29, v29, v231
    v_sub_f32 v30, v30, v231
    v_sub_f32 v31, v31, v231
    v_sub_f32 v32, v32, v228
    v_sub_f32 v33, v33, v228
    v_sub_f32 v34, v34, v228
    v_sub_f32 v35, v35, v228
    v_sub_f32 v36, v36, v229
    v_sub_f32 v37, v37, v229
    v_sub_f32 v38, v38, v229
    v_sub_f32 v39, v39, v229
    v_sub_f32 v40, v40, v230
    v_sub_f32 v41, v41, v230
    v_sub_f32 v42, v42, v230
    v_sub_f32 v43, v43, v230
    v_sub_f32 v44, v44, v231
    v_sub_f32 v45, v45, v231
    v_sub_f32 v46, v46, v231
    v_sub_f32 v47, v47, v231
    v_sub_f32 v48, v48, v228
    v_sub_f32 v49, v49, v228
    v_sub_f32 v50, v50, v228
    v_sub_f32 v51, v51, v228
    v_sub_f32 v52, v52, v229
    v_sub_f32 v53, v53, v229
    v_sub_f32 v54, v54, v229
    v_sub_f32 v55, v55, v229
    v_sub_f32 v56, v56, v230
    v_sub_f32 v57, v57, v230
    v_sub_f32 v58, v58, v230
    v_sub_f32 v59, v59, v230
    v_sub_f32 v60, v60, v231
    v_sub_f32 v61, v61, v231
    v_sub_f32 v62, v62, v231
    v_sub_f32 v63, v63, v231
    v_sub_f32 v64, v64, v228
    v_sub_f32 v65, v65, v228
    v_sub_f32 v66, v66, v228
    v_sub_f32 v67, v67, v228
    v_sub_f32 v68, v68, v229
    v_sub_f32 v69, v69, v229
    v_sub_f32 v70, v70, v229
    v_sub_f32 v71, v71, v229
    v_sub_f32 v72, v72, v230
    v_sub_f32 v73, v73, v230
    v_sub_f32 v74, v74, v230
    v_sub_f32 v75, v75, v230
    v_sub_f32 v76, v76, v231
    v_sub_f32 v77, v77, v231
    v_sub_f32 v78, v78, v231
    v_sub_f32 v79, v79, v231
    v_sub_f32 v80, v80, v228
    v_sub_f32 v81, v81, v228
    v_sub_f32 v82, v82, v228
    v_sub_f32 v83, v83, v228
    v_sub_f32 v84, v84, v229
    v_sub_f32 v85, v85, v229
    v_sub_f32 v86, v86, v229
    v_sub_f32 v87, v87, v229
    v_sub_f32 v88, v88, v230
    v_sub_f32 v89, v89, v230
    v_sub_f32 v90, v90, v230
    v_sub_f32 v91, v91, v230
    v_sub_f32 v92, v92, v231
    v_sub_f32 v93, v93, v231
    v_sub_f32 v94, v94, v231
    v_sub_f32 v95, v95, v231
    v_sub_f32 v96, v96, v228
    v_sub_f32 v97, v97, v228
    v_sub_f32 v98, v98, v228
    v_sub_f32 v99, v99, v228
    v_sub_f32 v100, v100, v229
    v_sub_f32 v101, v101, v229
    v_sub_f32 v102, v102, v229
    v_sub_f32 v103, v103, v229
    v_sub_f32 v104, v104, v230
    v_sub_f32 v105, v105, v230
    v_sub_f32 v106, v106, v230
    v_sub_f32 v107, v107, v230
    v_sub_f32 v108, v108, v231
    v_sub_f32 v109, v109, v231
    v_sub_f32 v110, v110, v231
    v_sub_f32 v111, v111, v231
    v_exp_f32 v232, -v228
    v_exp_f32 v233, -v229
    v_exp_f32 v234, -v230
    v_exp_f32 v235, -v231
    s_nop 0
    v_mul_f32 v224, v224, v232
    v_mul_f32 v225, v225, v233
    v_mul_f32 v226, v226, v234
    v_mul_f32 v227, v227, v235
    s_cmp_eq_u32 s58, 1
    s_cbranch_scc1 L_fs0
    v_accvgpr_read_b32 v208, a0
    v_accvgpr_read_b32 v209, a1
    v_accvgpr_read_b32 v210, a2
    v_accvgpr_read_b32 v211, a3
    v_mul_f32 v208, v208, v232
    v_mul_f32 v209, v209, v232
    v_mul_f32 v210, v210, v232
    v_mul_f32 v211, v211, v232
    v_accvgpr_write_b32 a0, v208
    v_accvgpr_write_b32 a1, v209
    v_accvgpr_write_b32 a2, v210
    v_accvgpr_write_b32 a3, v211
    v_accvgpr_read_b32 v208, a4
    v_accvgpr_read_b32 v209, a5
    v_accvgpr_read_b32 v210, a6
    v_accvgpr_read_b32 v211, a7
    v_mul_f32 v208, v208, v233
    v_mul_f32 v209, v209, v233
    v_mul_f32 v210, v210, v233
    v_mul_f32 v211, v211, v233
    v_accvgpr_write_b32 a4, v208
    v_accvgpr_write_b32 a5, v209
    v_accvgpr_write_b32 a6, v210
    v_accvgpr_write_b32 a7, v211
    v_accvgpr_read_b32 v208, a8
    v_accvgpr_read_b32 v209, a9
    v_accvgpr_read_b32 v210, a10
    v_accvgpr_read_b32 v211, a11
    v_mul_f32 v208, v208, v234
    v_mul_f32 v209, v209, v234
    v_mul_f32 v210, v210, v234
    v_mul_f32 v211, v211, v234
    v_accvgpr_write_b32 a8, v208
    v_accvgpr_write_b32 a9, v209
    v_accvgpr_write_b32 a10, v210
    v_accvgpr_write_b32 a11, v211
    v_accvgpr_read_b32 v208, a12
    v_accvgpr_read_b32 v209, a13
    v_accvgpr_read_b32 v210, a14
    v_accvgpr_read_b32 v211, a15
    v_mul_f32 v208, v208, v235
    v_mul_f32 v209, v209, v235
    v_mul_f32 v210, v210, v235
    v_mul_f32 v211, v211, v235
    v_accvgpr_write_b32 a12, v208
    v_accvgpr_write_b32 a13, v209
    v_accvgpr_write_b32 a14, v210
    v_accvgpr_write_b32 a15, v211
    v_accvgpr_read_b32 v208, a16
    v_accvgpr_read_b32 v209, a17
    v_accvgpr_read_b32 v210, a18
    v_accvgpr_read_b32 v211, a19
    v_mul_f32 v208, v208, v232
    v_mul_f32 v209, v209, v232
    v_mul_f32 v210, v210, v232
    v_mul_f32 v211, v211, v232
    v_accvgpr_write_b32 a16, v208
    v_accvgpr_write_b32 a17, v209
    v_accvgpr_write_b32 a18, v210
    v_accvgpr_write_b32 a19, v211
    v_accvgpr_read_b32 v208, a20
    v_accvgpr_read_b32 v209, a21
    v_accvgpr_read_b32 v210, a22
    v_accvgpr_read_b32 v211, a23
    v_mul_f32 v208, v208, v233
    v_mul_f32 v209, v209, v233
    v_mul_f32 v210, v210, v233
    v_mul_f32 v211, v211, v233
    v_accvgpr_write_b32 a20, v208
    v_accvgpr_write_b32 a21, v209
    v_accvgpr_write_b32 a22, v210
    v_accvgpr_write_b32 a23, v211
    v_accvgpr_read_b32 v208, a24
    v_accvgpr_read_b32 v209, a25
    v_accvgpr_read_b32 v210, a26
    v_accvgpr_read_b32 v211, a27
    v_mul_f32 v208, v208, v234
    v_mul_f32 v209, v209, v234
    v_mul_f32 v210, v210, v234
    v_mul_f32 v211, v211, v234
    v_accvgpr_write_b32 a24, v208
    v_accvgpr_write_b32 a25, v209
    v_accvgpr_write_b32 a26, v210
    v_accvgpr_write_b32 a27, v211
    v_accvgpr_read_b32 v208, a28
    v_accvgpr_read_b32 v209, a29
    v_accvgpr_read_b32 v210, a30
    v_accvgpr_read_b32 v211, a31
    v_mul_f32 v208, v208, v235
    v_mul_f32 v209, v209, v235
    v_mul_f32 v210, v210, v235
    v_mul_f32 v211, v211, v235
    v_accvgpr_write_b32 a28, v208
    v_accvgpr_write_b32 a29, v209
    v_accvgpr_write_b32 a30, v210
    v_accvgpr_write_b32 a31, v211
    v_accvgpr_read_b32 v208, a32
    v_accvgpr_read_b32 v209, a33
    v_accvgpr_read_b32 v210, a34
    v_accvgpr_read_b32 v211, a35
    v_mul_f32 v208, v208, v232
    v_mul_f32 v209, v209, v232
    v_mul_f32 v210, v210, v232
    v_mul_f32 v211, v211, v232
    v_accvgpr_write_b32 a32, v208
    v_accvgpr_write_b32 a33, v209
    v_accvgpr_write_b32 a34, v210
    v_accvgpr_write_b32 a35, v211
    v_accvgpr_read_b32 v208, a36
    v_accvgpr_read_b32 v209, a37
    v_accvgpr_read_b32 v210, a38
    v_accvgpr_read_b32 v211, a39
    v_mul_f32 v208, v208, v233
    v_mul_f32 v209, v209, v233
    v_mul_f32 v210, v210, v233
    v_mul_f32 v211, v211, v233
    v_accvgpr_write_b32 a36, v208
    v_accvgpr_write_b32 a37, v209
    v_accvgpr_write_b32 a38, v210
    v_accvgpr_write_b32 a39, v211
    v_accvgpr_read_b32 v208, a40
    v_accvgpr_read_b32 v209, a41
    v_accvgpr_read_b32 v210, a42
    v_accvgpr_read_b32 v211, a43
    v_mul_f32 v208, v208, v234
    v_mul_f32 v209, v209, v234
    v_mul_f32 v210, v210, v234
    v_mul_f32 v211, v211, v234
    v_accvgpr_write_b32 a40, v208
    v_accvgpr_write_b32 a41, v209
    v_accvgpr_write_b32 a42, v210
    v_accvgpr_write_b32 a43, v211
    v_accvgpr_read_b32 v208, a44
    v_accvgpr_read_b32 v209, a45
    v_accvgpr_read_b32 v210, a46
    v_accvgpr_read_b32 v211, a47
    v_mul_f32 v208, v208, v235
    v_mul_f32 v209, v209, v235
    v_mul_f32 v210, v210, v235
    v_mul_f32 v211, v211, v235
    v_accvgpr_write_b32 a44, v208
    v_accvgpr_write_b32 a45, v209
    v_accvgpr_write_b32 a46, v210
    v_accvgpr_write_b32 a47, v211
    v_accvgpr_read_b32 v208, a48
    v_accvgpr_read_b32 v209, a49
    v_accvgpr_read_b32 v210, a50
    v_accvgpr_read_b32 v211, a51
    v_mul_f32 v208, v208, v232
    v_mul_f32 v209, v209, v232
    v_mul_f32 v210, v210, v232
    v_mul_f32 v211, v211, v232
    v_accvgpr_write_b32 a48, v208
    v_accvgpr_write_b32 a49, v209
    v_accvgpr_write_b32 a50, v210
    v_accvgpr_write_b32 a51, v211
    v_accvgpr_read_b32 v208, a52
    v_accvgpr_read_b32 v209, a53
    v_accvgpr_read_b32 v210, a54
    v_accvgpr_read_b32 v211, a55
    v_mul_f32 v208, v208, v233
    v_mul_f32 v209, v209, v233
    v_mul_f32 v210, v210, v233
    v_mul_f32 v211, v211, v233
    v_accvgpr_write_b32 a52, v208
    v_accvgpr_write_b32 a53, v209
    v_accvgpr_write_b32 a54, v210
    v_accvgpr_write_b32 a55, v211
    v_accvgpr_read_b32 v208, a56
    v_accvgpr_read_b32 v209, a57
    v_accvgpr_read_b32 v210, a58
    v_accvgpr_read_b32 v211, a59
    v_mul_f32 v208, v208, v234
    v_mul_f32 v209, v209, v234
    v_mul_f32 v210, v210, v234
    v_mul_f32 v211, v211, v234
    v_accvgpr_write_b32 a56, v208
    v_accvgpr_write_b32 a57, v209
    v_accvgpr_write_b32 a58, v210
    v_accvgpr_write_b32 a59, v211
    v_accvgpr_read_b32 v208, a60
    v_accvgpr_read_b32 v209, a61
    v_accvgpr_read_b32 v210, a62
    v_accvgpr_read_b32 v211, a63
    v_mul_f32 v208, v208, v235
    v_mul_f32 v209, v209, v235
    v_mul_f32 v210, v210, v235
    v_mul_f32 v211, v211, v235
    v_accvgpr_write_b32 a60, v208
    v_accvgpr_write_b32 a61, v209
    v_accvgpr_write_b32 a62, v210
    v_accvgpr_write_b32 a63, v211
    v_accvgpr_read_b32 v208, a64
    v_accvgpr_read_b32 v209, a65
    v_accvgpr_read_b32 v210, a66
    v_accvgpr_read_b32 v211, a67
    v_mul_f32 v208, v208, v232
    v_mul_f32 v209, v209, v232
    v_mul_f32 v210, v210, v232
    v_mul_f32 v211, v211, v232
    v_accvgpr_write_b32 a64, v208
    v_accvgpr_write_b32 a65, v209
    v_accvgpr_write_b32 a66, v210
    v_accvgpr_write_b32 a67, v211
    v_accvgpr_read_b32 v208, a68
    v_accvgpr_read_b32 v209, a69
    v_accvgpr_read_b32 v210, a70
    v_accvgpr_read_b32 v211, a71
    v_mul_f32 v208, v208, v233
    v_mul_f32 v209, v209, v233
    v_mul_f32 v210, v210, v233
    v_mul_f32 v211, v211, v233
    v_accvgpr_write_b32 a68, v208
    v_accvgpr_write_b32 a69, v209
    v_accvgpr_write_b32 a70, v210
    v_accvgpr_write_b32 a71, v211
    v_accvgpr_read_b32 v208, a72
    v_accvgpr_read_b32 v209, a73
    v_accvgpr_read_b32 v210, a74
    v_accvgpr_read_b32 v211, a75
    v_mul_f32 v208, v208, v234
    v_mul_f32 v209, v209, v234
    v_mul_f32 v210, v210, v234
    v_mul_f32 v211, v211, v234
    v_accvgpr_write_b32 a72, v208
    v_accvgpr_write_b32 a73, v209
    v_accvgpr_write_b32 a74, v210
    v_accvgpr_write_b32 a75, v211
    v_accvgpr_read_b32 v208, a76
    v_accvgpr_read_b32 v209, a77
    v_accvgpr_read_b32 v210, a78
    v_accvgpr_read_b32 v211, a79
    v_mul_f32 v208, v208, v235
    v_mul_f32 v209, v209, v235
    v_mul_f32 v210, v210, v235
    v_mul_f32 v211, v211, v235
    v_accvgpr_write_b32 a76, v208
    v_accvgpr_write_b32 a77, v209
    v_accvgpr_write_b32 a78, v210
    v_accvgpr_write_b32 a79, v211
    v_accvgpr_read_b32 v208, a80
    v_accvgpr_read_b32 v209, a81
    v_accvgpr_read_b32 v210, a82
    v_accvgpr_read_b32 v211, a83
    v_mul_f32 v208, v208, v232
    v_mul_f32 v209, v209, v232
    v_mul_f32 v210, v210, v232
    v_mul_f32 v211, v211, v232
    v_accvgpr_write_b32 a80, v208
    v_accvgpr_write_b32 a81, v209
    v_accvgpr_write_b32 a82, v210
    v_accvgpr_write_b32 a83, v211
    v_accvgpr_read_b32 v208, a84
    v_accvgpr_read_b32 v209, a85
    v_accvgpr_read_b32 v210, a86
    v_accvgpr_read_b32 v211, a87
    v_mul_f32 v208, v208, v233
    v_mul_f32 v209, v209, v233
    v_mul_f32 v210, v210, v233
    v_mul_f32 v211, v211, v233
    v_accvgpr_write_b32 a84, v208
    v_accvgpr_write_b32 a85, v209
    v_accvgpr_write_b32 a86, v210
    v_accvgpr_write_b32 a87, v211
    v_accvgpr_read_b32 v208, a88
    v_accvgpr_read_b32 v209, a89
    v_accvgpr_read_b32 v210, a90
    v_accvgpr_read_b32 v211, a91
    v_mul_f32 v208, v208, v234
    v_mul_f32 v209, v209, v234
    v_mul_f32 v210, v210, v234
    v_mul_f32 v211, v211, v234
    v_accvgpr_write_b32 a88, v208
    v_accvgpr_write_b32 a89, v209
    v_accvgpr_write_b32 a90, v210
    v_accvgpr_write_b32 a91, v211
    v_accvgpr_read_b32 v208, a92
    v_accvgpr_read_b32 v209, a93
    v_accvgpr_read_b32 v210, a94
    v_accvgpr_read_b32 v211, a95
    v_mul_f32 v208, v208, v235
    v_mul_f32 v209, v209, v235
    v_mul_f32 v210, v210, v235
    v_mul_f32 v211, v211, v235
    v_accvgpr_write_b32 a92, v208
    v_accvgpr_write_b32 a93, v209
    v_accvgpr_write_b32 a94, v210
    v_accvgpr_write_b32 a95, v211
    v_accvgpr_read_b32 v208, a96
    v_accvgpr_read_b32 v209, a97
    v_accvgpr_read_b32 v210, a98
    v_accvgpr_read_b32 v211, a99
    v_mul_f32 v208, v208, v232
    v_mul_f32 v209, v209, v232
    v_mul_f32 v210, v210, v232
    v_mul_f32 v211, v211, v232
    v_accvgpr_write_b32 a96, v208
    v_accvgpr_write_b32 a97, v209
    v_accvgpr_write_b32 a98, v210
    v_accvgpr_write_b32 a99, v211
    v_accvgpr_read_b32 v208, a100
    v_accvgpr_read_b32 v209, a101
    v_accvgpr_read_b32 v210, a102
    v_accvgpr_read_b32 v211, a103
    v_mul_f32 v208, v208, v233
    v_mul_f32 v209, v209, v233
    v_mul_f32 v210, v210, v233
    v_mul_f32 v211, v211, v233
    v_accvgpr_write_b32 a100, v208
    v_accvgpr_write_b32 a101, v209
    v_accvgpr_write_b32 a102, v210
    v_accvgpr_write_b32 a103, v211
    v_accvgpr_read_b32 v208, a104
    v_accvgpr_read_b32 v209, a105
    v_accvgpr_read_b32 v210, a106
    v_accvgpr_read_b32 v211, a107
    v_mul_f32 v208, v208, v234
    v_mul_f32 v209, v209, v234
    v_mul_f32 v210, v210, v234
    v_mul_f32 v211, v211, v234
    v_accvgpr_write_b32 a104, v208
    v_accvgpr_write_b32 a105, v209
    v_accvgpr_write_b32 a106, v210
    v_accvgpr_write_b32 a107, v211
    v_accvgpr_read_b32 v208, a108
    v_accvgpr_read_b32 v209, a109
    v_accvgpr_read_b32 v210, a110
    v_accvgpr_read_b32 v211, a111
    v_mul_f32 v208, v208, v235
    v_mul_f32 v209, v209, v235
    v_mul_f32 v210, v210, v235
    v_mul_f32 v211, v211, v235
    v_accvgpr_write_b32 a108, v208
    v_accvgpr_write_b32 a109, v209
    v_accvgpr_write_b32 a110, v210
    v_accvgpr_write_b32 a111, v211
    v_accvgpr_read_b32 v208, a112
    v_accvgpr_read_b32 v209, a113
    v_accvgpr_read_b32 v210, a114
    v_accvgpr_read_b32 v211, a115
    v_mul_f32 v208, v208, v232
    v_mul_f32 v209, v209, v232
    v_mul_f32 v210, v210, v232
    v_mul_f32 v211, v211, v232
    v_accvgpr_write_b32 a112, v208
    v_accvgpr_write_b32 a113, v209
    v_accvgpr_write_b32 a114, v210
    v_accvgpr_write_b32 a115, v211
    v_accvgpr_read_b32 v208, a116
    v_accvgpr_read_b32 v209, a117
    v_accvgpr_read_b32 v210, a118
    v_accvgpr_read_b32 v211, a119
    v_mul_f32 v208, v208, v233
    v_mul_f32 v209, v209, v233
    v_mul_f32 v210, v210, v233
    v_mul_f32 v211, v211, v233
    v_accvgpr_write_b32 a116, v208
    v_accvgpr_write_b32 a117, v209
    v_accvgpr_write_b32 a118, v210
    v_accvgpr_write_b32 a119, v211
    v_accvgpr_read_b32 v208, a120
    v_accvgpr_read_b32 v209, a121
    v_accvgpr_read_b32 v210, a122
    v_accvgpr_read_b32 v211, a123
    v_mul_f32 v208, v208, v234
    v_mul_f32 v209, v209, v234
    v_mul_f32 v210, v210, v234
    v_mul_f32 v211, v211, v234
    v_accvgpr_write_b32 a120, v208
    v_accvgpr_write_b32 a121, v209
    v_accvgpr_write_b32 a122, v210
    v_accvgpr_write_b32 a123, v211
    v_accvgpr_read_b32 v208, a124
    v_accvgpr_read_b32 v209, a125
    v_accvgpr_read_b32 v210, a126
    v_accvgpr_read_b32 v211, a127
    v_mul_f32 v208, v208, v235
    v_mul_f32 v209, v209, v235
    v_mul_f32 v210, v210, v235
    v_mul_f32 v211, v211, v235
    v_accvgpr_write_b32 a124, v208
    v_accvgpr_write_b32 a125, v209
    v_accvgpr_write_b32 a126, v210
    v_accvgpr_write_b32 a127, v211
L_fs0:
    v_exp_f32 v208, v0
    v_exp_f32 v209, v1
    s_nop 0
    v_cvt_pk_bf16_f32 v128, v208, v209
    v_exp_f32 v208, v2
    v_exp_f32 v209, v3
    s_nop 0
    v_cvt_pk_bf16_f32 v129, v208, v209
    v_exp_f32 v208, v16
    v_exp_f32 v209, v17
    s_nop 0
    v_cvt_pk_bf16_f32 v130, v208, v209
    v_exp_f32 v208, v18
    v_exp_f32 v209, v19
    s_nop 0
    v_cvt_pk_bf16_f32 v131, v208, v209
    v_exp_f32 v208, v32
    v_exp_f32 v209, v33
    s_nop 0
    v_cvt_pk_bf16_f32 v132, v208, v209
    v_exp_f32 v208, v34
    v_exp_f32 v209, v35
    s_nop 0
    v_cvt_pk_bf16_f32 v133, v208, v209
    v_exp_f32 v208, v48
    v_exp_f32 v209, v49
    s_nop 0
    v_cvt_pk_bf16_f32 v134, v208, v209
    v_exp_f32 v208, v50
    v_exp_f32 v209, v51
    s_nop 0
    v_cvt_pk_bf16_f32 v135, v208, v209
    v_exp_f32 v208, v4
    v_exp_f32 v209, v5
    s_nop 0
    v_cvt_pk_bf16_f32 v136, v208, v209
    v_exp_f32 v208, v6
    v_exp_f32 v209, v7
    s_nop 0
    v_cvt_pk_bf16_f32 v137, v208, v209
    v_exp_f32 v208, v20
    v_exp_f32 v209, v21
    s_nop 0
    v_cvt_pk_bf16_f32 v138, v208, v209
    v_exp_f32 v208, v22
    v_exp_f32 v209, v23
    s_nop 0
    v_cvt_pk_bf16_f32 v139, v208, v209
    v_exp_f32 v208, v36
    v_exp_f32 v209, v37
    s_nop 0
    v_cvt_pk_bf16_f32 v140, v208, v209
    v_exp_f32 v208, v38
    v_exp_f32 v209, v39
    s_nop 0
    v_cvt_pk_bf16_f32 v141, v208, v209
    v_exp_f32 v208, v52
    v_exp_f32 v209, v53
    s_nop 0
    v_cvt_pk_bf16_f32 v142, v208, v209
    v_exp_f32 v208, v54
    v_exp_f32 v209, v55
    s_nop 0
    v_cvt_pk_bf16_f32 v143, v208, v209
    v_exp_f32 v208, v8
    v_exp_f32 v209, v9
    s_nop 0
    v_cvt_pk_bf16_f32 v144, v208, v209
    v_exp_f32 v208, v10
    v_exp_f32 v209, v11
    s_nop 0
    v_cvt_pk_bf16_f32 v145, v208, v209
    v_exp_f32 v208, v24
    v_exp_f32 v209, v25
    s_nop 0
    v_cvt_pk_bf16_f32 v146, v208, v209
    v_exp_f32 v208, v26
    v_exp_f32 v209, v27
    s_nop 0
    v_cvt_pk_bf16_f32 v147, v208, v209
    v_exp_f32 v208, v40
    v_exp_f32 v209, v41
    s_nop 0
    v_cvt_pk_bf16_f32 v148, v208, v209
    v_exp_f32 v208, v42
    v_exp_f32 v209, v43
    s_nop 0
    v_cvt_pk_bf16_f32 v149, v208, v209
    v_exp_f32 v208, v56
    v_exp_f32 v209, v57
    s_nop 0
    v_cvt_pk_bf16_f32 v150, v208, v209
    v_exp_f32 v208, v58
    v_exp_f32 v209, v59
    s_nop 0
    v_cvt_pk_bf16_f32 v151, v208, v209
    v_exp_f32 v208, v12
    v_exp_f32 v209, v13
    s_nop 0
    v_cvt_pk_bf16_f32 v152, v208, v209
    v_exp_f32 v208, v14
    v_exp_f32 v209, v15
    s_nop 0
    v_cvt_pk_bf16_f32 v153, v208, v209
    v_exp_f32 v208, v28
    v_exp_f32 v209, v29
    s_nop 0
    v_cvt_pk_bf16_f32 v154, v208, v209
    v_exp_f32 v208, v30
    v_exp_f32 v209, v31
    s_nop 0
    v_cvt_pk_bf16_f32 v155, v208, v209
    v_exp_f32 v208, v44
    v_exp_f32 v209, v45
    s_nop 0
    v_cvt_pk_bf16_f32 v156, v208, v209
    v_exp_f32 v208, v46
    v_exp_f32 v209, v47
    s_nop 0
    v_cvt_pk_bf16_f32 v157, v208, v209
    v_exp_f32 v208, v60
    v_exp_f32 v209, v61
    s_nop 0
    v_cvt_pk_bf16_f32 v158, v208, v209
    v_exp_f32 v208, v62
    v_exp_f32 v209, v63
    s_nop 0
    v_cvt_pk_bf16_f32 v159, v208, v209
    s_nop 1
    v_mfma_f32_16x16x32_bf16 v[208:211], v[244:247], v[128:131], 0
    v_mfma_f32_16x16x32_bf16 v[208:211], v[244:247], v[132:135], v[208:211]
    v_mfma_f32_16x16x32_bf16 v[212:215], v[244:247], v[136:139], 0
    v_mfma_f32_16x16x32_bf16 v[212:215], v[244:247], v[140:143], v[212:215]
    v_mfma_f32_16x16x32_bf16 v[216:219], v[244:247], v[144:147], 0
    v_mfma_f32_16x16x32_bf16 v[216:219], v[244:247], v[148:151], v[216:219]
    v_mfma_f32_16x16x32_bf16 v[220:223], v[244:247], v[152:155], 0
    v_mfma_f32_16x16x32_bf16 v[220:223], v[244:247], v[156:159], v[220:223]
    s_nop 7
    s_nop 1
    s_setpc_b64 s[68:69]
L_fix1:
    s_nop 7
    v_max3_f32 v228, v64, v65, v66
    v_max3_f32 v228, v228, v67, v80
    v_max3_f32 v228, v228, v81, v82
    v_max3_f32 v228, v228, v83, v96
    v_max3_f32 v228, v228, v97, v98
    v_max3_f32 v228, v228, v99, v112
    v_max3_f32 v228, v228, v113, v114
    v_max_f32 v228, v228, v115
    v_max3_f32 v229, v68, v69, v70
    v_max3_f32 v229, v229, v71, v84
    v_max3_f32 v229, v229, v85, v86
    v_max3_f32 v229, v229, v87, v100
    v_max3_f32 v229, v229, v101, v102
    v_max3_f32 v229, v229, v103, v116
    v_max3_f32 v229, v229, v117, v118
    v_max_f32 v229, v229, v119
    v_max3_f32 v230, v72, v73, v74
    v_max3_f32 v230, v230, v75, v88
    v_max3_f32 v230, v230, v89, v90
    v_max3_f32 v230, v230, v91, v104
    v_max3_f32 v230, v230, v105, v106
    v_max3_f32 v230, v230, v107, v120
    v_max3_f32 v230, v230, v121, v122
    v_max_f32 v230, v230, v123
    v_max3_f32 v231, v76, v77, v78
    v_max3_f32 v231, v231, v79, v92
    v_max3_f32 v231, v231, v93, v94
    v_max3_f32 v231, v231, v95, v108
    v_max3_f32 v231, v231, v109, v110
    v_max3_f32 v231, v231, v111, v124
    v_max3_f32 v231, v231, v125, v126
    v_max_f32 v231, v231, v127
    v_mov_b32 v232, v228
    v_mov_b32 v233, v229
    v_mov_b32 v234, v230
    v_mov_b32 v235, v231
    s_nop 1
    v_permlane16_swap_b32 v228, v232
    v_permlane16_swap_b32 v229, v233
    v_permlane16_swap_b32 v230, v234
    v_permlane16_swap_b32 v231, v235
    v_max_f32 v228, v228, v232
    v_max_f32 v229, v229, v233
    v_max_f32 v230, v230, v234
    v_max_f32 v231, v231, v235
    v_mov_b32 v232, v228
    v_mov_b32 v233, v229
    v_mov_b32 v234, v230
    v_mov_b32 v235, v231
    s_nop 1
    v_permlane32_swap_b32 v228, v232
    v_permlane32_swap_b32 v229, v233
    v_permlane32_swap_b32 v230, v234
    v_permlane32_swap_b32 v231, v235
    v_max_f32 v228, v228, v232
    v_max_f32 v229, v229, v233
    v_max_f32 v230, v230, v234
    v_max_f32 v231, v231, v235
    v_add_f32 v228, 0x42c40000, v228
    v_add_f32 v229, 0x42c40000, v229
    v_add_f32 v230, 0x42c40000, v230
    v_add_f32 v231, 0x42c40000, v231
    v_max_f32 v228, 0, v228
    v_max_f32 v229, 0, v229
    v_max_f32 v230, 0, v230
    v_max_f32 v231, 0, v231
    v_sub_f32 v192, v192, v228
    v_sub_f32 v193, v193, v228
    v_sub_f32 v194, v194, v228
    v_sub_f32 v195, v195, v228
    v_sub_f32 v196, v196, v229
    v_sub_f32 v197, v197, v229
    v_sub_f32 v198, v198, v229
    v_sub_f32 v199, v199, v229
    v_sub_f32 v200, v200, v230
    v_sub_f32 v201, v201, v230
    v_sub_f32 v202, v202, v230
    v_sub_f32 v203, v203, v230
    v_sub_f32 v204, v204, v231
    v_sub_f32 v205, v205, v231
    v_sub_f32 v206, v206, v231
    v_sub_f32 v207, v207, v231
    v_sub_f32 v64, v64, v228
    v_sub_f32 v65, v65, v228
    v_sub_f32 v66, v66, v228
    v_sub_f32 v67, v67, v228
    v_sub_f32 v68, v68, v229
    v_sub_f32 v69, v69, v229
    v_sub_f32 v70, v70, v229
    v_sub_f32 v71, v71, v229
    v_sub_f32 v72, v72, v230
    v_sub_f32 v73, v73, v230
    v_sub_f32 v74, v74, v230
    v_sub_f32 v75, v75, v230
    v_sub_f32 v76, v76, v231
    v_sub_f32 v77, v77, v231
    v_sub_f32 v78, v78, v231
    v_sub_f32 v79, v79, v231
    v_sub_f32 v80, v80, v228
    v_sub_f32 v81, v81, v228
    v_sub_f32 v82, v82, v228
    v_sub_f32 v83, v83, v228
    v_sub_f32 v84, v84, v229
    v_sub_f32 v85, v85, v229
    v_sub_f32 v86, v86, v229
    v_sub_f32 v87, v87, v229
    v_sub_f32 v88, v88, v230
    v_sub_f32 v89, v89, v230
    v_sub_f32 v90, v90, v230
    v_sub_f32 v91, v91, v230
    v_sub_f32 v92, v92, v231
    v_sub_f32 v93, v93, v231
    v_sub_f32 v94, v94, v231
    v_sub_f32 v95, v95, v231
    v_sub_f32 v96, v96, v228
    v_sub_f32 v97, v97, v228
    v_sub_f32 v98, v98, v228
    v_sub_f32 v99, v99, v228
    v_sub_f32 v100, v100, v229
    v_sub_f32 v101, v101, v229
    v_sub_f32 v102, v102, v229
    v_sub_f32 v103, v103, v229
    v_sub_f32 v104, v104, v230
    v_sub_f32 v105, v105, v230
    v_sub_f32 v106, v106, v230
    v_sub_f32 v107, v107, v230
    v_sub_f32 v108, v108, v231
    v_sub_f32 v109, v109, v231
    v_sub_f32 v110, v110, v231
    v_sub_f32 v111, v111, v231
    v_sub_f32 v112, v112, v228
    v_sub_f32 v113, v113, v228
    v_sub_f32 v114, v114, v228
    v_sub_f32 v115, v115, v228
    v_sub_f32 v116, v116, v229
    v_sub_f32 v117, v117, v229
    v_sub_f32 v118, v118, v229
    v_sub_f32 v119, v119, v229
    v_sub_f32 v120, v120, v230
    v_sub_f32 v121, v121, v230
    v_sub_f32 v122, v122, v230
    v_sub_f32 v123, v123, v230
    v_sub_f32 v124, v124, v231
    v_sub_f32 v125, v125, v231
    v_sub_f32 v126, v126, v231
    v_sub_f32 v127, v127, v231
    v_sub_f32 v0, v0, v228
    v_sub_f32 v1, v1, v228
    v_sub_f32 v2, v2, v228
    v_sub_f32 v3, v3, v228
    v_sub_f32 v4, v4, v229
    v_sub_f32 v5, v5, v229
    v_sub_f32 v6, v6, v229
    v_sub_f32 v7, v7, v229
    v_sub_f32 v8, v8, v230
    v_sub_f32 v9, v9, v230
    v_sub_f32 v10, v10, v230
    v_sub_f32 v11, v11, v230
    v_sub_f32 v12, v12, v231
    v_sub_f32 v13, v13, v231
    v_sub_f32 v14, v14, v231
    v_sub_f32 v15, v15, v231
    v_sub_f32 v16, v16, v228
    v_sub_f32 v17, v17, v228
    v_sub_f32 v18, v18, v228
    v_sub_f32 v19, v19, v228
    v_sub_f32 v20, v20, v229
    v_sub_f32 v21, v21, v229
    v_sub_f32 v22, v22, v229
    v_sub_f32 v23, v23, v229
    v_sub_f32 v24, v24, v230
    v_sub_f32 v25, v25, v230
    v_sub_f32 v26, v26, v230
    v_sub_f32 v27, v27, v230
    v_sub_f32 v28, v28, v231
    v_sub_f32 v29, v29, v231
    v_sub_f32 v30, v30, v231
    v_sub_f32 v31, v31, v231
    v_sub_f32 v32, v32, v228
    v_sub_f32 v33, v33, v228
    v_sub_f32 v34, v34, v228
    v_sub_f32 v35, v35, v228
    v_sub_f32 v36, v36, v229
    v_sub_f32 v37, v37, v229
    v_sub_f32 v38, v38, v229
    v_sub_f32 v39, v39, v229
    v_sub_f32 v40, v40, v230
    v_sub_f32 v41, v41, v230
    v_sub_f32 v42, v42, v230
    v_sub_f32 v43, v43, v230
    v_sub_f32 v44, v44, v231
    v_sub_f32 v45, v45, v231
    v_sub_f32 v46, v46, v231
    v_sub_f32 v47, v47, v231
    v_exp_f32 v232, -v228
    v_exp_f32 v233, -v229
    v_exp_f32 v234, -v230
    v_exp_f32 v235, -v231
    s_nop 0
    v_mul_f32 v224, v224, v232
    v_mul_f32 v225, v225, v233
    v_mul_f32 v226, v226, v234
    v_mul_f32 v227, v227, v235
    s_cmp_eq_u32 s58, 1
    s_cbranch_scc1 L_fs1
    v_accvgpr_read_b32 v208, a0
    v_accvgpr_read_b32 v209, a1
    v_accvgpr_read_b32 v210, a2
    v_accvgpr_read_b32 v211, a3
    v_mul_f32 v208, v208, v232
    v_mul_f32 v209, v209, v232
    v_mul_f32 v210, v210, v232
    v_mul_f32 v211, v211, v232
    v_accvgpr_write_b32 a0, v208
    v_accvgpr_write_b32 a1, v209
    v_accvgpr_write_b32 a2, v210
    v_accvgpr_write_b32 a3, v211
    v_accvgpr_read_b32 v208, a4
    v_accvgpr_read_b32 v209, a5
    v_accvgpr_read_b32 v210, a6
    v_accvgpr_read_b32 v211, a7
    v_mul_f32 v208, v208, v233
    v_mul_f32 v209, v209, v233
    v_mul_f32 v210, v210, v233
    v_mul_f32 v211, v211, v233
    v_accvgpr_write_b32 a4, v208
    v_accvgpr_write_b32 a5, v209
    v_accvgpr_write_b32 a6, v210
    v_accvgpr_write_b32 a7, v211
    v_accvgpr_read_b32 v208, a8
    v_accvgpr_read_b32 v209, a9
    v_accvgpr_read_b32 v210, a10
    v_accvgpr_read_b32 v211, a11
    v_mul_f32 v208, v208, v234
    v_mul_f32 v209, v209, v234
    v_mul_f32 v210, v210, v234
    v_mul_f32 v211, v211, v234
    v_accvgpr_write_b32 a8, v208
    v_accvgpr_write_b32 a9, v209
    v_accvgpr_write_b32 a10, v210
    v_accvgpr_write_b32 a11, v211
    v_accvgpr_read_b32 v208, a12
    v_accvgpr_read_b32 v209, a13
    v_accvgpr_read_b32 v210, a14
    v_accvgpr_read_b32 v211, a15
    v_mul_f32 v208, v208, v235
    v_mul_f32 v209, v209, v235
    v_mul_f32 v210, v210, v235
    v_mul_f32 v211, v211, v235
    v_accvgpr_write_b32 a12, v208
    v_accvgpr_write_b32 a13, v209
    v_accvgpr_write_b32 a14, v210
    v_accvgpr_write_b32 a15, v211
    v_accvgpr_read_b32 v208, a16
    v_accvgpr_read_b32 v209, a17
    v_accvgpr_read_b32 v210, a18
    v_accvgpr_read_b32 v211, a19
    v_mul_f32 v208, v208, v232
    v_mul_f32 v209, v209, v232
    v_mul_f32 v210, v210, v232
    v_mul_f32 v211, v211, v232
    v_accvgpr_write_b32 a16, v208
    v_accvgpr_write_b32 a17, v209
    v_accvgpr_write_b32 a18, v210
    v_accvgpr_write_b32 a19, v211
    v_accvgpr_read_b32 v208, a20
    v_accvgpr_read_b32 v209, a21
    v_accvgpr_read_b32 v210, a22
    v_accvgpr_read_b32 v211, a23
    v_mul_f32 v208, v208, v233
    v_mul_f32 v209, v209, v233
    v_mul_f32 v210, v210, v233
    v_mul_f32 v211, v211, v233
    v_accvgpr_write_b32 a20, v208
    v_accvgpr_write_b32 a21, v209
    v_accvgpr_write_b32 a22, v210
    v_accvgpr_write_b32 a23, v211
    v_accvgpr_read_b32 v208, a24
    v_accvgpr_read_b32 v209, a25
    v_accvgpr_read_b32 v210, a26
    v_accvgpr_read_b32 v211, a27
    v_mul_f32 v208, v208, v234
    v_mul_f32 v209, v209, v234
    v_mul_f32 v210, v210, v234
    v_mul_f32 v211, v211, v234
    v_accvgpr_write_b32 a24, v208
    v_accvgpr_write_b32 a25, v209
    v_accvgpr_write_b32 a26, v210
    v_accvgpr_write_b32 a27, v211
    v_accvgpr_read_b32 v208, a28
    v_accvgpr_read_b32 v209, a29
    v_accvgpr_read_b32 v210, a30
    v_accvgpr_read_b32 v211, a31
    v_mul_f32 v208, v208, v235
    v_mul_f32 v209, v209, v235
    v_mul_f32 v210, v210, v235
    v_mul_f32 v211, v211, v235
    v_accvgpr_write_b32 a28, v208
    v_accvgpr_write_b32 a29, v209
    v_accvgpr_write_b32 a30, v210
    v_accvgpr_write_b32 a31, v211
    v_accvgpr_read_b32 v208, a32
    v_accvgpr_read_b32 v209, a33
    v_accvgpr_read_b32 v210, a34
    v_accvgpr_read_b32 v211, a35
    v_mul_f32 v208, v208, v232
    v_mul_f32 v209, v209, v232
    v_mul_f32 v210, v210, v232
    v_mul_f32 v211, v211, v232
    v_accvgpr_write_b32 a32, v208
    v_accvgpr_write_b32 a33, v209
    v_accvgpr_write_b32 a34, v210
    v_accvgpr_write_b32 a35, v211
    v_accvgpr_read_b32 v208, a36
    v_accvgpr_read_b32 v209, a37
    v_accvgpr_read_b32 v210, a38
    v_accvgpr_read_b32 v211, a39
    v_mul_f32 v208, v208, v233
    v_mul_f32 v209, v209, v233
    v_mul_f32 v210, v210, v233
    v_mul_f32 v211, v211, v233
    v_accvgpr_write_b32 a36, v208
    v_accvgpr_write_b32 a37, v209
    v_accvgpr_write_b32 a38, v210
    v_accvgpr_write_b32 a39, v211
    v_accvgpr_read_b32 v208, a40
    v_accvgpr_read_b32 v209, a41
    v_accvgpr_read_b32 v210, a42
    v_accvgpr_read_b32 v211, a43
    v_mul_f32 v208, v208, v234
    v_mul_f32 v209, v209, v234
    v_mul_f32 v210, v210, v234
    v_mul_f32 v211, v211, v234
    v_accvgpr_write_b32 a40, v208
    v_accvgpr_write_b32 a41, v209
    v_accvgpr_write_b32 a42, v210
    v_accvgpr_write_b32 a43, v211
    v_accvgpr_read_b32 v208, a44
    v_accvgpr_read_b32 v209, a45
    v_accvgpr_read_b32 v210, a46
    v_accvgpr_read_b32 v211, a47
    v_mul_f32 v208, v208, v235
    v_mul_f32 v209, v209, v235
    v_mul_f32 v210, v210, v235
    v_mul_f32 v211, v211, v235
    v_accvgpr_write_b32 a44, v208
    v_accvgpr_write_b32 a45, v209
    v_accvgpr_write_b32 a46, v210
    v_accvgpr_write_b32 a47, v211
    v_accvgpr_read_b32 v208, a48
    v_accvgpr_read_b32 v209, a49
    v_accvgpr_read_b32 v210, a50
    v_accvgpr_read_b32 v211, a51
    v_mul_f32 v208, v208, v232
    v_mul_f32 v209, v209, v232
    v_mul_f32 v210, v210, v232
    v_mul_f32 v211, v211, v232
    v_accvgpr_write_b32 a48, v208
    v_accvgpr_write_b32 a49, v209
    v_accvgpr_write_b32 a50, v210
    v_accvgpr_write_b32 a51, v211
    v_accvgpr_read_b32 v208, a52
    v_accvgpr_read_b32 v209, a53
    v_accvgpr_read_b32 v210, a54
    v_accvgpr_read_b32 v211, a55
    v_mul_f32 v208, v208, v233
    v_mul_f32 v209, v209, v233
    v_mul_f32 v210, v210, v233
    v_mul_f32 v211, v211, v233
    v_accvgpr_write_b32 a52, v208
    v_accvgpr_write_b32 a53, v209
    v_accvgpr_write_b32 a54, v210
    v_accvgpr_write_b32 a55, v211
    v_accvgpr_read_b32 v208, a56
    v_accvgpr_read_b32 v209, a57
    v_accvgpr_read_b32 v210, a58
    v_accvgpr_read_b32 v211, a59
    v_mul_f32 v208, v208, v234
    v_mul_f32 v209, v209, v234
    v_mul_f32 v210, v210, v234
    v_mul_f32 v211, v211, v234
    v_accvgpr_write_b32 a56, v208
    v_accvgpr_write_b32 a57, v209
    v_accvgpr_write_b32 a58, v210
    v_accvgpr_write_b32 a59, v211
    v_accvgpr_read_b32 v208, a60
    v_accvgpr_read_b32 v209, a61
    v_accvgpr_read_b32 v210, a62
    v_accvgpr_read_b32 v211, a63
    v_mul_f32 v208, v208, v235
    v_mul_f32 v209, v209, v235
    v_mul_f32 v210, v210, v235
    v_mul_f32 v211, v211, v235
    v_accvgpr_write_b32 a60, v208
    v_accvgpr_write_b32 a61, v209
    v_accvgpr_write_b32 a62, v210
    v_accvgpr_write_b32 a63, v211
    v_accvgpr_read_b32 v208, a64
    v_accvgpr_read_b32 v209, a65
    v_accvgpr_read_b32 v210, a66
    v_accvgpr_read_b32 v211, a67
    v_mul_f32 v208, v208, v232
    v_mul_f32 v209, v209, v232
    v_mul_f32 v210, v210, v232
    v_mul_f32 v211, v211, v232
    v_accvgpr_write_b32 a64, v208
    v_accvgpr_write_b32 a65, v209
    v_accvgpr_write_b32 a66, v210
    v_accvgpr_write_b32 a67, v211
    v_accvgpr_read_b32 v208, a68
    v_accvgpr_read_b32 v209, a69
    v_accvgpr_read_b32 v210, a70
    v_accvgpr_read_b32 v211, a71
    v_mul_f32 v208, v208, v233
    v_mul_f32 v209, v209, v233
    v_mul_f32 v210, v210, v233
    v_mul_f32 v211, v211, v233
    v_accvgpr_write_b32 a68, v208
    v_accvgpr_write_b32 a69, v209
    v_accvgpr_write_b32 a70, v210
    v_accvgpr_write_b32 a71, v211
    v_accvgpr_read_b32 v208, a72
    v_accvgpr_read_b32 v209, a73
    v_accvgpr_read_b32 v210, a74
    v_accvgpr_read_b32 v211, a75
    v_mul_f32 v208, v208, v234
    v_mul_f32 v209, v209, v234
    v_mul_f32 v210, v210, v234
    v_mul_f32 v211, v211, v234
    v_accvgpr_write_b32 a72, v208
    v_accvgpr_write_b32 a73, v209
    v_accvgpr_write_b32 a74, v210
    v_accvgpr_write_b32 a75, v211
    v_accvgpr_read_b32 v208, a76
    v_accvgpr_read_b32 v209, a77
    v_accvgpr_read_b32 v210, a78
    v_accvgpr_read_b32 v211, a79
    v_mul_f32 v208, v208, v235
    v_mul_f32 v209, v209, v235
    v_mul_f32 v210, v210, v235
    v_mul_f32 v211, v211, v235
    v_accvgpr_write_b32 a76, v208
    v_accvgpr_write_b32 a77, v209
    v_accvgpr_write_b32 a78, v210
    v_accvgpr_write_b32 a79, v211
    v_accvgpr_read_b32 v208, a80
    v_accvgpr_read_b32 v209, a81
    v_accvgpr_read_b32 v210, a82
    v_accvgpr_read_b32 v211, a83
    v_mul_f32 v208, v208, v232
    v_mul_f32 v209, v209, v232
    v_mul_f32 v210, v210, v232
    v_mul_f32 v211, v211, v232
    v_accvgpr_write_b32 a80, v208
    v_accvgpr_write_b32 a81, v209
    v_accvgpr_write_b32 a82, v210
    v_accvgpr_write_b32 a83, v211
    v_accvgpr_read_b32 v208, a84
    v_accvgpr_read_b32 v209, a85
    v_accvgpr_read_b32 v210, a86
    v_accvgpr_read_b32 v211, a87
    v_mul_f32 v208, v208, v233
    v_mul_f32 v209, v209, v233
    v_mul_f32 v210, v210, v233
    v_mul_f32 v211, v211, v233
    v_accvgpr_write_b32 a84, v208
    v_accvgpr_write_b32 a85, v209
    v_accvgpr_write_b32 a86, v210
    v_accvgpr_write_b32 a87, v211
    v_accvgpr_read_b32 v208, a88
    v_accvgpr_read_b32 v209, a89
    v_accvgpr_read_b32 v210, a90
    v_accvgpr_read_b32 v211, a91
    v_mul_f32 v208, v208, v234
    v_mul_f32 v209, v209, v234
    v_mul_f32 v210, v210, v234
    v_mul_f32 v211, v211, v234
    v_accvgpr_write_b32 a88, v208
    v_accvgpr_write_b32 a89, v209
    v_accvgpr_write_b32 a90, v210
    v_accvgpr_write_b32 a91, v211
    v_accvgpr_read_b32 v208, a92
    v_accvgpr_read_b32 v209, a93
    v_accvgpr_read_b32 v210, a94
    v_accvgpr_read_b32 v211, a95
    v_mul_f32 v208, v208, v235
    v_mul_f32 v209, v209, v235
    v_mul_f32 v210, v210, v235
    v_mul_f32 v211, v211, v235
    v_accvgpr_write_b32 a92, v208
    v_accvgpr_write_b32 a93, v209
    v_accvgpr_write_b32 a94, v210
    v_accvgpr_write_b32 a95, v211
    v_accvgpr_read_b32 v208, a96
    v_accvgpr_read_b32 v209, a97
    v_accvgpr_read_b32 v210, a98
    v_accvgpr_read_b32 v211, a99
    v_mul_f32 v208, v208, v232
    v_mul_f32 v209, v209, v232
    v_mul_f32 v210, v210, v232
    v_mul_f32 v211, v211, v232
    v_accvgpr_write_b32 a96, v208
    v_accvgpr_write_b32 a97, v209
    v_accvgpr_write_b32 a98, v210
    v_accvgpr_write_b32 a99, v211
    v_accvgpr_read_b32 v208, a100
    v_accvgpr_read_b32 v209, a101
    v_accvgpr_read_b32 v210, a102
    v_accvgpr_read_b32 v211, a103
    v_mul_f32 v208, v208, v233
    v_mul_f32 v209, v209, v233
    v_mul_f32 v210, v210, v233
    v_mul_f32 v211, v211, v233
    v_accvgpr_write_b32 a100, v208
    v_accvgpr_write_b32 a101, v209
    v_accvgpr_write_b32 a102, v210
    v_accvgpr_write_b32 a103, v211
    v_accvgpr_read_b32 v208, a104
    v_accvgpr_read_b32 v209, a105
    v_accvgpr_read_b32 v210, a106
    v_accvgpr_read_b32 v211, a107
    v_mul_f32 v208, v208, v234
    v_mul_f32 v209, v209, v234
    v_mul_f32 v210, v210, v234
    v_mul_f32 v211, v211, v234
    v_accvgpr_write_b32 a104, v208
    v_accvgpr_write_b32 a105, v209
    v_accvgpr_write_b32 a106, v210
    v_accvgpr_write_b32 a107, v211
    v_accvgpr_read_b32 v208, a108
    v_accvgpr_read_b32 v209, a109
    v_accvgpr_read_b32 v210, a110
    v_accvgpr_read_b32 v211, a111
    v_mul_f32 v208, v208, v235
    v_mul_f32 v209, v209, v235
    v_mul_f32 v210, v210, v235
    v_mul_f32 v211, v211, v235
    v_accvgpr_write_b32 a108, v208
    v_accvgpr_write_b32 a109, v209
    v_accvgpr_write_b32 a110, v210
    v_accvgpr_write_b32 a111, v211
    v_accvgpr_read_b32 v208, a112
    v_accvgpr_read_b32 v209, a113
    v_accvgpr_read_b32 v210, a114
    v_accvgpr_read_b32 v211, a115
    v_mul_f32 v208, v208, v232
    v_mul_f32 v209, v209, v232
    v_mul_f32 v210, v210, v232
    v_mul_f32 v211, v211, v232
    v_accvgpr_write_b32 a112, v208
    v_accvgpr_write_b32 a113, v209
    v_accvgpr_write_b32 a114, v210
    v_accvgpr_write_b32 a115, v211
    v_accvgpr_read_b32 v208, a116
    v_accvgpr_read_b32 v209, a117
    v_accvgpr_read_b32 v210, a118
    v_accvgpr_read_b32 v211, a119
    v_mul_f32 v208, v208, v233
    v_mul_f32 v209, v209, v233
    v_mul_f32 v210, v210, v233
    v_mul_f32 v211, v211, v233
    v_accvgpr_write_b32 a116, v208
    v_accvgpr_write_b32 a117, v209
    v_accvgpr_write_b32 a118, v210
    v_accvgpr_write_b32 a119, v211
    v_accvgpr_read_b32 v208, a120
    v_accvgpr_read_b32 v209, a121
    v_accvgpr_read_b32 v210, a122
    v_accvgpr_read_b32 v211, a123
    v_mul_f32 v208, v208, v234
    v_mul_f32 v209, v209, v234
    v_mul_f32 v210, v210, v234
    v_mul_f32 v211, v211, v234
    v_accvgpr_write_b32 a120, v208
    v_accvgpr_write_b32 a121, v209
    v_accvgpr_write_b32 a122, v210
    v_accvgpr_write_b32 a123, v211
    v_accvgpr_read_b32 v208, a124
    v_accvgpr_read_b32 v209, a125
    v_accvgpr_read_b32 v210, a126
    v_accvgpr_read_b32 v211, a127
    v_mul_f32 v208, v208, v235
    v_mul_f32 v209, v209, v235
    v_mul_f32 v210, v210, v235
    v_mul_f32 v211, v211, v235
    v_accvgpr_write_b32 a124, v208
    v_accvgpr_write_b32 a125, v209
    v_accvgpr_write_b32 a126, v210
    v_accvgpr_write_b32 a127, v211
L_fs1:
    v_exp_f32 v208, v64
    v_exp_f32 v209, v65
    s_nop 0
    v_cvt_pk_bf16_f32 v160, v208, v209
    v_exp_f32 v208, v66
    v_exp_f32 v209, v67
    s_nop 0
    v_cvt_pk_bf16_f32 v161, v208, v209
    v_exp_f32 v208, v80
    v_exp_f32 v209, v81
    s_nop 0
    v_cvt_pk_bf16_f32 v162, v208, v209
    v_exp_f32 v208, v82
    v_exp_f32 v209, v83
    s_nop 0
    v_cvt_pk_bf16_f32 v163, v208, v209
    v_exp_f32 v208, v96
    v_exp_f32 v209, v97
    s_nop 0
    v_cvt_pk_bf16_f32 v164, v208, v209
    v_exp_f32 v208, v98
    v_exp_f32 v209, v99
    s_nop 0
    v_cvt_pk_bf16_f32 v165, v208, v209
    v_exp_f32 v208, v112
    v_exp_f32 v209, v113
    s_nop 0
    v_cvt_pk_bf16_f32 v166, v208, v209
    v_exp_f32 v208, v114
    v_exp_f32 v209, v115
    s_nop 0
    v_cvt_pk_bf16_f32 v167, v208, v209
    v_exp_f32 v208, v68
    v_exp_f32 v209, v69
    s_nop 0
    v_cvt_pk_bf16_f32 v168, v208, v209
    v_exp_f32 v208, v70
    v_exp_f32 v209, v71
    s_nop 0
    v_cvt_pk_bf16_f32 v169, v208, v209
    v_exp_f32 v208, v84
    v_exp_f32 v209, v85
    s_nop 0
    v_cvt_pk_bf16_f32 v170, v208, v209
    v_exp_f32 v208, v86
    v_exp_f32 v209, v87
    s_nop 0
    v_cvt_pk_bf16_f32 v171, v208, v209
    v_exp_f32 v208, v100
    v_exp_f32 v209, v101
    s_nop 0
    v_cvt_pk_bf16_f32 v172, v208, v209
    v_exp_f32 v208, v102
    v_exp_f32 v209, v103
    s_nop 0
    v_cvt_pk_bf16_f32 v173, v208, v209
    v_exp_f32 v208, v116
    v_exp_f32 v209, v117
    s_nop 0
    v_cvt_pk_bf16_f32 v174, v208, v209
    v_exp_f32 v208, v118
    v_exp_f32 v209, v119
    s_nop 0
    v_cvt_pk_bf16_f32 v175, v208, v209
    v_exp_f32 v208, v72
    v_exp_f32 v209, v73
    s_nop 0
    v_cvt_pk_bf16_f32 v176, v208, v209
    v_exp_f32 v208, v74
    v_exp_f32 v209, v75
    s_nop 0
    v_cvt_pk_bf16_f32 v177, v208, v209
    v_exp_f32 v208, v88
    v_exp_f32 v209, v89
    s_nop 0
    v_cvt_pk_bf16_f32 v178, v208, v209
    v_exp_f32 v208, v90
    v_exp_f32 v209, v91
    s_nop 0
    v_cvt_pk_bf16_f32 v179, v208, v209
    v_exp_f32 v208, v104
    v_exp_f32 v209, v105
    s_nop 0
    v_cvt_pk_bf16_f32 v180, v208, v209
    v_exp_f32 v208, v106
    v_exp_f32 v209, v107
    s_nop 0
    v_cvt_pk_bf16_f32 v181, v208, v209
    v_exp_f32 v208, v120
    v_exp_f32 v209, v121
    s_nop 0
    v_cvt_pk_bf16_f32 v182, v208, v209
    v_exp_f32 v208, v122
    v_exp_f32 v209, v123
    s_nop 0
    v_cvt_pk_bf16_f32 v183, v208, v209
    v_exp_f32 v208, v76
    v_exp_f32 v209, v77
    s_nop 0
    v_cvt_pk_bf16_f32 v184, v208, v209
    v_exp_f32 v208, v78
    v_exp_f32 v209, v79
    s_nop 0
    v_cvt_pk_bf16_f32 v185, v208, v209
    v_exp_f32 v208, v92
    v_exp_f32 v209, v93
    s_nop 0
    v_cvt_pk_bf16_f32 v186, v208, v209
    v_exp_f32 v208, v94
    v_exp_f32 v209, v95
    s_nop 0
    v_cvt_pk_bf16_f32 v187, v208, v209
    v_exp_f32 v208, v108
    v_exp_f32 v209, v109
    s_nop 0
    v_cvt_pk_bf16_f32 v188, v208, v209
    v_exp_f32 v208, v110
    v_exp_f32 v209, v111
    s_nop 0
    v_cvt_pk_bf16_f32 v189, v208, v209
    v_exp_f32 v208, v124
    v_exp_f32 v209, v125
    s_nop 0
    v_cvt_pk_bf16_f32 v190, v208, v209
    v_exp_f32 v208, v126
    v_exp_f32 v209, v127
    s_nop 0
    v_cvt_pk_bf16_f32 v191, v208, v209
    s_nop 1
    v_mfma_f32_16x16x32_bf16 v[208:211], v[244:247], v[160:163], 0
    v_mfma_f32_16x16x32_bf16 v[208:211], v[244:247], v[164:167], v[208:211]
    v_mfma_f32_16x16x32_bf16 v[212:215], v[244:247], v[168:171], 0
    v_mfma_f32_16x16x32_bf16 v[212:215], v[244:247], v[172:175], v[212:215]
    v_mfma_f32_16x16x32_bf16 v[216:219], v[244:247], v[176:179], 0
    v_mfma_f32_16x16x32_bf16 v[216:219], v[244:247], v[180:183], v[216:219]
    v_mfma_f32_16x16x32_bf16 v[220:223], v[244:247], v[184:187], 0
    v_mfma_f32_16x16x32_bf16 v[220:223], v[244:247], v[188:191], v[220:223]
    s_nop 7
    s_nop 1
    s_setpc_b64 s[68:69]
L_last:
    s_endpgm
.section .rodata,"a"
.p2align 6
.amdhsa_kernel recurrent_scan__mha_block_cached__dense_activation_silu__prompt_kernel
  .amdhsa_next_free_vgpr 512
  .amdhsa_next_free_sgpr 102
  .amdhsa_accum_offset 256
  .amdhsa_group_segment_fixed_size 0
  .amdhsa_kernarg_size 88
  .amdhsa_user_sgpr_count 2
  .amdhsa_user_sgpr_kernarg_segment_ptr 1
  .amdhsa_system_sgpr_workgroup_id_x 1
.end_amdhsa_kernel
```
